```python
import torch

def _softmax(x, axis=-1):
    return torch.softmax(x, dim=axis)

def _gelu(x):
    return torch.nn.functional.gelu(x, approximate='tanh')

def _silu(x):
    return torch.nn.functional.silu(x)

def _sigmoid(x):
    return torch.sigmoid(x)

def _layernorm(x, axis=-1, eps=1e-05):
    m = x.mean(dim=axis, keepdim=True)
    v = x.var(dim=axis, keepdim=True, unbiased=False)
    return (x - m) / torch.sqrt(v + eps)

def _scatter_add(tgt, idx, src, axis=0):
    return tgt.clone().index_add_(axis, idx, src)

def _segment_sum(src, seg, n):
    out = torch.zeros((n,) + src.shape[1:], dtype=src.dtype)
    return out.index_add_(0, seg, src)

def _pad(x, pw):
    flat = tuple((v for pair in reversed(pw) for v in pair))
    return torch.nn.functional.pad(x, flat)
kernel_name = 'adaLN_cond__compressed_kv_cla__mixer_channel_mlp__prompt'

def setup_inputs():

    _w = lambda a: (lambda t: t.to(torch.bfloat16) if t.is_floating_point() else t)(torch.as_tensor(a))

    def _A_setup():
        B, H, Sq, Sk, D, M = (1, 32, 2048, 2048, 128, 512)
        Dc = 4 * D
        return {'x': _w((lambda *s: torch.randn(*s, dtype=torch.bfloat16) * 0.05)(B, Sq, M)), 'c_kv': _w((lambda *s: torch.randn(*s, dtype=torch.bfloat16) * 0.4)(B, Sk, Dc)), 'w_q': _w((lambda *s: torch.randn(*s, dtype=torch.bfloat16) * 3.2)(M, H, D) * M ** (-0.5)), 'w_uk': _w((lambda *s: torch.randn(*s, dtype=torch.bfloat16) * 3.2)(Dc, H, D) * Dc ** (-0.5)), 'w_uv': _w((lambda *s: torch.randn(*s, dtype=torch.bfloat16) * 0.4)(Dc, H, D) * Dc ** (-0.5)), 'w_o': _w((lambda *s: torch.randn(*s, dtype=torch.bfloat16) * 0.4)(H, D, M) * (H * D) ** (-0.5))}
    _A_in = _A_setup()

    def _B_setup():
        B, S, D, F = (1, 2048, 512, 1792)
        return {'x': _w((lambda *s: torch.randn(*s, dtype=torch.bfloat16) * 0.05)(B, S, D)), 'w1': _w((lambda *s: torch.randn(*s, dtype=torch.bfloat16) * 1.6)(D, F) * D ** (-0.5)), 'b1': _w((lambda *s: torch.randn(*s, dtype=torch.bfloat16) * 0.4)(F)), 'w2': _w((lambda *s: torch.randn(*s, dtype=torch.bfloat16) * 0.05)(F, D) * F ** (-0.5)), 'b2': _w((lambda *s: torch.randn(*s, dtype=torch.bfloat16) * 0.05)(D))}
    _B_in = _B_setup()
    return {'A_x': _A_in['x'], 'A_c_kv': _A_in['c_kv'], 'A_w_q': _A_in['w_q'], 'A_w_uk': _A_in['w_uk'], 'A_w_uv': _A_in['w_uv'], 'A_w_o': _A_in['w_o'], 'B_x': _B_in['x'], 'B_w1': _B_in['w1'], 'B_b1': _B_in['b1'], 'B_w2': _B_in['w2'], 'B_b2': _B_in['b2'], 'c': _w((lambda *s: torch.randn(*s, dtype=torch.bfloat16) * 0.1)(1, 512) * 8.0), 'w_mod': _w((lambda *s: torch.randn(*s, dtype=torch.bfloat16) * 0.1)(512, 6 * 512) * 512 ** (-0.5) * 8.0)}

def reference(A_x, A_c_kv, A_w_q, A_w_uk, A_w_uv, A_w_o, B_x, B_w1, B_b1, B_w2, B_b2, c, w_mod):

    def _A_ref(x, c_kv, w_q, w_uk, w_uv, w_o):
        B, Sq, M = (x.shape[0], x.shape[1], x.shape[2])
        Sk = c_kv.shape[1]
        H, D = (w_q.shape[1], w_q.shape[2])
        q = torch.einsum('bqm,mhd->bhqd', x, w_q)
        k = torch.einsum('bkc,chd->bhkd', c_kv, w_uk)
        v = torch.einsum('bkc,chd->bhkd', c_kv, w_uv)
        scores = torch.einsum('bhqd,bhkd->bhqk', q, k) * D ** (-0.5)
        off = Sk - Sq
        qi = torch.arange(Sq)[:, None]
        kj = torch.arange(Sk)[None, :]
        cmask = kj <= qi + off
        scores = torch.where(cmask[None, None], scores, -1000000000.0)
        p = _softmax(scores, axis=-1)
        ctx = torch.einsum('bhqk,bhkd->bhqd', p, v)
        return torch.einsum('bhqd,hdm->bqm', ctx, w_o)

    def _B_ref(x, w1, b1, w2, b2):
        y = _layernorm(x, axis=-1)
        h = _gelu(torch.einsum('bsd,df->bsf', y, w1) + b1)
        return torch.einsum('bsf,fd->bsd', h, w2) + b2
    x = A_x
    mod = (_silu(c) @ w_mod).reshape(c.shape[0], 6, 1, -1)
    sa, ca, ga, sb, cb, gb = (mod[:, 0].clone(), mod[:, 1].clone(), mod[:, 2].clone(), mod[:, 3].clone(), mod[:, 4].clone(), mod[:, 5].clone())
    h = _layernorm(x, axis=-1) * (1 + ca) + sa
    x = x + ga * _A_ref(h, A_c_kv, A_w_q, A_w_uk, A_w_uv, A_w_o)
    h = _layernorm(x, axis=-1) * (1 + cb) + sb
    x = x + gb * _B_ref(h, B_w1, B_b1, B_w2, B_b2)
    return x
```

```asm
; @launch grid=(256,1,1) block=(256,1,1) lds=163840
.amdgcn_target "amdgcn-amd-amdhsa--gfx950"
.text
.globl adaLN_cond__compressed_kv_cla__mixer_channel_mlp__prompt_kernel
.p2align 8
.type adaLN_cond__compressed_kv_cla__mixer_channel_mlp__prompt_kernel,@function
adaLN_cond__compressed_kv_cla__mixer_channel_mlp__prompt_kernel:
  s_cmp_ge_u32 s2, 256
  s_cbranch_scc0 adaLN_cond__compressed_kv_cla__mixer_channel_mlp__prompt_kernel_go
  s_endpgm
adaLN_cond__compressed_kv_cla__mixer_channel_mlp__prompt_kernel_go:
  s_getpc_b64 s[50:51]
adaLN_cond__compressed_kv_cla__mixer_channel_mlp__prompt_kernel_pc:
  s_lshr_b32 s40, s2, 3
  s_lshl_b32 s40, s40, 12
  v_and_b32 v16, 15, v0
  v_lshrrev_b32 v17, 6, v0
  v_lshl_add_u32 v16, v17, 4, v16
  v_lshlrev_b32 v16, 6, v16
  v_add_u32 v16, s40, v16
  v_min_u32 v16, adaLN_cond__compressed_kv_cla__mixer_channel_mlp__prompt_kernel_last-adaLN_cond__compressed_kv_cla__mixer_channel_mlp__prompt_kernel_pc, v16
  global_load_dword v5, v16, s[50:51]
  s_load_dwordx16 s[64:79], s[0:1], 0
  s_load_dwordx16 s[80:95], s[0:1], 64
  s_memrealtime s[44:45]
  s_getreg_b32 s63, hwreg(HW_REG_XCC_ID, 0, 4)
  s_or_b32 s63, s63, 16
  v_and_b32 v1, 63, v0
  v_lshrrev_b32 v17, 6, v0
  s_and_b32 s40, s2, 7
  s_lshl_b32 s40, s40, 2
  v_readfirstlane_b32 s20, v17
  s_lshr_b32 s41, s2, 3
  s_and_b32 s41, s41, 3
  s_add_u32 s21, s40, s41
  s_lshr_b32 s22, s2, 5
  s_and_b32 s23, s20, 1
  s_lshr_b32 s24, s20, 1
  v_lshrrev_b32 v17, 4, v1
  v_bfe_u32 v18, v1, 2, 2
  v_lshl_add_u32 v19, v17, 3, v18
  v_and_b32 v20, 1, v17
  v_lshl_add_u32 v20, v20, 2, v18
  v_and_b32 v21, 3, v1
  v_lshlrev_b32 v21, 3, v21
  v_lshl_add_u32 v21, v19, 8, v21
  s_lshl_b32 s40, s24, 2
  s_add_u32 s42, s40, 0
  v_xor_b32 v22, s42, v20
  v_lshl_add_u32 v248, v22, 5, v21
  s_add_u32 s42, s40, 1
  v_xor_b32 v22, s42, v20
  v_lshl_add_u32 v249, v22, 5, v21
  s_add_u32 s42, s40, 2
  v_xor_b32 v22, s42, v20
  v_lshl_add_u32 v250, v22, 5, v21
  s_add_u32 s42, s40, 3
  v_xor_b32 v22, s42, v20
  v_lshl_add_u32 v251, v22, 5, v21
  v_and_b32 v18, 15, v1
  v_bfe_i32 v19, v1, 3, 1
  v_and_b32 v19, 3, v19
  v_xor_b32 v19, v17, v19
  v_lshlrev_b32 v19, 4, v19
  v_lshl_add_u32 v19, v18, 6, v19
  s_lshl_b32 s40, s23, 13
  s_add_u32 s40, s40, 0x10000
  v_add_u32 v252, s40, v19
  v_lshrrev_b32 v18, 2, v1
  v_bfe_i32 v19, v1, 5, 1
  v_xor_b32 v19, v19, v1
  v_and_b32 v19, 3, v19
  v_lshlrev_b32 v19, 4, v19
  v_lshl_add_u32 v19, v18, 10, v19
  s_lshl_b32 s40, s20, 16
  v_add_u32 v8, s40, v19
  v_add_u32 v9, 15360, v8
  v_add_u32 v10, 30720, v8
  v_add_u32 v11, 46080, v8
  v_bfe_u32 v18, v1, 1, 3
  v_xor_b32 v18, v18, v17
  v_lshlrev_b32 v18, 5, v18
  v_and_b32 v19, 1, v1
  v_lshl_add_u32 v18, v19, 4, v18
  v_lshl_add_u32 v244, v17, 13, v18
  v_add_u32 v245, 31744, v244
  v_xor_b32 v18, 0x80, v244
  v_add_u32 v246, 63488, v18
  v_add_u32 v247, 95232, v18
  v_lshlrev_b32 v4, 4, v1
  v_min_u32 v0, 1, v0
  v_lshlrev_b32 v0, 28, v0
  v_bfe_u32 v18, v1, 1, 4
  s_lshl_b32 s41, s41, 6
  s_lshl_b32 s42, s20, 4
  s_add_u32 s41, s41, s42
  v_add_u32 v18, s41, v18
  v_lshlrev_b32 v18, 10, v18
  v_lshl_add_u32 v2, v19, 6, v18
  v_bfe_u32 v18, v1, 2, 2
  s_lshl_b32 s41, s22, 2
  s_lshl_b32 s42, s23, 5
  s_add_u32 s41, s41, s42
  v_add_u32 v18, s41, v18
  v_lshlrev_b32 v18, 13, v18
  v_and_b32 v19, 3, v1
  v_lshl_add_u32 v3, v19, 6, v18
  v_and_b32 v18, 7, v1
  v_bfe_u32 v19, v1, 3, 2
  v_lshrrev_b32 v20, 5, v1
  v_lshlrev_b32 v21, 10, v18
  v_lshl_add_u32 v21, v20, 6, v21
  v_lshl_add_u32 v21, v19, 4, v21
  s_lshl_b32 s41, s20, 8
  v_add_u32 v6, s41, v21
  v_lshlrev_b32 v21, 4, v18
  v_lshl_add_u32 v21, v19, 8, v21
  v_lshl_add_u32 v21, v20, 10, v21
  s_lshl_b32 s41, s20, 12
  v_add_u32 v7, s41, v21
  s_lshl_b32 s25, s22, 18
  s_mov_b32 s26, s25
  s_lshl_b32 s28, s21, 8
  s_lshl_b32 s40, s20, 17
  s_add_u32 s32, s28, s40
  s_lshl_b32 s40, s23, 17
  s_add_u32 s27, s28, s40
  s_lshl_b32 s33, s20, 12
  s_add_u32 s29, s33, 0x10000
  s_waitcnt lgkmcnt(0)
  s_or_b32 s40, s2, s20
  s_cbranch_scc1 adaLN_cond__compressed_kv_cla__mixer_channel_mlp__prompt_kernel_tag15
  s_or_b32 s44, s44, 1
  s_xor_b32 s45, s45, 0x5bd1e995
  v_mov_b32 v22, s44
  v_mov_b32 v23, s45
  v_mov_b32 v21, 0
  s_mov_b64 exec, 1
  global_store_dwordx2 v21, v[22:23], s[92:93] sc1
  s_mov_b64 exec, -1
adaLN_cond__compressed_kv_cla__mixer_channel_mlp__prompt_kernel_tag15:
  s_mov_b32 s4, s66
  s_mov_b32 s5, s67
  s_mov_b32 s6, 0x200000
  s_mov_b32 s7, 0x20000
  s_cmp_ge_u32 s20, 2
  s_cselect_b32 s8, s72, s70
  s_cselect_b32 s9, s73, s71
  s_mov_b32 s10, 0x400000
  s_mov_b32 s11, 0x20000
  s_mov_b32 s12, s94
  s_mov_b32 s13, s95
  s_mov_b32 s14, 0x10000000
  s_mov_b32 s15, 0x20000
  s_mov_b32 s16, s88
  s_mov_b32 s17, s89
  s_mov_b32 s18, 0x300000
  s_mov_b32 s19, 0x20000
  s_add_u32 m0, s33, 0
  s_nop 0
  buffer_load_dwordx4 v244, s[8:11], s27 offen offset:0 sc1 lds
  buffer_load_dwordx4 v245, s[8:11], s27 offen offset:1024 sc1 lds
  buffer_load_dwordx4 v246, s[8:11], s27 offen offset:2048 sc1 lds
  buffer_load_dwordx4 v247, s[8:11], s27 offen offset:3072 sc1 lds
  s_add_u32 m0, s29, 0
  s_nop 0
  buffer_load_dwordx4 v8, s[4:7], s25 offen offset:0 sc1 lds
  buffer_load_dwordx4 v9, s[4:7], s25 offen offset:1024 sc1 lds
  buffer_load_dwordx4 v10, s[4:7], s25 offen offset:2048 sc1 lds
  buffer_load_dwordx4 v11, s[4:7], s25 offen offset:3072 sc1 lds
  s_add_u32 s27, s27, 0x40000
  s_add_u32 s25, s25, 64
  s_add_u32 m0, s33, 16384
  s_nop 0
  buffer_load_dwordx4 v244, s[8:11], s27 offen offset:0 sc1 lds
  buffer_load_dwordx4 v245, s[8:11], s27 offen offset:1024 sc1 lds
  buffer_load_dwordx4 v246, s[8:11], s27 offen offset:2048 sc1 lds
  buffer_load_dwordx4 v247, s[8:11], s27 offen offset:3072 sc1 lds
  s_add_u32 m0, s29, 16384
  s_nop 0
  buffer_load_dwordx4 v8, s[4:7], s25 offen offset:0 sc1 lds
  buffer_load_dwordx4 v9, s[4:7], s25 offen offset:1024 sc1 lds
  buffer_load_dwordx4 v10, s[4:7], s25 offen offset:2048 sc1 lds
  buffer_load_dwordx4 v11, s[4:7], s25 offen offset:3072 sc1 lds
  s_add_u32 s27, s27, 0x40000
  s_add_u32 s25, s25, 64
  s_sub_u32 s40, s2, 192
  s_cselect_b32 s40, s2, s40
  s_mul_i32 s41, s40, 1366
  s_lshr_b32 s41, s41, 16
  s_mul_i32 s42, s41, 48
  s_sub_u32 s40, s40, s42
  s_lshl_b32 s42, s41, 7
  s_lshl_b32 s43, s20, 5
  s_add_u32 s42, s42, s43
  v_lshrrev_b32 v18, 3, v1
  v_add_u32 v18, s42, v18
  v_lshlrev_b32 v19, 1, v18
  v_mul_u32_u24 v18, 6144, v18
  v_and_b32 v20, 7, v1
  v_lshl_add_u32 v18, v20, 4, v18
  s_lshl_b32 s43, s40, 7
  global_load_ushort v238, v19, s[86:87] offset:0
  buffer_load_dwordx4 v[222:225], v18, s[16:19], s43 offen
  s_add_u32 s43, s43, 49152
  global_load_ushort v239, v19, s[86:87] offset:16
  buffer_load_dwordx4 v[226:229], v18, s[16:19], s43 offen
  s_add_u32 s43, s43, 49152
  global_load_ushort v240, v19, s[86:87] offset:32
  buffer_load_dwordx4 v[230:233], v18, s[16:19], s43 offen
  s_add_u32 s43, s43, 49152
  global_load_ushort v241, v19, s[86:87] offset:48
  buffer_load_dwordx4 v[234:237], v18, s[16:19], s43 offen
  s_mul_i32 s41, s41, 12288
  s_lshl_b32 s40, s40, 8
  s_add_u32 s62, s41, s40
  s_add_u32 s62, s62, 0x3e00000
  s_cmp_lt_u32 s2, 192
  s_cselect_b32 s61, 0, 0x10000000
  s_cmp_eq_u32 s20, 0
  s_cselect_b32 s40, s61, 0x10000000
  s_add_u32 s62, s62, s40
  s_lshl_b32 s89, s2, 4
  s_add_u32 s89, s89, s61
  s_add_u32 s89, s89, 0x3f07000
  s_add_u32 m0, s33, 32768
  s_nop 0
  buffer_load_dwordx4 v244, s[8:11], s27 offen offset:0 sc1 lds
  buffer_load_dwordx4 v245, s[8:11], s27 offen offset:1024 sc1 lds
  buffer_load_dwordx4 v246, s[8:11], s27 offen offset:2048 sc1 lds
  buffer_load_dwordx4 v247, s[8:11], s27 offen offset:3072 sc1 lds
  s_add_u32 m0, s29, 32768
  s_nop 0
  buffer_load_dwordx4 v8, s[4:7], s25 offen offset:0 sc1 lds
  buffer_load_dwordx4 v9, s[4:7], s25 offen offset:1024 sc1 lds
  buffer_load_dwordx4 v10, s[4:7], s25 offen offset:2048 sc1 lds
  buffer_load_dwordx4 v11, s[4:7], s25 offen offset:3072 sc1 lds
  s_add_u32 s27, s27, 0x40000
  s_add_u32 s25, s25, 64
  s_mov_b32 s16, s68
  s_mov_b32 s17, s69
  s_mov_b32 s18, 0x400000
  s_mov_b32 s19, 0x20000
  v_and_b32 v18, 7, v1
  v_lshlrev_b32 v18, 5, v18
  v_lshrrev_b32 v19, 4, v1
  v_lshl_add_u32 v18, v19, 3, v18
  s_lshl_b32 s40, s20, 8
  s_add_u32 s40, s40, 0x20000
  v_add_u32 v18, s40, v18
  s_and_b32 s40, s2, 127
  s_lshl_b32 s40, s40, 3
  s_lshl_b32 s41, s20, 1
  s_add_u32 s40, s40, s41
  s_sub_u32 s70, s40, 448
  s_cselect_b32 s70, s40, s70
  s_cselect_b32 s86, s78, s82
  s_cselect_b32 s87, s79, s83
  s_mov_b32 s71, 1024
  s_cselect_b32 s71, 3584, s71
  s_cselect_b32 s73, 28, 8
  s_mov_b32 s72, 8192
  s_cselect_b32 s72, 2341, s72
  s_mov_b32 s67, 4096
  s_cselect_b32 s67, 2048, s67
  s_mov_b32 s66, 229376
  s_cselect_b32 s66, 65536, s66
  s_mov_b32 s42, 0x1600000
  s_cselect_b32 s42, 0x1400000, s42
  s_mov_b32 s43, 2048
  s_cselect_b32 s43, 32768, s43
  s_cmp_lt_u32 s40, 896
  s_cselect_b32 s88, 1835008, 0
  s_cselect_b32 s42, s42, 0x10000000
  s_cmp_lt_u32 s2, 128
  s_cselect_b32 s70, s40, s70
  s_cselect_b32 s86, s74, s86
  s_cselect_b32 s87, s75, s87
  s_cselect_b32 s71, 1024, s71
  s_cselect_b32 s73, 8, s73
  s_cselect_b32 s72, 8192, s72
  s_cselect_b32 s67, 4096, s67
  s_cselect_b32 s66, 0x80000, s66
  s_cselect_b32 s42, 0x1000000, s42
  s_cselect_b32 s43, 2048, s43
  s_cselect_b32 s88, 0x400000, s88
  s_mul_i32 s72, s70, s72
  s_lshr_b32 s72, s72, 16
  s_mul_i32 s73, s72, s73
  s_sub_u32 s73, s70, s73
  s_mul_i32 s70, s72, s71
  s_lshl_b32 s70, s70, 5
  s_lshl_b32 s41, s73, 7
  s_add_u32 s70, s70, s41
  s_mul_i32 s72, s72, s67
  s_mul_i32 s73, s73, s66
  s_add_u32 s72, s72, s73
  s_add_u32 s72, s72, s42
  s_add_u32 s73, s72, s43
  s_lshr_b32 s40, s2, 6
  s_cmp_eq_u32 s40, 2
  s_cselect_b32 s60, 1.0, 0
  s_mov_b32 s61, 0x10000000
  s_cselect_b32 s61, 0x3e14000, s61
  s_mov_b32 s45, s61
  s_cmp_eq_u32 s40, 1
  s_cselect_b32 s45, 0x3e14010, s45
  s_waitcnt vmcnt(24)
  s_barrier
  ds_read_b64_tr_b16 a[32:33], v248 offset:0
  ds_read_b64_tr_b16 a[34:35], v248 offset:1024
  ds_read_b64_tr_b16 a[36:37], v249 offset:0
  ds_read_b64_tr_b16 a[38:39], v249 offset:1024
  ds_read_b64_tr_b16 a[40:41], v250 offset:0
  ds_read_b64_tr_b16 a[42:43], v250 offset:1024
  ds_read_b64_tr_b16 a[44:45], v251 offset:0
  ds_read_b64_tr_b16 a[46:47], v251 offset:1024
  ds_read_b64_tr_b16 a[48:49], v248 offset:8192
  ds_read_b64_tr_b16 a[50:51], v248 offset:9216
  ds_read_b64_tr_b16 a[52:53], v249 offset:8192
  ds_read_b64_tr_b16 a[54:55], v249 offset:9216
  ds_read_b64_tr_b16 a[56:57], v250 offset:8192
  ds_read_b64_tr_b16 a[58:59], v250 offset:9216
  ds_read_b64_tr_b16 a[60:61], v251 offset:8192
  ds_read_b64_tr_b16 a[62:63], v251 offset:9216
  ds_read_b128 a[0:3], v252 offset:0
  ds_read_b128 a[4:7], v252 offset:1024
  ds_read_b128 a[8:11], v252 offset:2048
  ds_read_b128 a[12:15], v252 offset:3072
  ds_read_b128 a[16:19], v252 offset:4096
  ds_read_b128 a[20:23], v252 offset:5120
  ds_read_b128 a[24:27], v252 offset:6144
  ds_read_b128 a[28:31], v252 offset:7168
  s_waitcnt lgkmcnt(0)
  v_mfma_f32_16x16x32_bf16 v[20:23], a[32:35], a[0:3], 0
  v_mfma_f32_16x16x32_bf16 v[24:27], a[36:39], a[0:3], 0
  v_mfma_f32_16x16x32_bf16 v[28:31], a[40:43], a[0:3], 0
  s_add_u32 m0, s33, 49152
  v_mfma_f32_16x16x32_bf16 v[32:35], a[44:47], a[0:3], 0
  v_mfma_f32_16x16x32_bf16 v[48:51], a[44:47], a[4:7], 0
  buffer_load_dwordx4 v244, s[8:11], s27 offen offset:0 sc1 lds
  v_mfma_f32_16x16x32_bf16 v[44:47], a[40:43], a[4:7], 0
  v_mfma_f32_16x16x32_bf16 v[40:43], a[36:39], a[4:7], 0
  buffer_load_dwordx4 v245, s[8:11], s27 offen offset:1024 sc1 lds
  v_mfma_f32_16x16x32_bf16 v[36:39], a[32:35], a[4:7], 0
  v_mfma_f32_16x16x32_bf16 v[52:55], a[32:35], a[8:11], 0
  v_mfma_f32_16x16x32_bf16 v[56:59], a[36:39], a[8:11], 0
  buffer_load_dwordx4 v246, s[8:11], s27 offen offset:2048 sc1 lds
  v_mfma_f32_16x16x32_bf16 v[60:63], a[40:43], a[8:11], 0
  v_mfma_f32_16x16x32_bf16 v[64:67], a[44:47], a[8:11], 0
  buffer_load_dwordx4 v247, s[8:11], s27 offen offset:3072 sc1 lds
  v_mfma_f32_16x16x32_bf16 v[80:83], a[44:47], a[12:15], 0
  v_mfma_f32_16x16x32_bf16 v[76:79], a[40:43], a[12:15], 0
  v_mfma_f32_16x16x32_bf16 v[72:75], a[36:39], a[12:15], 0
  s_add_u32 m0, s29, 49152
  v_mfma_f32_16x16x32_bf16 v[68:71], a[32:35], a[12:15], 0
  v_mfma_f32_16x16x32_bf16 v[84:87], a[32:35], a[16:19], 0
  buffer_load_dwordx4 v8, s[4:7], s25 offen offset:0 sc1 lds
  v_mfma_f32_16x16x32_bf16 v[88:91], a[36:39], a[16:19], 0
  v_mfma_f32_16x16x32_bf16 v[92:95], a[40:43], a[16:19], 0
  buffer_load_dwordx4 v9, s[4:7], s25 offen offset:1024 sc1 lds
  v_mfma_f32_16x16x32_bf16 v[96:99], a[44:47], a[16:19], 0
  v_mfma_f32_16x16x32_bf16 v[112:115], a[44:47], a[20:23], 0
  v_mfma_f32_16x16x32_bf16 v[108:111], a[40:43], a[20:23], 0
  buffer_load_dwordx4 v10, s[4:7], s25 offen offset:2048 sc1 lds
  v_mfma_f32_16x16x32_bf16 v[104:107], a[36:39], a[20:23], 0
  v_mfma_f32_16x16x32_bf16 v[100:103], a[32:35], a[20:23], 0
  buffer_load_dwordx4 v11, s[4:7], s25 offen offset:3072 sc1 lds
  v_mfma_f32_16x16x32_bf16 v[116:119], a[32:35], a[24:27], 0
  v_mfma_f32_16x16x32_bf16 v[120:123], a[36:39], a[24:27], 0
  v_mfma_f32_16x16x32_bf16 v[124:127], a[40:43], a[24:27], 0
  s_add_u32 s27, s27, 0x40000
  v_mfma_f32_16x16x32_bf16 v[128:131], a[44:47], a[24:27], 0
  v_mfma_f32_16x16x32_bf16 v[144:147], a[44:47], a[28:31], 0
  s_waitcnt vmcnt(24)
  s_barrier
  v_mfma_f32_16x16x32_bf16 v[140:143], a[40:43], a[28:31], 0
  ds_read_b64_tr_b16 a[96:97], v248 offset:16384
  s_add_u32 s25, s25, 64
  v_mfma_f32_16x16x32_bf16 v[136:139], a[36:39], a[28:31], 0
  ds_read_b64_tr_b16 a[98:99], v248 offset:17408
  v_mfma_f32_16x16x32_bf16 v[132:135], a[32:35], a[28:31], 0
  ds_read_b64_tr_b16 a[100:101], v249 offset:16384
  s_add_u32 m0, s33, 0
  v_mfma_f32_16x16x32_bf16 a[188:191], a[28:31], a[60:63], 0
  ds_read_b64_tr_b16 a[102:103], v249 offset:17408
  v_mfma_f32_16x16x32_bf16 a[180:183], a[28:31], a[56:59], 0
  buffer_load_dwordx4 v244, s[8:11], s27 offen offset:0 sc1 lds
  v_mfma_f32_16x16x32_bf16 a[172:175], a[28:31], a[52:55], 0
  ds_read_b64_tr_b16 a[104:105], v250 offset:16384
  ds_read_b64_tr_b16 a[106:107], v250 offset:17408
  v_mfma_f32_16x16x32_bf16 a[164:167], a[28:31], a[48:51], 0
  buffer_load_dwordx4 v245, s[8:11], s27 offen offset:1024 sc1 lds
  v_mfma_f32_16x16x32_bf16 a[160:163], a[24:27], a[48:51], 0
  ds_read_b64_tr_b16 a[108:109], v251 offset:16384
  ds_read_b64_tr_b16 a[110:111], v251 offset:17408
  v_mfma_f32_16x16x32_bf16 a[168:171], a[24:27], a[52:55], 0
  v_mfma_f32_16x16x32_bf16 a[176:179], a[24:27], a[56:59], 0
  buffer_load_dwordx4 v246, s[8:11], s27 offen offset:2048 sc1 lds
  v_mfma_f32_16x16x32_bf16 a[184:187], a[24:27], a[60:63], 0
  ds_read_b64_tr_b16 a[112:113], v248 offset:24576
  ds_read_b64_tr_b16 a[114:115], v248 offset:25600
  v_mfma_f32_16x16x32_bf16 a[156:159], a[20:23], a[60:63], 0
  buffer_load_dwordx4 v247, s[8:11], s27 offen offset:3072 sc1 lds
  v_mfma_f32_16x16x32_bf16 a[148:151], a[20:23], a[56:59], 0
  ds_read_b64_tr_b16 a[116:117], v249 offset:24576
  ds_read_b64_tr_b16 a[118:119], v249 offset:25600
  v_mfma_f32_16x16x32_bf16 a[140:143], a[20:23], a[52:55], 0
  ds_read_b64_tr_b16 a[120:121], v250 offset:24576
  v_mfma_f32_16x16x32_bf16 a[132:135], a[20:23], a[48:51], 0
  ds_read_b64_tr_b16 a[122:123], v250 offset:25600
  s_add_u32 m0, s29, 0
  v_mfma_f32_16x16x32_bf16 a[128:131], a[16:19], a[48:51], 0
  ds_read_b64_tr_b16 a[124:125], v251 offset:24576
  v_mfma_f32_16x16x32_bf16 a[136:139], a[16:19], a[52:55], 0
  buffer_load_dwordx4 v8, s[4:7], s25 offen offset:0 sc1 lds
  v_mfma_f32_16x16x32_bf16 a[144:147], a[16:19], a[56:59], 0
  ds_read_b64_tr_b16 a[126:127], v251 offset:25600
  v_mfma_f32_16x16x32_bf16 a[152:155], a[16:19], a[60:63], 0
  buffer_load_dwordx4 v9, s[4:7], s25 offen offset:1024 sc1 lds
  v_mfma_f32_16x16x32_bf16 v[208:211], a[12:15], a[60:63], 0
  ds_read_b128 a[64:67], v252 offset:16384
  ds_read_b128 a[68:71], v252 offset:17408
  v_mfma_f32_16x16x32_bf16 v[200:203], a[12:15], a[56:59], 0
  ds_read_b128 a[72:75], v252 offset:18432
  v_mfma_f32_16x16x32_bf16 v[192:195], a[12:15], a[52:55], 0
  buffer_load_dwordx4 v10, s[4:7], s25 offen offset:2048 sc1 lds
  v_mfma_f32_16x16x32_bf16 v[184:187], a[12:15], a[48:51], 0
  ds_read_b128 a[76:79], v252 offset:19456
  ds_read_b128 a[80:83], v252 offset:20480
  v_mfma_f32_16x16x32_bf16 v[180:183], a[8:11], a[48:51], 0
  buffer_load_dwordx4 v11, s[4:7], s25 offen offset:3072 sc1 lds
  v_mfma_f32_16x16x32_bf16 v[188:191], a[8:11], a[52:55], 0
  ds_read_b128 a[84:87], v252 offset:21504
  ds_read_b128 a[88:91], v252 offset:22528
  v_mfma_f32_16x16x32_bf16 v[196:199], a[8:11], a[56:59], 0
  ds_read_b128 a[92:95], v252 offset:23552
  v_mfma_f32_16x16x32_bf16 v[204:207], a[8:11], a[60:63], 0
  s_add_u32 s27, s27, 0x40000
  v_mfma_f32_16x16x32_bf16 v[176:179], a[4:7], a[60:63], 0
  v_mfma_f32_16x16x32_bf16 v[168:171], a[4:7], a[56:59], 0
  s_add_u32 s25, s25, 64
  v_mfma_f32_16x16x32_bf16 v[160:163], a[4:7], a[52:55], 0
  v_mfma_f32_16x16x32_bf16 v[152:155], a[4:7], a[48:51], 0
  v_mfma_f32_16x16x32_bf16 v[148:151], a[0:3], a[48:51], 0
  v_mfma_f32_16x16x32_bf16 v[156:159], a[0:3], a[52:55], 0
  v_mfma_f32_16x16x32_bf16 v[164:167], a[0:3], a[56:59], 0
  s_waitcnt lgkmcnt(0)
  s_barrier
  v_mfma_f32_16x16x32_bf16 v[172:175], a[0:3], a[60:63], 0
  v_mfma_f32_16x16x32_bf16 v[20:23], a[96:99], a[64:67], v[20:23]
  s_waitcnt vmcnt(24)
  v_lshlrev_b32 v238, 16, v238
  v_mfma_f32_16x16x32_bf16 v[24:27], a[100:103], a[64:67], v[24:27]
  v_mul_f32 v12, 0xbfb8aa3b, v238
  v_lshlrev_b32 v239, 16, v239
  v_mfma_f32_16x16x32_bf16 v[28:31], a[104:107], a[64:67], v[28:31]
  v_mul_f32 v13, 0xbfb8aa3b, v239
  v_lshlrev_b32 v240, 16, v240
  v_mfma_f32_16x16x32_bf16 v[32:35], a[108:111], a[64:67], v[32:35]
  v_mul_f32 v14, 0xbfb8aa3b, v240
  v_lshlrev_b32 v241, 16, v241
  v_mfma_f32_16x16x32_bf16 v[48:51], a[108:111], a[68:71], v[48:51]
  v_mul_f32 v15, 0xbfb8aa3b, v241
  s_add_u32 m0, s33, 16384
  v_mfma_f32_16x16x32_bf16 v[44:47], a[104:107], a[68:71], v[44:47]
  v_exp_f32 v12, v12
  v_mfma_f32_16x16x32_bf16 v[40:43], a[100:103], a[68:71], v[40:43]
  v_exp_f32 v13, v13
  v_mfma_f32_16x16x32_bf16 v[36:39], a[96:99], a[68:71], v[36:39]
  v_exp_f32 v14, v14
  v_mfma_f32_16x16x32_bf16 v[52:55], a[96:99], a[72:75], v[52:55]
  v_exp_f32 v15, v15
  v_mfma_f32_16x16x32_bf16 v[56:59], a[100:103], a[72:75], v[56:59]
  v_add_f32 v12, 1.0, v12
  v_add_f32 v13, 1.0, v13
  v_mfma_f32_16x16x32_bf16 v[60:63], a[104:107], a[72:75], v[60:63]
  v_add_f32 v14, 1.0, v14
  v_add_f32 v15, 1.0, v15
  v_mfma_f32_16x16x32_bf16 v[64:67], a[108:111], a[72:75], v[64:67]
  buffer_load_dwordx4 v244, s[8:11], s27 offen offset:0 sc1 lds
  v_rcp_f32 v12, v12
  v_rcp_f32 v13, v13
  v_mfma_f32_16x16x32_bf16 v[80:83], a[108:111], a[76:79], v[80:83]
  v_rcp_f32 v14, v14
  v_rcp_f32 v15, v15
  v_mfma_f32_16x16x32_bf16 v[76:79], a[104:107], a[76:79], v[76:79]
  v_mul_f32 v238, v238, v12
  v_mul_f32 v239, v239, v13
  v_mfma_f32_16x16x32_bf16 v[72:75], a[100:103], a[76:79], v[72:75]
  v_mul_f32 v240, v240, v14
  v_mul_f32 v241, v241, v15
  v_mfma_f32_16x16x32_bf16 v[68:71], a[96:99], a[76:79], v[68:71]
  buffer_load_dwordx4 v245, s[8:11], s27 offen offset:1024 sc1 lds
  v_cvt_pk_bf16_f32 v238, v238, v238
  v_and_b32 v238, 0xffff0000, v238
  v_mfma_f32_16x16x32_bf16 v[84:87], a[96:99], a[80:83], v[84:87]
  v_cvt_pk_bf16_f32 v239, v239, v239
  v_and_b32 v239, 0xffff0000, v239
  v_mfma_f32_16x16x32_bf16 v[88:91], a[100:103], a[80:83], v[88:91]
  v_cvt_pk_bf16_f32 v240, v240, v240
  v_and_b32 v240, 0xffff0000, v240
  v_mfma_f32_16x16x32_bf16 v[92:95], a[104:107], a[80:83], v[92:95]
  v_cvt_pk_bf16_f32 v241, v241, v241
  v_and_b32 v241, 0xffff0000, v241
  v_mfma_f32_16x16x32_bf16 v[96:99], a[108:111], a[80:83], v[96:99]
  buffer_load_dwordx4 v246, s[8:11], s27 offen offset:2048 sc1 lds
  v_lshlrev_b32 v16, 16, v222
  v_mfma_f32_16x16x32_bf16 v[112:115], a[108:111], a[84:87], v[112:115]
  v_and_b32 v17, 0xffff0000, v222
  v_mul_f32 v212, v16, v238
  v_mfma_f32_16x16x32_bf16 v[108:111], a[104:107], a[84:87], v[108:111]
  v_mul_f32 v213, v17, v238
  v_lshlrev_b32 v16, 16, v223
  v_mfma_f32_16x16x32_bf16 v[104:107], a[100:103], a[84:87], v[104:107]
  v_and_b32 v17, 0xffff0000, v223
  v_mul_f32 v214, v16, v238
  v_mfma_f32_16x16x32_bf16 v[100:103], a[96:99], a[84:87], v[100:103]
  buffer_load_dwordx4 v247, s[8:11], s27 offen offset:3072 sc1 lds
  v_mul_f32 v215, v17, v238
  v_lshlrev_b32 v16, 16, v224
  v_mfma_f32_16x16x32_bf16 v[116:119], a[96:99], a[88:91], v[116:119]
  v_and_b32 v17, 0xffff0000, v224
  v_mul_f32 v216, v16, v238
  v_mfma_f32_16x16x32_bf16 v[120:123], a[100:103], a[88:91], v[120:123]
  v_mul_f32 v217, v17, v238
  v_lshlrev_b32 v16, 16, v225
  v_mfma_f32_16x16x32_bf16 v[124:127], a[104:107], a[88:91], v[124:127]
  v_and_b32 v17, 0xffff0000, v225
  v_mul_f32 v218, v16, v238
  v_mfma_f32_16x16x32_bf16 v[128:131], a[108:111], a[88:91], v[128:131]
  s_add_u32 m0, s29, 16384
  v_mul_f32 v219, v17, v238
  v_lshlrev_b32 v16, 16, v226
  v_mfma_f32_16x16x32_bf16 v[144:147], a[108:111], a[92:95], v[144:147]
  s_waitcnt vmcnt(20)
  s_barrier
  v_mfma_f32_16x16x32_bf16 v[140:143], a[104:107], a[92:95], v[140:143]
  ds_read_b64_tr_b16 a[32:33], v248 offset:32768
  v_and_b32 v17, 0xffff0000, v226
  v_fmac_f32 v212, v16, v239
  v_fmac_f32 v213, v17, v239
  v_lshlrev_b32 v16, 16, v227
  v_mfma_f32_16x16x32_bf16 v[136:139], a[100:103], a[92:95], v[136:139]
  ds_read_b64_tr_b16 a[34:35], v248 offset:33792
  v_and_b32 v17, 0xffff0000, v227
  v_mfma_f32_16x16x32_bf16 v[132:135], a[96:99], a[92:95], v[132:135]
  buffer_load_dwordx4 v8, s[4:7], s25 offen offset:0 sc1 lds
  v_fmac_f32 v214, v16, v239
  v_fmac_f32 v215, v17, v239
  v_mfma_f32_16x16x32_bf16 a[188:191], a[92:95], a[124:127], a[188:191]
  ds_read_b64_tr_b16 a[36:37], v249 offset:32768
  v_lshlrev_b32 v16, 16, v228
  v_and_b32 v17, 0xffff0000, v228
  v_mfma_f32_16x16x32_bf16 a[180:183], a[92:95], a[120:123], a[180:183]
  ds_read_b64_tr_b16 a[38:39], v249 offset:33792
  v_fmac_f32 v216, v16, v239
  v_fmac_f32 v217, v17, v239
  v_mfma_f32_16x16x32_bf16 a[172:175], a[92:95], a[116:119], a[172:175]
  buffer_load_dwordx4 v9, s[4:7], s25 offen offset:1024 sc1 lds
  v_lshlrev_b32 v16, 16, v229
  v_and_b32 v17, 0xffff0000, v229
  v_mfma_f32_16x16x32_bf16 a[164:167], a[92:95], a[112:115], a[164:167]
  ds_read_b64_tr_b16 a[40:41], v250 offset:32768
  v_fmac_f32 v218, v16, v239
  v_fmac_f32 v219, v17, v239
  v_mfma_f32_16x16x32_bf16 a[160:163], a[88:91], a[112:115], a[160:163]
  ds_read_b64_tr_b16 a[42:43], v250 offset:33792
  v_lshlrev_b32 v16, 16, v230
  v_and_b32 v17, 0xffff0000, v230
  v_mfma_f32_16x16x32_bf16 a[168:171], a[88:91], a[116:119], a[168:171]
  ds_read_b64_tr_b16 a[44:45], v251 offset:32768
  v_fmac_f32 v212, v16, v240
  v_fmac_f32 v213, v17, v240
  v_mfma_f32_16x16x32_bf16 a[176:179], a[88:91], a[120:123], a[176:179]
  buffer_load_dwordx4 v10, s[4:7], s25 offen offset:2048 sc1 lds
  v_lshlrev_b32 v16, 16, v231
  v_and_b32 v17, 0xffff0000, v231
  v_mfma_f32_16x16x32_bf16 a[184:187], a[88:91], a[124:127], a[184:187]
  ds_read_b64_tr_b16 a[46:47], v251 offset:33792
  v_fmac_f32 v214, v16, v240
  v_fmac_f32 v215, v17, v240
  v_mfma_f32_16x16x32_bf16 a[156:159], a[84:87], a[124:127], a[156:159]
  ds_read_b64_tr_b16 a[48:49], v248 offset:40960
  v_lshlrev_b32 v16, 16, v232
  v_and_b32 v17, 0xffff0000, v232
  v_mfma_f32_16x16x32_bf16 a[148:151], a[84:87], a[120:123], a[148:151]
  ds_read_b64_tr_b16 a[50:51], v248 offset:41984
  v_fmac_f32 v216, v16, v240
  v_fmac_f32 v217, v17, v240
  v_mfma_f32_16x16x32_bf16 a[140:143], a[84:87], a[116:119], a[140:143]
  buffer_load_dwordx4 v11, s[4:7], s25 offen offset:3072 sc1 lds
  v_lshlrev_b32 v16, 16, v233
  v_and_b32 v17, 0xffff0000, v233
  v_mfma_f32_16x16x32_bf16 a[132:135], a[84:87], a[112:115], a[132:135]
  ds_read_b64_tr_b16 a[52:53], v249 offset:40960
  v_fmac_f32 v218, v16, v240
  v_fmac_f32 v219, v17, v240
  v_mfma_f32_16x16x32_bf16 a[128:131], a[80:83], a[112:115], a[128:131]
  ds_read_b64_tr_b16 a[54:55], v249 offset:41984
  v_lshlrev_b32 v16, 16, v234
  v_and_b32 v17, 0xffff0000, v234
  v_mfma_f32_16x16x32_bf16 a[136:139], a[80:83], a[116:119], a[136:139]
  ds_read_b64_tr_b16 a[56:57], v250 offset:40960
  v_fmac_f32 v212, v16, v241
  v_mfma_f32_16x16x32_bf16 a[144:147], a[80:83], a[120:123], a[144:147]
  ds_read_b64_tr_b16 a[58:59], v250 offset:41984
  s_add_u32 s27, s27, 0x40000
  v_fmac_f32 v213, v17, v241
  v_lshlrev_b32 v16, 16, v235
  v_mfma_f32_16x16x32_bf16 a[152:155], a[80:83], a[124:127], a[152:155]
  ds_read_b64_tr_b16 a[60:61], v251 offset:40960
  v_and_b32 v17, 0xffff0000, v235
  v_fmac_f32 v214, v16, v241
  v_mfma_f32_16x16x32_bf16 v[208:211], a[76:79], a[124:127], v[208:211]
  ds_read_b64_tr_b16 a[62:63], v251 offset:41984
  v_fmac_f32 v215, v17, v241
  v_lshlrev_b32 v16, 16, v236
  v_mfma_f32_16x16x32_bf16 v[200:203], a[76:79], a[120:123], v[200:203]
  ds_read_b128 a[0:3], v252 offset:32768
  v_and_b32 v17, 0xffff0000, v236
  v_fmac_f32 v216, v16, v241
  v_mfma_f32_16x16x32_bf16 v[192:195], a[76:79], a[116:119], v[192:195]
  ds_read_b128 a[4:7], v252 offset:33792
  s_add_u32 s25, s25, 64
  v_fmac_f32 v217, v17, v241
  v_lshlrev_b32 v16, 16, v237
  v_mfma_f32_16x16x32_bf16 v[184:187], a[76:79], a[112:115], v[184:187]
  ds_read_b128 a[8:11], v252 offset:34816
  v_and_b32 v17, 0xffff0000, v237
  v_fmac_f32 v218, v16, v241
  v_mfma_f32_16x16x32_bf16 v[180:183], a[72:75], a[112:115], v[180:183]
  ds_read_b128 a[12:15], v252 offset:35840
  v_fmac_f32 v219, v17, v241
  v_mfma_f32_16x16x32_bf16 v[188:191], a[72:75], a[116:119], v[188:191]
  ds_read_b128 a[16:19], v252 offset:36864
  v_permlane32_swap_b32 v212, v216
  v_permlane32_swap_b32 v213, v217
  v_permlane32_swap_b32 v214, v218
  v_mfma_f32_16x16x32_bf16 v[196:199], a[72:75], a[120:123], v[196:199]
  ds_read_b128 a[20:23], v252 offset:37888
  s_add_u32 s44, s28, 1572864
  v_permlane32_swap_b32 v215, v219
  v_add_f32 v212, v212, v216
  v_mfma_f32_16x16x32_bf16 v[204:207], a[72:75], a[124:127], v[204:207]
  ds_read_b128 a[24:27], v252 offset:38912
  v_add_f32 v213, v213, v217
  v_add_f32 v214, v214, v218
  v_mfma_f32_16x16x32_bf16 v[176:179], a[68:71], a[124:127], v[176:179]
  ds_read_b128 a[28:31], v252 offset:39936
  v_add_f32 v215, v215, v219
  v_mfma_f32_16x16x32_bf16 v[168:171], a[68:71], a[120:123], v[168:171]
  buffer_load_dword v5, v3, s[8:11], s44 offen
  v_permlane16_swap_b32 v212, v214
  v_permlane16_swap_b32 v213, v215
  v_add_f32 v212, v212, v214
  v_mfma_f32_16x16x32_bf16 v[160:163], a[68:71], a[116:119], v[160:163]
  v_add_f32 v213, v213, v215
  v_mfma_f32_16x16x32_bf16 v[152:155], a[68:71], a[112:115], v[152:155]
  buffer_load_dword v5, v2, s[4:7], s26 offen offset:384
  v_add_f32_dpp v212, v212, v212 row_ror:8 row_mask:0xf bank_mask:0xf
  v_add_f32_dpp v213, v213, v213 row_ror:8 row_mask:0xf bank_mask:0xf
  v_mfma_f32_16x16x32_bf16 v[148:151], a[64:67], a[112:115], v[148:151]
  ds_write_b64 v18, v[212:213]
  v_mfma_f32_16x16x32_bf16 v[156:159], a[64:67], a[116:119], v[156:159]
  v_mfma_f32_16x16x32_bf16 v[164:167], a[64:67], a[120:123], v[164:167]
  s_waitcnt vmcnt(18) lgkmcnt(0)
  s_barrier
  v_mfma_f32_16x16x32_bf16 v[172:175], a[64:67], a[124:127], v[172:175]
  v_mfma_f32_16x16x32_bf16 v[20:23], a[32:35], a[0:3], v[20:23]
  ds_read_b64_tr_b16 a[96:97], v248 offset:49152
  v_mov_b32 v19, 0
  v_mfma_f32_16x16x32_bf16 v[24:27], a[36:39], a[0:3], v[24:27]
  global_load_dwordx2 v[220:221], v19, s[92:93] sc1
  v_lshlrev_b32 v18, 2, v1
  v_add_u32 v17, 0x20000, v18
  v_mfma_f32_16x16x32_bf16 v[28:31], a[40:43], a[0:3], v[28:31]
  ds_read_b64_tr_b16 a[98:99], v248 offset:50176
  s_add_u32 m0, s33, 32768
  v_mfma_f32_16x16x32_bf16 v[32:35], a[44:47], a[0:3], v[32:35]
  ds_read_b32 v12, v17 offset:0
  ds_read_b32 v13, v17 offset:256
  v_mfma_f32_16x16x32_bf16 v[48:51], a[44:47], a[4:7], v[48:51]
  ds_read_b64_tr_b16 a[100:101], v249 offset:49152
  ds_read_b32 v14, v17 offset:512
  v_mfma_f32_16x16x32_bf16 v[44:47], a[40:43], a[4:7], v[44:47]
  ds_read_b32 v15, v17 offset:768
  v_mfma_f32_16x16x32_bf16 v[40:43], a[36:39], a[4:7], v[40:43]
  buffer_load_dwordx4 v244, s[8:11], s27 offen offset:0 sc1 lds
  v_mfma_f32_16x16x32_bf16 v[36:39], a[32:35], a[4:7], v[36:39]
  ds_read_b64_tr_b16 a[102:103], v249 offset:50176
  v_mfma_f32_16x16x32_bf16 v[52:55], a[32:35], a[8:11], v[52:55]
  v_mfma_f32_16x16x32_bf16 v[56:59], a[36:39], a[8:11], v[56:59]
  ds_read_b64_tr_b16 a[104:105], v250 offset:49152
  v_mfma_f32_16x16x32_bf16 v[60:63], a[40:43], a[8:11], v[60:63]
  s_waitcnt lgkmcnt(2)
  v_add_f32 v12, v12, v13
  v_mfma_f32_16x16x32_bf16 v[64:67], a[44:47], a[8:11], v[64:67]
  ds_read_b64_tr_b16 a[106:107], v250 offset:50176
  v_add_f32 v14, v14, v15
  v_mfma_f32_16x16x32_bf16 v[80:83], a[44:47], a[12:15], v[80:83]
  buffer_load_dwordx4 v245, s[8:11], s27 offen offset:1024 sc1 lds
  v_mfma_f32_16x16x32_bf16 v[76:79], a[40:43], a[12:15], v[76:79]
  ds_read_b64_tr_b16 a[108:109], v251 offset:49152
  v_add_f32 v12, v12, v14
  v_mfma_f32_16x16x32_bf16 v[72:75], a[36:39], a[12:15], v[72:75]
  buffer_store_dword v12, v18, s[12:15], s62 offen sc1
  v_mfma_f32_16x16x32_bf16 v[68:71], a[32:35], a[12:15], v[68:71]
  ds_read_b64_tr_b16 a[110:111], v251 offset:50176
  s_lshl_b32 s46, s2, 13
  v_mfma_f32_16x16x32_bf16 v[84:87], a[32:35], a[16:19], v[84:87]
  buffer_load_dwordx4 v246, s[8:11], s27 offen offset:2048 sc1 lds
  v_mfma_f32_16x16x32_bf16 v[88:91], a[36:39], a[16:19], v[88:91]
  v_add_u32 v16, s46, v6
  v_mfma_f32_16x16x32_bf16 v[92:95], a[40:43], a[16:19], v[92:95]
  global_load_dwordx4 v[212:215], v16, s[64:65] offset:0
  v_mfma_f32_16x16x32_bf16 v[96:99], a[44:47], a[16:19], v[96:99]
  global_load_dwordx4 v[216:219], v16, s[64:65] offset:128
  v_mfma_f32_16x16x32_bf16 v[112:115], a[44:47], a[20:23], v[112:115]
  ds_read_b64_tr_b16 a[112:113], v248 offset:57344
  ds_read_b64_tr_b16 a[114:115], v248 offset:58368
  v_mfma_f32_16x16x32_bf16 v[108:111], a[40:43], a[20:23], v[108:111]
  buffer_load_dwordx4 v247, s[8:11], s27 offen offset:3072 sc1 lds
  v_mfma_f32_16x16x32_bf16 v[104:107], a[36:39], a[20:23], v[104:107]
  ds_read_b64_tr_b16 a[116:117], v249 offset:57344
  v_mfma_f32_16x16x32_bf16 v[100:103], a[32:35], a[20:23], v[100:103]
  v_mfma_f32_16x16x32_bf16 v[116:119], a[32:35], a[24:27], v[116:119]
  ds_read_b64_tr_b16 a[118:119], v249 offset:58368
  v_mfma_f32_16x16x32_bf16 v[120:123], a[36:39], a[24:27], v[120:123]
  v_mfma_f32_16x16x32_bf16 v[124:127], a[40:43], a[24:27], v[124:127]
  s_add_u32 m0, s29, 32768
  v_mfma_f32_16x16x32_bf16 v[128:131], a[44:47], a[24:27], v[128:131]
  ds_read_b64_tr_b16 a[120:121], v250 offset:57344
  v_mfma_f32_16x16x32_bf16 v[144:147], a[44:47], a[28:31], v[144:147]
  v_mfma_f32_16x16x32_bf16 v[140:143], a[40:43], a[28:31], v[140:143]
  ds_read_b64_tr_b16 a[122:123], v250 offset:58368
  v_mfma_f32_16x16x32_bf16 v[136:139], a[36:39], a[28:31], v[136:139]
  v_mfma_f32_16x16x32_bf16 v[132:135], a[32:35], a[28:31], v[132:135]
  buffer_load_dwordx4 v8, s[4:7], s25 offen offset:0 sc1 lds
  v_mfma_f32_16x16x32_bf16 a[188:191], a[28:31], a[60:63], a[188:191]
  ds_read_b64_tr_b16 a[124:125], v251 offset:57344
  v_mfma_f32_16x16x32_bf16 a[180:183], a[28:31], a[56:59], a[180:183]
  ds_read_b64_tr_b16 a[126:127], v251 offset:58368
  v_mfma_f32_16x16x32_bf16 a[172:175], a[28:31], a[52:55], a[172:175]
  v_mfma_f32_16x16x32_bf16 a[164:167], a[28:31], a[48:51], a[164:167]
  buffer_load_dwordx4 v9, s[4:7], s25 offen offset:1024 sc1 lds
  v_mfma_f32_16x16x32_bf16 a[160:163], a[24:27], a[48:51], a[160:163]
  ds_read_b128 a[64:67], v252 offset:49152
  v_mfma_f32_16x16x32_bf16 a[168:171], a[24:27], a[52:55], a[168:171]
  v_mfma_f32_16x16x32_bf16 a[176:179], a[24:27], a[56:59], a[176:179]
  ds_read_b128 a[68:71], v252 offset:50176
  v_mfma_f32_16x16x32_bf16 a[184:187], a[24:27], a[60:63], a[184:187]
  v_mfma_f32_16x16x32_bf16 a[156:159], a[20:23], a[60:63], a[156:159]
  buffer_load_dwordx4 v10, s[4:7], s25 offen offset:2048 sc1 lds
  v_mfma_f32_16x16x32_bf16 a[148:151], a[20:23], a[56:59], a[148:151]
  ds_read_b128 a[72:75], v252 offset:51200
  v_mfma_f32_16x16x32_bf16 a[140:143], a[20:23], a[52:55], a[140:143]
  ds_read_b128 a[76:79], v252 offset:52224
  v_mfma_f32_16x16x32_bf16 a[132:135], a[20:23], a[48:51], a[132:135]
  v_mfma_f32_16x16x32_bf16 a[128:131], a[16:19], a[48:51], a[128:131]
  v_mfma_f32_16x16x32_bf16 a[136:139], a[16:19], a[52:55], a[136:139]
  buffer_load_dwordx4 v11, s[4:7], s25 offen offset:3072 sc1 lds
  v_mfma_f32_16x16x32_bf16 a[144:147], a[16:19], a[56:59], a[144:147]
  ds_read_b128 a[80:83], v252 offset:53248
  v_mfma_f32_16x16x32_bf16 a[152:155], a[16:19], a[60:63], a[152:155]
  ds_read_b128 a[84:87], v252 offset:54272
  v_mfma_f32_16x16x32_bf16 v[208:211], a[12:15], a[60:63], v[208:211]
  v_mfma_f32_16x16x32_bf16 v[200:203], a[12:15], a[56:59], v[200:203]
  ds_read_b128 a[88:91], v252 offset:55296
  v_mfma_f32_16x16x32_bf16 v[192:195], a[12:15], a[52:55], v[192:195]
  s_add_u32 s27, s27, 0x40000
  v_mfma_f32_16x16x32_bf16 v[184:187], a[12:15], a[48:51], v[184:187]
  ds_read_b128 a[92:95], v252 offset:56320
  v_mfma_f32_16x16x32_bf16 v[180:183], a[8:11], a[48:51], v[180:183]
  v_mfma_f32_16x16x32_bf16 v[188:191], a[8:11], a[52:55], v[188:191]
  v_mfma_f32_16x16x32_bf16 v[196:199], a[8:11], a[56:59], v[196:199]
  v_mfma_f32_16x16x32_bf16 v[204:207], a[8:11], a[60:63], v[204:207]
  s_add_u32 s25, s25, 64
  v_mfma_f32_16x16x32_bf16 v[176:179], a[4:7], a[60:63], v[176:179]
  v_mfma_f32_16x16x32_bf16 v[168:171], a[4:7], a[56:59], v[168:171]
  v_mfma_f32_16x16x32_bf16 v[160:163], a[4:7], a[52:55], v[160:163]
  v_mfma_f32_16x16x32_bf16 v[152:155], a[4:7], a[48:51], v[152:155]
  v_mfma_f32_16x16x32_bf16 v[148:151], a[0:3], a[48:51], v[148:151]
  v_mfma_f32_16x16x32_bf16 v[156:159], a[0:3], a[52:55], v[156:159]
  v_mfma_f32_16x16x32_bf16 v[164:167], a[0:3], a[56:59], v[164:167]
  s_waitcnt vmcnt(22) lgkmcnt(0)
  s_barrier
  v_mfma_f32_16x16x32_bf16 v[172:175], a[0:3], a[60:63], v[172:175]
  v_mfma_f32_16x16x32_bf16 v[20:23], a[96:99], a[64:67], v[20:23]
  ds_read_b64_tr_b16 a[32:33], v248 offset:0
  v_mfma_f32_16x16x32_bf16 v[24:27], a[100:103], a[64:67], v[24:27]
  v_mfma_f32_16x16x32_bf16 v[28:31], a[104:107], a[64:67], v[28:31]
  ds_read_b64_tr_b16 a[34:35], v248 offset:1024
  s_add_u32 m0, s33, 49152
  v_mfma_f32_16x16x32_bf16 v[32:35], a[108:111], a[64:67], v[32:35]
  v_mfma_f32_16x16x32_bf16 v[48:51], a[108:111], a[68:71], v[48:51]
  ds_read_b64_tr_b16 a[36:37], v249 offset:0
  v_mfma_f32_16x16x32_bf16 v[44:47], a[104:107], a[68:71], v[44:47]
  v_mfma_f32_16x16x32_bf16 v[40:43], a[100:103], a[68:71], v[40:43]
  buffer_load_dwordx4 v244, s[8:11], s27 offen offset:0 sc1 lds
  v_mfma_f32_16x16x32_bf16 v[36:39], a[96:99], a[68:71], v[36:39]
  ds_read_b64_tr_b16 a[38:39], v249 offset:1024
  v_mfma_f32_16x16x32_bf16 v[52:55], a[96:99], a[72:75], v[52:55]
  v_mfma_f32_16x16x32_bf16 v[56:59], a[100:103], a[72:75], v[56:59]
  ds_read_b64_tr_b16 a[40:41], v250 offset:0
  v_mfma_f32_16x16x32_bf16 v[60:63], a[104:107], a[72:75], v[60:63]
  v_mfma_f32_16x16x32_bf16 v[64:67], a[108:111], a[72:75], v[64:67]
  buffer_load_dwordx4 v245, s[8:11], s27 offen offset:1024 sc1 lds
  v_mfma_f32_16x16x32_bf16 v[80:83], a[108:111], a[76:79], v[80:83]
  ds_read_b64_tr_b16 a[42:43], v250 offset:1024
  v_mfma_f32_16x16x32_bf16 v[76:79], a[104:107], a[76:79], v[76:79]
  ds_read_b64_tr_b16 a[44:45], v251 offset:0
  v_mfma_f32_16x16x32_bf16 v[72:75], a[100:103], a[76:79], v[72:75]
  v_mfma_f32_16x16x32_bf16 v[68:71], a[96:99], a[76:79], v[68:71]
  ds_read_b64_tr_b16 a[46:47], v251 offset:1024
  v_mfma_f32_16x16x32_bf16 v[84:87], a[96:99], a[80:83], v[84:87]
  buffer_load_dwordx4 v246, s[8:11], s27 offen offset:2048 sc1 lds
  v_mfma_f32_16x16x32_bf16 v[88:91], a[100:103], a[80:83], v[88:91]
  v_mfma_f32_16x16x32_bf16 v[92:95], a[104:107], a[80:83], v[92:95]
  ds_read_b64_tr_b16 a[48:49], v248 offset:8192
  v_mfma_f32_16x16x32_bf16 v[96:99], a[108:111], a[80:83], v[96:99]
  v_mfma_f32_16x16x32_bf16 v[112:115], a[108:111], a[84:87], v[112:115]
  ds_read_b64_tr_b16 a[50:51], v248 offset:9216
  v_mfma_f32_16x16x32_bf16 v[108:111], a[104:107], a[84:87], v[108:111]
  buffer_load_dwordx4 v247, s[8:11], s27 offen offset:3072 sc1 lds
  v_mfma_f32_16x16x32_bf16 v[104:107], a[100:103], a[84:87], v[104:107]
  ds_read_b64_tr_b16 a[52:53], v249 offset:8192
  v_mfma_f32_16x16x32_bf16 v[100:103], a[96:99], a[84:87], v[100:103]
  v_mfma_f32_16x16x32_bf16 v[116:119], a[96:99], a[88:91], v[116:119]
  ds_read_b64_tr_b16 a[54:55], v249 offset:9216
  v_mfma_f32_16x16x32_bf16 v[120:123], a[100:103], a[88:91], v[120:123]
  v_mfma_f32_16x16x32_bf16 v[124:127], a[104:107], a[88:91], v[124:127]
  s_add_u32 m0, s29, 49152
  v_mfma_f32_16x16x32_bf16 v[128:131], a[108:111], a[88:91], v[128:131]
  ds_read_b64_tr_b16 a[56:57], v250 offset:8192
  v_mfma_f32_16x16x32_bf16 v[144:147], a[108:111], a[92:95], v[144:147]
  v_mfma_f32_16x16x32_bf16 v[140:143], a[104:107], a[92:95], v[140:143]
  ds_read_b64_tr_b16 a[58:59], v250 offset:9216
  v_mfma_f32_16x16x32_bf16 v[136:139], a[100:103], a[92:95], v[136:139]
  v_mfma_f32_16x16x32_bf16 v[132:135], a[96:99], a[92:95], v[132:135]
  buffer_load_dwordx4 v8, s[4:7], s25 offen offset:0 sc1 lds
  v_mfma_f32_16x16x32_bf16 a[188:191], a[92:95], a[124:127], a[188:191]
  ds_read_b64_tr_b16 a[60:61], v251 offset:8192
  v_mfma_f32_16x16x32_bf16 a[180:183], a[92:95], a[120:123], a[180:183]
  ds_read_b64_tr_b16 a[62:63], v251 offset:9216
  v_mfma_f32_16x16x32_bf16 a[172:175], a[92:95], a[116:119], a[172:175]
  v_mfma_f32_16x16x32_bf16 a[164:167], a[92:95], a[112:115], a[164:167]
  buffer_load_dwordx4 v9, s[4:7], s25 offen offset:1024 sc1 lds
  v_mfma_f32_16x16x32_bf16 a[160:163], a[88:91], a[112:115], a[160:163]
  ds_read_b128 a[0:3], v252 offset:0
  v_mfma_f32_16x16x32_bf16 a[168:171], a[88:91], a[116:119], a[168:171]
  v_mfma_f32_16x16x32_bf16 a[176:179], a[88:91], a[120:123], a[176:179]
  ds_read_b128 a[4:7], v252 offset:1024
  v_mfma_f32_16x16x32_bf16 a[184:187], a[88:91], a[124:127], a[184:187]
  v_mfma_f32_16x16x32_bf16 a[156:159], a[84:87], a[124:127], a[156:159]
  buffer_load_dwordx4 v10, s[4:7], s25 offen offset:2048 sc1 lds
  v_mfma_f32_16x16x32_bf16 a[148:151], a[84:87], a[120:123], a[148:151]
  ds_read_b128 a[8:11], v252 offset:2048
  v_mfma_f32_16x16x32_bf16 a[140:143], a[84:87], a[116:119], a[140:143]
  ds_read_b128 a[12:15], v252 offset:3072
  v_mfma_f32_16x16x32_bf16 a[132:135], a[84:87], a[112:115], a[132:135]
  v_mfma_f32_16x16x32_bf16 a[128:131], a[80:83], a[112:115], a[128:131]
  v_mfma_f32_16x16x32_bf16 a[136:139], a[80:83], a[116:119], a[136:139]
  buffer_load_dwordx4 v11, s[4:7], s25 offen offset:3072 sc1 lds
  v_mfma_f32_16x16x32_bf16 a[144:147], a[80:83], a[120:123], a[144:147]
  ds_read_b128 a[16:19], v252 offset:4096
  v_mfma_f32_16x16x32_bf16 a[152:155], a[80:83], a[124:127], a[152:155]
  ds_read_b128 a[20:23], v252 offset:5120
  v_mfma_f32_16x16x32_bf16 v[208:211], a[76:79], a[124:127], v[208:211]
  v_mfma_f32_16x16x32_bf16 v[200:203], a[76:79], a[120:123], v[200:203]
  ds_read_b128 a[24:27], v252 offset:6144
  v_mfma_f32_16x16x32_bf16 v[192:195], a[76:79], a[116:119], v[192:195]
  s_add_u32 s27, s27, 0x40000
  v_mfma_f32_16x16x32_bf16 v[184:187], a[76:79], a[112:115], v[184:187]
  ds_read_b128 a[28:31], v252 offset:7168
  v_mfma_f32_16x16x32_bf16 v[180:183], a[72:75], a[112:115], v[180:183]
  v_mfma_f32_16x16x32_bf16 v[188:191], a[72:75], a[116:119], v[188:191]
  v_mfma_f32_16x16x32_bf16 v[196:199], a[72:75], a[120:123], v[196:199]
  v_mfma_f32_16x16x32_bf16 v[204:207], a[72:75], a[124:127], v[204:207]
  s_add_u32 s25, s25, 64
  v_mfma_f32_16x16x32_bf16 v[176:179], a[68:71], a[124:127], v[176:179]
  v_mfma_f32_16x16x32_bf16 v[168:171], a[68:71], a[120:123], v[168:171]
  v_mfma_f32_16x16x32_bf16 v[160:163], a[68:71], a[116:119], v[160:163]
  v_mfma_f32_16x16x32_bf16 v[152:155], a[68:71], a[112:115], v[152:155]
  v_mfma_f32_16x16x32_bf16 v[148:151], a[64:67], a[112:115], v[148:151]
  v_mfma_f32_16x16x32_bf16 v[156:159], a[64:67], a[116:119], v[156:159]
  v_mfma_f32_16x16x32_bf16 v[164:167], a[64:67], a[120:123], v[164:167]
  s_waitcnt vmcnt(16)
  s_waitcnt lgkmcnt(0)
  s_barrier
  v_mfma_f32_16x16x32_bf16 v[172:175], a[64:67], a[124:127], v[172:175]
  s_mov_b32 s40, 0
  v_cmp_eq_u32 vcc, 0, v220
  s_nop 0
  s_cbranch_vccz adaLN_cond__compressed_kv_cla__mixer_channel_mlp__prompt_kernel_ok16
adaLN_cond__compressed_kv_cla__mixer_channel_mlp__prompt_kernel_sp17:
  s_sleep 2
  global_load_dwordx2 v[220:221], v19, s[92:93] sc1
  s_waitcnt vmcnt(0)
  s_add_u32 s40, s40, 1
  v_cmp_eq_u32 vcc, 0, v220
  s_nop 0
  s_cbranch_vccz adaLN_cond__compressed_kv_cla__mixer_channel_mlp__prompt_kernel_ok16
  s_cmp_lt_u32 s40, 0x4000
  s_cbranch_scc1 adaLN_cond__compressed_kv_cla__mixer_channel_mlp__prompt_kernel_sp17
adaLN_cond__compressed_kv_cla__mixer_channel_mlp__prompt_kernel_ok16:
  v_readfirstlane_b32 s76, v220
  v_readfirstlane_b32 s77, v221
  s_nop 1
  v_mfma_f32_16x16x32_bf16 v[20:23], a[32:35], a[0:3], v[20:23]
  ds_read_b64_tr_b16 a[96:97], v248 offset:16384
  v_mov_b32 v230, s76
  v_mfma_f32_16x16x32_bf16 v[24:27], a[36:39], a[0:3], v[24:27]
  v_mov_b32 v231, s77
  v_mfma_f32_16x16x32_bf16 v[28:31], a[40:43], a[0:3], v[28:31]
  buffer_store_dwordx2 v[230:231], v0, s[12:15], s89 offen sc1
  s_lshl_b32 s47, s21, 7
  v_mfma_f32_16x16x32_bf16 v[32:35], a[44:47], a[0:3], v[32:35]
  ds_read_b64_tr_b16 a[98:99], v248 offset:17408
  s_lshl_b32 s48, s22, 4
  v_mfma_f32_16x16x32_bf16 v[48:51], a[44:47], a[4:7], v[48:51]
  ds_read_b64_tr_b16 a[100:101], v249 offset:16384
  s_add_u32 s47, s47, s48
  v_mfma_f32_16x16x32_bf16 v[44:47], a[40:43], a[4:7], v[44:47]
  s_add_u32 m0, s33, 0
  s_add_u32 s47, s47, 0x3f06000
  v_mfma_f32_16x16x32_bf16 v[40:43], a[36:39], a[4:7], v[40:43]
  ds_read_b64_tr_b16 a[102:103], v249 offset:17408
  v_mov_b32 v232, s76
  v_mfma_f32_16x16x32_bf16 v[36:39], a[32:35], a[4:7], v[36:39]
  buffer_load_dwordx4 v244, s[8:11], s27 offen offset:0 sc1 lds
  v_mfma_f32_16x16x32_bf16 v[52:55], a[32:35], a[8:11], v[52:55]
  v_mov_b32 v233, s63
  v_mfma_f32_16x16x32_bf16 v[56:59], a[36:39], a[8:11], v[56:59]
  buffer_store_dwordx2 v[232:233], v0, s[12:15], s47 offen sc1
  v_mfma_f32_16x16x32_bf16 v[60:63], a[40:43], a[8:11], v[60:63]
  ds_read_b64_tr_b16 a[104:105], v250 offset:16384
  s_waitcnt vmcnt(16)
  v_mfma_f32_16x16x32_bf16 v[64:67], a[44:47], a[8:11], v[64:67]
  ds_read_b64_tr_b16 a[106:107], v250 offset:17408
  v_lshlrev_b32 v222, 16, v212
  v_mfma_f32_16x16x32_bf16 v[80:83], a[44:47], a[12:15], v[80:83]
  v_and_b32 v223, 0xffff0000, v212
  v_add_f32 v220, v222, v223
  v_mfma_f32_16x16x32_bf16 v[76:79], a[40:43], a[12:15], v[76:79]
  ds_read_b64_tr_b16 a[108:109], v251 offset:16384
  v_mul_f32 v221, v222, v222
  v_mfma_f32_16x16x32_bf16 v[72:75], a[36:39], a[12:15], v[72:75]
  v_fmac_f32 v221, v223, v223
  v_lshlrev_b32 v222, 16, v213
  v_mfma_f32_16x16x32_bf16 v[68:71], a[32:35], a[12:15], v[68:71]
  ds_read_b64_tr_b16 a[110:111], v251 offset:17408
  v_and_b32 v223, 0xffff0000, v213
  v_mfma_f32_16x16x32_bf16 v[84:87], a[32:35], a[16:19], v[84:87]
  v_add_f32 v220, v220, v222
  v_fmac_f32 v221, v222, v222
  v_mfma_f32_16x16x32_bf16 v[88:91], a[36:39], a[16:19], v[88:91]
  buffer_load_dwordx4 v245, s[8:11], s27 offen offset:1024 sc1 lds
  v_mfma_f32_16x16x32_bf16 v[92:95], a[40:43], a[16:19], v[92:95]
  ds_read_b64_tr_b16 a[112:113], v248 offset:24576
  v_add_f32 v220, v220, v223
  v_mfma_f32_16x16x32_bf16 v[96:99], a[44:47], a[16:19], v[96:99]
  v_fmac_f32 v221, v223, v223
  v_lshlrev_b32 v222, 16, v214
  v_mfma_f32_16x16x32_bf16 v[112:115], a[44:47], a[20:23], v[112:115]
  ds_read_b64_tr_b16 a[114:115], v248 offset:25600
  v_and_b32 v223, 0xffff0000, v214
  v_mfma_f32_16x16x32_bf16 v[108:111], a[40:43], a[20:23], v[108:111]
  v_add_f32 v220, v220, v222
  v_fmac_f32 v221, v222, v222
  v_mfma_f32_16x16x32_bf16 v[104:107], a[36:39], a[20:23], v[104:107]
  buffer_load_dwordx4 v246, s[8:11], s27 offen offset:2048 sc1 lds
  v_mfma_f32_16x16x32_bf16 v[100:103], a[32:35], a[20:23], v[100:103]
  ds_read_b64_tr_b16 a[116:117], v249 offset:24576
  v_add_f32 v220, v220, v223
  v_mfma_f32_16x16x32_bf16 v[116:119], a[32:35], a[24:27], v[116:119]
  ds_read_b64_tr_b16 a[118:119], v249 offset:25600
  v_fmac_f32 v221, v223, v223
  v_mfma_f32_16x16x32_bf16 v[120:123], a[36:39], a[24:27], v[120:123]
  v_lshlrev_b32 v222, 16, v215
  v_and_b32 v223, 0xffff0000, v215
  v_mfma_f32_16x16x32_bf16 v[124:127], a[40:43], a[24:27], v[124:127]
  v_add_f32 v220, v220, v222
  v_fmac_f32 v221, v222, v222
  v_mfma_f32_16x16x32_bf16 v[128:131], a[44:47], a[24:27], v[128:131]
  buffer_load_dwordx4 v247, s[8:11], s27 offen offset:3072 sc1 lds
  v_mfma_f32_16x16x32_bf16 v[144:147], a[44:47], a[28:31], v[144:147]
  ds_read_b64_tr_b16 a[120:121], v250 offset:24576
  v_add_f32 v220, v220, v223
  v_mfma_f32_16x16x32_bf16 v[140:143], a[40:43], a[28:31], v[140:143]
  ds_read_b64_tr_b16 a[122:123], v250 offset:25600
  v_fmac_f32 v221, v223, v223
  v_mfma_f32_16x16x32_bf16 v[136:139], a[36:39], a[28:31], v[136:139]
  v_lshlrev_b32 v222, 16, v216
  v_and_b32 v223, 0xffff0000, v216
  v_mfma_f32_16x16x32_bf16 v[132:135], a[32:35], a[28:31], v[132:135]
  ds_read_b64_tr_b16 a[124:125], v251 offset:24576
  v_add_f32 v220, v220, v222
  v_mfma_f32_16x16x32_bf16 a[188:191], a[28:31], a[60:63], a[188:191]
  v_fmac_f32 v221, v222, v222
  v_add_f32 v220, v220, v223
  v_mfma_f32_16x16x32_bf16 a[180:183], a[28:31], a[56:59], a[180:183]
  ds_read_b64_tr_b16 a[126:127], v251 offset:25600
  s_add_u32 m0, s29, 0
  v_mfma_f32_16x16x32_bf16 a[172:175], a[28:31], a[52:55], a[172:175]
  v_fmac_f32 v221, v223, v223
  v_lshlrev_b32 v222, 16, v217
  v_mfma_f32_16x16x32_bf16 a[164:167], a[28:31], a[48:51], a[164:167]
  v_and_b32 v223, 0xffff0000, v217
  v_add_f32 v220, v220, v222
  v_mfma_f32_16x16x32_bf16 a[160:163], a[24:27], a[48:51], a[160:163]
  ds_read_b128 a[64:67], v252 offset:16384
  v_fmac_f32 v221, v222, v222
  v_mfma_f32_16x16x32_bf16 a[168:171], a[24:27], a[52:55], a[168:171]
  buffer_load_dwordx4 v8, s[4:7], s25 offen offset:0 sc1 lds
  v_mfma_f32_16x16x32_bf16 a[176:179], a[24:27], a[56:59], a[176:179]
  ds_read_b128 a[68:71], v252 offset:17408
  v_add_f32 v220, v220, v223
  v_fmac_f32 v221, v223, v223
  v_mfma_f32_16x16x32_bf16 a[184:187], a[24:27], a[60:63], a[184:187]
  v_lshlrev_b32 v222, 16, v218
  v_and_b32 v223, 0xffff0000, v218
  v_mfma_f32_16x16x32_bf16 a[156:159], a[20:23], a[60:63], a[156:159]
  ds_read_b128 a[72:75], v252 offset:18432
  v_add_f32 v220, v220, v222
  v_mfma_f32_16x16x32_bf16 a[148:151], a[20:23], a[56:59], a[148:151]
  v_fmac_f32 v221, v222, v222
  v_add_f32 v220, v220, v223
  v_mfma_f32_16x16x32_bf16 a[140:143], a[20:23], a[52:55], a[140:143]
  buffer_load_dwordx4 v9, s[4:7], s25 offen offset:1024 sc1 lds
  v_mfma_f32_16x16x32_bf16 a[132:135], a[20:23], a[48:51], a[132:135]
  ds_read_b128 a[76:79], v252 offset:19456
  v_fmac_f32 v221, v223, v223
  v_mfma_f32_16x16x32_bf16 a[128:131], a[16:19], a[48:51], a[128:131]
  v_lshlrev_b32 v222, 16, v219
  v_and_b32 v223, 0xffff0000, v219
  v_mfma_f32_16x16x32_bf16 a[136:139], a[16:19], a[52:55], a[136:139]
  ds_read_b128 a[80:83], v252 offset:20480
  v_add_f32 v220, v220, v222
  v_mfma_f32_16x16x32_bf16 a[144:147], a[16:19], a[56:59], a[144:147]
  v_fmac_f32 v221, v222, v222
  v_add_f32 v220, v220, v223
  v_mfma_f32_16x16x32_bf16 a[152:155], a[16:19], a[60:63], a[152:155]
  ds_read_b128 a[84:87], v252 offset:21504
  v_fmac_f32 v221, v223, v223
  v_mfma_f32_16x16x32_bf16 v[208:211], a[12:15], a[60:63], v[208:211]
  buffer_load_dwordx4 v10, s[4:7], s25 offen offset:2048 sc1 lds
  v_permlane32_swap_b32 v220, v221
  v_mfma_f32_16x16x32_bf16 v[200:203], a[12:15], a[56:59], v[200:203]
  ds_read_b128 a[88:91], v252 offset:22528
  v_add_f32 v220, v220, v221
  v_mfma_f32_16x16x32_bf16 v[192:195], a[12:15], a[52:55], v[192:195]
  v_mov_b32 v221, v220
  v_mfma_f32_16x16x32_bf16 v[184:187], a[12:15], a[48:51], v[184:187]
  buffer_load_dwordx4 v11, s[4:7], s25 offen offset:3072 sc1 lds
  v_permlane16_swap_b32 v220, v221
  v_add_f32 v220, v220, v221
  v_mfma_f32_16x16x32_bf16 v[180:183], a[8:11], a[48:51], v[180:183]
  ds_read_b128 a[92:95], v252 offset:23552
  v_add_f32_dpp v220, v220, v220 row_ror:8 row_mask:0xf bank_mask:0xf
  v_mfma_f32_16x16x32_bf16 v[188:191], a[8:11], a[52:55], v[188:191]
  v_and_b32 v222, 7, v1
  v_lshlrev_b32 v222, 5, v222
  v_mfma_f32_16x16x32_bf16 v[196:199], a[8:11], a[56:59], v[196:199]
  v_add_u32 v222, 0x20400, v222
  v_lshrrev_b32 v223, 5, v1
  v_mfma_f32_16x16x32_bf16 v[204:207], a[8:11], a[60:63], v[204:207]
  v_lshl_add_u32 v223, v223, 4, v222
  s_lshl_b32 s46, s20, 2
  v_mfma_f32_16x16x32_bf16 v[176:179], a[4:7], a[60:63], v[176:179]
  v_add_u32 v223, s46, v223
  s_add_u32 s27, s27, 0x40000
  v_mfma_f32_16x16x32_bf16 v[168:171], a[4:7], a[56:59], v[168:171]
  ds_write_b32 v223, v220
  s_add_u32 s25, s25, 64
  v_mfma_f32_16x16x32_bf16 v[160:163], a[4:7], a[52:55], v[160:163]
  v_mfma_f32_16x16x32_bf16 v[152:155], a[4:7], a[48:51], v[152:155]
  v_mfma_f32_16x16x32_bf16 v[148:151], a[0:3], a[48:51], v[148:151]
  v_mfma_f32_16x16x32_bf16 v[156:159], a[0:3], a[52:55], v[156:159]
  v_mfma_f32_16x16x32_bf16 v[164:167], a[0:3], a[56:59], v[164:167]
  s_waitcnt vmcnt(18) lgkmcnt(0)
  s_barrier
  v_mfma_f32_16x16x32_bf16 v[172:175], a[0:3], a[60:63], v[172:175]
  v_mfma_f32_16x16x32_bf16 v[20:23], a[96:99], a[64:67], v[20:23]
  ds_read_b128 v[12:15], v222
  ds_read_b128 v[16:19], v222 offset:16
  v_mfma_f32_16x16x32_bf16 v[24:27], a[100:103], a[64:67], v[24:27]
  ds_read_b64_tr_b16 a[32:33], v248 offset:32768
  v_mfma_f32_16x16x32_bf16 v[28:31], a[104:107], a[64:67], v[28:31]
  ds_read_b64_tr_b16 a[34:35], v248 offset:33792
  s_add_u32 m0, s33, 16384
  v_mfma_f32_16x16x32_bf16 v[32:35], a[108:111], a[64:67], v[32:35]
  v_mfma_f32_16x16x32_bf16 v[48:51], a[108:111], a[68:71], v[48:51]
  ds_read_b64_tr_b16 a[36:37], v249 offset:32768
  v_mfma_f32_16x16x32_bf16 v[44:47], a[104:107], a[68:71], v[44:47]
  v_mfma_f32_16x16x32_bf16 v[40:43], a[100:103], a[68:71], v[40:43]
  buffer_load_dwordx4 v244, s[8:11], s27 offen offset:0 sc1 lds
  v_mfma_f32_16x16x32_bf16 v[36:39], a[96:99], a[68:71], v[36:39]
  ds_read_b64_tr_b16 a[38:39], v249 offset:33792
  v_mfma_f32_16x16x32_bf16 v[52:55], a[96:99], a[72:75], v[52:55]
  v_mfma_f32_16x16x32_bf16 v[56:59], a[100:103], a[72:75], v[56:59]
  ds_read_b64_tr_b16 a[40:41], v250 offset:32768
  v_mfma_f32_16x16x32_bf16 v[60:63], a[104:107], a[72:75], v[60:63]
  v_mfma_f32_16x16x32_bf16 v[64:67], a[108:111], a[72:75], v[64:67]
  buffer_load_dwordx4 v245, s[8:11], s27 offen offset:1024 sc1 lds
  v_mfma_f32_16x16x32_bf16 v[80:83], a[108:111], a[76:79], v[80:83]
  ds_read_b64_tr_b16 a[42:43], v250 offset:33792
  s_waitcnt lgkmcnt(6)
  v_add_f32 v12, v12, v13
  v_mfma_f32_16x16x32_bf16 v[76:79], a[104:107], a[76:79], v[76:79]
  ds_read_b64_tr_b16 a[44:45], v251 offset:32768
  v_add_f32 v14, v14, v15
  v_mfma_f32_16x16x32_bf16 v[72:75], a[100:103], a[76:79], v[72:75]
  v_add_f32 v16, v16, v17
  v_add_f32 v18, v18, v19
  v_mfma_f32_16x16x32_bf16 v[68:71], a[96:99], a[76:79], v[68:71]
  ds_read_b64_tr_b16 a[46:47], v251 offset:33792
  v_add_f32 v12, v12, v14
  v_mfma_f32_16x16x32_bf16 v[84:87], a[96:99], a[80:83], v[84:87]
  v_add_f32 v16, v16, v18
  v_mul_f32 v220, 0x3b000000, v12
  v_mfma_f32_16x16x32_bf16 v[88:91], a[100:103], a[80:83], v[88:91]
  v_mul_f32 v221, 0x3b000000, v16
  v_fma_f32 v221, -v220, v220, v221
  v_mfma_f32_16x16x32_bf16 v[92:95], a[104:107], a[80:83], v[92:95]
  ds_read_b64_tr_b16 a[48:49], v248 offset:40960
  v_max_f32 v221, 0, v221
  v_mfma_f32_16x16x32_bf16 v[96:99], a[108:111], a[80:83], v[96:99]
  buffer_load_dwordx4 v246, s[8:11], s27 offen offset:2048 sc1 lds
  v_mfma_f32_16x16x32_bf16 v[112:115], a[108:111], a[84:87], v[112:115]
  ds_read_b64_tr_b16 a[50:51], v248 offset:41984
  v_add_f32 v221, 0x3727c5ac, v221
  v_mfma_f32_16x16x32_bf16 v[108:111], a[104:107], a[84:87], v[108:111]
  buffer_load_dwordx4 v247, s[8:11], s27 offen offset:3072 sc1 lds
  v_mfma_f32_16x16x32_bf16 v[104:107], a[100:103], a[84:87], v[104:107]
  v_rsq_f32 v221, v221
  v_mfma_f32_16x16x32_bf16 v[100:103], a[96:99], a[84:87], v[100:103]
  ds_read_b64_tr_b16 a[52:53], v249 offset:40960
  v_mul_f32 v220, v220, v221
  v_mfma_f32_16x16x32_bf16 v[116:119], a[96:99], a[88:91], v[116:119]
  ds_read_b64_tr_b16 a[54:55], v249 offset:41984
  v_sub_f32 v220, 0, v220
  v_mfma_f32_16x16x32_bf16 v[120:123], a[100:103], a[88:91], v[120:123]
  v_lshrrev_b32 v12, 4, v1
  v_mul_u32_u24 v12, 48, v12
  v_mfma_f32_16x16x32_bf16 v[124:127], a[104:107], a[88:91], v[124:127]
  s_add_u32 m0, s29, 16384
  v_and_b32 v13, 15, v1
  v_mfma_f32_16x16x32_bf16 v[128:131], a[108:111], a[88:91], v[128:131]
  ds_read_b64_tr_b16 a[56:57], v250 offset:40960
  v_add_u32 v12, v12, v13
  v_mfma_f32_16x16x32_bf16 v[144:147], a[108:111], a[92:95], v[144:147]
  v_lshlrev_b32 v12, 4, v12
  v_add_u32 v16, 0x3f07000, v12
  v_mfma_f32_16x16x32_bf16 v[140:143], a[104:107], a[92:95], v[140:143]
  ds_read_b64_tr_b16 a[58:59], v250 offset:41984
  v_and_b32 v13, 3, v1
  v_mfma_f32_16x16x32_bf16 v[136:139], a[100:103], a[92:95], v[136:139]
  v_mul_u32_u24 v13, 768, v13
  s_lshr_b32 s46, s2, 3
  v_mfma_f32_16x16x32_bf16 v[132:135], a[96:99], a[92:95], v[132:135]
  ds_read_b64_tr_b16 a[60:61], v251 offset:40960
  s_lshl_b32 s46, s46, 4
  v_mfma_f32_16x16x32_bf16 a[188:191], a[92:95], a[124:127], a[188:191]
  buffer_load_dwordx4 v8, s[4:7], s25 offen offset:0 sc1 lds
  v_mfma_f32_16x16x32_bf16 a[180:183], a[92:95], a[120:123], a[180:183]
  ds_read_b64_tr_b16 a[62:63], v251 offset:41984
  s_add_u32 s46, s46, 0x3f07100
  v_mfma_f32_16x16x32_bf16 a[172:175], a[92:95], a[116:119], a[172:175]
  v_add_u32 v17, s46, v13
  v_mfma_f32_16x16x32_bf16 a[164:167], a[92:95], a[112:115], a[164:167]
  buffer_load_dwordx4 v9, s[4:7], s25 offen offset:1024 sc1 lds
  v_mfma_f32_16x16x32_bf16 a[160:163], a[88:91], a[112:115], a[160:163]
  ds_read_b128 a[0:3], v252 offset:32768
  v_mfma_f32_16x16x32_bf16 a[168:171], a[88:91], a[116:119], a[168:171]
  v_mfma_f32_16x16x32_bf16 a[176:179], a[88:91], a[120:123], a[176:179]
  ds_read_b128 a[4:7], v252 offset:33792
  v_mfma_f32_16x16x32_bf16 a[184:187], a[88:91], a[124:127], a[184:187]
  v_mfma_f32_16x16x32_bf16 a[156:159], a[84:87], a[124:127], a[156:159]
  buffer_load_dwordx4 v10, s[4:7], s25 offen offset:2048 sc1 lds
  v_mfma_f32_16x16x32_bf16 a[148:151], a[84:87], a[120:123], a[148:151]
  ds_read_b128 a[8:11], v252 offset:34816
  v_mfma_f32_16x16x32_bf16 a[140:143], a[84:87], a[116:119], a[140:143]
  ds_read_b128 a[12:15], v252 offset:35840
  v_mfma_f32_16x16x32_bf16 a[132:135], a[84:87], a[112:115], a[132:135]
  v_mfma_f32_16x16x32_bf16 a[128:131], a[80:83], a[112:115], a[128:131]
  v_mfma_f32_16x16x32_bf16 a[136:139], a[80:83], a[116:119], a[136:139]
  buffer_load_dwordx4 v11, s[4:7], s25 offen offset:3072 sc1 lds
  v_mfma_f32_16x16x32_bf16 a[144:147], a[80:83], a[120:123], a[144:147]
  ds_read_b128 a[16:19], v252 offset:36864
  v_mfma_f32_16x16x32_bf16 a[152:155], a[80:83], a[124:127], a[152:155]
  ds_read_b128 a[20:23], v252 offset:37888
  v_mfma_f32_16x16x32_bf16 v[208:211], a[76:79], a[124:127], v[208:211]
  v_mfma_f32_16x16x32_bf16 v[200:203], a[76:79], a[120:123], v[200:203]
  ds_read_b128 a[24:27], v252 offset:38912
  v_mfma_f32_16x16x32_bf16 v[192:195], a[76:79], a[116:119], v[192:195]
  s_add_u32 s27, s27, 0x40000
  v_mfma_f32_16x16x32_bf16 v[184:187], a[76:79], a[112:115], v[184:187]
  ds_read_b128 a[28:31], v252 offset:39936
  v_mfma_f32_16x16x32_bf16 v[180:183], a[72:75], a[112:115], v[180:183]
  v_mfma_f32_16x16x32_bf16 v[188:191], a[72:75], a[116:119], v[188:191]
  v_mfma_f32_16x16x32_bf16 v[196:199], a[72:75], a[120:123], v[196:199]
  v_mfma_f32_16x16x32_bf16 v[204:207], a[72:75], a[124:127], v[204:207]
  s_add_u32 s25, s25, 64
  v_mfma_f32_16x16x32_bf16 v[176:179], a[68:71], a[124:127], v[176:179]
  v_mfma_f32_16x16x32_bf16 v[168:171], a[68:71], a[120:123], v[168:171]
  v_mfma_f32_16x16x32_bf16 v[160:163], a[68:71], a[116:119], v[160:163]
  v_mfma_f32_16x16x32_bf16 v[152:155], a[68:71], a[112:115], v[152:155]
  v_mfma_f32_16x16x32_bf16 v[148:151], a[64:67], a[112:115], v[148:151]
  v_mfma_f32_16x16x32_bf16 v[156:159], a[64:67], a[116:119], v[156:159]
  v_mfma_f32_16x16x32_bf16 v[164:167], a[64:67], a[120:123], v[164:167]
  s_waitcnt vmcnt(18) lgkmcnt(0)
  s_barrier
  v_mfma_f32_16x16x32_bf16 v[172:175], a[64:67], a[124:127], v[172:175]
  v_mfma_f32_16x16x32_bf16 v[20:23], a[32:35], a[0:3], v[20:23]
  buffer_load_dwordx2 v[242:243], v16, s[12:15], 0 offen sc1
  v_mfma_f32_16x16x32_bf16 v[24:27], a[36:39], a[0:3], v[24:27]
  buffer_load_dwordx2 v[18:19], v17, s[12:15], 0 offen sc1
  v_lshrrev_b32 v12, 5, v1
  v_cvt_f32_u32 v14, v12
  v_mfma_f32_16x16x32_bf16 v[28:31], a[40:43], a[0:3], v[28:31]
  ds_read_b64_tr_b16 a[96:97], v248 offset:49152
  ds_read_b64_tr_b16 a[98:99], v248 offset:50176
  v_mfma_f32_16x16x32_bf16 v[32:35], a[44:47], a[0:3], v[32:35]
  s_add_u32 m0, s33, 32768
  v_lshlrev_b32 v12, 11, v12
  v_mfma_f32_16x16x32_bf16 v[48:51], a[44:47], a[4:7], v[48:51]
  ds_read_b64_tr_b16 a[100:101], v249 offset:49152
  v_and_b32 v13, 31, v1
  v_mfma_f32_16x16x32_bf16 v[44:47], a[40:43], a[4:7], v[44:47]
  v_lshl_add_u32 v12, v13, 4, v12
  s_lshl_b32 s46, s20, 9
  v_mfma_f32_16x16x32_bf16 v[40:43], a[36:39], a[4:7], v[40:43]
  ds_read_b64_tr_b16 a[102:103], v249 offset:50176
  v_add_u32 v12, s46, v12
  v_mfma_f32_16x16x32_bf16 v[36:39], a[32:35], a[4:7], v[36:39]
  buffer_load_dwordx4 v244, s[8:11], s27 offen offset:0 sc1 lds
  v_mfma_f32_16x16x32_bf16 v[52:55], a[32:35], a[8:11], v[52:55]
  v_and_b32 v13, 7, v1
  s_lshl_b32 s46, s2, 3
  v_mfma_f32_16x16x32_bf16 v[56:59], a[36:39], a[8:11], v[56:59]
  ds_read_b64_tr_b16 a[104:105], v250 offset:49152
  s_add_u32 s46, s46, 1024
  v_mfma_f32_16x16x32_bf16 v[60:63], a[40:43], a[8:11], v[60:63]
  v_add_u32 v13, s46, v13
  v_lshlrev_b32 v15, 2, v13
  v_mfma_f32_16x16x32_bf16 v[64:67], a[44:47], a[8:11], v[64:67]
  buffer_load_dwordx4 v245, s[8:11], s27 offen offset:1024 sc1 lds
  v_mfma_f32_16x16x32_bf16 v[80:83], a[44:47], a[12:15], v[80:83]
  ds_read_b64_tr_b16 a[106:107], v250 offset:50176
  v_mfma_f32_16x16x32_bf16 v[76:79], a[40:43], a[12:15], v[76:79]
  ds_read_b64_tr_b16 a[108:109], v251 offset:49152
  v_mfma_f32_16x16x32_bf16 v[72:75], a[36:39], a[12:15], v[72:75]
  v_mfma_f32_16x16x32_bf16 v[68:71], a[32:35], a[12:15], v[68:71]
  ds_read_b64_tr_b16 a[110:111], v251 offset:50176
  v_mfma_f32_16x16x32_bf16 v[84:87], a[32:35], a[16:19], v[84:87]
  buffer_load_dwordx4 v246, s[8:11], s27 offen offset:2048 sc1 lds
  v_mfma_f32_16x16x32_bf16 v[88:91], a[36:39], a[16:19], v[88:91]
  v_mfma_f32_16x16x32_bf16 v[92:95], a[40:43], a[16:19], v[92:95]
  ds_read_b64_tr_b16 a[112:113], v248 offset:57344
  v_mfma_f32_16x16x32_bf16 v[96:99], a[44:47], a[16:19], v[96:99]
  v_mfma_f32_16x16x32_bf16 v[112:115], a[44:47], a[20:23], v[112:115]
  ds_read_b64_tr_b16 a[114:115], v248 offset:58368
  v_mfma_f32_16x16x32_bf16 v[108:111], a[40:43], a[20:23], v[108:111]
  buffer_load_dwordx4 v247, s[8:11], s27 offen offset:3072 sc1 lds
  v_mfma_f32_16x16x32_bf16 v[104:107], a[36:39], a[20:23], v[104:107]
  ds_read_b64_tr_b16 a[116:117], v249 offset:57344
  v_mfma_f32_16x16x32_bf16 v[100:103], a[32:35], a[20:23], v[100:103]
  v_mfma_f32_16x16x32_bf16 v[116:119], a[32:35], a[24:27], v[116:119]
  ds_read_b64_tr_b16 a[118:119], v249 offset:58368
  v_mfma_f32_16x16x32_bf16 v[120:123], a[36:39], a[24:27], v[120:123]
  v_mfma_f32_16x16x32_bf16 v[124:127], a[40:43], a[24:27], v[124:127]
  s_add_u32 m0, s29, 32768
  v_mfma_f32_16x16x32_bf16 v[128:131], a[44:47], a[24:27], v[128:131]
  ds_read_b64_tr_b16 a[120:121], v250 offset:57344
  v_mfma_f32_16x16x32_bf16 v[144:147], a[44:47], a[28:31], v[144:147]
  v_mfma_f32_16x16x32_bf16 v[140:143], a[40:43], a[28:31], v[140:143]
  ds_read_b64_tr_b16 a[122:123], v250 offset:58368
  v_mfma_f32_16x16x32_bf16 v[136:139], a[36:39], a[28:31], v[136:139]
  v_mfma_f32_16x16x32_bf16 v[132:135], a[32:35], a[28:31], v[132:135]
  buffer_load_dwordx4 v8, s[4:7], s25 offen offset:0 sc1 lds
  v_mfma_f32_16x16x32_bf16 a[188:191], a[28:31], a[60:63], a[188:191]
  ds_read_b64_tr_b16 a[124:125], v251 offset:57344
  v_mfma_f32_16x16x32_bf16 a[180:183], a[28:31], a[56:59], a[180:183]
  ds_read_b64_tr_b16 a[126:127], v251 offset:58368
  v_mfma_f32_16x16x32_bf16 a[172:175], a[28:31], a[52:55], a[172:175]
  v_mfma_f32_16x16x32_bf16 a[164:167], a[28:31], a[48:51], a[164:167]
  buffer_load_dwordx4 v9, s[4:7], s25 offen offset:1024 sc1 lds
  v_mfma_f32_16x16x32_bf16 a[160:163], a[24:27], a[48:51], a[160:163]
  ds_read_b128 a[64:67], v252 offset:49152
  v_mfma_f32_16x16x32_bf16 a[168:171], a[24:27], a[52:55], a[168:171]
  v_mfma_f32_16x16x32_bf16 a[176:179], a[24:27], a[56:59], a[176:179]
  ds_read_b128 a[68:71], v252 offset:50176
  v_mfma_f32_16x16x32_bf16 a[184:187], a[24:27], a[60:63], a[184:187]
  v_mfma_f32_16x16x32_bf16 a[156:159], a[20:23], a[60:63], a[156:159]
  buffer_load_dwordx4 v10, s[4:7], s25 offen offset:2048 sc1 lds
  v_mfma_f32_16x16x32_bf16 a[148:151], a[20:23], a[56:59], a[148:151]
  ds_read_b128 a[72:75], v252 offset:51200
  v_mfma_f32_16x16x32_bf16 a[140:143], a[20:23], a[52:55], a[140:143]
  ds_read_b128 a[76:79], v252 offset:52224
  v_mfma_f32_16x16x32_bf16 a[132:135], a[20:23], a[48:51], a[132:135]
  v_mfma_f32_16x16x32_bf16 a[128:131], a[16:19], a[48:51], a[128:131]
  v_mfma_f32_16x16x32_bf16 a[136:139], a[16:19], a[52:55], a[136:139]
  buffer_load_dwordx4 v11, s[4:7], s25 offen offset:3072 sc1 lds
  v_mfma_f32_16x16x32_bf16 a[144:147], a[16:19], a[56:59], a[144:147]
  ds_read_b128 a[80:83], v252 offset:53248
  v_mfma_f32_16x16x32_bf16 a[152:155], a[16:19], a[60:63], a[152:155]
  ds_read_b128 a[84:87], v252 offset:54272
  v_mfma_f32_16x16x32_bf16 v[208:211], a[12:15], a[60:63], v[208:211]
  v_mfma_f32_16x16x32_bf16 v[200:203], a[12:15], a[56:59], v[200:203]
  ds_read_b128 a[88:91], v252 offset:55296
  v_mfma_f32_16x16x32_bf16 v[192:195], a[12:15], a[52:55], v[192:195]
  s_add_u32 s27, s27, 0x40000
  v_mfma_f32_16x16x32_bf16 v[184:187], a[12:15], a[48:51], v[184:187]
  ds_read_b128 a[92:95], v252 offset:56320
  v_mfma_f32_16x16x32_bf16 v[180:183], a[8:11], a[48:51], v[180:183]
  v_mfma_f32_16x16x32_bf16 v[188:191], a[8:11], a[52:55], v[188:191]
  v_mfma_f32_16x16x32_bf16 v[196:199], a[8:11], a[56:59], v[196:199]
  v_mfma_f32_16x16x32_bf16 v[204:207], a[8:11], a[60:63], v[204:207]
  s_add_u32 s25, s25, 64
  v_mfma_f32_16x16x32_bf16 v[176:179], a[4:7], a[60:63], v[176:179]
  v_mfma_f32_16x16x32_bf16 v[168:171], a[4:7], a[56:59], v[168:171]
  v_mfma_f32_16x16x32_bf16 v[160:163], a[4:7], a[52:55], v[160:163]
  v_mfma_f32_16x16x32_bf16 v[152:155], a[4:7], a[48:51], v[152:155]
  v_mfma_f32_16x16x32_bf16 v[148:151], a[0:3], a[48:51], v[148:151]
  v_mfma_f32_16x16x32_bf16 v[156:159], a[0:3], a[52:55], v[156:159]
  v_mfma_f32_16x16x32_bf16 v[164:167], a[0:3], a[56:59], v[164:167]
  s_waitcnt vmcnt(8) lgkmcnt(0)
  s_barrier
  v_mfma_f32_16x16x32_bf16 v[172:175], a[0:3], a[60:63], v[172:175]
  s_mov_b32 s40, 0
  v_cmp_ne_u64 vcc, s[76:77], v[242:243]
  v_cmp_ne_u64_e64 s[42:43], s[76:77], v[18:19]
  s_nop 1
  s_or_b64 vcc, vcc, s[42:43]
  s_cbranch_vccz adaLN_cond__compressed_kv_cla__mixer_channel_mlp__prompt_kernel_ok18
adaLN_cond__compressed_kv_cla__mixer_channel_mlp__prompt_kernel_sp19:
  s_sleep 2
  buffer_load_dwordx2 v[242:243], v16, s[12:15], 0 offen sc1
  buffer_load_dwordx2 v[18:19], v17, s[12:15], 0 offen sc1
  s_waitcnt vmcnt(0)
  s_add_u32 s40, s40, 1
  v_cmp_ne_u64 vcc, s[76:77], v[242:243]
  v_cmp_ne_u64_e64 s[42:43], s[76:77], v[18:19]
  s_nop 1
  s_or_b64 vcc, vcc, s[42:43]
  s_cbranch_vccz adaLN_cond__compressed_kv_cla__mixer_channel_mlp__prompt_kernel_ok18
  s_cmp_lt_u32 s40, 0x4000
  s_cbranch_scc1 adaLN_cond__compressed_kv_cla__mixer_channel_mlp__prompt_kernel_sp19
adaLN_cond__compressed_kv_cla__mixer_channel_mlp__prompt_kernel_ok18:
  v_mfma_f32_16x16x32_bf16 v[20:23], a[96:99], a[64:67], v[20:23]
  ds_read_b64_tr_b16 a[32:33], v248 offset:0
  s_mov_b32 s46, 0x3e00000
  v_mfma_f32_16x16x32_bf16 v[24:27], a[100:103], a[64:67], v[24:27]
  buffer_load_dwordx4 v[222:225], v12, s[12:15], s46 offen sc1
  buffer_load_dword v238, v15, s[12:15], s46 offen sc1
  s_mov_b32 s46, 0x3e03000
  v_mfma_f32_16x16x32_bf16 v[28:31], a[104:107], a[64:67], v[28:31]
  ds_read_b64_tr_b16 a[34:35], v248 offset:1024
  s_add_u32 m0, s33, 49152
  v_mfma_f32_16x16x32_bf16 v[32:35], a[108:111], a[64:67], v[32:35]
  buffer_load_dwordx4 v[226:229], v12, s[12:15], s46 offen sc1
  v_mfma_f32_16x16x32_bf16 v[48:51], a[108:111], a[68:71], v[48:51]
  buffer_load_dword v239, v15, s[12:15], s46 offen sc1
  v_mfma_f32_16x16x32_bf16 v[44:47], a[104:107], a[68:71], v[44:47]
  ds_read_b64_tr_b16 a[36:37], v249 offset:0
  s_mov_b32 s46, 0x3e06000
  v_mfma_f32_16x16x32_bf16 v[40:43], a[100:103], a[68:71], v[40:43]
  buffer_load_dwordx4 v244, s[8:11], s27 offen offset:0 sc1 lds
  v_mfma_f32_16x16x32_bf16 v[36:39], a[96:99], a[68:71], v[36:39]
  buffer_load_dwordx4 v[230:233], v12, s[12:15], s46 offen sc1
  v_mfma_f32_16x16x32_bf16 v[52:55], a[96:99], a[72:75], v[52:55]
  buffer_load_dword v240, v15, s[12:15], s46 offen sc1
  v_mfma_f32_16x16x32_bf16 v[56:59], a[100:103], a[72:75], v[56:59]
  ds_read_b64_tr_b16 a[38:39], v249 offset:1024
  ds_read_b64_tr_b16 a[40:41], v250 offset:0
  v_mfma_f32_16x16x32_bf16 v[60:63], a[104:107], a[72:75], v[60:63]
  s_mov_b32 s46, 0x3e09000
  v_mfma_f32_16x16x32_bf16 v[64:67], a[108:111], a[72:75], v[64:67]
  buffer_load_dwordx4 v245, s[8:11], s27 offen offset:1024 sc1 lds
  v_mfma_f32_16x16x32_bf16 v[80:83], a[108:111], a[76:79], v[80:83]
  buffer_load_dwordx4 v[234:237], v12, s[12:15], s46 offen sc1
  v_mfma_f32_16x16x32_bf16 v[76:79], a[104:107], a[76:79], v[76:79]
  ds_read_b64_tr_b16 a[42:43], v250 offset:1024
  ds_read_b64_tr_b16 a[44:45], v251 offset:0
  v_mfma_f32_16x16x32_bf16 v[72:75], a[100:103], a[76:79], v[72:75]
  buffer_load_dword v241, v15, s[12:15], s46 offen sc1
  v_mfma_f32_16x16x32_bf16 v[68:71], a[96:99], a[76:79], v[68:71]
  ds_read_b64_tr_b16 a[46:47], v251 offset:1024
  v_mfma_f32_16x16x32_bf16 v[84:87], a[96:99], a[80:83], v[84:87]
  buffer_load_dwordx4 v246, s[8:11], s27 offen offset:2048 sc1 lds
  v_mfma_f32_16x16x32_bf16 v[88:91], a[100:103], a[80:83], v[88:91]
  v_mfma_f32_16x16x32_bf16 v[92:95], a[104:107], a[80:83], v[92:95]
  ds_read_b64_tr_b16 a[48:49], v248 offset:8192
  v_mfma_f32_16x16x32_bf16 v[96:99], a[108:111], a[80:83], v[96:99]
  v_mfma_f32_16x16x32_bf16 v[112:115], a[108:111], a[84:87], v[112:115]
  ds_read_b64_tr_b16 a[50:51], v248 offset:9216
  v_mfma_f32_16x16x32_bf16 v[108:111], a[104:107], a[84:87], v[108:111]
  buffer_load_dwordx4 v247, s[8:11], s27 offen offset:3072 sc1 lds
  v_mfma_f32_16x16x32_bf16 v[104:107], a[100:103], a[84:87], v[104:107]
  ds_read_b64_tr_b16 a[52:53], v249 offset:8192
  v_mfma_f32_16x16x32_bf16 v[100:103], a[96:99], a[84:87], v[100:103]
  v_mfma_f32_16x16x32_bf16 v[116:119], a[96:99], a[88:91], v[116:119]
  ds_read_b64_tr_b16 a[54:55], v249 offset:9216
  v_mfma_f32_16x16x32_bf16 v[120:123], a[100:103], a[88:91], v[120:123]
  v_mfma_f32_16x16x32_bf16 v[124:127], a[104:107], a[88:91], v[124:127]
  s_add_u32 m0, s29, 49152
  v_mfma_f32_16x16x32_bf16 v[128:131], a[108:111], a[88:91], v[128:131]
  ds_read_b64_tr_b16 a[56:57], v250 offset:8192
  v_mfma_f32_16x16x32_bf16 v[144:147], a[108:111], a[92:95], v[144:147]
  v_mfma_f32_16x16x32_bf16 v[140:143], a[104:107], a[92:95], v[140:143]
  ds_read_b64_tr_b16 a[58:59], v250 offset:9216
  v_mfma_f32_16x16x32_bf16 v[136:139], a[100:103], a[92:95], v[136:139]
  v_mfma_f32_16x16x32_bf16 v[132:135], a[96:99], a[92:95], v[132:135]
  buffer_load_dwordx4 v8, s[4:7], s25 offen offset:0 sc1 lds
  v_mfma_f32_16x16x32_bf16 a[188:191], a[92:95], a[124:127], a[188:191]
  ds_read_b64_tr_b16 a[60:61], v251 offset:8192
  v_mfma_f32_16x16x32_bf16 a[180:183], a[92:95], a[120:123], a[180:183]
  ds_read_b64_tr_b16 a[62:63], v251 offset:9216
  v_mfma_f32_16x16x32_bf16 a[172:175], a[92:95], a[116:119], a[172:175]
  v_mfma_f32_16x16x32_bf16 a[164:167], a[92:95], a[112:115], a[164:167]
  buffer_load_dwordx4 v9, s[4:7], s25 offen offset:1024 sc1 lds
  v_mfma_f32_16x16x32_bf16 a[160:163], a[88:91], a[112:115], a[160:163]
  ds_read_b128 a[0:3], v252 offset:0
  v_mfma_f32_16x16x32_bf16 a[168:171], a[88:91], a[116:119], a[168:171]
  v_mfma_f32_16x16x32_bf16 a[176:179], a[88:91], a[120:123], a[176:179]
  ds_read_b128 a[4:7], v252 offset:1024
  v_mfma_f32_16x16x32_bf16 a[184:187], a[88:91], a[124:127], a[184:187]
  v_mfma_f32_16x16x32_bf16 a[156:159], a[84:87], a[124:127], a[156:159]
  buffer_load_dwordx4 v10, s[4:7], s25 offen offset:2048 sc1 lds
  v_mfma_f32_16x16x32_bf16 a[148:151], a[84:87], a[120:123], a[148:151]
  ds_read_b128 a[8:11], v252 offset:2048
  v_mfma_f32_16x16x32_bf16 a[140:143], a[84:87], a[116:119], a[140:143]
  ds_read_b128 a[12:15], v252 offset:3072
  v_mfma_f32_16x16x32_bf16 a[132:135], a[84:87], a[112:115], a[132:135]
  v_mfma_f32_16x16x32_bf16 a[128:131], a[80:83], a[112:115], a[128:131]
  v_mfma_f32_16x16x32_bf16 a[136:139], a[80:83], a[116:119], a[136:139]
  buffer_load_dwordx4 v11, s[4:7], s25 offen offset:3072 sc1 lds
  v_mfma_f32_16x16x32_bf16 a[144:147], a[80:83], a[120:123], a[144:147]
  ds_read_b128 a[16:19], v252 offset:4096
  v_mfma_f32_16x16x32_bf16 a[152:155], a[80:83], a[124:127], a[152:155]
  ds_read_b128 a[20:23], v252 offset:5120
  v_mfma_f32_16x16x32_bf16 v[208:211], a[76:79], a[124:127], v[208:211]
  v_mfma_f32_16x16x32_bf16 v[200:203], a[76:79], a[120:123], v[200:203]
  ds_read_b128 a[24:27], v252 offset:6144
  v_mfma_f32_16x16x32_bf16 v[192:195], a[76:79], a[116:119], v[192:195]
  s_add_u32 s27, s27, 0x40000
  v_mfma_f32_16x16x32_bf16 v[184:187], a[76:79], a[112:115], v[184:187]
  ds_read_b128 a[28:31], v252 offset:7168
  v_mfma_f32_16x16x32_bf16 v[180:183], a[72:75], a[112:115], v[180:183]
  v_mfma_f32_16x16x32_bf16 v[188:191], a[72:75], a[116:119], v[188:191]
  v_mfma_f32_16x16x32_bf16 v[196:199], a[72:75], a[120:123], v[196:199]
  v_mfma_f32_16x16x32_bf16 v[204:207], a[72:75], a[124:127], v[204:207]
  s_add_u32 s25, s25, 64
  v_mfma_f32_16x16x32_bf16 v[176:179], a[68:71], a[124:127], v[176:179]
  v_mfma_f32_16x16x32_bf16 v[168:171], a[68:71], a[120:123], v[168:171]
  v_mfma_f32_16x16x32_bf16 v[160:163], a[68:71], a[116:119], v[160:163]
  v_mfma_f32_16x16x32_bf16 v[152:155], a[68:71], a[112:115], v[152:155]
  v_mfma_f32_16x16x32_bf16 v[148:151], a[64:67], a[112:115], v[148:151]
  v_mfma_f32_16x16x32_bf16 v[156:159], a[64:67], a[116:119], v[156:159]
  v_mfma_f32_16x16x32_bf16 v[164:167], a[64:67], a[120:123], v[164:167]
  s_waitcnt lgkmcnt(0)
  s_barrier
  v_mfma_f32_16x16x32_bf16 v[172:175], a[64:67], a[124:127], v[172:175]
  v_mfma_f32_16x16x32_bf16 v[20:23], a[32:35], a[0:3], v[20:23]
  ds_read_b64_tr_b16 a[96:97], v248 offset:16384
  v_mfma_f32_16x16x32_bf16 v[24:27], a[36:39], a[0:3], v[24:27]
  v_mfma_f32_16x16x32_bf16 v[28:31], a[40:43], a[0:3], v[28:31]
  ds_read_b64_tr_b16 a[98:99], v248 offset:17408
  s_add_u32 m0, s33, 0
  v_mfma_f32_16x16x32_bf16 v[32:35], a[44:47], a[0:3], v[32:35]
  v_mfma_f32_16x16x32_bf16 v[48:51], a[44:47], a[4:7], v[48:51]
  ds_read_b64_tr_b16 a[100:101], v249 offset:16384
  v_mfma_f32_16x16x32_bf16 v[44:47], a[40:43], a[4:7], v[44:47]
  v_mfma_f32_16x16x32_bf16 v[40:43], a[36:39], a[4:7], v[40:43]
  buffer_load_dwordx4 v244, s[8:11], s27 offen offset:0 sc1 lds
  v_mfma_f32_16x16x32_bf16 v[36:39], a[32:35], a[4:7], v[36:39]
  ds_read_b64_tr_b16 a[102:103], v249 offset:17408
  v_mfma_f32_16x16x32_bf16 v[52:55], a[32:35], a[8:11], v[52:55]
  v_mfma_f32_16x16x32_bf16 v[56:59], a[36:39], a[8:11], v[56:59]
  ds_read_b64_tr_b16 a[104:105], v250 offset:16384
  v_mfma_f32_16x16x32_bf16 v[60:63], a[40:43], a[8:11], v[60:63]
  v_mfma_f32_16x16x32_bf16 v[64:67], a[44:47], a[8:11], v[64:67]
  buffer_load_dwordx4 v245, s[8:11], s27 offen offset:1024 sc1 lds
  v_mfma_f32_16x16x32_bf16 v[80:83], a[44:47], a[12:15], v[80:83]
  ds_read_b64_tr_b16 a[106:107], v250 offset:17408
  s_waitcnt vmcnt(8)
  v_add_f32 v222, v222, v226
  v_add_f32 v230, v230, v234
  v_add_f32 v222, v222, v230
  v_mfma_f32_16x16x32_bf16 v[76:79], a[40:43], a[12:15], v[76:79]
  ds_read_b64_tr_b16 a[108:109], v251 offset:16384
  v_add_f32 v223, v223, v227
  v_mfma_f32_16x16x32_bf16 v[72:75], a[36:39], a[12:15], v[72:75]
  v_add_f32 v231, v231, v235
  v_add_f32 v223, v223, v231
  v_add_f32 v224, v224, v228
  v_add_f32 v232, v232, v236
  v_add_f32 v224, v224, v232
  v_mfma_f32_16x16x32_bf16 v[68:71], a[32:35], a[12:15], v[68:71]
  ds_read_b64_tr_b16 a[110:111], v251 offset:17408
  v_add_f32 v225, v225, v229
  v_mfma_f32_16x16x32_bf16 v[84:87], a[32:35], a[16:19], v[84:87]
  v_add_f32 v233, v233, v237
  v_add_f32 v225, v225, v233
  v_mfma_f32_16x16x32_bf16 v[88:91], a[36:39], a[16:19], v[88:91]
  v_cvt_pk_bf16_f32 v222, v222, v222
  v_and_b32 v222, 0xffff0000, v222
  v_mfma_f32_16x16x32_bf16 v[92:95], a[40:43], a[16:19], v[92:95]
  ds_read_b64_tr_b16 a[112:113], v248 offset:24576
  v_add_f32 v222, v222, v14
  v_mfma_f32_16x16x32_bf16 v[96:99], a[44:47], a[16:19], v[96:99]
  v_cvt_pk_bf16_f32 v222, v222, v222
  v_and_b32 v222, 0xffff0000, v222
  v_mfma_f32_16x16x32_bf16 v[112:115], a[44:47], a[20:23], v[112:115]
  buffer_load_dwordx4 v246, s[8:11], s27 offen offset:2048 sc1 lds
  v_mfma_f32_16x16x32_bf16 v[108:111], a[40:43], a[20:23], v[108:111]
  ds_read_b64_tr_b16 a[114:115], v248 offset:25600
  v_mul_f32 v222, 0x3e0293ee, v222
  v_mfma_f32_16x16x32_bf16 v[104:107], a[36:39], a[20:23], v[104:107]
  ds_read_b64_tr_b16 a[116:117], v249 offset:24576
  v_cvt_pk_bf16_f32 v223, v223, v223
  v_mfma_f32_16x16x32_bf16 v[100:103], a[32:35], a[20:23], v[100:103]
  v_and_b32 v223, 0xffff0000, v223
  v_add_f32 v223, v223, v14
  v_mfma_f32_16x16x32_bf16 v[116:119], a[32:35], a[24:27], v[116:119]
  ds_read_b64_tr_b16 a[118:119], v249 offset:25600
  v_cvt_pk_bf16_f32 v223, v223, v223
  v_mfma_f32_16x16x32_bf16 v[120:123], a[36:39], a[24:27], v[120:123]
  buffer_load_dwordx4 v247, s[8:11], s27 offen offset:3072 sc1 lds
  v_mfma_f32_16x16x32_bf16 v[124:127], a[40:43], a[24:27], v[124:127]
  v_and_b32 v223, 0xffff0000, v223
  v_mul_f32 v223, 0x3e0293ee, v223
  v_mfma_f32_16x16x32_bf16 v[128:131], a[44:47], a[24:27], v[128:131]
  ds_read_b64_tr_b16 a[120:121], v250 offset:24576
  v_cvt_pk_bf16_f32 v224, v224, v224
  v_mfma_f32_16x16x32_bf16 v[144:147], a[44:47], a[28:31], v[144:147]
  v_and_b32 v224, 0xffff0000, v224
  v_add_f32 v224, v224, v14
  v_mfma_f32_16x16x32_bf16 v[140:143], a[40:43], a[28:31], v[140:143]
  ds_read_b64_tr_b16 a[122:123], v250 offset:25600
  s_add_u32 m0, s29, 0
  v_mfma_f32_16x16x32_bf16 v[136:139], a[36:39], a[28:31], v[136:139]
  v_cvt_pk_bf16_f32 v224, v224, v224
  v_and_b32 v224, 0xffff0000, v224
  v_mfma_f32_16x16x32_bf16 v[132:135], a[32:35], a[28:31], v[132:135]
  ds_read_b64_tr_b16 a[124:125], v251 offset:24576
  v_mul_f32 v224, 0x3e0293ee, v224
  v_mfma_f32_16x16x32_bf16 a[188:191], a[28:31], a[60:63], a[188:191]
  v_cvt_pk_bf16_f32 v225, v225, v225
  v_and_b32 v225, 0xffff0000, v225
  v_mfma_f32_16x16x32_bf16 a[180:183], a[28:31], a[56:59], a[180:183]
  buffer_load_dwordx4 v8, s[4:7], s25 offen offset:0 sc1 lds
  v_mfma_f32_16x16x32_bf16 a[172:175], a[28:31], a[52:55], a[172:175]
  ds_read_b64_tr_b16 a[126:127], v251 offset:25600
  v_add_f32 v225, v225, v14
  v_mfma_f32_16x16x32_bf16 a[164:167], a[28:31], a[48:51], a[164:167]
  v_cvt_pk_bf16_f32 v225, v225, v225
  v_and_b32 v225, 0xffff0000, v225
  v_mfma_f32_16x16x32_bf16 a[160:163], a[24:27], a[48:51], a[160:163]
  ds_read_b128 a[64:67], v252 offset:16384
  v_mul_f32 v225, 0x3e0293ee, v225
  v_mfma_f32_16x16x32_bf16 a[168:171], a[24:27], a[52:55], a[168:171]
  buffer_load_dwordx4 v9, s[4:7], s25 offen offset:1024 sc1 lds
  v_mfma_f32_16x16x32_bf16 a[176:179], a[24:27], a[56:59], a[176:179]
  ds_read_b128 a[68:71], v252 offset:17408
  s_lshl_b32 s46, s20, 10
  v_mfma_f32_16x16x32_bf16 a[184:187], a[24:27], a[60:63], a[184:187]
  s_add_u32 s46, s46, 0x20800
  v_add_u32 v12, s46, v4
  v_mfma_f32_16x16x32_bf16 a[156:159], a[20:23], a[60:63], a[156:159]
  ds_read_b128 a[72:75], v252 offset:18432
  ds_write_b128 v12, v[222:225]
  v_mfma_f32_16x16x32_bf16 a[148:151], a[20:23], a[56:59], a[148:151]
  buffer_load_dwordx4 v10, s[4:7], s25 offen offset:2048 sc1 lds
  v_mfma_f32_16x16x32_bf16 a[140:143], a[20:23], a[52:55], a[140:143]
  ds_read_b128 a[76:79], v252 offset:19456
  v_lshrrev_b32 v12, 5, v1
  v_mfma_f32_16x16x32_bf16 a[132:135], a[20:23], a[48:51], a[132:135]
  v_lshlrev_b32 v12, 7, v12
  v_bfe_u32 v16, v1, 3, 2
  v_mfma_f32_16x16x32_bf16 a[128:131], a[16:19], a[48:51], a[128:131]
  v_lshl_add_u32 v12, v16, 5, v12
  v_add_u32 v12, s46, v12
  v_mfma_f32_16x16x32_bf16 a[136:139], a[16:19], a[52:55], a[136:139]
  ds_read_b128 a[80:83], v252 offset:20480
  v_add_f32 v238, v238, v239
  v_mfma_f32_16x16x32_bf16 a[144:147], a[16:19], a[56:59], a[144:147]
  buffer_load_dwordx4 v11, s[4:7], s25 offen offset:3072 sc1 lds
  v_mfma_f32_16x16x32_bf16 a[152:155], a[16:19], a[60:63], a[152:155]
  ds_read_b128 a[84:87], v252 offset:21504
  v_add_f32 v240, v240, v241
  v_mfma_f32_16x16x32_bf16 v[208:211], a[12:15], a[60:63], v[208:211]
  v_add_f32 v238, v238, v240
  v_cvt_pk_bf16_f32 v238, v238, v238
  v_mfma_f32_16x16x32_bf16 v[200:203], a[12:15], a[56:59], v[200:203]
  ds_read_b128 a[88:91], v252 offset:22528
  v_and_b32 v238, 0xffff0000, v238
  v_mfma_f32_16x16x32_bf16 v[192:195], a[12:15], a[52:55], v[192:195]
  s_add_u32 s27, s27, 0x40000
  v_mfma_f32_16x16x32_bf16 v[184:187], a[12:15], a[48:51], v[184:187]
  ds_read_b128 a[92:95], v252 offset:23552
  v_mfma_f32_16x16x32_bf16 v[180:183], a[8:11], a[48:51], v[180:183]
  v_mfma_f32_16x16x32_bf16 v[188:191], a[8:11], a[52:55], v[188:191]
  v_mfma_f32_16x16x32_bf16 v[196:199], a[8:11], a[56:59], v[196:199]
  v_mfma_f32_16x16x32_bf16 v[204:207], a[8:11], a[60:63], v[204:207]
  s_add_u32 s25, s25, 64
  v_mfma_f32_16x16x32_bf16 v[176:179], a[4:7], a[60:63], v[176:179]
  v_mfma_f32_16x16x32_bf16 v[168:171], a[4:7], a[56:59], v[168:171]
  v_mfma_f32_16x16x32_bf16 v[160:163], a[4:7], a[52:55], v[160:163]
  v_mfma_f32_16x16x32_bf16 v[152:155], a[4:7], a[48:51], v[152:155]
  v_mfma_f32_16x16x32_bf16 v[148:151], a[0:3], a[48:51], v[148:151]
  v_mfma_f32_16x16x32_bf16 v[156:159], a[0:3], a[52:55], v[156:159]
  v_mfma_f32_16x16x32_bf16 v[164:167], a[0:3], a[56:59], v[164:167]
  s_waitcnt lgkmcnt(0)
  s_barrier
  v_mfma_f32_16x16x32_bf16 v[172:175], a[0:3], a[60:63], v[172:175]
  v_mfma_f32_16x16x32_bf16 v[20:23], a[96:99], a[64:67], v[20:23]
  ds_read_b128 v[222:225], v12 offset:0
  ds_read_b128 v[226:229], v12 offset:16
  v_mfma_f32_16x16x32_bf16 v[24:27], a[100:103], a[64:67], v[24:27]
  ds_read_b128 v[230:233], v12 offset:512
  ds_read_b128 v[234:237], v12 offset:528
  v_mfma_f32_16x16x32_bf16 v[28:31], a[104:107], a[64:67], v[28:31]
  ds_read_b64_tr_b16 a[32:33], v248 offset:32768
  ds_read_b64_tr_b16 a[34:35], v248 offset:33792
  v_mfma_f32_16x16x32_bf16 v[32:35], a[108:111], a[64:67], v[32:35]
  s_add_u32 m0, s33, 16384
  v_mfma_f32_16x16x32_bf16 v[48:51], a[108:111], a[68:71], v[48:51]
  ds_read_b64_tr_b16 a[36:37], v249 offset:32768
  v_mfma_f32_16x16x32_bf16 v[44:47], a[104:107], a[68:71], v[44:47]
  v_mfma_f32_16x16x32_bf16 v[40:43], a[100:103], a[68:71], v[40:43]
  buffer_load_dwordx4 v244, s[8:11], s27 offen offset:0 sc1 lds
  v_mfma_f32_16x16x32_bf16 v[36:39], a[96:99], a[68:71], v[36:39]
  ds_read_b64_tr_b16 a[38:39], v249 offset:33792
  v_mfma_f32_16x16x32_bf16 v[52:55], a[96:99], a[72:75], v[52:55]
  s_waitcnt lgkmcnt(4)
  v_lshlrev_b32 v16, 16, v212
  v_mfma_f32_16x16x32_bf16 v[56:59], a[100:103], a[72:75], v[56:59]
  ds_read_b64_tr_b16 a[40:41], v250 offset:32768
  v_and_b32 v17, 0xffff0000, v212
  v_mfma_f32_16x16x32_bf16 v[60:63], a[104:107], a[72:75], v[60:63]
  v_fma_f32 v16, v16, v221, v220
  v_fma_f32 v17, v17, v221, v220
  v_mfma_f32_16x16x32_bf16 v[64:67], a[108:111], a[72:75], v[64:67]
  ds_read_b64_tr_b16 a[42:43], v250 offset:33792
  v_fma_f32 v16, v16, v230, v222
  v_mfma_f32_16x16x32_bf16 v[80:83], a[108:111], a[76:79], v[80:83]
  v_fma_f32 v17, v17, v231, v223
  v_cvt_pk_bf16_f32 v212, v16, v17
  v_mfma_f32_16x16x32_bf16 v[76:79], a[104:107], a[76:79], v[76:79]
  ds_read_b64_tr_b16 a[44:45], v251 offset:32768
  v_lshlrev_b32 v16, 16, v213
  v_mfma_f32_16x16x32_bf16 v[72:75], a[100:103], a[76:79], v[72:75]
  v_and_b32 v17, 0xffff0000, v213
  v_fma_f32 v16, v16, v221, v220
  v_mfma_f32_16x16x32_bf16 v[68:71], a[96:99], a[76:79], v[68:71]
  ds_read_b64_tr_b16 a[46:47], v251 offset:33792
  v_fma_f32 v17, v17, v221, v220
  v_mfma_f32_16x16x32_bf16 v[84:87], a[96:99], a[80:83], v[84:87]
  v_fma_f32 v16, v16, v232, v224
  v_fma_f32 v17, v17, v233, v225
  v_mfma_f32_16x16x32_bf16 v[88:91], a[100:103], a[80:83], v[88:91]
  v_cvt_pk_bf16_f32 v213, v16, v17
  v_lshlrev_b32 v16, 16, v214
  v_mfma_f32_16x16x32_bf16 v[92:95], a[104:107], a[80:83], v[92:95]
  buffer_load_dwordx4 v245, s[8:11], s27 offen offset:1024 sc1 lds
  v_mfma_f32_16x16x32_bf16 v[96:99], a[108:111], a[80:83], v[96:99]
  ds_read_b64_tr_b16 a[48:49], v248 offset:40960
  v_and_b32 v17, 0xffff0000, v214
  v_mfma_f32_16x16x32_bf16 v[112:115], a[108:111], a[84:87], v[112:115]
  ds_read_b64_tr_b16 a[50:51], v248 offset:41984
  v_fma_f32 v16, v16, v221, v220
  v_mfma_f32_16x16x32_bf16 v[108:111], a[104:107], a[84:87], v[108:111]
  v_fma_f32 v17, v17, v221, v220
  v_fma_f32 v16, v16, v234, v226
  v_mfma_f32_16x16x32_bf16 v[104:107], a[100:103], a[84:87], v[104:107]
  ds_read_b64_tr_b16 a[52:53], v249 offset:40960
  v_fma_f32 v17, v17, v235, v227
  v_mfma_f32_16x16x32_bf16 v[100:103], a[96:99], a[84:87], v[100:103]
  v_cvt_pk_bf16_f32 v214, v16, v17
  v_lshlrev_b32 v16, 16, v215
  v_mfma_f32_16x16x32_bf16 v[116:119], a[96:99], a[88:91], v[116:119]
  buffer_load_dwordx4 v246, s[8:11], s27 offen offset:2048 sc1 lds
  v_and_b32 v17, 0xffff0000, v215
  v_mfma_f32_16x16x32_bf16 v[120:123], a[100:103], a[88:91], v[120:123]
  ds_read_b64_tr_b16 a[54:55], v249 offset:41984
  v_fma_f32 v16, v16, v221, v220
  v_mfma_f32_16x16x32_bf16 v[124:127], a[104:107], a[88:91], v[124:127]
  v_fma_f32 v17, v17, v221, v220
  v_fma_f32 v16, v16, v236, v228
  v_mfma_f32_16x16x32_bf16 v[128:131], a[108:111], a[88:91], v[128:131]
  ds_read_b64_tr_b16 a[56:57], v250 offset:40960
  v_fma_f32 v17, v17, v237, v229
  v_mfma_f32_16x16x32_bf16 v[144:147], a[108:111], a[92:95], v[144:147]
  v_cvt_pk_bf16_f32 v215, v16, v17
  s_lshr_b32 s46, s2, 1
  v_mfma_f32_16x16x32_bf16 v[140:143], a[104:107], a[92:95], v[140:143]
  buffer_load_dwordx4 v247, s[8:11], s27 offen offset:3072 sc1 lds
  s_lshl_b32 s46, s46, 14
  v_mfma_f32_16x16x32_bf16 v[136:139], a[100:103], a[92:95], v[136:139]
  ds_read_b64_tr_b16 a[58:59], v250 offset:41984
  s_and_b32 s47, s2, 1
  v_mfma_f32_16x16x32_bf16 v[132:135], a[96:99], a[92:95], v[132:135]
  ds_read_b64_tr_b16 a[60:61], v251 offset:40960
  s_lshl_b32 s47, s47, 7
  v_mfma_f32_16x16x32_bf16 a[188:191], a[92:95], a[124:127], a[188:191]
  s_add_u32 s46, s46, s47
  s_add_u32 s47, s46, 0x3000000
  v_mfma_f32_16x16x32_bf16 a[180:183], a[92:95], a[120:123], a[180:183]
  buffer_store_dwordx4 v[212:215], v7, s[12:15], s47 offen offset:0 sc1
  s_add_u32 m0, s29, 16384
  v_mfma_f32_16x16x32_bf16 a[172:175], a[92:95], a[116:119], a[172:175]
  ds_read_b128 v[222:225], v12 offset:256
  ds_read_b128 v[226:229], v12 offset:272
  v_mfma_f32_16x16x32_bf16 a[164:167], a[92:95], a[112:115], a[164:167]
  ds_read_b128 v[230:233], v12 offset:768
  ds_read_b128 v[234:237], v12 offset:784
  v_mfma_f32_16x16x32_bf16 a[160:163], a[88:91], a[112:115], a[160:163]
  buffer_load_dwordx4 v8, s[4:7], s25 offen offset:0 sc1 lds
  v_mfma_f32_16x16x32_bf16 a[168:171], a[88:91], a[116:119], a[168:171]
  ds_read_b64_tr_b16 a[62:63], v251 offset:41984
  s_waitcnt lgkmcnt(1)
  v_mfma_f32_16x16x32_bf16 a[176:179], a[88:91], a[120:123], a[176:179]
  ds_read_b128 a[0:3], v252 offset:32768
  v_lshlrev_b32 v16, 16, v216
  v_and_b32 v17, 0xffff0000, v216
  v_mfma_f32_16x16x32_bf16 a[184:187], a[88:91], a[124:127], a[184:187]
  ds_read_b128 a[4:7], v252 offset:33792
  v_fma_f32 v16, v16, v221, v220
  v_mfma_f32_16x16x32_bf16 a[156:159], a[84:87], a[124:127], a[156:159]
  ds_read_b128 a[8:11], v252 offset:34816
  v_fma_f32 v17, v17, v221, v220
  v_fma_f32 v16, v16, v230, v222
  v_mfma_f32_16x16x32_bf16 a[148:151], a[84:87], a[120:123], a[148:151]
  v_fma_f32 v17, v17, v231, v223
  v_cvt_pk_bf16_f32 v216, v16, v17
  v_mfma_f32_16x16x32_bf16 a[140:143], a[84:87], a[116:119], a[140:143]
  ds_read_b128 a[12:15], v252 offset:35840
  v_lshlrev_b32 v16, 16, v217
  v_mfma_f32_16x16x32_bf16 a[132:135], a[84:87], a[112:115], a[132:135]
  buffer_load_dwordx4 v9, s[4:7], s25 offen offset:1024 sc1 lds
  v_and_b32 v17, 0xffff0000, v217
  v_mfma_f32_16x16x32_bf16 a[128:131], a[80:83], a[112:115], a[128:131]
  v_fma_f32 v16, v16, v221, v220
  v_fma_f32 v17, v17, v221, v220
  v_mfma_f32_16x16x32_bf16 a[136:139], a[80:83], a[116:119], a[136:139]
  ds_read_b128 a[16:19], v252 offset:36864
  v_fma_f32 v16, v16, v232, v224
  v_mfma_f32_16x16x32_bf16 a[144:147], a[80:83], a[120:123], a[144:147]
  v_fma_f32 v17, v17, v233, v225
  v_cvt_pk_bf16_f32 v217, v16, v17
  v_mfma_f32_16x16x32_bf16 a[152:155], a[80:83], a[124:127], a[152:155]
  buffer_load_dwordx4 v10, s[4:7], s25 offen offset:2048 sc1 lds
  v_mfma_f32_16x16x32_bf16 v[208:211], a[76:79], a[124:127], v[208:211]
  ds_read_b128 a[20:23], v252 offset:37888
  v_lshlrev_b32 v16, 16, v218
  v_and_b32 v17, 0xffff0000, v218
  v_mfma_f32_16x16x32_bf16 v[200:203], a[76:79], a[120:123], v[200:203]
  ds_read_b128 a[24:27], v252 offset:38912
  v_fma_f32 v16, v16, v221, v220
  v_mfma_f32_16x16x32_bf16 v[192:195], a[76:79], a[116:119], v[192:195]
  v_fma_f32 v17, v17, v221, v220
  v_fma_f32 v16, v16, v234, v226
  v_mfma_f32_16x16x32_bf16 v[184:187], a[76:79], a[112:115], v[184:187]
  ds_read_b128 a[28:31], v252 offset:39936
  v_fma_f32 v17, v17, v235, v227
  v_mfma_f32_16x16x32_bf16 v[180:183], a[72:75], a[112:115], v[180:183]
  v_cvt_pk_bf16_f32 v218, v16, v17
  v_lshlrev_b32 v16, 16, v219
  v_mfma_f32_16x16x32_bf16 v[188:191], a[72:75], a[116:119], v[188:191]
  buffer_load_dwordx4 v11, s[4:7], s25 offen offset:3072 sc1 lds
  v_and_b32 v17, 0xffff0000, v219
  v_mfma_f32_16x16x32_bf16 v[196:199], a[72:75], a[120:123], v[196:199]
  v_fma_f32 v16, v16, v221, v220
  v_fma_f32 v17, v17, v221, v220
  v_mfma_f32_16x16x32_bf16 v[204:207], a[72:75], a[124:127], v[204:207]
  v_fma_f32 v16, v16, v236, v228
  v_fma_f32 v17, v17, v237, v229
  v_mfma_f32_16x16x32_bf16 v[176:179], a[68:71], a[124:127], v[176:179]
  v_cvt_pk_bf16_f32 v219, v16, v17
  s_add_u32 s27, s27, 0x40000
  v_mfma_f32_16x16x32_bf16 v[168:171], a[68:71], a[120:123], v[168:171]
  buffer_store_dwordx4 v[216:219], v7, s[12:15], s47 offen offset:2048 sc1
  v_mfma_f32_16x16x32_bf16 v[160:163], a[68:71], a[116:119], v[160:163]
  s_add_u32 s25, s25, 64
  v_mfma_f32_16x16x32_bf16 v[152:155], a[68:71], a[112:115], v[152:155]
  v_mfma_f32_16x16x32_bf16 v[148:151], a[64:67], a[112:115], v[148:151]
  v_mfma_f32_16x16x32_bf16 v[156:159], a[64:67], a[116:119], v[156:159]
  v_mfma_f32_16x16x32_bf16 v[164:167], a[64:67], a[120:123], v[164:167]
  s_waitcnt vmcnt(18) lgkmcnt(0)
  s_barrier
  v_mfma_f32_16x16x32_bf16 v[172:175], a[64:67], a[124:127], v[172:175]
  v_mfma_f32_16x16x32_bf16 v[20:23], a[32:35], a[0:3], v[20:23]
  ds_read_b64_tr_b16 a[96:97], v248 offset:49152
  s_lshl_b32 s46, s20, 6
  v_mfma_f32_16x16x32_bf16 v[24:27], a[36:39], a[0:3], v[24:27]
  v_add_u32 v241, s46, v1
  v_lshrrev_b32 v241, 3, v241
  v_min_u32 v241, 1, v241
  v_mfma_f32_16x16x32_bf16 v[28:31], a[40:43], a[0:3], v[28:31]
  ds_read_b64_tr_b16 a[98:99], v248 offset:50176
  s_add_u32 m0, s33, 32768
  v_mfma_f32_16x16x32_bf16 v[32:35], a[44:47], a[0:3], v[32:35]
  v_lshlrev_b32 v241, 28, v241
  v_add_u32 v15, v15, v241
  v_mfma_f32_16x16x32_bf16 v[48:51], a[44:47], a[4:7], v[48:51]
  ds_read_b64_tr_b16 a[100:101], v249 offset:49152
  s_mov_b32 s46, 0x3e10000
  v_mfma_f32_16x16x32_bf16 v[44:47], a[40:43], a[4:7], v[44:47]
  buffer_store_dword v238, v15, s[12:15], s46 offen sc1
  v_mfma_f32_16x16x32_bf16 v[40:43], a[36:39], a[4:7], v[40:43]
  ds_read_b64_tr_b16 a[102:103], v249 offset:50176
  v_bfe_u32 v239, v13, 5, 4
  v_mfma_f32_16x16x32_bf16 v[36:39], a[32:35], a[4:7], v[36:39]
  buffer_load_dwordx4 v244, s[8:11], s27 offen offset:0 sc1 lds
  v_mfma_f32_16x16x32_bf16 v[52:55], a[32:35], a[8:11], v[52:55]
  v_lshl_add_u32 v241, v239, 10, v241
  v_bfe_u32 v239, v13, 2, 2
  v_mfma_f32_16x16x32_bf16 v[56:59], a[36:39], a[8:11], v[56:59]
  ds_read_b64_tr_b16 a[104:105], v250 offset:49152
  v_lshl_add_u32 v241, v239, 8, v241
  v_mfma_f32_16x16x32_bf16 v[60:63], a[40:43], a[8:11], v[60:63]
  v_bfe_u32 v239, v13, 4, 1
  v_lshl_add_u32 v241, v239, 3, v241
  v_mfma_f32_16x16x32_bf16 v[64:67], a[44:47], a[8:11], v[64:67]
  ds_read_b64_tr_b16 a[106:107], v250 offset:50176
  v_and_b32 v239, 3, v13
  v_mfma_f32_16x16x32_bf16 v[80:83], a[44:47], a[12:15], v[80:83]
  buffer_load_dwordx4 v245, s[8:11], s27 offen offset:1024 sc1 lds
  v_mfma_f32_16x16x32_bf16 v[76:79], a[40:43], a[12:15], v[76:79]
  ds_read_b64_tr_b16 a[108:109], v251 offset:49152
  v_lshl_add_u32 v241, v239, 1, v241
  v_mfma_f32_16x16x32_bf16 v[72:75], a[36:39], a[12:15], v[72:75]
  v_add_f32 v238, s60, v238
  v_mov_b32 v240, 0x3f80
  v_mfma_f32_16x16x32_bf16 v[68:71], a[32:35], a[12:15], v[68:71]
  ds_read_b64_tr_b16 a[110:111], v251 offset:50176
  v_cvt_pk_bf16_f32 v238, v238, v238
  v_mfma_f32_16x16x32_bf16 v[84:87], a[32:35], a[16:19], v[84:87]
  buffer_load_dwordx4 v246, s[8:11], s27 offen offset:2048 sc1 lds
  v_mfma_f32_16x16x32_bf16 v[88:91], a[36:39], a[16:19], v[88:91]
  buffer_store_short v240, v241, s[12:15], s61 offen offset:32 sc1
  v_mfma_f32_16x16x32_bf16 v[92:95], a[40:43], a[16:19], v[92:95]
  buffer_store_short v238, v241, s[12:15], s45 offen sc1
  v_mfma_f32_16x16x32_bf16 v[96:99], a[44:47], a[16:19], v[96:99]
  ds_read_b64_tr_b16 a[112:113], v248 offset:57344
  v_and_b32 v240, 7, v1
  v_mfma_f32_16x16x32_bf16 v[112:115], a[44:47], a[20:23], v[112:115]
  ds_read_b64_tr_b16 a[114:115], v248 offset:58368
  v_lshlrev_b32 v240, 4, v240
  v_mfma_f32_16x16x32_bf16 v[108:111], a[40:43], a[20:23], v[108:111]
  buffer_load_dwordx4 v247, s[8:11], s27 offen offset:3072 sc1 lds
  v_mfma_f32_16x16x32_bf16 v[104:107], a[36:39], a[20:23], v[104:107]
  ds_read_b64_tr_b16 a[116:117], v249 offset:57344
  s_lshl_b32 s46, s21, 7
  v_mfma_f32_16x16x32_bf16 v[100:103], a[32:35], a[20:23], v[100:103]
  s_add_u32 s46, s46, 0x3f06000
  v_mfma_f32_16x16x32_bf16 v[116:119], a[32:35], a[24:27], v[116:119]
  ds_read_b64_tr_b16 a[118:119], v249 offset:58368
  v_mfma_f32_16x16x32_bf16 v[120:123], a[36:39], a[24:27], v[120:123]
  v_mfma_f32_16x16x32_bf16 v[124:127], a[40:43], a[24:27], v[124:127]
  s_add_u32 m0, s29, 32768
  v_mfma_f32_16x16x32_bf16 v[128:131], a[44:47], a[24:27], v[128:131]
  ds_read_b64_tr_b16 a[120:121], v250 offset:57344
  v_mfma_f32_16x16x32_bf16 v[144:147], a[44:47], a[28:31], v[144:147]
  v_mfma_f32_16x16x32_bf16 v[140:143], a[40:43], a[28:31], v[140:143]
  ds_read_b64_tr_b16 a[122:123], v250 offset:58368
  v_mfma_f32_16x16x32_bf16 v[136:139], a[36:39], a[28:31], v[136:139]
  v_mfma_f32_16x16x32_bf16 v[132:135], a[32:35], a[28:31], v[132:135]
  buffer_load_dwordx4 v8, s[4:7], s25 offen offset:0 sc1 lds
  v_mfma_f32_16x16x32_bf16 a[188:191], a[28:31], a[60:63], a[188:191]
  ds_read_b64_tr_b16 a[124:125], v251 offset:57344
  v_mfma_f32_16x16x32_bf16 a[180:183], a[28:31], a[56:59], a[180:183]
  ds_read_b64_tr_b16 a[126:127], v251 offset:58368
  v_mfma_f32_16x16x32_bf16 a[172:175], a[28:31], a[52:55], a[172:175]
  v_mfma_f32_16x16x32_bf16 a[164:167], a[28:31], a[48:51], a[164:167]
  buffer_load_dwordx4 v9, s[4:7], s25 offen offset:1024 sc1 lds
  v_mfma_f32_16x16x32_bf16 a[160:163], a[24:27], a[48:51], a[160:163]
  ds_read_b128 a[64:67], v252 offset:49152
  v_mfma_f32_16x16x32_bf16 a[168:171], a[24:27], a[52:55], a[168:171]
  v_mfma_f32_16x16x32_bf16 a[176:179], a[24:27], a[56:59], a[176:179]
  ds_read_b128 a[68:71], v252 offset:50176
  v_mfma_f32_16x16x32_bf16 a[184:187], a[24:27], a[60:63], a[184:187]
  v_mfma_f32_16x16x32_bf16 a[156:159], a[20:23], a[60:63], a[156:159]
  buffer_load_dwordx4 v10, s[4:7], s25 offen offset:2048 sc1 lds
  v_mfma_f32_16x16x32_bf16 a[148:151], a[20:23], a[56:59], a[148:151]
  ds_read_b128 a[72:75], v252 offset:51200
  v_mfma_f32_16x16x32_bf16 a[140:143], a[20:23], a[52:55], a[140:143]
  ds_read_b128 a[76:79], v252 offset:52224
  v_mfma_f32_16x16x32_bf16 a[132:135], a[20:23], a[48:51], a[132:135]
  v_mfma_f32_16x16x32_bf16 a[128:131], a[16:19], a[48:51], a[128:131]
  v_mfma_f32_16x16x32_bf16 a[136:139], a[16:19], a[52:55], a[136:139]
  buffer_load_dwordx4 v11, s[4:7], s25 offen offset:3072 sc1 lds
  v_mfma_f32_16x16x32_bf16 a[144:147], a[16:19], a[56:59], a[144:147]
  ds_read_b128 a[80:83], v252 offset:53248
  v_mfma_f32_16x16x32_bf16 a[152:155], a[16:19], a[60:63], a[152:155]
  ds_read_b128 a[84:87], v252 offset:54272
  v_mfma_f32_16x16x32_bf16 v[208:211], a[12:15], a[60:63], v[208:211]
  v_mfma_f32_16x16x32_bf16 v[200:203], a[12:15], a[56:59], v[200:203]
  ds_read_b128 a[88:91], v252 offset:55296
  v_mfma_f32_16x16x32_bf16 v[192:195], a[12:15], a[52:55], v[192:195]
  s_add_u32 s27, s27, 0x40000
  v_mfma_f32_16x16x32_bf16 v[184:187], a[12:15], a[48:51], v[184:187]
  ds_read_b128 a[92:95], v252 offset:56320
  v_mfma_f32_16x16x32_bf16 v[180:183], a[8:11], a[48:51], v[180:183]
  v_mfma_f32_16x16x32_bf16 v[188:191], a[8:11], a[52:55], v[188:191]
  v_mfma_f32_16x16x32_bf16 v[196:199], a[8:11], a[56:59], v[196:199]
  v_mfma_f32_16x16x32_bf16 v[204:207], a[8:11], a[60:63], v[204:207]
  s_add_u32 s25, s25, 64
  v_mfma_f32_16x16x32_bf16 v[176:179], a[4:7], a[60:63], v[176:179]
  v_mfma_f32_16x16x32_bf16 v[168:171], a[4:7], a[56:59], v[168:171]
  v_mfma_f32_16x16x32_bf16 v[160:163], a[4:7], a[52:55], v[160:163]
  v_mfma_f32_16x16x32_bf16 v[152:155], a[4:7], a[48:51], v[152:155]
  v_mfma_f32_16x16x32_bf16 v[148:151], a[0:3], a[48:51], v[148:151]
  v_mfma_f32_16x16x32_bf16 v[156:159], a[0:3], a[52:55], v[156:159]
  v_mfma_f32_16x16x32_bf16 v[164:167], a[0:3], a[56:59], v[164:167]
  s_waitcnt vmcnt(21) lgkmcnt(0)
  s_barrier
  v_mfma_f32_16x16x32_bf16 v[172:175], a[0:3], a[60:63], v[172:175]
  v_mfma_f32_16x16x32_bf16 v[20:23], a[96:99], a[64:67], v[20:23]
  buffer_load_dwordx2 v[242:243], v240, s[12:15], s46 offen sc1
  v_mfma_f32_16x16x32_bf16 v[24:27], a[100:103], a[64:67], v[24:27]
  ds_read_b64_tr_b16 a[32:33], v248 offset:0
  v_mfma_f32_16x16x32_bf16 v[28:31], a[104:107], a[64:67], v[28:31]
  ds_read_b64_tr_b16 a[34:35], v248 offset:1024
  s_add_u32 m0, s33, 49152
  v_mfma_f32_16x16x32_bf16 v[32:35], a[108:111], a[64:67], v[32:35]
  v_mfma_f32_16x16x32_bf16 v[48:51], a[108:111], a[68:71], v[48:51]
  ds_read_b64_tr_b16 a[36:37], v249 offset:0
  v_mfma_f32_16x16x32_bf16 v[44:47], a[104:107], a[68:71], v[44:47]
  v_mfma_f32_16x16x32_bf16 v[40:43], a[100:103], a[68:71], v[40:43]
  buffer_load_dwordx4 v244, s[8:11], s27 offen offset:0 sc1 lds
  v_mfma_f32_16x16x32_bf16 v[36:39], a[96:99], a[68:71], v[36:39]
  ds_read_b64_tr_b16 a[38:39], v249 offset:1024
  v_mfma_f32_16x16x32_bf16 v[52:55], a[96:99], a[72:75], v[52:55]
  v_mfma_f32_16x16x32_bf16 v[56:59], a[100:103], a[72:75], v[56:59]
  ds_read_b64_tr_b16 a[40:41], v250 offset:0
  v_mfma_f32_16x16x32_bf16 v[60:63], a[104:107], a[72:75], v[60:63]
  v_mfma_f32_16x16x32_bf16 v[64:67], a[108:111], a[72:75], v[64:67]
  buffer_load_dwordx4 v245, s[8:11], s27 offen offset:1024 sc1 lds
  v_mfma_f32_16x16x32_bf16 v[80:83], a[108:111], a[76:79], v[80:83]
  ds_read_b64_tr_b16 a[42:43], v250 offset:1024
  v_mfma_f32_16x16x32_bf16 v[76:79], a[104:107], a[76:79], v[76:79]
  ds_read_b64_tr_b16 a[44:45], v251 offset:0
  v_mfma_f32_16x16x32_bf16 v[72:75], a[100:103], a[76:79], v[72:75]
  v_mfma_f32_16x16x32_bf16 v[68:71], a[96:99], a[76:79], v[68:71]
  ds_read_b64_tr_b16 a[46:47], v251 offset:1024
  v_mfma_f32_16x16x32_bf16 v[84:87], a[96:99], a[80:83], v[84:87]
  buffer_load_dwordx4 v246, s[8:11], s27 offen offset:2048 sc1 lds
  v_mfma_f32_16x16x32_bf16 v[88:91], a[100:103], a[80:83], v[88:91]
  v_mfma_f32_16x16x32_bf16 v[92:95], a[104:107], a[80:83], v[92:95]
  ds_read_b64_tr_b16 a[48:49], v248 offset:8192
  v_mfma_f32_16x16x32_bf16 v[96:99], a[108:111], a[80:83], v[96:99]
  v_mfma_f32_16x16x32_bf16 v[112:115], a[108:111], a[84:87], v[112:115]
  ds_read_b64_tr_b16 a[50:51], v248 offset:9216
  v_mfma_f32_16x16x32_bf16 v[108:111], a[104:107], a[84:87], v[108:111]
  buffer_load_dwordx4 v247, s[8:11], s27 offen offset:3072 sc1 lds
  v_mfma_f32_16x16x32_bf16 v[104:107], a[100:103], a[84:87], v[104:107]
  ds_read_b64_tr_b16 a[52:53], v249 offset:8192
  v_mfma_f32_16x16x32_bf16 v[100:103], a[96:99], a[84:87], v[100:103]
  v_mfma_f32_16x16x32_bf16 v[116:119], a[96:99], a[88:91], v[116:119]
  ds_read_b64_tr_b16 a[54:55], v249 offset:9216
  v_mfma_f32_16x16x32_bf16 v[120:123], a[100:103], a[88:91], v[120:123]
  v_mfma_f32_16x16x32_bf16 v[124:127], a[104:107], a[88:91], v[124:127]
  s_add_u32 m0, s29, 49152
  v_mfma_f32_16x16x32_bf16 v[128:131], a[108:111], a[88:91], v[128:131]
  ds_read_b64_tr_b16 a[56:57], v250 offset:8192
  v_mfma_f32_16x16x32_bf16 v[144:147], a[108:111], a[92:95], v[144:147]
  v_mfma_f32_16x16x32_bf16 v[140:143], a[104:107], a[92:95], v[140:143]
  ds_read_b64_tr_b16 a[58:59], v250 offset:9216
  v_mfma_f32_16x16x32_bf16 v[136:139], a[100:103], a[92:95], v[136:139]
  v_mfma_f32_16x16x32_bf16 v[132:135], a[96:99], a[92:95], v[132:135]
  buffer_load_dwordx4 v8, s[4:7], s25 offen offset:0 sc1 lds
  v_mfma_f32_16x16x32_bf16 a[188:191], a[92:95], a[124:127], a[188:191]
  ds_read_b64_tr_b16 a[60:61], v251 offset:8192
  v_mfma_f32_16x16x32_bf16 a[180:183], a[92:95], a[120:123], a[180:183]
  ds_read_b64_tr_b16 a[62:63], v251 offset:9216
  v_mfma_f32_16x16x32_bf16 a[172:175], a[92:95], a[116:119], a[172:175]
  v_mfma_f32_16x16x32_bf16 a[164:167], a[92:95], a[112:115], a[164:167]
  buffer_load_dwordx4 v9, s[4:7], s25 offen offset:1024 sc1 lds
  v_mfma_f32_16x16x32_bf16 a[160:163], a[88:91], a[112:115], a[160:163]
  ds_read_b128 a[0:3], v252 offset:0
  v_mfma_f32_16x16x32_bf16 a[168:171], a[88:91], a[116:119], a[168:171]
  v_mfma_f32_16x16x32_bf16 a[176:179], a[88:91], a[120:123], a[176:179]
  ds_read_b128 a[4:7], v252 offset:1024
  v_mfma_f32_16x16x32_bf16 a[184:187], a[88:91], a[124:127], a[184:187]
  v_mfma_f32_16x16x32_bf16 a[156:159], a[84:87], a[124:127], a[156:159]
  buffer_load_dwordx4 v10, s[4:7], s25 offen offset:2048 sc1 lds
  v_mfma_f32_16x16x32_bf16 a[148:151], a[84:87], a[120:123], a[148:151]
  ds_read_b128 a[8:11], v252 offset:2048
  v_mfma_f32_16x16x32_bf16 a[140:143], a[84:87], a[116:119], a[140:143]
  ds_read_b128 a[12:15], v252 offset:3072
  v_mfma_f32_16x16x32_bf16 a[132:135], a[84:87], a[112:115], a[132:135]
  v_mfma_f32_16x16x32_bf16 a[128:131], a[80:83], a[112:115], a[128:131]
  v_mfma_f32_16x16x32_bf16 a[136:139], a[80:83], a[116:119], a[136:139]
  buffer_load_dwordx4 v11, s[4:7], s25 offen offset:3072 sc1 lds
  v_mfma_f32_16x16x32_bf16 a[144:147], a[80:83], a[120:123], a[144:147]
  ds_read_b128 a[16:19], v252 offset:4096
  v_mfma_f32_16x16x32_bf16 a[152:155], a[80:83], a[124:127], a[152:155]
  ds_read_b128 a[20:23], v252 offset:5120
  v_mfma_f32_16x16x32_bf16 v[208:211], a[76:79], a[124:127], v[208:211]
  v_mfma_f32_16x16x32_bf16 v[200:203], a[76:79], a[120:123], v[200:203]
  ds_read_b128 a[24:27], v252 offset:6144
  v_mfma_f32_16x16x32_bf16 v[192:195], a[76:79], a[116:119], v[192:195]
  s_add_u32 s27, s27, 0x40000
  v_mfma_f32_16x16x32_bf16 v[184:187], a[76:79], a[112:115], v[184:187]
  ds_read_b128 a[28:31], v252 offset:7168
  v_mfma_f32_16x16x32_bf16 v[180:183], a[72:75], a[112:115], v[180:183]
  v_mfma_f32_16x16x32_bf16 v[188:191], a[72:75], a[116:119], v[188:191]
  v_mfma_f32_16x16x32_bf16 v[196:199], a[72:75], a[120:123], v[196:199]
  v_mfma_f32_16x16x32_bf16 v[204:207], a[72:75], a[124:127], v[204:207]
  s_add_u32 s25, s25, 64
  v_mfma_f32_16x16x32_bf16 v[176:179], a[68:71], a[124:127], v[176:179]
  v_mfma_f32_16x16x32_bf16 v[168:171], a[68:71], a[120:123], v[168:171]
  v_mfma_f32_16x16x32_bf16 v[160:163], a[68:71], a[116:119], v[160:163]
  v_mfma_f32_16x16x32_bf16 v[152:155], a[68:71], a[112:115], v[152:155]
  v_mfma_f32_16x16x32_bf16 v[148:151], a[64:67], a[112:115], v[148:151]
  v_mfma_f32_16x16x32_bf16 v[156:159], a[64:67], a[116:119], v[156:159]
  v_mfma_f32_16x16x32_bf16 v[164:167], a[64:67], a[120:123], v[164:167]
  s_waitcnt vmcnt(8) lgkmcnt(0)
  s_barrier
  v_mfma_f32_16x16x32_bf16 v[172:175], a[64:67], a[124:127], v[172:175]
  s_mov_b32 s62, s76
  v_cmp_ne_u64 vcc, s[62:63], v[242:243]
  s_nop 1
  s_cmp_lg_u64 vcc, 0
  s_cselect_b32 s96, 0x10000000, 0
  s_cmp_eq_u32 s20, 0
  s_cselect_b32 s96, s96, 0
  v_mfma_f32_16x16x32_bf16 v[20:23], a[32:35], a[0:3], v[20:23]
  ds_read_b64_tr_b16 a[96:97], v248 offset:16384
  s_lshl_b32 s47, s2, 4
  v_mfma_f32_16x16x32_bf16 v[24:27], a[36:39], a[0:3], v[24:27]
  s_add_u32 s47, s47, 0x3f00000
  v_mov_b32 v230, s76
  v_mov_b32 v231, s77
  v_mfma_f32_16x16x32_bf16 v[28:31], a[40:43], a[0:3], v[28:31]
  ds_read_b64_tr_b16 a[98:99], v248 offset:17408
  s_add_u32 s44, s32, 0
  v_mfma_f32_16x16x32_bf16 v[32:35], a[44:47], a[0:3], v[32:35]
  buffer_store_dwordx2 v[230:231], v0, s[12:15], s47 offen sc1
  v_mfma_f32_16x16x32_bf16 v[48:51], a[44:47], a[4:7], v[48:51]
  ds_read_b64_tr_b16 a[100:101], v249 offset:16384
  v_and_b32 v240, 15, v1
  v_mfma_f32_16x16x32_bf16 v[44:47], a[40:43], a[4:7], v[44:47]
  v_lshlrev_b32 v240, 4, v240
  v_bfe_u32 v241, v1, 4, 1
  v_mfma_f32_16x16x32_bf16 v[40:43], a[36:39], a[4:7], v[40:43]
  ds_read_b64_tr_b16 a[102:103], v249 offset:17408
  s_add_u32 m0, s33, 0
  v_mfma_f32_16x16x32_bf16 v[36:39], a[32:35], a[4:7], v[36:39]
  s_lshl_b32 s50, s22, 9
  s_sub_u32 s51, 3840, s50
  v_mfma_f32_16x16x32_bf16 v[52:55], a[32:35], a[8:11], v[52:55]
  v_mul_u32_u24 v241, s51, v241
  v_add_u32 v240, v240, v241
  v_mfma_f32_16x16x32_bf16 v[56:59], a[36:39], a[8:11], v[56:59]
  ds_read_b64_tr_b16 a[104:105], v250 offset:16384
  s_lshr_b32 s50, s50, 1
  v_mfma_f32_16x16x32_bf16 v[60:63], a[40:43], a[8:11], v[60:63]
  s_add_u32 s50, s50, 0x3f00000
  v_add_u32 v240, s50, v240
  v_mfma_f32_16x16x32_bf16 v[64:67], a[44:47], a[8:11], v[64:67]
  buffer_load_dwordx4 v244, s[16:19], s44 offen offset:0 sc1 lds
  v_mfma_f32_16x16x32_bf16 v[80:83], a[44:47], a[12:15], v[80:83]
  ds_read_b64_tr_b16 a[106:107], v250 offset:17408
  v_mfma_f32_16x16x32_bf16 v[76:79], a[40:43], a[12:15], v[76:79]
  ds_read_b64_tr_b16 a[108:109], v251 offset:16384
  v_mfma_f32_16x16x32_bf16 v[72:75], a[36:39], a[12:15], v[72:75]
  v_mfma_f32_16x16x32_bf16 v[68:71], a[32:35], a[12:15], v[68:71]
  ds_read_b64_tr_b16 a[110:111], v251 offset:17408
  v_mfma_f32_16x16x32_bf16 v[84:87], a[32:35], a[16:19], v[84:87]
  buffer_load_dwordx4 v245, s[16:19], s44 offen offset:1024 sc1 lds
  v_mfma_f32_16x16x32_bf16 v[88:91], a[36:39], a[16:19], v[88:91]
  v_mfma_f32_16x16x32_bf16 v[92:95], a[40:43], a[16:19], v[92:95]
  ds_read_b64_tr_b16 a[112:113], v248 offset:24576
  v_mfma_f32_16x16x32_bf16 v[96:99], a[44:47], a[16:19], v[96:99]
  v_mfma_f32_16x16x32_bf16 v[112:115], a[44:47], a[20:23], v[112:115]
  ds_read_b64_tr_b16 a[114:115], v248 offset:25600
  v_mfma_f32_16x16x32_bf16 v[108:111], a[40:43], a[20:23], v[108:111]
  buffer_load_dwordx4 v246, s[16:19], s44 offen offset:2048 sc1 lds
  v_mfma_f32_16x16x32_bf16 v[104:107], a[36:39], a[20:23], v[104:107]
  ds_read_b64_tr_b16 a[116:117], v249 offset:24576
  v_mfma_f32_16x16x32_bf16 v[100:103], a[32:35], a[20:23], v[100:103]
  v_mfma_f32_16x16x32_bf16 v[116:119], a[32:35], a[24:27], v[116:119]
  ds_read_b64_tr_b16 a[118:119], v249 offset:25600
  v_mfma_f32_16x16x32_bf16 v[120:123], a[36:39], a[24:27], v[120:123]
  v_mfma_f32_16x16x32_bf16 v[124:127], a[40:43], a[24:27], v[124:127]
  buffer_load_dwordx4 v247, s[16:19], s44 offen offset:3072 sc1 lds
  v_mfma_f32_16x16x32_bf16 v[128:131], a[44:47], a[24:27], v[128:131]
  ds_read_b64_tr_b16 a[120:121], v250 offset:24576
  v_mfma_f32_16x16x32_bf16 v[144:147], a[44:47], a[28:31], v[144:147]
  v_mfma_f32_16x16x32_bf16 v[140:143], a[40:43], a[28:31], v[140:143]
  ds_read_b64_tr_b16 a[122:123], v250 offset:25600
  v_mfma_f32_16x16x32_bf16 v[136:139], a[36:39], a[28:31], v[136:139]
  v_mfma_f32_16x16x32_bf16 v[132:135], a[32:35], a[28:31], v[132:135]
  ds_read_b64_tr_b16 a[124:125], v251 offset:24576
  s_add_u32 s44, s32, 2097152
  v_mfma_f32_16x16x32_bf16 a[188:191], a[28:31], a[60:63], a[188:191]
  v_mfma_f32_16x16x32_bf16 a[180:183], a[28:31], a[56:59], a[180:183]
  ds_read_b64_tr_b16 a[126:127], v251 offset:25600
  v_mfma_f32_16x16x32_bf16 a[172:175], a[28:31], a[52:55], a[172:175]
  v_mfma_f32_16x16x32_bf16 a[164:167], a[28:31], a[48:51], a[164:167]
  s_add_u32 m0, s33, 65536
  v_mfma_f32_16x16x32_bf16 a[160:163], a[24:27], a[48:51], a[160:163]
  ds_read_b128 a[64:67], v252 offset:16384
  v_mfma_f32_16x16x32_bf16 a[168:171], a[24:27], a[52:55], a[168:171]
  v_mfma_f32_16x16x32_bf16 a[176:179], a[24:27], a[56:59], a[176:179]
  ds_read_b128 a[68:71], v252 offset:17408
  v_mfma_f32_16x16x32_bf16 a[184:187], a[24:27], a[60:63], a[184:187]
  v_mfma_f32_16x16x32_bf16 a[156:159], a[20:23], a[60:63], a[156:159]
  buffer_load_dwordx4 v244, s[16:19], s44 offen offset:0 sc1 lds
  v_mfma_f32_16x16x32_bf16 a[148:151], a[20:23], a[56:59], a[148:151]
  ds_read_b128 a[72:75], v252 offset:18432
  v_mfma_f32_16x16x32_bf16 a[140:143], a[20:23], a[52:55], a[140:143]
  ds_read_b128 a[76:79], v252 offset:19456
  v_mfma_f32_16x16x32_bf16 a[132:135], a[20:23], a[48:51], a[132:135]
  v_mfma_f32_16x16x32_bf16 a[128:131], a[16:19], a[48:51], a[128:131]
  v_mfma_f32_16x16x32_bf16 a[136:139], a[16:19], a[52:55], a[136:139]
  buffer_load_dwordx4 v245, s[16:19], s44 offen offset:1024 sc1 lds
  v_mfma_f32_16x16x32_bf16 a[144:147], a[16:19], a[56:59], a[144:147]
  ds_read_b128 a[80:83], v252 offset:20480
  v_mfma_f32_16x16x32_bf16 a[152:155], a[16:19], a[60:63], a[152:155]
  ds_read_b128 a[84:87], v252 offset:21504
  v_mfma_f32_16x16x32_bf16 v[208:211], a[12:15], a[60:63], v[208:211]
  v_mfma_f32_16x16x32_bf16 v[200:203], a[12:15], a[56:59], v[200:203]
  ds_read_b128 a[88:91], v252 offset:22528
  v_mfma_f32_16x16x32_bf16 v[192:195], a[12:15], a[52:55], v[192:195]
  buffer_load_dwordx4 v246, s[16:19], s44 offen offset:2048 sc1 lds
  v_mfma_f32_16x16x32_bf16 v[184:187], a[12:15], a[48:51], v[184:187]
  ds_read_b128 a[92:95], v252 offset:23552
  v_mfma_f32_16x16x32_bf16 v[180:183], a[8:11], a[48:51], v[180:183]
  v_mfma_f32_16x16x32_bf16 v[188:191], a[8:11], a[52:55], v[188:191]
  v_mfma_f32_16x16x32_bf16 v[196:199], a[8:11], a[56:59], v[196:199]
  v_mfma_f32_16x16x32_bf16 v[204:207], a[8:11], a[60:63], v[204:207]
  buffer_load_dwordx4 v247, s[16:19], s44 offen offset:3072 sc1 lds
  v_mfma_f32_16x16x32_bf16 v[176:179], a[4:7], a[60:63], v[176:179]
  v_mfma_f32_16x16x32_bf16 v[168:171], a[4:7], a[56:59], v[168:171]
  v_mfma_f32_16x16x32_bf16 v[160:163], a[4:7], a[52:55], v[160:163]
  v_mfma_f32_16x16x32_bf16 v[152:155], a[4:7], a[48:51], v[152:155]
  v_mfma_f32_16x16x32_bf16 v[148:151], a[0:3], a[48:51], v[148:151]
  v_mfma_f32_16x16x32_bf16 v[156:159], a[0:3], a[52:55], v[156:159]
  v_mfma_f32_16x16x32_bf16 v[164:167], a[0:3], a[56:59], v[164:167]
  s_waitcnt lgkmcnt(0)
  s_barrier
  v_mfma_f32_16x16x32_bf16 v[172:175], a[0:3], a[60:63], v[172:175]
  v_mfma_f32_16x16x32_bf16 v[20:23], a[96:99], a[64:67], v[20:23]
  ds_read_b64_tr_b16 a[32:33], v248 offset:32768
  v_lshrrev_b32 v16, 4, v1
  v_mfma_f32_16x16x32_bf16 v[24:27], a[100:103], a[64:67], v[24:27]
  v_bfe_u32 v17, v1, 2, 2
  v_mfma_f32_16x16x32_bf16 v[28:31], a[104:107], a[64:67], v[28:31]
  ds_read_b64_tr_b16 a[34:35], v248 offset:33792
  v_lshl_add_u32 v18, v16, 3, v17
  v_mfma_f32_16x16x32_bf16 v[32:35], a[108:111], a[64:67], v[32:35]
  v_and_b32 v19, 1, v16
  s_add_u32 s44, s32, 524288
  v_mfma_f32_16x16x32_bf16 v[48:51], a[108:111], a[68:71], v[48:51]
  ds_read_b64_tr_b16 a[36:37], v249 offset:32768
  v_lshl_add_u32 v19, v19, 2, v17
  v_mfma_f32_16x16x32_bf16 v[44:47], a[104:107], a[68:71], v[44:47]
  v_and_b32 v17, 3, v1
  v_mfma_f32_16x16x32_bf16 v[40:43], a[100:103], a[68:71], v[40:43]
  ds_read_b64_tr_b16 a[38:39], v249 offset:33792
  v_lshlrev_b32 v17, 3, v17
  v_mfma_f32_16x16x32_bf16 v[36:39], a[96:99], a[68:71], v[36:39]
  v_lshl_add_u32 v17, v18, 8, v17
  s_add_u32 m0, s33, 16384
  v_mfma_f32_16x16x32_bf16 v[52:55], a[96:99], a[72:75], v[52:55]
  v_xor_b32 v18, 0, v19
  v_mfma_f32_16x16x32_bf16 v[56:59], a[100:103], a[72:75], v[56:59]
  ds_read_b64_tr_b16 a[40:41], v250 offset:32768
  v_lshl_add_u32 v8, v18, 5, v17
  v_mfma_f32_16x16x32_bf16 v[60:63], a[104:107], a[72:75], v[60:63]
  v_xor_b32 v18, 1, v19
  v_mfma_f32_16x16x32_bf16 v[64:67], a[108:111], a[72:75], v[64:67]
  ds_read_b64_tr_b16 a[42:43], v250 offset:33792
  v_lshl_add_u32 v9, v18, 5, v17
  v_mfma_f32_16x16x32_bf16 v[80:83], a[108:111], a[76:79], v[80:83]
  buffer_load_dwordx4 v244, s[16:19], s44 offen offset:0 sc1 lds
  v_mfma_f32_16x16x32_bf16 v[76:79], a[104:107], a[76:79], v[76:79]
  ds_read_b64_tr_b16 a[44:45], v251 offset:32768
  v_xor_b32 v18, 2, v19
  v_mfma_f32_16x16x32_bf16 v[72:75], a[100:103], a[76:79], v[72:75]
  v_lshl_add_u32 v10, v18, 5, v17
  v_xor_b32 v18, 3, v19
  v_mfma_f32_16x16x32_bf16 v[68:71], a[96:99], a[76:79], v[68:71]
  ds_read_b64_tr_b16 a[46:47], v251 offset:33792
  v_lshl_add_u32 v11, v18, 5, v17
  v_mfma_f32_16x16x32_bf16 v[84:87], a[96:99], a[80:83], v[84:87]
  buffer_load_dwordx4 v245, s[16:19], s44 offen offset:1024 sc1 lds
  v_mfma_f32_16x16x32_bf16 v[88:91], a[100:103], a[80:83], v[88:91]
  v_xor_b32 v18, 4, v19
  v_lshl_add_u32 v12, v18, 5, v17
  v_mfma_f32_16x16x32_bf16 v[92:95], a[104:107], a[80:83], v[92:95]
  ds_read_b64_tr_b16 a[48:49], v248 offset:40960
  v_xor_b32 v18, 5, v19
  v_mfma_f32_16x16x32_bf16 v[96:99], a[108:111], a[80:83], v[96:99]
  v_lshl_add_u32 v13, v18, 5, v17
  v_mfma_f32_16x16x32_bf16 v[112:115], a[108:111], a[84:87], v[112:115]
  ds_read_b64_tr_b16 a[50:51], v248 offset:41984
  v_xor_b32 v18, 6, v19
  v_mfma_f32_16x16x32_bf16 v[108:111], a[104:107], a[84:87], v[108:111]
  buffer_load_dwordx4 v246, s[16:19], s44 offen offset:2048 sc1 lds
  v_mfma_f32_16x16x32_bf16 v[104:107], a[100:103], a[84:87], v[104:107]
  ds_read_b64_tr_b16 a[52:53], v249 offset:40960
  v_lshl_add_u32 v14, v18, 5, v17
  v_mfma_f32_16x16x32_bf16 v[100:103], a[96:99], a[84:87], v[100:103]
  v_xor_b32 v18, 7, v19
  v_lshl_add_u32 v15, v18, 5, v17
  v_mfma_f32_16x16x32_bf16 v[116:119], a[96:99], a[88:91], v[116:119]
  ds_read_b64_tr_b16 a[54:55], v249 offset:41984
  v_mov_b32 v2, v4
  v_mfma_f32_16x16x32_bf16 v[120:123], a[100:103], a[88:91], v[120:123]
  v_xor_b32 v254, 0x10000, v4
  v_mfma_f32_16x16x32_bf16 v[124:127], a[104:107], a[88:91], v[124:127]
  buffer_load_dwordx4 v247, s[16:19], s44 offen offset:3072 sc1 lds
  v_mfma_f32_16x16x32_bf16 v[128:131], a[108:111], a[88:91], v[128:131]
  ds_read_b64_tr_b16 a[56:57], v250 offset:40960
  v_and_b32 v18, 15, v1
  v_mfma_f32_16x16x32_bf16 v[144:147], a[108:111], a[92:95], v[144:147]
  v_lshlrev_b32 v19, 2, v16
  v_sub_u32 v18, v18, v19
  v_mfma_f32_16x16x32_bf16 v[140:143], a[104:107], a[92:95], v[140:143]
  ds_read_b64_tr_b16 a[58:59], v250 offset:41984
  v_mfma_f32_16x16x32_bf16 v[136:139], a[100:103], a[92:95], v[136:139]
  s_lshl_b32 s46, s20, 4
  v_mfma_f32_16x16x32_bf16 v[132:135], a[96:99], a[92:95], v[132:135]
  ds_read_b64_tr_b16 a[60:61], v251 offset:40960
  v_add_u32 v5, s46, v18
  v_mfma_f32_16x16x32_bf16 a[188:191], a[92:95], a[124:127], a[188:191]
  s_sub_u32 s46, 48, s46
  s_add_u32 s44, s32, 2621440
  v_mfma_f32_16x16x32_bf16 a[180:183], a[92:95], a[120:123], a[180:183]
  ds_read_b64_tr_b16 a[62:63], v251 offset:41984
  v_add_u32 v6, s46, v18
  v_mfma_f32_16x16x32_bf16 a[172:175], a[92:95], a[116:119], a[172:175]
  v_mov_b32 v7, 0xff800000
  v_mfma_f32_16x16x32_bf16 a[164:167], a[92:95], a[112:115], a[164:167]
  s_mul_i32 s46, s21, 0x90000
  s_add_u32 m0, s33, 81920
  v_mfma_f32_16x16x32_bf16 a[160:163], a[88:91], a[112:115], a[160:163]
  ds_read_b128 a[0:3], v252 offset:32768
  s_lshl_b32 s47, s22, 1
  v_mfma_f32_16x16x32_bf16 a[168:171], a[88:91], a[116:119], a[168:171]
  s_add_u32 s47, s47, s23
  v_mfma_f32_16x16x32_bf16 a[176:179], a[88:91], a[120:123], a[176:179]
  ds_read_b128 a[4:7], v252 offset:33792
  s_lshl_b32 s47, s47, 15
  v_mfma_f32_16x16x32_bf16 a[184:187], a[88:91], a[124:127], a[184:187]
  s_add_u32 s47, s46, s47
  v_mfma_f32_16x16x32_bf16 a[156:159], a[84:87], a[124:127], a[156:159]
  ds_read_b128 a[8:11], v252 offset:34816
  s_lshl_b32 s48, s24, 11
  v_mfma_f32_16x16x32_bf16 a[148:151], a[84:87], a[120:123], a[148:151]
  buffer_load_dwordx4 v244, s[16:19], s44 offen offset:0 sc1 lds
  v_mfma_f32_16x16x32_bf16 a[140:143], a[84:87], a[116:119], a[140:143]
  ds_read_b128 a[12:15], v252 offset:35840
  s_add_u32 s38, s47, s48
  v_mfma_f32_16x16x32_bf16 a[132:135], a[84:87], a[112:115], a[132:135]
  s_add_u32 s38, s38, 0x5000000
  s_lshl_b32 s48, s24, 12
  v_mfma_f32_16x16x32_bf16 a[128:131], a[80:83], a[112:115], a[128:131]
  s_add_u32 s39, s47, s48
  v_mfma_f32_16x16x32_bf16 a[136:139], a[80:83], a[116:119], a[136:139]
  ds_read_b128 a[16:19], v252 offset:36864
  s_add_u32 s39, s39, 0x6400000
  v_mfma_f32_16x16x32_bf16 a[144:147], a[80:83], a[120:123], a[144:147]
  buffer_load_dwordx4 v245, s[16:19], s44 offen offset:1024 sc1 lds
  v_mfma_f32_16x16x32_bf16 a[152:155], a[80:83], a[124:127], a[152:155]
  ds_read_b128 a[20:23], v252 offset:37888
  s_lshl_b32 s47, s23, 13
  v_mfma_f32_16x16x32_bf16 v[208:211], a[76:79], a[124:127], v[208:211]
  s_add_u32 s47, s47, 4096
  s_mul_i32 s48, s24, 0x1400000
  v_mfma_f32_16x16x32_bf16 v[200:203], a[76:79], a[120:123], v[200:203]
  ds_read_b128 a[24:27], v252 offset:38912
  s_add_u32 s46, s46, s48
  v_mfma_f32_16x16x32_bf16 v[192:195], a[76:79], a[116:119], v[192:195]
  buffer_load_dwordx4 v246, s[16:19], s44 offen offset:2048 sc1 lds
  v_mfma_f32_16x16x32_bf16 v[184:187], a[76:79], a[112:115], v[184:187]
  ds_read_b128 a[28:31], v252 offset:39936
  s_add_u32 s46, s46, s47
  v_mfma_f32_16x16x32_bf16 v[180:183], a[72:75], a[112:115], v[180:183]
  s_add_u32 s46, s46, 0x5000000
  s_xor_b32 s48, s24, 1
  v_mfma_f32_16x16x32_bf16 v[188:191], a[72:75], a[116:119], v[188:191]
  s_mul_i32 s48, s48, 0x6000
  v_mfma_f32_16x16x32_bf16 v[196:199], a[72:75], a[120:123], v[196:199]
  s_add_u32 s46, s46, s48
  v_mfma_f32_16x16x32_bf16 v[204:207], a[72:75], a[124:127], v[204:207]
  buffer_load_dwordx4 v247, s[16:19], s44 offen offset:3072 sc1 lds
  v_mfma_f32_16x16x32_bf16 v[176:179], a[68:71], a[124:127], v[176:179]
  v_add_u32 v3, s46, v4
  s_lshl_b32 s48, s24, 14
  v_mfma_f32_16x16x32_bf16 v[168:171], a[68:71], a[120:123], v[168:171]
  s_add_u32 s30, s48, s47
  v_mfma_f32_16x16x32_bf16 v[160:163], a[68:71], a[116:119], v[160:163]
  s_xor_b32 s31, s30, 0x10000
  v_mfma_f32_16x16x32_bf16 v[152:155], a[68:71], a[112:115], v[152:155]
  v_mfma_f32_16x16x32_bf16 v[148:151], a[64:67], a[112:115], v[148:151]
  v_mfma_f32_16x16x32_bf16 v[156:159], a[64:67], a[116:119], v[156:159]
  v_mfma_f32_16x16x32_bf16 v[164:167], a[64:67], a[120:123], v[164:167]
  s_waitcnt vmcnt(17) lgkmcnt(0)
  s_barrier
  v_mfma_f32_16x16x32_bf16 v[172:175], a[64:67], a[124:127], v[172:175]
  v_mfma_f32_16x16x32_bf16 v[20:23], a[32:35], a[0:3], v[20:23]
  buffer_load_dwordx2 v[242:243], v240, s[12:15], 0 offen sc1
  v_mfma_f32_16x16x32_bf16 v[24:27], a[36:39], a[0:3], v[24:27]
  ds_read_b64_tr_b16 a[96:97], v248 offset:49152
  s_lshl_b32 s46, s22, 3
  s_sub_u32 s47, 7, s20
  s_add_u32 s48, s46, s20
  v_mfma_f32_16x16x32_bf16 v[28:31], a[40:43], a[0:3], v[28:31]
  ds_read_b64_tr_b16 a[98:99], v248 offset:50176
  s_add_u32 s44, s32, 1048576
  v_mfma_f32_16x16x32_bf16 v[32:35], a[44:47], a[0:3], v[32:35]
  s_add_u32 s49, s46, s47
  s_sub_u32 s46, 120, s46
  v_mfma_f32_16x16x32_bf16 v[48:51], a[44:47], a[4:7], v[48:51]
  ds_read_b64_tr_b16 a[100:101], v249 offset:49152
  s_add_u32 s50, s46, s20
  v_mfma_f32_16x16x32_bf16 v[44:47], a[40:43], a[4:7], v[44:47]
  s_add_u32 m0, s33, 32768
  s_add_u32 s51, s46, s47
  v_mfma_f32_16x16x32_bf16 v[40:43], a[36:39], a[4:7], v[40:43]
  ds_read_b64_tr_b16 a[102:103], v249 offset:50176
  s_lshl_b32 s34, s48, 14
  v_mfma_f32_16x16x32_bf16 v[36:39], a[32:35], a[4:7], v[36:39]
  s_add_u32 s34, s34, 0x3000000
  s_lshl_b32 s35, s49, 14
  v_mfma_f32_16x16x32_bf16 v[52:55], a[32:35], a[8:11], v[52:55]
  buffer_load_dwordx4 v244, s[16:19], s44 offen offset:0 sc1 lds
  v_mfma_f32_16x16x32_bf16 v[56:59], a[36:39], a[8:11], v[56:59]
  ds_read_b64_tr_b16 a[104:105], v250 offset:49152
  s_add_u32 s35, s35, 0x3000000
  v_mfma_f32_16x16x32_bf16 v[60:63], a[40:43], a[8:11], v[60:63]
  s_lshl_b32 s36, s50, 14
  s_add_u32 s36, s36, 0x3000000
  v_mfma_f32_16x16x32_bf16 v[64:67], a[44:47], a[8:11], v[64:67]
  ds_read_b64_tr_b16 a[106:107], v250 offset:50176
  s_lshl_b32 s37, s51, 14
  v_mfma_f32_16x16x32_bf16 v[80:83], a[44:47], a[12:15], v[80:83]
  buffer_load_dwordx4 v245, s[16:19], s44 offen offset:1024 sc1 lds
  v_mfma_f32_16x16x32_bf16 v[76:79], a[40:43], a[12:15], v[76:79]
  ds_read_b64_tr_b16 a[108:109], v251 offset:49152
  s_add_u32 s37, s37, 0x3000000
  v_mfma_f32_16x16x32_bf16 v[72:75], a[36:39], a[12:15], v[72:75]
  buffer_load_dwordx4 v246, s[16:19], s44 offen offset:2048 sc1 lds
  v_mfma_f32_16x16x32_bf16 v[68:71], a[32:35], a[12:15], v[68:71]
  ds_read_b64_tr_b16 a[110:111], v251 offset:50176
  v_mfma_f32_16x16x32_bf16 v[84:87], a[32:35], a[16:19], v[84:87]
  v_mfma_f32_16x16x32_bf16 v[88:91], a[36:39], a[16:19], v[88:91]
  v_mfma_f32_16x16x32_bf16 v[92:95], a[40:43], a[16:19], v[92:95]
  buffer_load_dwordx4 v247, s[16:19], s44 offen offset:3072 sc1 lds
  v_mfma_f32_16x16x32_bf16 v[96:99], a[44:47], a[16:19], v[96:99]
  ds_read_b64_tr_b16 a[112:113], v248 offset:57344
  v_mfma_f32_16x16x32_bf16 v[112:115], a[44:47], a[20:23], v[112:115]
  ds_read_b64_tr_b16 a[114:115], v248 offset:58368
  v_mfma_f32_16x16x32_bf16 v[108:111], a[40:43], a[20:23], v[108:111]
  s_add_u32 s44, s32, 3145728
  v_mfma_f32_16x16x32_bf16 v[104:107], a[36:39], a[20:23], v[104:107]
  ds_read_b64_tr_b16 a[116:117], v249 offset:57344
  v_mfma_f32_16x16x32_bf16 v[100:103], a[32:35], a[20:23], v[100:103]
  v_mfma_f32_16x16x32_bf16 v[116:119], a[32:35], a[24:27], v[116:119]
  ds_read_b64_tr_b16 a[118:119], v249 offset:58368
  s_add_u32 m0, s33, 131072
  v_mfma_f32_16x16x32_bf16 v[120:123], a[36:39], a[24:27], v[120:123]
  v_mfma_f32_16x16x32_bf16 v[124:127], a[40:43], a[24:27], v[124:127]
  v_mfma_f32_16x16x32_bf16 v[128:131], a[44:47], a[24:27], v[128:131]
  buffer_load_dwordx4 v244, s[16:19], s44 offen offset:0 sc1 lds
  v_mfma_f32_16x16x32_bf16 v[144:147], a[44:47], a[28:31], v[144:147]
  ds_read_b64_tr_b16 a[120:121], v250 offset:57344
  v_mfma_f32_16x16x32_bf16 v[140:143], a[40:43], a[28:31], v[140:143]
  ds_read_b64_tr_b16 a[122:123], v250 offset:58368
  v_mfma_f32_16x16x32_bf16 v[136:139], a[36:39], a[28:31], v[136:139]
  v_mfma_f32_16x16x32_bf16 v[132:135], a[32:35], a[28:31], v[132:135]
  buffer_load_dwordx4 v245, s[16:19], s44 offen offset:1024 sc1 lds
  v_mfma_f32_16x16x32_bf16 a[188:191], a[28:31], a[60:63], a[188:191]
  ds_read_b64_tr_b16 a[124:125], v251 offset:57344
  v_mfma_f32_16x16x32_bf16 a[180:183], a[28:31], a[56:59], a[180:183]
  ds_read_b64_tr_b16 a[126:127], v251 offset:58368
  v_mfma_f32_16x16x32_bf16 a[172:175], a[28:31], a[52:55], a[172:175]
  buffer_load_dwordx4 v246, s[16:19], s44 offen offset:2048 sc1 lds
  v_mfma_f32_16x16x32_bf16 a[164:167], a[28:31], a[48:51], a[164:167]
  v_mfma_f32_16x16x32_bf16 a[160:163], a[24:27], a[48:51], a[160:163]
  ds_read_b128 a[64:67], v252 offset:49152
  v_mfma_f32_16x16x32_bf16 a[168:171], a[24:27], a[52:55], a[168:171]
  buffer_load_dwordx4 v247, s[16:19], s44 offen offset:3072 sc1 lds
  v_mfma_f32_16x16x32_bf16 a[176:179], a[24:27], a[56:59], a[176:179]
  ds_read_b128 a[68:71], v252 offset:50176
  v_mfma_f32_16x16x32_bf16 a[184:187], a[24:27], a[60:63], a[184:187]
  v_mfma_f32_16x16x32_bf16 a[156:159], a[20:23], a[60:63], a[156:159]
  ds_read_b128 a[72:75], v252 offset:51200
  s_add_u32 s44, s32, 3670016
  v_mfma_f32_16x16x32_bf16 a[148:151], a[20:23], a[56:59], a[148:151]
  v_mfma_f32_16x16x32_bf16 a[140:143], a[20:23], a[52:55], a[140:143]
  ds_read_b128 a[76:79], v252 offset:52224
  v_mfma_f32_16x16x32_bf16 a[132:135], a[20:23], a[48:51], a[132:135]
  s_add_u32 m0, s33, 147456
  v_mfma_f32_16x16x32_bf16 a[128:131], a[16:19], a[48:51], a[128:131]
  v_mfma_f32_16x16x32_bf16 a[136:139], a[16:19], a[52:55], a[136:139]
  ds_read_b128 a[80:83], v252 offset:53248
  v_mfma_f32_16x16x32_bf16 a[144:147], a[16:19], a[56:59], a[144:147]
  v_mfma_f32_16x16x32_bf16 a[152:155], a[16:19], a[60:63], a[152:155]
  buffer_load_dwordx4 v244, s[16:19], s44 offen offset:0 sc1 lds
  v_mfma_f32_16x16x32_bf16 v[208:211], a[12:15], a[60:63], v[208:211]
  ds_read_b128 a[84:87], v252 offset:54272
  v_mfma_f32_16x16x32_bf16 v[200:203], a[12:15], a[56:59], v[200:203]
  ds_read_b128 a[88:91], v252 offset:55296
  v_mfma_f32_16x16x32_bf16 v[192:195], a[12:15], a[52:55], v[192:195]
  buffer_load_dwordx4 v245, s[16:19], s44 offen offset:1024 sc1 lds
  v_mfma_f32_16x16x32_bf16 v[184:187], a[12:15], a[48:51], v[184:187]
  ds_read_b128 a[92:95], v252 offset:56320
  v_mfma_f32_16x16x32_bf16 v[180:183], a[8:11], a[48:51], v[180:183]
  v_mfma_f32_16x16x32_bf16 v[188:191], a[8:11], a[52:55], v[188:191]
  buffer_load_dwordx4 v246, s[16:19], s44 offen offset:2048 sc1 lds
  v_mfma_f32_16x16x32_bf16 v[196:199], a[8:11], a[56:59], v[196:199]
  v_mfma_f32_16x16x32_bf16 v[204:207], a[8:11], a[60:63], v[204:207]
  v_mfma_f32_16x16x32_bf16 v[176:179], a[4:7], a[60:63], v[176:179]
  buffer_load_dwordx4 v247, s[16:19], s44 offen offset:3072 sc1 lds
  v_mfma_f32_16x16x32_bf16 v[168:171], a[4:7], a[56:59], v[168:171]
  v_mfma_f32_16x16x32_bf16 v[160:163], a[4:7], a[52:55], v[160:163]
  v_mfma_f32_16x16x32_bf16 v[152:155], a[4:7], a[48:51], v[152:155]
  v_mfma_f32_16x16x32_bf16 v[148:151], a[0:3], a[48:51], v[148:151]
  v_mfma_f32_16x16x32_bf16 v[156:159], a[0:3], a[52:55], v[156:159]
  v_mfma_f32_16x16x32_bf16 v[164:167], a[0:3], a[56:59], v[164:167]
  s_waitcnt vmcnt(12) lgkmcnt(0)
  s_barrier
  v_mfma_f32_16x16x32_bf16 v[172:175], a[0:3], a[60:63], v[172:175]
  s_mov_b32 s40, 0
  v_cmp_ne_u64 vcc, s[76:77], v[242:243]
  s_nop 0
  s_cbranch_vccz adaLN_cond__compressed_kv_cla__mixer_channel_mlp__prompt_kernel_ok20
adaLN_cond__compressed_kv_cla__mixer_channel_mlp__prompt_kernel_sp21:
  s_sleep 2
  buffer_load_dwordx2 v[242:243], v240, s[12:15], 0 offen sc1
  s_waitcnt vmcnt(0)
  s_add_u32 s40, s40, 1
  v_cmp_ne_u64 vcc, s[76:77], v[242:243]
  s_nop 0
  s_cbranch_vccz adaLN_cond__compressed_kv_cla__mixer_channel_mlp__prompt_kernel_ok20
  s_cmp_lt_u32 s40, 0x4000
  s_cbranch_scc1 adaLN_cond__compressed_kv_cla__mixer_channel_mlp__prompt_kernel_sp21
adaLN_cond__compressed_kv_cla__mixer_channel_mlp__prompt_kernel_ok20:
  v_mfma_f32_16x16x32_bf16 v[20:23], a[96:99], a[64:67], v[20:23]
  v_mfma_f32_16x16x32_bf16 v[24:27], a[100:103], a[64:67], v[24:27]
  v_mfma_f32_16x16x32_bf16 v[28:31], a[104:107], a[64:67], v[28:31]
  s_add_u32 s44, s32, 1572864
  v_mfma_f32_16x16x32_bf16 v[32:35], a[108:111], a[64:67], v[32:35]
  v_mfma_f32_16x16x32_bf16 v[148:151], a[64:67], a[112:115], v[148:151]
  v_mfma_f32_16x16x32_bf16 v[156:159], a[64:67], a[116:119], v[156:159]
  s_add_u32 m0, s33, 49152
  v_mfma_f32_16x16x32_bf16 v[164:167], a[64:67], a[120:123], v[164:167]
  v_mfma_f32_16x16x32_bf16 v[172:175], a[64:67], a[124:127], v[172:175]
  v_mfma_f32_16x16x32_bf16 v[36:39], a[96:99], a[68:71], v[36:39]
  buffer_load_dwordx4 v244, s[16:19], s44 offen offset:0 sc1 lds
  v_mfma_f32_16x16x32_bf16 v[40:43], a[100:103], a[68:71], v[40:43]
  v_mfma_f32_16x16x32_bf16 v[44:47], a[104:107], a[68:71], v[44:47]
  v_cvt_pk_bf16_f32 v20, v20, v21
  v_cvt_pk_bf16_f32 v21, v22, v23
  v_mfma_f32_16x16x32_bf16 v[48:51], a[108:111], a[68:71], v[48:51]
  buffer_load_dwordx4 v245, s[16:19], s44 offen offset:1024 sc1 lds
  v_mfma_f32_16x16x32_bf16 v[152:155], a[68:71], a[112:115], v[152:155]
  v_cvt_pk_bf16_f32 v22, v24, v25
  v_cvt_pk_bf16_f32 v23, v26, v27
  v_mfma_f32_16x16x32_bf16 v[160:163], a[68:71], a[116:119], v[160:163]
  v_cvt_pk_bf16_f32 v24, v28, v29
  v_cvt_pk_bf16_f32 v25, v30, v31
  v_mfma_f32_16x16x32_bf16 v[168:171], a[68:71], a[120:123], v[168:171]
  buffer_load_dwordx4 v246, s[16:19], s44 offen offset:2048 sc1 lds
  v_mfma_f32_16x16x32_bf16 v[176:179], a[68:71], a[124:127], v[176:179]
  v_cvt_pk_bf16_f32 v26, v32, v33
  v_cvt_pk_bf16_f32 v27, v34, v35
  v_mfma_f32_16x16x32_bf16 v[52:55], a[96:99], a[72:75], v[52:55]
  v_mfma_f32_16x16x32_bf16 v[56:59], a[100:103], a[72:75], v[56:59]
  v_mfma_f32_16x16x32_bf16 v[60:63], a[104:107], a[72:75], v[60:63]
  buffer_load_dwordx4 v247, s[16:19], s44 offen offset:3072 sc1 lds
  v_mfma_f32_16x16x32_bf16 v[64:67], a[108:111], a[72:75], v[64:67]
  v_cvt_pk_bf16_f32 v28, v36, v37
  v_cvt_pk_bf16_f32 v29, v38, v39
  v_mfma_f32_16x16x32_bf16 v[180:183], a[72:75], a[112:115], v[180:183]
  v_cvt_pk_bf16_f32 v30, v40, v41
  v_cvt_pk_bf16_f32 v31, v42, v43
  v_mfma_f32_16x16x32_bf16 v[188:191], a[72:75], a[116:119], v[188:191]
  buffer_load_dwordx4 a[0:3], v4, s[12:15], s34 offen offset:0 sc1
  v_mfma_f32_16x16x32_bf16 v[196:199], a[72:75], a[120:123], v[196:199]
  v_cvt_pk_bf16_f32 v32, v44, v45
  v_cvt_pk_bf16_f32 v33, v46, v47
  v_mfma_f32_16x16x32_bf16 v[204:207], a[72:75], a[124:127], v[204:207]
  v_cvt_pk_bf16_f32 v34, v48, v49
  v_cvt_pk_bf16_f32 v35, v50, v51
  v_mfma_f32_16x16x32_bf16 v[68:71], a[96:99], a[76:79], v[68:71]
  buffer_load_dwordx4 a[4:7], v4, s[12:15], s35 offen offset:0 sc1
  v_mfma_f32_16x16x32_bf16 v[72:75], a[100:103], a[76:79], v[72:75]
  v_mfma_f32_16x16x32_bf16 v[76:79], a[104:107], a[76:79], v[76:79]
  v_cvt_pk_bf16_f32 v36, v52, v53
  v_cvt_pk_bf16_f32 v37, v54, v55
  v_mfma_f32_16x16x32_bf16 v[80:83], a[108:111], a[76:79], v[80:83]
  buffer_load_dwordx4 a[8:11], v4, s[12:15], s36 offen offset:0 sc1
  v_mfma_f32_16x16x32_bf16 v[184:187], a[76:79], a[112:115], v[184:187]
  v_cvt_pk_bf16_f32 v38, v56, v57
  v_cvt_pk_bf16_f32 v39, v58, v59
  v_mfma_f32_16x16x32_bf16 v[192:195], a[76:79], a[116:119], v[192:195]
  v_cvt_pk_bf16_f32 v40, v60, v61
  v_cvt_pk_bf16_f32 v41, v62, v63
  v_mfma_f32_16x16x32_bf16 v[200:203], a[76:79], a[120:123], v[200:203]
  v_cvt_pk_bf16_f32 v42, v64, v65
  v_cvt_pk_bf16_f32 v43, v66, v67
  v_mfma_f32_16x16x32_bf16 v[208:211], a[76:79], a[124:127], v[208:211]
  buffer_load_dwordx4 a[12:15], v4, s[12:15], s37 offen offset:0 sc1
  v_mfma_f32_16x16x32_bf16 v[84:87], a[96:99], a[80:83], v[84:87]
  v_mfma_f32_16x16x32_bf16 v[88:91], a[100:103], a[80:83], v[88:91]
  v_mfma_f32_16x16x32_bf16 v[92:95], a[104:107], a[80:83], v[92:95]
  buffer_load_dwordx4 a[16:19], v4, s[12:15], s34 offen offset:1024 sc1
  v_mfma_f32_16x16x32_bf16 v[96:99], a[108:111], a[80:83], v[96:99]
  v_cvt_pk_bf16_f32 v44, v68, v69
  v_cvt_pk_bf16_f32 v45, v70, v71
  v_mfma_f32_16x16x32_bf16 a[128:131], a[80:83], a[112:115], a[128:131]
  v_cvt_pk_bf16_f32 v46, v72, v73
  v_cvt_pk_bf16_f32 v47, v74, v75
  v_mfma_f32_16x16x32_bf16 a[136:139], a[80:83], a[116:119], a[136:139]
  buffer_load_dwordx4 a[20:23], v4, s[12:15], s35 offen offset:1024 sc1
  v_mfma_f32_16x16x32_bf16 a[144:147], a[80:83], a[120:123], a[144:147]
  v_cvt_pk_bf16_f32 v48, v76, v77
  v_cvt_pk_bf16_f32 v49, v78, v79
  v_mfma_f32_16x16x32_bf16 a[152:155], a[80:83], a[124:127], a[152:155]
  v_cvt_pk_bf16_f32 v50, v80, v81
  v_cvt_pk_bf16_f32 v51, v82, v83
  v_mfma_f32_16x16x32_bf16 v[100:103], a[96:99], a[84:87], v[100:103]
  buffer_load_dwordx4 a[24:27], v4, s[12:15], s36 offen offset:1024 sc1
  v_mfma_f32_16x16x32_bf16 v[104:107], a[100:103], a[84:87], v[104:107]
  v_mfma_f32_16x16x32_bf16 v[108:111], a[104:107], a[84:87], v[108:111]
  v_cvt_pk_bf16_f32 v52, v84, v85
  v_cvt_pk_bf16_f32 v53, v86, v87
  v_mfma_f32_16x16x32_bf16 v[112:115], a[108:111], a[84:87], v[112:115]
  buffer_load_dwordx4 a[28:31], v4, s[12:15], s37 offen offset:1024 sc1
  v_mfma_f32_16x16x32_bf16 a[132:135], a[84:87], a[112:115], a[132:135]
  v_cvt_pk_bf16_f32 v54, v88, v89
  v_cvt_pk_bf16_f32 v55, v90, v91
  v_mfma_f32_16x16x32_bf16 a[140:143], a[84:87], a[116:119], a[140:143]
  v_cvt_pk_bf16_f32 v56, v92, v93
  v_cvt_pk_bf16_f32 v57, v94, v95
  v_mfma_f32_16x16x32_bf16 a[148:151], a[84:87], a[120:123], a[148:151]
  v_cvt_pk_bf16_f32 v58, v96, v97
  v_cvt_pk_bf16_f32 v59, v98, v99
  v_mfma_f32_16x16x32_bf16 a[156:159], a[84:87], a[124:127], a[156:159]
  buffer_load_dwordx4 a[32:35], v4, s[12:15], s34 offen offset:2048 sc1
  v_mfma_f32_16x16x32_bf16 v[116:119], a[96:99], a[88:91], v[116:119]
  v_mfma_f32_16x16x32_bf16 v[120:123], a[100:103], a[88:91], v[120:123]
  v_mfma_f32_16x16x32_bf16 v[124:127], a[104:107], a[88:91], v[124:127]
  buffer_load_dwordx4 a[36:39], v4, s[12:15], s35 offen offset:2048 sc1
  v_mfma_f32_16x16x32_bf16 v[128:131], a[108:111], a[88:91], v[128:131]
  v_cvt_pk_bf16_f32 v60, v100, v101
  v_cvt_pk_bf16_f32 v61, v102, v103
  v_mfma_f32_16x16x32_bf16 a[160:163], a[88:91], a[112:115], a[160:163]
  v_cvt_pk_bf16_f32 v62, v104, v105
  v_cvt_pk_bf16_f32 v63, v106, v107
  v_mfma_f32_16x16x32_bf16 a[168:171], a[88:91], a[116:119], a[168:171]
  buffer_load_dwordx4 a[40:43], v4, s[12:15], s36 offen offset:2048 sc1
  v_mfma_f32_16x16x32_bf16 a[176:179], a[88:91], a[120:123], a[176:179]
  v_cvt_pk_bf16_f32 v64, v108, v109
  v_cvt_pk_bf16_f32 v65, v110, v111
  v_mfma_f32_16x16x32_bf16 a[184:187], a[88:91], a[124:127], a[184:187]
  v_cvt_pk_bf16_f32 v66, v112, v113
  v_cvt_pk_bf16_f32 v67, v114, v115
  v_mfma_f32_16x16x32_bf16 v[132:135], a[96:99], a[92:95], v[132:135]
  buffer_load_dwordx4 a[44:47], v4, s[12:15], s37 offen offset:2048 sc1
  v_mfma_f32_16x16x32_bf16 v[136:139], a[100:103], a[92:95], v[136:139]
  v_cvt_pk_bf16_f32 v84, v148, v149
  v_cvt_pk_bf16_f32 v85, v150, v151
  v_mfma_f32_16x16x32_bf16 v[140:143], a[104:107], a[92:95], v[140:143]
  v_cvt_pk_bf16_f32 v86, v152, v153
  v_cvt_pk_bf16_f32 v87, v154, v155
  v_mfma_f32_16x16x32_bf16 v[144:147], a[108:111], a[92:95], v[144:147]
  v_cvt_pk_bf16_f32 v88, v156, v157
  v_cvt_pk_bf16_f32 v89, v158, v159
  v_mfma_f32_16x16x32_bf16 a[164:167], a[92:95], a[112:115], a[164:167]
  v_cvt_pk_bf16_f32 v90, v160, v161
  v_cvt_pk_bf16_f32 v91, v162, v163
  v_mfma_f32_16x16x32_bf16 a[172:175], a[92:95], a[116:119], a[172:175]
  v_cvt_pk_bf16_f32 v92, v164, v165
  v_cvt_pk_bf16_f32 v93, v166, v167
  v_mfma_f32_16x16x32_bf16 a[180:183], a[92:95], a[120:123], a[180:183]
  v_cvt_pk_bf16_f32 v94, v168, v169
  v_cvt_pk_bf16_f32 v95, v170, v171
  v_mfma_f32_16x16x32_bf16 a[188:191], a[92:95], a[124:127], a[188:191]
  v_cvt_pk_bf16_f32 v96, v172, v173
  v_cvt_pk_bf16_f32 v97, v174, v175
  v_cvt_pk_bf16_f32 v98, v176, v177
  v_cvt_pk_bf16_f32 v99, v178, v179
  v_cvt_pk_bf16_f32 v100, v180, v181
  v_cvt_pk_bf16_f32 v101, v182, v183
  v_cvt_pk_bf16_f32 v102, v184, v185
  v_cvt_pk_bf16_f32 v103, v186, v187
  v_cvt_pk_bf16_f32 v104, v188, v189
  v_cvt_pk_bf16_f32 v105, v190, v191
  v_cvt_pk_bf16_f32 v106, v192, v193
  v_cvt_pk_bf16_f32 v107, v194, v195
  v_cvt_pk_bf16_f32 v108, v196, v197
  v_cvt_pk_bf16_f32 v109, v198, v199
  v_cvt_pk_bf16_f32 v110, v200, v201
  v_cvt_pk_bf16_f32 v111, v202, v203
  v_cvt_pk_bf16_f32 v112, v204, v205
  v_cvt_pk_bf16_f32 v113, v206, v207
  v_cvt_pk_bf16_f32 v114, v208, v209
  v_cvt_pk_bf16_f32 v115, v210, v211
  v_cvt_pk_bf16_f32 v68, v116, v117
  v_cvt_pk_bf16_f32 v69, v118, v119
  v_cvt_pk_bf16_f32 v70, v120, v121
  v_cvt_pk_bf16_f32 v71, v122, v123
  v_cvt_pk_bf16_f32 v72, v124, v125
  v_cvt_pk_bf16_f32 v73, v126, v127
  v_cvt_pk_bf16_f32 v74, v128, v129
  v_cvt_pk_bf16_f32 v75, v130, v131
  v_cvt_pk_bf16_f32 v76, v132, v133
  v_cvt_pk_bf16_f32 v77, v134, v135
  v_cvt_pk_bf16_f32 v78, v136, v137
  v_cvt_pk_bf16_f32 v79, v138, v139
  v_cvt_pk_bf16_f32 v80, v140, v141
  v_cvt_pk_bf16_f32 v81, v142, v143
  v_cvt_pk_bf16_f32 v82, v144, v145
  v_cvt_pk_bf16_f32 v83, v146, v147
  buffer_load_dwordx4 a[48:51], v4, s[12:15], s34 offen offset:3072 sc1
  buffer_load_dwordx4 a[52:55], v4, s[12:15], s35 offen offset:3072 sc1
  buffer_load_dwordx4 a[56:59], v4, s[12:15], s36 offen offset:3072 sc1
  buffer_load_dwordx4 a[60:63], v4, s[12:15], s37 offen offset:3072 sc1
  v_accvgpr_read_b32 v116, a128
  v_accvgpr_read_b32 v117, a129
  v_accvgpr_read_b32 v118, a130
  v_accvgpr_read_b32 v119, a131
  v_accvgpr_read_b32 v120, a132
  v_accvgpr_read_b32 v121, a133
  v_accvgpr_read_b32 v122, a134
  v_accvgpr_read_b32 v123, a135
  v_cvt_pk_bf16_f32 v212, v116, v117
  v_cvt_pk_bf16_f32 v213, v118, v119
  v_cvt_pk_bf16_f32 v214, v120, v121
  v_cvt_pk_bf16_f32 v215, v122, v123
  s_add_u32 s34, s34, 4096
  s_add_u32 s35, s35, 4096
  s_add_u32 s36, s36, 4096
  s_add_u32 s37, s37, 4096
  buffer_load_dwordx4 a[64:67], v4, s[12:15], s34 offen offset:0 sc1
  v_accvgpr_read_b32 v124, a136
  v_accvgpr_read_b32 v125, a137
  v_accvgpr_read_b32 v126, a138
  v_accvgpr_read_b32 v127, a139
  v_accvgpr_read_b32 v128, a140
  v_accvgpr_read_b32 v129, a141
  v_accvgpr_read_b32 v130, a142
  v_accvgpr_read_b32 v131, a143
  v_cvt_pk_bf16_f32 v216, v124, v125
  v_cvt_pk_bf16_f32 v217, v126, v127
  v_cvt_pk_bf16_f32 v218, v128, v129
  v_cvt_pk_bf16_f32 v219, v130, v131
  buffer_load_dwordx4 a[68:71], v4, s[12:15], s35 offen offset:0 sc1
  v_accvgpr_read_b32 v116, a144
  v_accvgpr_read_b32 v117, a145
  v_accvgpr_read_b32 v118, a146
  v_accvgpr_read_b32 v119, a147
  v_accvgpr_read_b32 v120, a148
  v_accvgpr_read_b32 v121, a149
  v_accvgpr_read_b32 v122, a150
  v_accvgpr_read_b32 v123, a151
  v_cvt_pk_bf16_f32 v220, v116, v117
  v_cvt_pk_bf16_f32 v221, v118, v119
  v_cvt_pk_bf16_f32 v222, v120, v121
  v_cvt_pk_bf16_f32 v223, v122, v123
  buffer_load_dwordx4 a[72:75], v4, s[12:15], s36 offen offset:0 sc1
  v_accvgpr_read_b32 v124, a152
  v_accvgpr_read_b32 v125, a153
  v_accvgpr_read_b32 v126, a154
  v_accvgpr_read_b32 v127, a155
  v_accvgpr_read_b32 v128, a156
  v_accvgpr_read_b32 v129, a157
  v_accvgpr_read_b32 v130, a158
  v_accvgpr_read_b32 v131, a159
  v_cvt_pk_bf16_f32 v224, v124, v125
  v_cvt_pk_bf16_f32 v225, v126, v127
  v_cvt_pk_bf16_f32 v226, v128, v129
  v_cvt_pk_bf16_f32 v227, v130, v131
  buffer_load_dwordx4 a[76:79], v4, s[12:15], s37 offen offset:0 sc1
  v_accvgpr_read_b32 v116, a160
  v_accvgpr_read_b32 v117, a161
  v_accvgpr_read_b32 v118, a162
  v_accvgpr_read_b32 v119, a163
  v_accvgpr_read_b32 v120, a164
  v_accvgpr_read_b32 v121, a165
  v_accvgpr_read_b32 v122, a166
  v_accvgpr_read_b32 v123, a167
  v_cvt_pk_bf16_f32 v228, v116, v117
  v_cvt_pk_bf16_f32 v229, v118, v119
  v_cvt_pk_bf16_f32 v230, v120, v121
  v_cvt_pk_bf16_f32 v231, v122, v123
  buffer_load_dwordx4 a[80:83], v4, s[12:15], s34 offen offset:1024 sc1
  v_accvgpr_read_b32 v124, a168
  v_accvgpr_read_b32 v125, a169
  v_accvgpr_read_b32 v126, a170
  v_accvgpr_read_b32 v127, a171
  v_accvgpr_read_b32 v128, a172
  v_accvgpr_read_b32 v129, a173
  v_accvgpr_read_b32 v130, a174
  v_accvgpr_read_b32 v131, a175
  v_cvt_pk_bf16_f32 v232, v124, v125
  v_cvt_pk_bf16_f32 v233, v126, v127
  v_cvt_pk_bf16_f32 v234, v128, v129
  v_cvt_pk_bf16_f32 v235, v130, v131
  buffer_load_dwordx4 a[84:87], v4, s[12:15], s35 offen offset:1024 sc1
  v_accvgpr_read_b32 v116, a176
  v_accvgpr_read_b32 v117, a177
  v_accvgpr_read_b32 v118, a178
  v_accvgpr_read_b32 v119, a179
  v_accvgpr_read_b32 v120, a180
  v_accvgpr_read_b32 v121, a181
  v_accvgpr_read_b32 v122, a182
  v_accvgpr_read_b32 v123, a183
  v_cvt_pk_bf16_f32 v236, v116, v117
  v_cvt_pk_bf16_f32 v237, v118, v119
  v_cvt_pk_bf16_f32 v238, v120, v121
  v_cvt_pk_bf16_f32 v239, v122, v123
  buffer_load_dwordx4 a[88:91], v4, s[12:15], s36 offen offset:1024 sc1
  v_accvgpr_read_b32 v124, a184
  v_accvgpr_read_b32 v125, a185
  v_accvgpr_read_b32 v126, a186
  v_accvgpr_read_b32 v127, a187
  v_accvgpr_read_b32 v128, a188
  v_accvgpr_read_b32 v129, a189
  v_accvgpr_read_b32 v130, a190
  v_accvgpr_read_b32 v131, a191
  v_cvt_pk_bf16_f32 v240, v124, v125
  v_cvt_pk_bf16_f32 v241, v126, v127
  v_cvt_pk_bf16_f32 v242, v128, v129
  v_cvt_pk_bf16_f32 v243, v130, v131
  buffer_load_dwordx4 a[92:95], v4, s[12:15], s37 offen offset:1024 sc1
  s_waitcnt vmcnt(20)
  s_barrier
  ds_read_b64_tr_b16 a[192:193], v8 offset:0
  ds_read_b64_tr_b16 a[194:195], v8 offset:1024
  ds_read_b64_tr_b16 a[196:197], v9 offset:0
  ds_read_b64_tr_b16 a[198:199], v9 offset:1024
  ds_read_b64_tr_b16 a[200:201], v10 offset:0
  ds_read_b64_tr_b16 a[202:203], v10 offset:1024
  ds_read_b64_tr_b16 a[204:205], v11 offset:0
  ds_read_b64_tr_b16 a[206:207], v11 offset:1024
  ds_read_b64_tr_b16 a[208:209], v12 offset:0
  ds_read_b64_tr_b16 a[210:211], v12 offset:1024
  ds_read_b64_tr_b16 a[212:213], v13 offset:0
  ds_read_b64_tr_b16 a[214:215], v13 offset:1024
  ds_read_b64_tr_b16 a[216:217], v14 offset:0
  ds_read_b64_tr_b16 a[218:219], v14 offset:1024
  ds_read_b64_tr_b16 a[220:221], v15 offset:0
  ds_read_b64_tr_b16 a[222:223], v15 offset:1024
  s_add_u32 s46, s39, 16384
  buffer_store_dwordx4 v[212:215], v4, s[12:15], s46 offen offset:0
  s_add_u32 s46, s39, 16384
  buffer_store_dwordx4 v[216:219], v4, s[12:15], s46 offen offset:1024
  s_add_u32 s46, s39, 16384
  buffer_store_dwordx4 v[220:223], v4, s[12:15], s46 offen offset:2048
  s_add_u32 s46, s39, 16384
  buffer_store_dwordx4 v[224:227], v4, s[12:15], s46 offen offset:3072
  s_add_u32 s46, s39, 24576
  buffer_store_dwordx4 v[228:231], v4, s[12:15], s46 offen offset:0
  s_add_u32 s46, s39, 24576
  buffer_store_dwordx4 v[232:235], v4, s[12:15], s46 offen offset:1024
  s_add_u32 s46, s39, 24576
  buffer_store_dwordx4 v[236:239], v4, s[12:15], s46 offen offset:2048
  s_add_u32 s46, s39, 24576
  buffer_store_dwordx4 v[240:243], v4, s[12:15], s46 offen offset:3072
  s_waitcnt lgkmcnt(0)
  v_mfma_f32_16x16x32_bf16 v[116:119], a[192:195], a[0:3], 0
  buffer_load_dwordx4 a[96:99], v4, s[12:15], s34 offen offset:2048 sc1
  v_mfma_f32_16x16x32_bf16 v[120:123], a[192:195], a[4:7], 0
  ds_read_b64_tr_b16 a[224:225], v8 offset:8192
  ds_read_b64_tr_b16 a[226:227], v8 offset:9216
  v_mfma_f32_16x16x32_bf16 v[124:127], a[192:195], a[8:11], 0
  v_mfma_f32_16x16x32_bf16 v[128:131], a[192:195], a[12:15], 0
  buffer_load_dwordx4 a[100:103], v4, s[12:15], s35 offen offset:2048 sc1
  v_mfma_f32_16x16x32_bf16 v[132:135], a[196:199], a[0:3], 0
  ds_read_b64_tr_b16 a[228:229], v9 offset:8192
  ds_read_b64_tr_b16 a[230:231], v9 offset:9216
  v_mfma_f32_16x16x32_bf16 v[136:139], a[196:199], a[4:7], 0
  v_mfma_f32_16x16x32_bf16 v[140:143], a[196:199], a[8:11], 0
  ds_read_b64_tr_b16 a[232:233], v10 offset:8192
  v_mfma_f32_16x16x32_bf16 v[144:147], a[196:199], a[12:15], 0
  buffer_load_dwordx4 a[104:107], v4, s[12:15], s36 offen offset:2048 sc1
  v_mfma_f32_16x16x32_bf16 v[148:151], a[200:203], a[0:3], 0
  ds_read_b64_tr_b16 a[234:235], v10 offset:9216
  v_mfma_f32_16x16x32_bf16 v[152:155], a[200:203], a[4:7], 0
  ds_read_b64_tr_b16 a[236:237], v11 offset:8192
  v_mfma_f32_16x16x32_bf16 v[156:159], a[200:203], a[8:11], 0
  buffer_load_dwordx4 a[108:111], v4, s[12:15], s37 offen offset:2048 sc1
  v_mfma_f32_16x16x32_bf16 v[160:163], a[200:203], a[12:15], 0
  ds_read_b64_tr_b16 a[238:239], v11 offset:9216
  v_mfma_f32_16x16x32_bf16 v[164:167], a[204:207], a[0:3], 0
  v_mfma_f32_16x16x32_bf16 v[168:171], a[204:207], a[4:7], 0
  ds_read_b64_tr_b16 a[240:241], v12 offset:8192
  v_mfma_f32_16x16x32_bf16 v[172:175], a[204:207], a[8:11], 0
  ds_read_b64_tr_b16 a[242:243], v12 offset:9216
  s_add_u32 s46, s38, 16384
  v_mfma_f32_16x16x32_bf16 v[176:179], a[204:207], a[12:15], 0
  v_mfma_f32_16x16x32_bf16 v[180:183], a[208:211], a[0:3], 0
  ds_read_b64_tr_b16 a[244:245], v13 offset:8192
  v_mfma_f32_16x16x32_bf16 v[184:187], a[208:211], a[4:7], 0
  buffer_store_dwordx4 v[52:55], v4, s[12:15], s46 offen offset:0 sc1
  v_mfma_f32_16x16x32_bf16 v[188:191], a[208:211], a[8:11], 0
  ds_read_b64_tr_b16 a[246:247], v13 offset:9216
  v_mfma_f32_16x16x32_bf16 v[192:195], a[208:211], a[12:15], 0
  ds_read_b64_tr_b16 a[248:249], v14 offset:8192
  v_mfma_f32_16x16x32_bf16 v[196:199], a[212:215], a[0:3], 0
  v_mfma_f32_16x16x32_bf16 v[200:203], a[212:215], a[4:7], 0
  ds_read_b64_tr_b16 a[250:251], v14 offset:9216
  s_add_u32 s46, s38, 16384
  v_mfma_f32_16x16x32_bf16 v[204:207], a[212:215], a[8:11], 0
  ds_read_b64_tr_b16 a[252:253], v15 offset:8192
  v_mfma_f32_16x16x32_bf16 v[208:211], a[212:215], a[12:15], 0
  v_mfma_f32_16x16x32_bf16 v[212:215], a[216:219], a[0:3], 0
  buffer_store_dwordx4 v[56:59], v4, s[12:15], s46 offen offset:1024 sc1
  v_mfma_f32_16x16x32_bf16 v[216:219], a[216:219], a[4:7], 0
  ds_read_b64_tr_b16 a[254:255], v15 offset:9216
  v_mfma_f32_16x16x32_bf16 v[220:223], a[216:219], a[8:11], 0
  v_mfma_f32_16x16x32_bf16 v[224:227], a[216:219], a[12:15], 0
  v_mfma_f32_16x16x32_bf16 v[228:231], a[220:223], a[0:3], 0
  v_mfma_f32_16x16x32_bf16 v[232:235], a[220:223], a[4:7], 0
  v_mfma_f32_16x16x32_bf16 v[236:239], a[220:223], a[8:11], 0
  v_mfma_f32_16x16x32_bf16 v[240:243], a[220:223], a[12:15], 0
  s_waitcnt vmcnt(30) lgkmcnt(0)
  v_mfma_f32_16x16x32_bf16 v[116:119], a[224:227], a[16:19], v[116:119]
  ds_read_b64_tr_b16 a[192:193], v8 offset:16384
  v_accvgpr_write_b32 a0, 0
  v_mfma_f32_16x16x32_bf16 v[120:123], a[224:227], a[20:23], v[120:123]
  buffer_load_dwordx4 a[112:115], v4, s[12:15], s34 offen offset:3072 sc1
  v_mfma_f32_16x16x32_bf16 v[124:127], a[224:227], a[24:27], v[124:127]
  ds_read_b64_tr_b16 a[194:195], v8 offset:17408
  v_accvgpr_write_b32 a1, 0
  v_mfma_f32_16x16x32_bf16 v[128:131], a[224:227], a[28:31], v[128:131]
  ds_read_b64_tr_b16 a[196:197], v9 offset:16384
  v_accvgpr_write_b32 a2, 0
  v_mfma_f32_16x16x32_bf16 v[132:135], a[228:231], a[16:19], v[132:135]
  buffer_load_dwordx4 a[116:119], v4, s[12:15], s35 offen offset:3072 sc1
  v_mfma_f32_16x16x32_bf16 v[136:139], a[228:231], a[20:23], v[136:139]
  ds_read_b64_tr_b16 a[198:199], v9 offset:17408
  v_accvgpr_write_b32 a3, 0
  v_mfma_f32_16x16x32_bf16 v[140:143], a[228:231], a[24:27], v[140:143]
  buffer_load_dwordx4 a[120:123], v4, s[12:15], s36 offen offset:3072 sc1
  v_mfma_f32_16x16x32_bf16 v[144:147], a[228:231], a[28:31], v[144:147]
  ds_read_b64_tr_b16 a[200:201], v10 offset:16384
  v_accvgpr_write_b32 a4, 0
  v_mfma_f32_16x16x32_bf16 v[148:151], a[232:235], a[16:19], v[148:151]
  buffer_load_dwordx4 a[124:127], v4, s[12:15], s37 offen offset:3072 sc1
  v_mfma_f32_16x16x32_bf16 v[152:155], a[232:235], a[20:23], v[152:155]
  ds_read_b64_tr_b16 a[202:203], v10 offset:17408
  v_accvgpr_write_b32 a5, 0
  v_mfma_f32_16x16x32_bf16 v[156:159], a[232:235], a[24:27], v[156:159]
  ds_read_b64_tr_b16 a[204:205], v11 offset:16384
  s_add_u32 s34, s34, 4096
  v_mfma_f32_16x16x32_bf16 v[160:163], a[232:235], a[28:31], v[160:163]
  ds_read_b64_tr_b16 a[206:207], v11 offset:17408
  v_accvgpr_write_b32 a6, 0
  v_mfma_f32_16x16x32_bf16 v[164:167], a[236:239], a[16:19], v[164:167]
  s_add_u32 s35, s35, 4096
  v_accvgpr_write_b32 a7, 0
  v_mfma_f32_16x16x32_bf16 v[168:171], a[236:239], a[20:23], v[168:171]
  ds_read_b64_tr_b16 a[208:209], v12 offset:16384
  v_mfma_f32_16x16x32_bf16 v[172:175], a[236:239], a[24:27], v[172:175]
  ds_read_b64_tr_b16 a[210:211], v12 offset:17408
  s_add_u32 s36, s36, 4096
  v_mfma_f32_16x16x32_bf16 v[176:179], a[236:239], a[28:31], v[176:179]
  v_accvgpr_write_b32 a8, 0
  v_mfma_f32_16x16x32_bf16 v[180:183], a[240:243], a[16:19], v[180:183]
  ds_read_b64_tr_b16 a[212:213], v13 offset:16384
  s_add_u32 s37, s37, 4096
  v_mfma_f32_16x16x32_bf16 v[184:187], a[240:243], a[20:23], v[184:187]
  ds_read_b64_tr_b16 a[214:215], v13 offset:17408
  v_accvgpr_write_b32 a9, 0
  v_mfma_f32_16x16x32_bf16 v[188:191], a[240:243], a[24:27], v[188:191]
  v_accvgpr_write_b32 a10, 0
  s_add_u32 s46, s38, 20480
  v_mfma_f32_16x16x32_bf16 v[192:195], a[240:243], a[28:31], v[192:195]
  ds_read_b64_tr_b16 a[216:217], v14 offset:16384
  v_accvgpr_write_b32 a11, 0
  v_mfma_f32_16x16x32_bf16 v[196:199], a[244:247], a[16:19], v[196:199]
  v_mfma_f32_16x16x32_bf16 v[200:203], a[244:247], a[20:23], v[200:203]
  ds_read_b64_tr_b16 a[218:219], v14 offset:17408
  v_accvgpr_write_b32 a12, 0
  v_mfma_f32_16x16x32_bf16 v[204:207], a[244:247], a[24:27], v[204:207]
  buffer_store_dwordx4 v[60:63], v4, s[12:15], s46 offen offset:0 sc1
  v_mfma_f32_16x16x32_bf16 v[208:211], a[244:247], a[28:31], v[208:211]
  ds_read_b64_tr_b16 a[220:221], v15 offset:16384
  s_add_u32 s46, s38, 20480
  v_mfma_f32_16x16x32_bf16 v[212:215], a[248:251], a[16:19], v[212:215]
  ds_read_b64_tr_b16 a[222:223], v15 offset:17408
  v_accvgpr_write_b32 a13, 0
  v_mfma_f32_16x16x32_bf16 v[216:219], a[248:251], a[20:23], v[216:219]
  buffer_store_dwordx4 v[64:67], v4, s[12:15], s46 offen offset:1024 sc1
  v_mfma_f32_16x16x32_bf16 v[220:223], a[248:251], a[24:27], v[220:223]
  v_accvgpr_write_b32 a14, 0
  v_mfma_f32_16x16x32_bf16 v[224:227], a[248:251], a[28:31], v[224:227]
  v_accvgpr_write_b32 a15, 0
  v_mfma_f32_16x16x32_bf16 v[228:231], a[252:255], a[16:19], v[228:231]
  v_mfma_f32_16x16x32_bf16 v[232:235], a[252:255], a[20:23], v[232:235]
  v_mfma_f32_16x16x32_bf16 v[236:239], a[252:255], a[24:27], v[236:239]
  v_mfma_f32_16x16x32_bf16 v[240:243], a[252:255], a[28:31], v[240:243]
  s_waitcnt vmcnt(32) lgkmcnt(0)
  v_mfma_f32_16x16x32_bf16 v[116:119], a[192:195], a[32:35], v[116:119]
  ds_read_b64_tr_b16 a[224:225], v8 offset:24576
  v_accvgpr_write_b32 a16, 0
  v_mfma_f32_16x16x32_bf16 v[120:123], a[192:195], a[36:39], v[120:123]
  ds_read_b64_tr_b16 a[226:227], v8 offset:25600
  v_accvgpr_write_b32 a17, 0
  v_mfma_f32_16x16x32_bf16 v[124:127], a[192:195], a[40:43], v[124:127]
  buffer_load_dwordx4 a[128:131], v4, s[12:15], s34 offen offset:0 sc1
  v_mfma_f32_16x16x32_bf16 v[128:131], a[192:195], a[44:47], v[128:131]
  ds_read_b64_tr_b16 a[228:229], v9 offset:24576
  v_accvgpr_write_b32 a18, 0
  v_mfma_f32_16x16x32_bf16 v[132:135], a[196:199], a[32:35], v[132:135]
  buffer_load_dwordx4 a[132:135], v4, s[12:15], s35 offen offset:0 sc1
  v_mfma_f32_16x16x32_bf16 v[136:139], a[196:199], a[36:39], v[136:139]
  ds_read_b64_tr_b16 a[230:231], v9 offset:25600
  v_accvgpr_write_b32 a19, 0
  v_mfma_f32_16x16x32_bf16 v[140:143], a[196:199], a[40:43], v[140:143]
  ds_read_b64_tr_b16 a[232:233], v10 offset:24576
  v_mfma_f32_16x16x32_bf16 v[144:147], a[196:199], a[44:47], v[144:147]
  buffer_load_dwordx4 a[136:139], v4, s[12:15], s36 offen offset:0 sc1
  v_mfma_f32_16x16x32_bf16 v[148:151], a[200:203], a[32:35], v[148:151]
  ds_read_b64_tr_b16 a[234:235], v10 offset:25600
  v_accvgpr_write_b32 a20, 0
  v_mfma_f32_16x16x32_bf16 v[152:155], a[200:203], a[36:39], v[152:155]
  ds_read_b64_tr_b16 a[236:237], v11 offset:24576
  v_accvgpr_write_b32 a21, 0
  v_mfma_f32_16x16x32_bf16 v[156:159], a[200:203], a[40:43], v[156:159]
  buffer_load_dwordx4 a[140:143], v4, s[12:15], s37 offen offset:0 sc1
  v_mfma_f32_16x16x32_bf16 v[160:163], a[200:203], a[44:47], v[160:163]
  ds_read_b64_tr_b16 a[238:239], v11 offset:25600
  v_accvgpr_write_b32 a22, 0
  v_mfma_f32_16x16x32_bf16 v[164:167], a[204:207], a[32:35], v[164:167]
  v_accvgpr_write_b32 a23, 0
  v_mfma_f32_16x16x32_bf16 v[168:171], a[204:207], a[36:39], v[168:171]
  ds_read_b64_tr_b16 a[240:241], v12 offset:24576
  v_mfma_f32_16x16x32_bf16 v[172:175], a[204:207], a[40:43], v[172:175]
  ds_read_b64_tr_b16 a[242:243], v12 offset:25600
  v_accvgpr_write_b32 a24, 0
  v_mfma_f32_16x16x32_bf16 v[176:179], a[204:207], a[44:47], v[176:179]
  s_add_u32 s46, s38, 24576
  v_mfma_f32_16x16x32_bf16 v[180:183], a[208:211], a[32:35], v[180:183]
  ds_read_b64_tr_b16 a[244:245], v13 offset:24576
  v_accvgpr_write_b32 a25, 0
  v_mfma_f32_16x16x32_bf16 v[184:187], a[208:211], a[36:39], v[184:187]
  buffer_store_dwordx4 v[68:71], v4, s[12:15], s46 offen offset:0 sc1
  v_mfma_f32_16x16x32_bf16 v[188:191], a[208:211], a[40:43], v[188:191]
  ds_read_b64_tr_b16 a[246:247], v13 offset:25600
  v_accvgpr_write_b32 a26, 0
  v_mfma_f32_16x16x32_bf16 v[192:195], a[208:211], a[44:47], v[192:195]
  ds_read_b64_tr_b16 a[248:249], v14 offset:24576
  v_accvgpr_write_b32 a27, 0
  v_mfma_f32_16x16x32_bf16 v[196:199], a[212:215], a[32:35], v[196:199]
  v_mfma_f32_16x16x32_bf16 v[200:203], a[212:215], a[36:39], v[200:203]
  ds_read_b64_tr_b16 a[250:251], v14 offset:25600
  v_accvgpr_write_b32 a28, 0
  v_mfma_f32_16x16x32_bf16 v[204:207], a[212:215], a[40:43], v[204:207]
  ds_read_b64_tr_b16 a[252:253], v15 offset:24576
  s_add_u32 s46, s38, 24576
  v_mfma_f32_16x16x32_bf16 v[208:211], a[212:215], a[44:47], v[208:211]
  v_accvgpr_write_b32 a29, 0
  v_mfma_f32_16x16x32_bf16 v[212:215], a[216:219], a[32:35], v[212:215]
  buffer_store_dwordx4 v[72:75], v4, s[12:15], s46 offen offset:1024 sc1
  v_mfma_f32_16x16x32_bf16 v[216:219], a[216:219], a[36:39], v[216:219]
  ds_read_b64_tr_b16 a[254:255], v15 offset:25600
  v_accvgpr_write_b32 a30, 0
  v_mfma_f32_16x16x32_bf16 v[220:223], a[216:219], a[40:43], v[220:223]
  v_mfma_f32_16x16x32_bf16 v[224:227], a[216:219], a[44:47], v[224:227]
  v_accvgpr_write_b32 a31, 0
  v_mfma_f32_16x16x32_bf16 v[228:231], a[220:223], a[32:35], v[228:231]
  v_mfma_f32_16x16x32_bf16 v[232:235], a[220:223], a[36:39], v[232:235]
  v_mfma_f32_16x16x32_bf16 v[236:239], a[220:223], a[40:43], v[236:239]
  v_mfma_f32_16x16x32_bf16 v[240:243], a[220:223], a[44:47], v[240:243]
  s_waitcnt vmcnt(34) lgkmcnt(0)
  v_mfma_f32_16x16x32_bf16 v[116:119], a[224:227], a[48:51], v[116:119]
  ds_read_b64_tr_b16 a[192:193], v8 offset:32768
  v_accvgpr_write_b32 a32, 0
  v_mfma_f32_16x16x32_bf16 v[120:123], a[224:227], a[52:55], v[120:123]
  ds_read_b64_tr_b16 a[194:195], v8 offset:33792
  v_accvgpr_write_b32 a33, 0
  v_mfma_f32_16x16x32_bf16 v[124:127], a[224:227], a[56:59], v[124:127]
  buffer_load_dwordx4 a[144:147], v4, s[12:15], s34 offen offset:1024 sc1
  v_mfma_f32_16x16x32_bf16 v[128:131], a[224:227], a[60:63], v[128:131]
  ds_read_b64_tr_b16 a[196:197], v9 offset:32768
  v_accvgpr_write_b32 a34, 0
  v_mfma_f32_16x16x32_bf16 v[132:135], a[228:231], a[48:51], v[132:135]
  buffer_load_dwordx4 a[148:151], v4, s[12:15], s35 offen offset:1024 sc1
  v_mfma_f32_16x16x32_bf16 v[136:139], a[228:231], a[52:55], v[136:139]
  ds_read_b64_tr_b16 a[198:199], v9 offset:33792
  v_accvgpr_write_b32 a35, 0
  v_mfma_f32_16x16x32_bf16 v[140:143], a[228:231], a[56:59], v[140:143]
  ds_read_b64_tr_b16 a[200:201], v10 offset:32768
  v_mfma_f32_16x16x32_bf16 v[144:147], a[228:231], a[60:63], v[144:147]
  buffer_load_dwordx4 a[152:155], v4, s[12:15], s36 offen offset:1024 sc1
  v_mfma_f32_16x16x32_bf16 v[148:151], a[232:235], a[48:51], v[148:151]
  ds_read_b64_tr_b16 a[202:203], v10 offset:33792
  v_accvgpr_write_b32 a36, 0
  v_mfma_f32_16x16x32_bf16 v[152:155], a[232:235], a[52:55], v[152:155]
  ds_read_b64_tr_b16 a[204:205], v11 offset:32768
  v_accvgpr_write_b32 a37, 0
  v_mfma_f32_16x16x32_bf16 v[156:159], a[232:235], a[56:59], v[156:159]
  buffer_load_dwordx4 a[156:159], v4, s[12:15], s37 offen offset:1024 sc1
  v_mfma_f32_16x16x32_bf16 v[160:163], a[232:235], a[60:63], v[160:163]
  ds_read_b64_tr_b16 a[206:207], v11 offset:33792
  v_accvgpr_write_b32 a38, 0
  v_mfma_f32_16x16x32_bf16 v[164:167], a[236:239], a[48:51], v[164:167]
  v_accvgpr_write_b32 a39, 0
  v_mfma_f32_16x16x32_bf16 v[168:171], a[236:239], a[52:55], v[168:171]
  ds_read_b64_tr_b16 a[208:209], v12 offset:32768
  v_mfma_f32_16x16x32_bf16 v[172:175], a[236:239], a[56:59], v[172:175]
  ds_read_b64_tr_b16 a[210:211], v12 offset:33792
  v_accvgpr_write_b32 a40, 0
  v_mfma_f32_16x16x32_bf16 v[176:179], a[236:239], a[60:63], v[176:179]
  s_add_u32 s46, s38, 28672
  v_mfma_f32_16x16x32_bf16 v[180:183], a[240:243], a[48:51], v[180:183]
  ds_read_b64_tr_b16 a[212:213], v13 offset:32768
  v_accvgpr_write_b32 a41, 0
  v_mfma_f32_16x16x32_bf16 v[184:187], a[240:243], a[52:55], v[184:187]
  buffer_store_dwordx4 v[76:79], v4, s[12:15], s46 offen offset:0 sc1
  v_mfma_f32_16x16x32_bf16 v[188:191], a[240:243], a[56:59], v[188:191]
  ds_read_b64_tr_b16 a[214:215], v13 offset:33792
  v_accvgpr_write_b32 a42, 0
  v_mfma_f32_16x16x32_bf16 v[192:195], a[240:243], a[60:63], v[192:195]
  ds_read_b64_tr_b16 a[216:217], v14 offset:32768
  v_accvgpr_write_b32 a43, 0
  v_mfma_f32_16x16x32_bf16 v[196:199], a[244:247], a[48:51], v[196:199]
  v_mfma_f32_16x16x32_bf16 v[200:203], a[244:247], a[52:55], v[200:203]
  ds_read_b64_tr_b16 a[218:219], v14 offset:33792
  v_accvgpr_write_b32 a44, 0
  v_mfma_f32_16x16x32_bf16 v[204:207], a[244:247], a[56:59], v[204:207]
  ds_read_b64_tr_b16 a[220:221], v15 offset:32768
  s_add_u32 s46, s38, 28672
  v_mfma_f32_16x16x32_bf16 v[208:211], a[244:247], a[60:63], v[208:211]
  v_accvgpr_write_b32 a45, 0
  v_mfma_f32_16x16x32_bf16 v[212:215], a[248:251], a[48:51], v[212:215]
  buffer_store_dwordx4 v[80:83], v4, s[12:15], s46 offen offset:1024 sc1
  v_mfma_f32_16x16x32_bf16 v[216:219], a[248:251], a[52:55], v[216:219]
  ds_read_b64_tr_b16 a[222:223], v15 offset:33792
  v_accvgpr_write_b32 a46, 0
  v_mfma_f32_16x16x32_bf16 v[220:223], a[248:251], a[56:59], v[220:223]
  v_mfma_f32_16x16x32_bf16 v[224:227], a[248:251], a[60:63], v[224:227]
  v_accvgpr_write_b32 a47, 0
  v_mfma_f32_16x16x32_bf16 v[228:231], a[252:255], a[48:51], v[228:231]
  v_mfma_f32_16x16x32_bf16 v[232:235], a[252:255], a[52:55], v[232:235]
  v_mfma_f32_16x16x32_bf16 v[236:239], a[252:255], a[56:59], v[236:239]
  v_mfma_f32_16x16x32_bf16 v[240:243], a[252:255], a[60:63], v[240:243]
  s_waitcnt vmcnt(36) lgkmcnt(0)
  v_mfma_f32_16x16x32_bf16 v[116:119], a[192:195], a[64:67], v[116:119]
  ds_read_b64_tr_b16 a[224:225], v8 offset:40960
  v_accvgpr_write_b32 a48, 0
  v_mfma_f32_16x16x32_bf16 v[120:123], a[192:195], a[68:71], v[120:123]
  ds_read_b64_tr_b16 a[226:227], v8 offset:41984
  v_accvgpr_write_b32 a49, 0
  v_mfma_f32_16x16x32_bf16 v[124:127], a[192:195], a[72:75], v[124:127]
  buffer_load_dwordx4 a[160:163], v4, s[12:15], s34 offen offset:2048 sc1
  v_mfma_f32_16x16x32_bf16 v[128:131], a[192:195], a[76:79], v[128:131]
  ds_read_b64_tr_b16 a[228:229], v9 offset:40960
  v_accvgpr_write_b32 a50, 0
  v_mfma_f32_16x16x32_bf16 v[132:135], a[196:199], a[64:67], v[132:135]
  buffer_load_dwordx4 a[164:167], v4, s[12:15], s35 offen offset:2048 sc1
  v_mfma_f32_16x16x32_bf16 v[136:139], a[196:199], a[68:71], v[136:139]
  ds_read_b64_tr_b16 a[230:231], v9 offset:41984
  v_accvgpr_write_b32 a51, 0
  v_mfma_f32_16x16x32_bf16 v[140:143], a[196:199], a[72:75], v[140:143]
  ds_read_b64_tr_b16 a[232:233], v10 offset:40960
  v_mfma_f32_16x16x32_bf16 v[144:147], a[196:199], a[76:79], v[144:147]
  buffer_load_dwordx4 a[168:171], v4, s[12:15], s36 offen offset:2048 sc1
  v_mfma_f32_16x16x32_bf16 v[148:151], a[200:203], a[64:67], v[148:151]
  ds_read_b64_tr_b16 a[234:235], v10 offset:41984
  v_accvgpr_write_b32 a52, 0
  v_mfma_f32_16x16x32_bf16 v[152:155], a[200:203], a[68:71], v[152:155]
  ds_read_b64_tr_b16 a[236:237], v11 offset:40960
  v_accvgpr_write_b32 a53, 0
  v_mfma_f32_16x16x32_bf16 v[156:159], a[200:203], a[72:75], v[156:159]
  buffer_load_dwordx4 a[172:175], v4, s[12:15], s37 offen offset:2048 sc1
  v_mfma_f32_16x16x32_bf16 v[160:163], a[200:203], a[76:79], v[160:163]
  ds_read_b64_tr_b16 a[238:239], v11 offset:41984
  v_accvgpr_write_b32 a54, 0
  v_mfma_f32_16x16x32_bf16 v[164:167], a[204:207], a[64:67], v[164:167]
  v_accvgpr_write_b32 a55, 0
  v_mfma_f32_16x16x32_bf16 v[168:171], a[204:207], a[68:71], v[168:171]
  ds_read_b64_tr_b16 a[240:241], v12 offset:40960
  v_mfma_f32_16x16x32_bf16 v[172:175], a[204:207], a[72:75], v[172:175]
  ds_read_b64_tr_b16 a[242:243], v12 offset:41984
  v_accvgpr_write_b32 a56, 0
  v_mfma_f32_16x16x32_bf16 v[176:179], a[204:207], a[76:79], v[176:179]
  s_add_u32 s46, s39, 0
  v_mfma_f32_16x16x32_bf16 v[180:183], a[208:211], a[64:67], v[180:183]
  ds_read_b64_tr_b16 a[244:245], v13 offset:40960
  v_accvgpr_write_b32 a57, 0
  v_mfma_f32_16x16x32_bf16 v[184:187], a[208:211], a[68:71], v[184:187]
  buffer_store_dwordx4 v[84:87], v4, s[12:15], s46 offen offset:0
  v_mfma_f32_16x16x32_bf16 v[188:191], a[208:211], a[72:75], v[188:191]
  ds_read_b64_tr_b16 a[246:247], v13 offset:41984
  v_accvgpr_write_b32 a58, 0
  v_mfma_f32_16x16x32_bf16 v[192:195], a[208:211], a[76:79], v[192:195]
  ds_read_b64_tr_b16 a[248:249], v14 offset:40960
  v_accvgpr_write_b32 a59, 0
  v_mfma_f32_16x16x32_bf16 v[196:199], a[212:215], a[64:67], v[196:199]
  v_mfma_f32_16x16x32_bf16 v[200:203], a[212:215], a[68:71], v[200:203]
  ds_read_b64_tr_b16 a[250:251], v14 offset:41984
  v_accvgpr_write_b32 a60, 0
  v_mfma_f32_16x16x32_bf16 v[204:207], a[212:215], a[72:75], v[204:207]
  ds_read_b64_tr_b16 a[252:253], v15 offset:40960
  s_add_u32 s46, s39, 0
  v_mfma_f32_16x16x32_bf16 v[208:211], a[212:215], a[76:79], v[208:211]
  v_accvgpr_write_b32 a61, 0
  v_mfma_f32_16x16x32_bf16 v[212:215], a[216:219], a[64:67], v[212:215]
  buffer_store_dwordx4 v[88:91], v4, s[12:15], s46 offen offset:1024
  v_mfma_f32_16x16x32_bf16 v[216:219], a[216:219], a[68:71], v[216:219]
  ds_read_b64_tr_b16 a[254:255], v15 offset:41984
  v_accvgpr_write_b32 a62, 0
  v_mfma_f32_16x16x32_bf16 v[220:223], a[216:219], a[72:75], v[220:223]
  v_mfma_f32_16x16x32_bf16 v[224:227], a[216:219], a[76:79], v[224:227]
  v_accvgpr_write_b32 a63, 0
  v_mfma_f32_16x16x32_bf16 v[228:231], a[220:223], a[64:67], v[228:231]
  v_mfma_f32_16x16x32_bf16 v[232:235], a[220:223], a[68:71], v[232:235]
  v_mfma_f32_16x16x32_bf16 v[236:239], a[220:223], a[72:75], v[236:239]
  v_mfma_f32_16x16x32_bf16 v[240:243], a[220:223], a[76:79], v[240:243]
  s_waitcnt vmcnt(38) lgkmcnt(0)
  s_barrier
  v_mfma_f32_16x16x32_bf16 v[116:119], a[224:227], a[80:83], v[116:119]
  ds_read_b64_tr_b16 a[192:193], v8 offset:49152
  v_accvgpr_write_b32 a64, 0
  v_mfma_f32_16x16x32_bf16 v[120:123], a[224:227], a[84:87], v[120:123]
  buffer_load_dwordx4 a[176:179], v4, s[12:15], s34 offen offset:3072 sc1
  v_mfma_f32_16x16x32_bf16 v[124:127], a[224:227], a[88:91], v[124:127]
  ds_read_b64_tr_b16 a[194:195], v8 offset:50176
  v_accvgpr_write_b32 a65, 0
  v_mfma_f32_16x16x32_bf16 v[128:131], a[224:227], a[92:95], v[128:131]
  ds_read_b64_tr_b16 a[196:197], v9 offset:49152
  v_accvgpr_write_b32 a66, 0
  v_mfma_f32_16x16x32_bf16 v[132:135], a[228:231], a[80:83], v[132:135]
  buffer_load_dwordx4 a[180:183], v4, s[12:15], s35 offen offset:3072 sc1
  v_mfma_f32_16x16x32_bf16 v[136:139], a[228:231], a[84:87], v[136:139]
  ds_read_b64_tr_b16 a[198:199], v9 offset:50176
  v_accvgpr_write_b32 a67, 0
  v_mfma_f32_16x16x32_bf16 v[140:143], a[228:231], a[88:91], v[140:143]
  buffer_load_dwordx4 a[184:187], v4, s[12:15], s36 offen offset:3072 sc1
  v_mfma_f32_16x16x32_bf16 v[144:147], a[228:231], a[92:95], v[144:147]
  ds_read_b64_tr_b16 a[200:201], v10 offset:49152
  v_accvgpr_write_b32 a68, 0
  v_mfma_f32_16x16x32_bf16 v[148:151], a[232:235], a[80:83], v[148:151]
  buffer_load_dwordx4 a[188:191], v4, s[12:15], s37 offen offset:3072 sc1
  v_mfma_f32_16x16x32_bf16 v[152:155], a[232:235], a[84:87], v[152:155]
  ds_read_b64_tr_b16 a[202:203], v10 offset:50176
  v_accvgpr_write_b32 a69, 0
  v_mfma_f32_16x16x32_bf16 v[156:159], a[232:235], a[88:91], v[156:159]
  ds_read_b64_tr_b16 a[204:205], v11 offset:49152
  s_add_u32 s34, s34, 4096
  v_mfma_f32_16x16x32_bf16 v[160:163], a[232:235], a[92:95], v[160:163]
  ds_read_b64_tr_b16 a[206:207], v11 offset:50176
  v_accvgpr_write_b32 a70, 0
  v_mfma_f32_16x16x32_bf16 v[164:167], a[236:239], a[80:83], v[164:167]
  s_add_u32 s35, s35, 4096
  v_accvgpr_write_b32 a71, 0
  v_mfma_f32_16x16x32_bf16 v[168:171], a[236:239], a[84:87], v[168:171]
  ds_read_b64_tr_b16 a[208:209], v12 offset:49152
  v_mfma_f32_16x16x32_bf16 v[172:175], a[236:239], a[88:91], v[172:175]
  ds_read_b64_tr_b16 a[210:211], v12 offset:50176
  s_add_u32 s36, s36, 4096
  v_mfma_f32_16x16x32_bf16 v[176:179], a[236:239], a[92:95], v[176:179]
  v_accvgpr_write_b32 a72, 0
  v_mfma_f32_16x16x32_bf16 v[180:183], a[240:243], a[80:83], v[180:183]
  ds_read_b64_tr_b16 a[212:213], v13 offset:49152
  s_add_u32 s37, s37, 4096
  v_mfma_f32_16x16x32_bf16 v[184:187], a[240:243], a[84:87], v[184:187]
  ds_read_b64_tr_b16 a[214:215], v13 offset:50176
  v_accvgpr_write_b32 a73, 0
  v_mfma_f32_16x16x32_bf16 v[188:191], a[240:243], a[88:91], v[188:191]
  v_accvgpr_write_b32 a74, 0
  s_add_u32 s46, s39, 0
  v_mfma_f32_16x16x32_bf16 v[192:195], a[240:243], a[92:95], v[192:195]
  ds_read_b64_tr_b16 a[216:217], v14 offset:49152
  v_accvgpr_write_b32 a75, 0
  v_mfma_f32_16x16x32_bf16 v[196:199], a[244:247], a[80:83], v[196:199]
  v_mfma_f32_16x16x32_bf16 v[200:203], a[244:247], a[84:87], v[200:203]
  ds_read_b64_tr_b16 a[218:219], v14 offset:50176
  v_accvgpr_write_b32 a76, 0
  v_mfma_f32_16x16x32_bf16 v[204:207], a[244:247], a[88:91], v[204:207]
  buffer_store_dwordx4 v[92:95], v4, s[12:15], s46 offen offset:2048
  v_mfma_f32_16x16x32_bf16 v[208:211], a[244:247], a[92:95], v[208:211]
  ds_read_b64_tr_b16 a[220:221], v15 offset:49152
  s_add_u32 s46, s39, 0
  v_mfma_f32_16x16x32_bf16 v[212:215], a[248:251], a[80:83], v[212:215]
  ds_read_b64_tr_b16 a[222:223], v15 offset:50176
  v_accvgpr_write_b32 a77, 0
  v_mfma_f32_16x16x32_bf16 v[216:219], a[248:251], a[84:87], v[216:219]
  buffer_store_dwordx4 v[96:99], v4, s[12:15], s46 offen offset:3072
  v_mfma_f32_16x16x32_bf16 v[220:223], a[248:251], a[88:91], v[220:223]
  v_accvgpr_write_b32 a78, 0
  v_mfma_f32_16x16x32_bf16 v[224:227], a[248:251], a[92:95], v[224:227]
  v_accvgpr_write_b32 a79, 0
  v_mfma_f32_16x16x32_bf16 v[228:231], a[252:255], a[80:83], v[228:231]
  v_mfma_f32_16x16x32_bf16 v[232:235], a[252:255], a[84:87], v[232:235]
  v_mfma_f32_16x16x32_bf16 v[236:239], a[252:255], a[88:91], v[236:239]
  v_mfma_f32_16x16x32_bf16 v[240:243], a[252:255], a[92:95], v[240:243]
  s_waitcnt vmcnt(32) lgkmcnt(0)
  v_mfma_f32_16x16x32_bf16 v[116:119], a[192:195], a[96:99], v[116:119]
  ds_read_b64_tr_b16 a[224:225], v8 offset:57344
  v_accvgpr_write_b32 a80, 0
  v_mfma_f32_16x16x32_bf16 v[120:123], a[192:195], a[100:103], v[120:123]
  ds_read_b64_tr_b16 a[226:227], v8 offset:58368
  v_accvgpr_write_b32 a81, 0
  v_mfma_f32_16x16x32_bf16 v[124:127], a[192:195], a[104:107], v[124:127]
  buffer_load_dwordx4 v[52:55], v4, s[12:15], s34 offen offset:0 sc1
  v_mfma_f32_16x16x32_bf16 v[128:131], a[192:195], a[108:111], v[128:131]
  ds_read_b64_tr_b16 a[228:229], v9 offset:57344
  v_accvgpr_write_b32 a82, 0
  v_mfma_f32_16x16x32_bf16 v[132:135], a[196:199], a[96:99], v[132:135]
  buffer_load_dwordx4 v[56:59], v4, s[12:15], s35 offen offset:0 sc1
  v_mfma_f32_16x16x32_bf16 v[136:139], a[196:199], a[100:103], v[136:139]
  ds_read_b64_tr_b16 a[230:231], v9 offset:58368
  v_accvgpr_write_b32 a83, 0
  v_mfma_f32_16x16x32_bf16 v[140:143], a[196:199], a[104:107], v[140:143]
  ds_read_b64_tr_b16 a[232:233], v10 offset:57344
  v_mfma_f32_16x16x32_bf16 v[144:147], a[196:199], a[108:111], v[144:147]
  buffer_load_dwordx4 v[60:63], v4, s[12:15], s36 offen offset:0 sc1
  v_mfma_f32_16x16x32_bf16 v[148:151], a[200:203], a[96:99], v[148:151]
  ds_read_b64_tr_b16 a[234:235], v10 offset:58368
  v_accvgpr_write_b32 a84, 0
  v_mfma_f32_16x16x32_bf16 v[152:155], a[200:203], a[100:103], v[152:155]
  ds_read_b64_tr_b16 a[236:237], v11 offset:57344
  v_accvgpr_write_b32 a85, 0
  v_mfma_f32_16x16x32_bf16 v[156:159], a[200:203], a[104:107], v[156:159]
  buffer_load_dwordx4 v[64:67], v4, s[12:15], s37 offen offset:0 sc1
  v_mfma_f32_16x16x32_bf16 v[160:163], a[200:203], a[108:111], v[160:163]
  ds_read_b64_tr_b16 a[238:239], v11 offset:58368
  v_accvgpr_write_b32 a86, 0
  v_mfma_f32_16x16x32_bf16 v[164:167], a[204:207], a[96:99], v[164:167]
  v_accvgpr_write_b32 a87, 0
  v_mfma_f32_16x16x32_bf16 v[168:171], a[204:207], a[100:103], v[168:171]
  ds_read_b64_tr_b16 a[240:241], v12 offset:57344
  v_mfma_f32_16x16x32_bf16 v[172:175], a[204:207], a[104:107], v[172:175]
  ds_read_b64_tr_b16 a[242:243], v12 offset:58368
  v_accvgpr_write_b32 a88, 0
  v_mfma_f32_16x16x32_bf16 v[176:179], a[204:207], a[108:111], v[176:179]
  s_add_u32 s46, s39, 8192
  v_mfma_f32_16x16x32_bf16 v[180:183], a[208:211], a[96:99], v[180:183]
  ds_read_b64_tr_b16 a[244:245], v13 offset:57344
  v_accvgpr_write_b32 a89, 0
  v_mfma_f32_16x16x32_bf16 v[184:187], a[208:211], a[100:103], v[184:187]
  buffer_store_dwordx4 v[100:103], v4, s[12:15], s46 offen offset:0
  v_mfma_f32_16x16x32_bf16 v[188:191], a[208:211], a[104:107], v[188:191]
  ds_read_b64_tr_b16 a[246:247], v13 offset:58368
  v_accvgpr_write_b32 a90, 0
  v_mfma_f32_16x16x32_bf16 v[192:195], a[208:211], a[108:111], v[192:195]
  ds_read_b64_tr_b16 a[248:249], v14 offset:57344
  v_accvgpr_write_b32 a91, 0
  v_mfma_f32_16x16x32_bf16 v[196:199], a[212:215], a[96:99], v[196:199]
  v_mfma_f32_16x16x32_bf16 v[200:203], a[212:215], a[100:103], v[200:203]
  ds_read_b64_tr_b16 a[250:251], v14 offset:58368
  v_accvgpr_write_b32 a92, 0
  v_mfma_f32_16x16x32_bf16 v[204:207], a[212:215], a[104:107], v[204:207]
  ds_read_b64_tr_b16 a[252:253], v15 offset:57344
  s_add_u32 s46, s39, 8192
  v_mfma_f32_16x16x32_bf16 v[208:211], a[212:215], a[108:111], v[208:211]
  v_accvgpr_write_b32 a93, 0
  v_mfma_f32_16x16x32_bf16 v[212:215], a[216:219], a[96:99], v[212:215]
  buffer_store_dwordx4 v[104:107], v4, s[12:15], s46 offen offset:1024
  v_mfma_f32_16x16x32_bf16 v[216:219], a[216:219], a[100:103], v[216:219]
  ds_read_b64_tr_b16 a[254:255], v15 offset:58368
  v_accvgpr_write_b32 a94, 0
  v_mfma_f32_16x16x32_bf16 v[220:223], a[216:219], a[104:107], v[220:223]
  v_mfma_f32_16x16x32_bf16 v[224:227], a[216:219], a[108:111], v[224:227]
  v_accvgpr_write_b32 a95, 0
  v_mfma_f32_16x16x32_bf16 v[228:231], a[220:223], a[96:99], v[228:231]
  v_mfma_f32_16x16x32_bf16 v[232:235], a[220:223], a[100:103], v[232:235]
  v_mfma_f32_16x16x32_bf16 v[236:239], a[220:223], a[104:107], v[236:239]
  v_mfma_f32_16x16x32_bf16 v[240:243], a[220:223], a[108:111], v[240:243]
  s_waitcnt vmcnt(32) lgkmcnt(0)
  v_mfma_f32_16x16x32_bf16 v[116:119], a[224:227], a[112:115], v[116:119]
  v_add_u32 v8, 0x10000, v8
  v_accvgpr_write_b32 a96, 0
  v_mfma_f32_16x16x32_bf16 v[120:123], a[224:227], a[116:119], v[120:123]
  v_add_u32 v9, 0x10000, v9
  v_accvgpr_write_b32 a97, 0
  v_mfma_f32_16x16x32_bf16 v[124:127], a[224:227], a[120:123], v[124:127]
  buffer_load_dwordx4 v[68:71], v4, s[12:15], s34 offen offset:1024 sc1
  v_mfma_f32_16x16x32_bf16 v[128:131], a[224:227], a[124:127], v[128:131]
  v_add_u32 v10, 0x10000, v10
  v_add_u32 v11, 0x10000, v11
  v_mfma_f32_16x16x32_bf16 v[132:135], a[228:231], a[112:115], v[132:135]
  v_add_u32 v12, 0x10000, v12
  v_accvgpr_write_b32 a98, 0
  v_mfma_f32_16x16x32_bf16 v[136:139], a[228:231], a[116:119], v[136:139]
  v_add_u32 v13, 0x10000, v13
  v_accvgpr_write_b32 a99, 0
  v_mfma_f32_16x16x32_bf16 v[140:143], a[228:231], a[120:123], v[140:143]
  buffer_load_dwordx4 v[72:75], v4, s[12:15], s35 offen offset:1024 sc1
  v_mfma_f32_16x16x32_bf16 v[144:147], a[228:231], a[124:127], v[144:147]
  v_add_u32 v14, 0x10000, v14
  v_add_u32 v15, 0x10000, v15
  v_mfma_f32_16x16x32_bf16 v[148:151], a[232:235], a[112:115], v[148:151]
  ds_read_b64_tr_b16 a[192:193], v8 offset:0
  v_accvgpr_write_b32 a100, 0
  v_mfma_f32_16x16x32_bf16 v[152:155], a[232:235], a[116:119], v[152:155]
  ds_read_b64_tr_b16 a[194:195], v8 offset:1024
  v_accvgpr_write_b32 a101, 0
  v_mfma_f32_16x16x32_bf16 v[156:159], a[232:235], a[120:123], v[156:159]
  buffer_load_dwordx4 v[76:79], v4, s[12:15], s36 offen offset:1024 sc1
  v_mfma_f32_16x16x32_bf16 v[160:163], a[232:235], a[124:127], v[160:163]
  ds_read_b64_tr_b16 a[196:197], v9 offset:0
  v_accvgpr_write_b32 a102, 0
  v_mfma_f32_16x16x32_bf16 v[164:167], a[236:239], a[112:115], v[164:167]
  ds_read_b64_tr_b16 a[198:199], v9 offset:1024
  v_accvgpr_write_b32 a103, 0
  v_mfma_f32_16x16x32_bf16 v[168:171], a[236:239], a[116:119], v[168:171]
  buffer_load_dwordx4 v[80:83], v4, s[12:15], s37 offen offset:1024 sc1
  v_mfma_f32_16x16x32_bf16 v[172:175], a[236:239], a[120:123], v[172:175]
  ds_read_b64_tr_b16 a[200:201], v10 offset:0
  ds_read_b64_tr_b16 a[202:203], v10 offset:1024
  v_mfma_f32_16x16x32_bf16 v[176:179], a[236:239], a[124:127], v[176:179]
  ds_read_b64_tr_b16 a[204:205], v11 offset:0
  v_accvgpr_write_b32 a104, 0
  v_mfma_f32_16x16x32_bf16 v[180:183], a[240:243], a[112:115], v[180:183]
  ds_read_b64_tr_b16 a[206:207], v11 offset:1024
  s_add_u32 s46, s39, 8192
  v_mfma_f32_16x16x32_bf16 v[184:187], a[240:243], a[116:119], v[184:187]
  ds_read_b64_tr_b16 a[208:209], v12 offset:0
  v_accvgpr_write_b32 a105, 0
  v_mfma_f32_16x16x32_bf16 v[188:191], a[240:243], a[120:123], v[188:191]
  ds_read_b64_tr_b16 a[210:211], v12 offset:1024
  v_accvgpr_write_b32 a106, 0
  v_mfma_f32_16x16x32_bf16 v[192:195], a[240:243], a[124:127], v[192:195]
  ds_read_b64_tr_b16 a[212:213], v13 offset:0
  v_accvgpr_write_b32 a107, 0
  v_mfma_f32_16x16x32_bf16 v[196:199], a[244:247], a[112:115], v[196:199]
  buffer_store_dwordx4 v[108:111], v4, s[12:15], s46 offen offset:2048
  v_mfma_f32_16x16x32_bf16 v[200:203], a[244:247], a[116:119], v[200:203]
  ds_read_b64_tr_b16 a[214:215], v13 offset:1024
  ds_read_b64_tr_b16 a[216:217], v14 offset:0
  v_mfma_f32_16x16x32_bf16 v[204:207], a[244:247], a[120:123], v[204:207]
  ds_read_b64_tr_b16 a[218:219], v14 offset:1024
  v_accvgpr_write_b32 a108, 0
  v_mfma_f32_16x16x32_bf16 v[208:211], a[244:247], a[124:127], v[208:211]
  ds_read_b64_tr_b16 a[220:221], v15 offset:0
  s_add_u32 s46, s39, 8192
  v_mfma_f32_16x16x32_bf16 v[212:215], a[248:251], a[112:115], v[212:215]
  ds_read_b64_tr_b16 a[222:223], v15 offset:1024
  v_accvgpr_write_b32 a109, 0
  v_mfma_f32_16x16x32_bf16 v[216:219], a[248:251], a[116:119], v[216:219]
  buffer_store_dwordx4 v[112:115], v4, s[12:15], s46 offen offset:3072
  v_mfma_f32_16x16x32_bf16 v[220:223], a[248:251], a[120:123], v[220:223]
  v_accvgpr_write_b32 a110, 0
  v_mfma_f32_16x16x32_bf16 v[224:227], a[248:251], a[124:127], v[224:227]
  v_accvgpr_write_b32 a111, 0
  v_mfma_f32_16x16x32_bf16 v[228:231], a[252:255], a[112:115], v[228:231]
  v_mfma_f32_16x16x32_bf16 v[232:235], a[252:255], a[116:119], v[232:235]
  v_mfma_f32_16x16x32_bf16 v[236:239], a[252:255], a[120:123], v[236:239]
  v_mfma_f32_16x16x32_bf16 v[240:243], a[252:255], a[124:127], v[240:243]
  s_waitcnt vmcnt(32) lgkmcnt(0)
  v_mfma_f32_16x16x32_bf16 v[116:119], a[192:195], a[128:131], v[116:119]
  ds_read_b64_tr_b16 a[224:225], v8 offset:8192
  v_accvgpr_write_b32 a112, 0
  v_mfma_f32_16x16x32_bf16 v[120:123], a[192:195], a[132:135], v[120:123]
  ds_read_b64_tr_b16 a[226:227], v8 offset:9216
  v_accvgpr_write_b32 a113, 0
  v_mfma_f32_16x16x32_bf16 v[124:127], a[192:195], a[136:139], v[124:127]
  buffer_load_dwordx4 v[84:87], v4, s[12:15], s34 offen offset:2048 sc1
  v_mfma_f32_16x16x32_bf16 v[128:131], a[192:195], a[140:143], v[128:131]
  ds_read_b64_tr_b16 a[228:229], v9 offset:8192
  v_accvgpr_write_b32 a114, 0
  v_mfma_f32_16x16x32_bf16 v[132:135], a[196:199], a[128:131], v[132:135]
  buffer_load_dwordx4 v[88:91], v4, s[12:15], s35 offen offset:2048 sc1
  v_mfma_f32_16x16x32_bf16 v[136:139], a[196:199], a[132:135], v[136:139]
  ds_read_b64_tr_b16 a[230:231], v9 offset:9216
  v_accvgpr_write_b32 a115, 0
  v_mfma_f32_16x16x32_bf16 v[140:143], a[196:199], a[136:139], v[140:143]
  ds_read_b64_tr_b16 a[232:233], v10 offset:8192
  v_mfma_f32_16x16x32_bf16 v[144:147], a[196:199], a[140:143], v[144:147]
  buffer_load_dwordx4 v[92:95], v4, s[12:15], s36 offen offset:2048 sc1
  v_mfma_f32_16x16x32_bf16 v[148:151], a[200:203], a[128:131], v[148:151]
  ds_read_b64_tr_b16 a[234:235], v10 offset:9216
  v_accvgpr_write_b32 a116, 0
  v_mfma_f32_16x16x32_bf16 v[152:155], a[200:203], a[132:135], v[152:155]
  ds_read_b64_tr_b16 a[236:237], v11 offset:8192
  v_accvgpr_write_b32 a117, 0
  v_mfma_f32_16x16x32_bf16 v[156:159], a[200:203], a[136:139], v[156:159]
  buffer_load_dwordx4 v[96:99], v4, s[12:15], s37 offen offset:2048 sc1
  v_mfma_f32_16x16x32_bf16 v[160:163], a[200:203], a[140:143], v[160:163]
  ds_read_b64_tr_b16 a[238:239], v11 offset:9216
  v_accvgpr_write_b32 a118, 0
  v_mfma_f32_16x16x32_bf16 v[164:167], a[204:207], a[128:131], v[164:167]
  v_accvgpr_write_b32 a119, 0
  v_mfma_f32_16x16x32_bf16 v[168:171], a[204:207], a[132:135], v[168:171]
  ds_read_b64_tr_b16 a[240:241], v12 offset:8192
  v_mfma_f32_16x16x32_bf16 v[172:175], a[204:207], a[136:139], v[172:175]
  ds_read_b64_tr_b16 a[242:243], v12 offset:9216
  v_accvgpr_write_b32 a120, 0
  v_mfma_f32_16x16x32_bf16 v[176:179], a[204:207], a[140:143], v[176:179]
  s_add_u32 s46, s38, 0
  v_mfma_f32_16x16x32_bf16 v[180:183], a[208:211], a[128:131], v[180:183]
  ds_read_b64_tr_b16 a[244:245], v13 offset:8192
  v_accvgpr_write_b32 a121, 0
  v_mfma_f32_16x16x32_bf16 v[184:187], a[208:211], a[132:135], v[184:187]
  buffer_store_dwordx4 v[20:23], v4, s[12:15], s46 offen offset:0 sc1
  v_mfma_f32_16x16x32_bf16 v[188:191], a[208:211], a[136:139], v[188:191]
  ds_read_b64_tr_b16 a[246:247], v13 offset:9216
  v_accvgpr_write_b32 a122, 0
  v_mfma_f32_16x16x32_bf16 v[192:195], a[208:211], a[140:143], v[192:195]
  ds_read_b64_tr_b16 a[248:249], v14 offset:8192
  v_accvgpr_write_b32 a123, 0
  v_mfma_f32_16x16x32_bf16 v[196:199], a[212:215], a[128:131], v[196:199]
  v_mfma_f32_16x16x32_bf16 v[200:203], a[212:215], a[132:135], v[200:203]
  ds_read_b64_tr_b16 a[250:251], v14 offset:9216
  v_accvgpr_write_b32 a124, 0
  v_mfma_f32_16x16x32_bf16 v[204:207], a[212:215], a[136:139], v[204:207]
  ds_read_b64_tr_b16 a[252:253], v15 offset:8192
  s_add_u32 s46, s38, 0
  v_mfma_f32_16x16x32_bf16 v[208:211], a[212:215], a[140:143], v[208:211]
  v_accvgpr_write_b32 a125, 0
  v_mfma_f32_16x16x32_bf16 v[212:215], a[216:219], a[128:131], v[212:215]
  buffer_store_dwordx4 v[24:27], v4, s[12:15], s46 offen offset:1024 sc1
  v_mfma_f32_16x16x32_bf16 v[216:219], a[216:219], a[132:135], v[216:219]
  ds_read_b64_tr_b16 a[254:255], v15 offset:9216
  v_accvgpr_write_b32 a126, 0
  v_mfma_f32_16x16x32_bf16 v[220:223], a[216:219], a[136:139], v[220:223]
  v_mfma_f32_16x16x32_bf16 v[224:227], a[216:219], a[140:143], v[224:227]
  v_accvgpr_write_b32 a127, 0
  v_mfma_f32_16x16x32_bf16 v[228:231], a[220:223], a[128:131], v[228:231]
  v_mfma_f32_16x16x32_bf16 v[232:235], a[220:223], a[132:135], v[232:235]
  v_mfma_f32_16x16x32_bf16 v[236:239], a[220:223], a[136:139], v[236:239]
  v_mfma_f32_16x16x32_bf16 v[240:243], a[220:223], a[140:143], v[240:243]
  s_waitcnt vmcnt(32) lgkmcnt(0)
  v_mfma_f32_16x16x32_bf16 v[116:119], a[224:227], a[144:147], v[116:119]
  buffer_load_dwordx4 v[100:103], v4, s[12:15], s34 offen offset:3072 sc1
  v_mfma_f32_16x16x32_bf16 v[120:123], a[224:227], a[148:151], v[120:123]
  ds_read_b64_tr_b16 a[192:193], v8 offset:16384
  ds_read_b64_tr_b16 a[194:195], v8 offset:17408
  v_mfma_f32_16x16x32_bf16 v[124:127], a[224:227], a[152:155], v[124:127]
  v_mfma_f32_16x16x32_bf16 v[128:131], a[224:227], a[156:159], v[128:131]
  buffer_load_dwordx4 v[104:107], v4, s[12:15], s35 offen offset:3072 sc1
  v_mfma_f32_16x16x32_bf16 v[132:135], a[228:231], a[144:147], v[132:135]
  ds_read_b64_tr_b16 a[196:197], v9 offset:16384
  ds_read_b64_tr_b16 a[198:199], v9 offset:17408
  v_mfma_f32_16x16x32_bf16 v[136:139], a[228:231], a[148:151], v[136:139]
  v_mfma_f32_16x16x32_bf16 v[140:143], a[228:231], a[152:155], v[140:143]
  ds_read_b64_tr_b16 a[200:201], v10 offset:16384
  v_mfma_f32_16x16x32_bf16 v[144:147], a[228:231], a[156:159], v[144:147]
  buffer_load_dwordx4 v[108:111], v4, s[12:15], s36 offen offset:3072 sc1
  v_mfma_f32_16x16x32_bf16 v[148:151], a[232:235], a[144:147], v[148:151]
  ds_read_b64_tr_b16 a[202:203], v10 offset:17408
  v_mfma_f32_16x16x32_bf16 v[152:155], a[232:235], a[148:151], v[152:155]
  ds_read_b64_tr_b16 a[204:205], v11 offset:16384
  v_mfma_f32_16x16x32_bf16 v[156:159], a[232:235], a[152:155], v[156:159]
  buffer_load_dwordx4 v[112:115], v4, s[12:15], s37 offen offset:3072 sc1
  v_mfma_f32_16x16x32_bf16 v[160:163], a[232:235], a[156:159], v[160:163]
  ds_read_b64_tr_b16 a[206:207], v11 offset:17408
  v_mfma_f32_16x16x32_bf16 v[164:167], a[236:239], a[144:147], v[164:167]
  v_mfma_f32_16x16x32_bf16 v[168:171], a[236:239], a[148:151], v[168:171]
  ds_read_b64_tr_b16 a[208:209], v12 offset:16384
  v_mfma_f32_16x16x32_bf16 v[172:175], a[236:239], a[152:155], v[172:175]
  ds_read_b64_tr_b16 a[210:211], v12 offset:17408
  s_add_u32 s46, s38, 4096
  v_mfma_f32_16x16x32_bf16 v[176:179], a[236:239], a[156:159], v[176:179]
  v_mfma_f32_16x16x32_bf16 v[180:183], a[240:243], a[144:147], v[180:183]
  ds_read_b64_tr_b16 a[212:213], v13 offset:16384
  v_mfma_f32_16x16x32_bf16 v[184:187], a[240:243], a[148:151], v[184:187]
  buffer_store_dwordx4 v[28:31], v4, s[12:15], s46 offen offset:0 sc1
  v_mfma_f32_16x16x32_bf16 v[188:191], a[240:243], a[152:155], v[188:191]
  ds_read_b64_tr_b16 a[214:215], v13 offset:17408
  v_mfma_f32_16x16x32_bf16 v[192:195], a[240:243], a[156:159], v[192:195]
  ds_read_b64_tr_b16 a[216:217], v14 offset:16384
  v_mfma_f32_16x16x32_bf16 v[196:199], a[244:247], a[144:147], v[196:199]
  v_mfma_f32_16x16x32_bf16 v[200:203], a[244:247], a[148:151], v[200:203]
  ds_read_b64_tr_b16 a[218:219], v14 offset:17408
  s_add_u32 s46, s38, 4096
  v_mfma_f32_16x16x32_bf16 v[204:207], a[244:247], a[152:155], v[204:207]
  ds_read_b64_tr_b16 a[220:221], v15 offset:16384
  v_mfma_f32_16x16x32_bf16 v[208:211], a[244:247], a[156:159], v[208:211]
  v_mfma_f32_16x16x32_bf16 v[212:215], a[248:251], a[144:147], v[212:215]
  buffer_store_dwordx4 v[32:35], v4, s[12:15], s46 offen offset:1024 sc1
  v_mfma_f32_16x16x32_bf16 v[216:219], a[248:251], a[148:151], v[216:219]
  ds_read_b64_tr_b16 a[222:223], v15 offset:17408
  v_mfma_f32_16x16x32_bf16 v[220:223], a[248:251], a[152:155], v[220:223]
  v_mfma_f32_16x16x32_bf16 v[224:227], a[248:251], a[156:159], v[224:227]
  v_mfma_f32_16x16x32_bf16 v[228:231], a[252:255], a[144:147], v[228:231]
  v_mfma_f32_16x16x32_bf16 v[232:235], a[252:255], a[148:151], v[232:235]
  v_mfma_f32_16x16x32_bf16 v[236:239], a[252:255], a[152:155], v[236:239]
  v_mfma_f32_16x16x32_bf16 v[240:243], a[252:255], a[156:159], v[240:243]
  s_waitcnt vmcnt(32) lgkmcnt(0)
  v_mfma_f32_16x16x32_bf16 v[116:119], a[192:195], a[160:163], v[116:119]
  ds_read_b64_tr_b16 a[224:225], v8 offset:24576
  s_add_u32 s46, s38, 8192
  v_mfma_f32_16x16x32_bf16 v[120:123], a[192:195], a[164:167], v[120:123]
  ds_read_b64_tr_b16 a[226:227], v8 offset:25600
  v_mfma_f32_16x16x32_bf16 v[124:127], a[192:195], a[168:171], v[124:127]
  v_mfma_f32_16x16x32_bf16 v[128:131], a[192:195], a[172:175], v[128:131]
  ds_read_b64_tr_b16 a[228:229], v9 offset:24576
  v_mfma_f32_16x16x32_bf16 v[132:135], a[196:199], a[160:163], v[132:135]
  ds_read_b64_tr_b16 a[230:231], v9 offset:25600
  v_mfma_f32_16x16x32_bf16 v[136:139], a[196:199], a[164:167], v[136:139]
  v_mfma_f32_16x16x32_bf16 v[140:143], a[196:199], a[168:171], v[140:143]
  ds_read_b64_tr_b16 a[232:233], v10 offset:24576
  v_mfma_f32_16x16x32_bf16 v[144:147], a[196:199], a[172:175], v[144:147]
  buffer_store_dwordx4 v[36:39], v4, s[12:15], s46 offen offset:0 sc1
  v_mfma_f32_16x16x32_bf16 v[148:151], a[200:203], a[160:163], v[148:151]
  ds_read_b64_tr_b16 a[234:235], v10 offset:25600
  v_mfma_f32_16x16x32_bf16 v[152:155], a[200:203], a[164:167], v[152:155]
  ds_read_b64_tr_b16 a[236:237], v11 offset:24576
  v_mfma_f32_16x16x32_bf16 v[156:159], a[200:203], a[168:171], v[156:159]
  v_mfma_f32_16x16x32_bf16 v[160:163], a[200:203], a[172:175], v[160:163]
  ds_read_b64_tr_b16 a[238:239], v11 offset:25600
  v_mfma_f32_16x16x32_bf16 v[164:167], a[204:207], a[160:163], v[164:167]
  v_mfma_f32_16x16x32_bf16 v[168:171], a[204:207], a[164:167], v[168:171]
  ds_read_b64_tr_b16 a[240:241], v12 offset:24576
  v_mfma_f32_16x16x32_bf16 v[172:175], a[204:207], a[168:171], v[172:175]
  ds_read_b64_tr_b16 a[242:243], v12 offset:25600
  s_add_u32 s46, s38, 8192
  v_mfma_f32_16x16x32_bf16 v[176:179], a[204:207], a[172:175], v[176:179]
  v_mfma_f32_16x16x32_bf16 v[180:183], a[208:211], a[160:163], v[180:183]
  ds_read_b64_tr_b16 a[244:245], v13 offset:24576
  v_mfma_f32_16x16x32_bf16 v[184:187], a[208:211], a[164:167], v[184:187]
  ds_read_b64_tr_b16 a[246:247], v13 offset:25600
  v_mfma_f32_16x16x32_bf16 v[188:191], a[208:211], a[168:171], v[188:191]
  v_mfma_f32_16x16x32_bf16 v[192:195], a[208:211], a[172:175], v[192:195]
  ds_read_b64_tr_b16 a[248:249], v14 offset:24576
  v_mfma_f32_16x16x32_bf16 v[196:199], a[212:215], a[160:163], v[196:199]
  v_mfma_f32_16x16x32_bf16 v[200:203], a[212:215], a[164:167], v[200:203]
  buffer_store_dwordx4 v[40:43], v4, s[12:15], s46 offen offset:1024 sc1
  v_mfma_f32_16x16x32_bf16 v[204:207], a[212:215], a[168:171], v[204:207]
  ds_read_b64_tr_b16 a[250:251], v14 offset:25600
  ds_read_b64_tr_b16 a[252:253], v15 offset:24576
  v_mfma_f32_16x16x32_bf16 v[208:211], a[212:215], a[172:175], v[208:211]
  v_mfma_f32_16x16x32_bf16 v[212:215], a[216:219], a[160:163], v[212:215]
  ds_read_b64_tr_b16 a[254:255], v15 offset:25600
  v_mfma_f32_16x16x32_bf16 v[216:219], a[216:219], a[164:167], v[216:219]
  v_mfma_f32_16x16x32_bf16 v[220:223], a[216:219], a[168:171], v[220:223]
  v_mfma_f32_16x16x32_bf16 v[224:227], a[216:219], a[172:175], v[224:227]
  v_mfma_f32_16x16x32_bf16 v[228:231], a[220:223], a[160:163], v[228:231]
  v_mfma_f32_16x16x32_bf16 v[232:235], a[220:223], a[164:167], v[232:235]
  v_mfma_f32_16x16x32_bf16 v[236:239], a[220:223], a[168:171], v[236:239]
  v_mfma_f32_16x16x32_bf16 v[240:243], a[220:223], a[172:175], v[240:243]
  s_waitcnt vmcnt(28) lgkmcnt(0)
  v_mfma_f32_16x16x32_bf16 v[116:119], a[224:227], a[176:179], v[116:119]
  v_add_u32 v8, 0x10000, v8
  s_add_u32 s46, s38, 12288
  v_mfma_f32_16x16x32_bf16 v[120:123], a[224:227], a[180:183], v[120:123]
  v_add_u32 v9, 0x10000, v9
  v_mfma_f32_16x16x32_bf16 v[124:127], a[224:227], a[184:187], v[124:127]
  v_add_u32 v10, 0x10000, v10
  v_mfma_f32_16x16x32_bf16 v[128:131], a[224:227], a[188:191], v[128:131]
  v_add_u32 v11, 0x10000, v11
  v_mfma_f32_16x16x32_bf16 v[132:135], a[228:231], a[176:179], v[132:135]
  v_add_u32 v12, 0x10000, v12
  v_mfma_f32_16x16x32_bf16 v[136:139], a[228:231], a[180:183], v[136:139]
  v_add_u32 v13, 0x10000, v13
  v_mfma_f32_16x16x32_bf16 v[140:143], a[228:231], a[184:187], v[140:143]
  v_add_u32 v14, 0x10000, v14
  v_mfma_f32_16x16x32_bf16 v[144:147], a[228:231], a[188:191], v[144:147]
  buffer_store_dwordx4 v[44:47], v4, s[12:15], s46 offen offset:0 sc1
  v_mfma_f32_16x16x32_bf16 v[148:151], a[232:235], a[176:179], v[148:151]
  v_add_u32 v15, 0x10000, v15
  v_mfma_f32_16x16x32_bf16 v[152:155], a[232:235], a[180:183], v[152:155]
  ds_read_b64_tr_b16 a[192:193], v8 offset:0
  ds_read_b64_tr_b16 a[194:195], v8 offset:1024
  v_mfma_f32_16x16x32_bf16 v[156:159], a[232:235], a[184:187], v[156:159]
  ds_read_b64_tr_b16 a[196:197], v9 offset:0
  v_mfma_f32_16x16x32_bf16 v[160:163], a[232:235], a[188:191], v[160:163]
  ds_read_b64_tr_b16 a[198:199], v9 offset:1024
  v_mfma_f32_16x16x32_bf16 v[164:167], a[236:239], a[176:179], v[164:167]
  v_mfma_f32_16x16x32_bf16 v[168:171], a[236:239], a[180:183], v[168:171]
  ds_read_b64_tr_b16 a[200:201], v10 offset:0
  v_mfma_f32_16x16x32_bf16 v[172:175], a[236:239], a[184:187], v[172:175]
  ds_read_b64_tr_b16 a[202:203], v10 offset:1024
  s_add_u32 s46, s38, 12288
  v_mfma_f32_16x16x32_bf16 v[176:179], a[236:239], a[188:191], v[176:179]
  ds_read_b64_tr_b16 a[204:205], v11 offset:0
  v_mfma_f32_16x16x32_bf16 v[180:183], a[240:243], a[176:179], v[180:183]
  ds_read_b64_tr_b16 a[206:207], v11 offset:1024
  v_mfma_f32_16x16x32_bf16 v[184:187], a[240:243], a[180:183], v[184:187]
  ds_read_b64_tr_b16 a[208:209], v12 offset:0
  v_mfma_f32_16x16x32_bf16 v[188:191], a[240:243], a[184:187], v[188:191]
  ds_read_b64_tr_b16 a[210:211], v12 offset:1024
  v_mfma_f32_16x16x32_bf16 v[192:195], a[240:243], a[188:191], v[192:195]
  ds_read_b64_tr_b16 a[212:213], v13 offset:0
  v_mfma_f32_16x16x32_bf16 v[196:199], a[244:247], a[176:179], v[196:199]
  ds_read_b64_tr_b16 a[214:215], v13 offset:1024
  v_mfma_f32_16x16x32_bf16 v[200:203], a[244:247], a[180:183], v[200:203]
  buffer_store_dwordx4 v[48:51], v4, s[12:15], s46 offen offset:1024 sc1
  v_mfma_f32_16x16x32_bf16 v[204:207], a[244:247], a[184:187], v[204:207]
  ds_read_b64_tr_b16 a[216:217], v14 offset:0
  ds_read_b64_tr_b16 a[218:219], v14 offset:1024
  v_mfma_f32_16x16x32_bf16 v[208:211], a[244:247], a[188:191], v[208:211]
  ds_read_b64_tr_b16 a[220:221], v15 offset:0
  v_mfma_f32_16x16x32_bf16 v[212:215], a[248:251], a[176:179], v[212:215]
  ds_read_b64_tr_b16 a[222:223], v15 offset:1024
  v_mfma_f32_16x16x32_bf16 v[216:219], a[248:251], a[180:183], v[216:219]
  v_mfma_f32_16x16x32_bf16 v[220:223], a[248:251], a[184:187], v[220:223]
  v_mfma_f32_16x16x32_bf16 v[224:227], a[248:251], a[188:191], v[224:227]
  v_mfma_f32_16x16x32_bf16 v[228:231], a[252:255], a[176:179], v[228:231]
  v_mfma_f32_16x16x32_bf16 v[232:235], a[252:255], a[180:183], v[232:235]
  v_mfma_f32_16x16x32_bf16 v[236:239], a[252:255], a[184:187], v[236:239]
  v_mfma_f32_16x16x32_bf16 v[240:243], a[252:255], a[188:191], v[240:243]
  s_waitcnt vmcnt(24) lgkmcnt(0)
  v_mfma_f32_16x16x32_bf16 v[116:119], a[192:195], v[52:55], v[116:119]
  ds_read_b64_tr_b16 a[224:225], v8 offset:8192
  v_mfma_f32_16x16x32_bf16 v[120:123], a[192:195], v[56:59], v[120:123]
  ds_read_b64_tr_b16 a[226:227], v8 offset:9216
  v_mfma_f32_16x16x32_bf16 v[124:127], a[192:195], v[60:63], v[124:127]
  v_mfma_f32_16x16x32_bf16 v[128:131], a[192:195], v[64:67], v[128:131]
  ds_read_b64_tr_b16 a[228:229], v9 offset:8192
  v_mfma_f32_16x16x32_bf16 v[132:135], a[196:199], v[52:55], v[132:135]
  ds_read_b64_tr_b16 a[230:231], v9 offset:9216
  v_mfma_f32_16x16x32_bf16 v[136:139], a[196:199], v[56:59], v[136:139]
  v_mfma_f32_16x16x32_bf16 v[140:143], a[196:199], v[60:63], v[140:143]
  ds_read_b64_tr_b16 a[232:233], v10 offset:8192
  v_mfma_f32_16x16x32_bf16 v[144:147], a[196:199], v[64:67], v[144:147]
  v_mfma_f32_16x16x32_bf16 v[148:151], a[200:203], v[52:55], v[148:151]
  ds_read_b64_tr_b16 a[234:235], v10 offset:9216
  v_mfma_f32_16x16x32_bf16 v[152:155], a[200:203], v[56:59], v[152:155]
  ds_read_b64_tr_b16 a[236:237], v11 offset:8192
  v_mfma_f32_16x16x32_bf16 v[156:159], a[200:203], v[60:63], v[156:159]
  v_mfma_f32_16x16x32_bf16 v[160:163], a[200:203], v[64:67], v[160:163]
  ds_read_b64_tr_b16 a[238:239], v11 offset:9216
  v_mfma_f32_16x16x32_bf16 v[164:167], a[204:207], v[52:55], v[164:167]
  v_mfma_f32_16x16x32_bf16 v[168:171], a[204:207], v[56:59], v[168:171]
  ds_read_b64_tr_b16 a[240:241], v12 offset:8192
  v_mfma_f32_16x16x32_bf16 v[172:175], a[204:207], v[60:63], v[172:175]
  ds_read_b64_tr_b16 a[242:243], v12 offset:9216
  v_mfma_f32_16x16x32_bf16 v[176:179], a[204:207], v[64:67], v[176:179]
  v_mfma_f32_16x16x32_bf16 v[180:183], a[208:211], v[52:55], v[180:183]
  ds_read_b64_tr_b16 a[244:245], v13 offset:8192
  v_mfma_f32_16x16x32_bf16 v[184:187], a[208:211], v[56:59], v[184:187]
  ds_read_b64_tr_b16 a[246:247], v13 offset:9216
  v_mfma_f32_16x16x32_bf16 v[188:191], a[208:211], v[60:63], v[188:191]
  v_mfma_f32_16x16x32_bf16 v[192:195], a[208:211], v[64:67], v[192:195]
  ds_read_b64_tr_b16 a[248:249], v14 offset:8192
  v_mfma_f32_16x16x32_bf16 v[196:199], a[212:215], v[52:55], v[196:199]
  v_mfma_f32_16x16x32_bf16 v[200:203], a[212:215], v[56:59], v[200:203]
  ds_read_b64_tr_b16 a[250:251], v14 offset:9216
  v_mfma_f32_16x16x32_bf16 v[204:207], a[212:215], v[60:63], v[204:207]
  ds_read_b64_tr_b16 a[252:253], v15 offset:8192
  v_mfma_f32_16x16x32_bf16 v[208:211], a[212:215], v[64:67], v[208:211]
  v_mfma_f32_16x16x32_bf16 v[212:215], a[216:219], v[52:55], v[212:215]
  ds_read_b64_tr_b16 a[254:255], v15 offset:9216
  v_mfma_f32_16x16x32_bf16 v[216:219], a[216:219], v[56:59], v[216:219]
  v_mfma_f32_16x16x32_bf16 v[220:223], a[216:219], v[60:63], v[220:223]
  v_mfma_f32_16x16x32_bf16 v[224:227], a[216:219], v[64:67], v[224:227]
  v_mfma_f32_16x16x32_bf16 v[228:231], a[220:223], v[52:55], v[228:231]
  v_mfma_f32_16x16x32_bf16 v[232:235], a[220:223], v[56:59], v[232:235]
  v_mfma_f32_16x16x32_bf16 v[236:239], a[220:223], v[60:63], v[236:239]
  v_mfma_f32_16x16x32_bf16 v[240:243], a[220:223], v[64:67], v[240:243]
  s_waitcnt vmcnt(18) lgkmcnt(0)
  v_mfma_f32_16x16x32_bf16 v[116:119], a[224:227], v[68:71], v[116:119]
  ds_read_b64_tr_b16 a[192:193], v8 offset:16384
  v_mov_b32 v16, 0x3f803f80
  v_mfma_f32_16x16x32_bf16 v[120:123], a[224:227], v[72:75], v[120:123]
  ds_read_b64_tr_b16 a[194:195], v8 offset:17408
  v_mov_b32 v17, 0x3f803f80
  v_mfma_f32_16x16x32_bf16 v[124:127], a[224:227], v[76:79], v[124:127]
  v_mfma_f32_16x16x32_bf16 v[128:131], a[224:227], v[80:83], v[128:131]
  ds_read_b64_tr_b16 a[196:197], v9 offset:16384
  v_mov_b32 v18, 0x3f803f80
  v_mfma_f32_16x16x32_bf16 v[132:135], a[228:231], v[68:71], v[132:135]
  ds_read_b64_tr_b16 a[198:199], v9 offset:17408
  v_mov_b32 v19, 0x3f803f80
  v_mfma_f32_16x16x32_bf16 v[136:139], a[228:231], v[72:75], v[136:139]
  v_mfma_f32_16x16x32_bf16 v[140:143], a[228:231], v[76:79], v[140:143]
  ds_read_b64_tr_b16 a[200:201], v10 offset:16384
  v_mov_b32 v20, 0
  v_mfma_f32_16x16x32_bf16 v[144:147], a[228:231], v[80:83], v[144:147]
  v_mov_b32 v21, 0
  v_mfma_f32_16x16x32_bf16 v[148:151], a[232:235], v[68:71], v[148:151]
  ds_read_b64_tr_b16 a[202:203], v10 offset:17408
  v_mfma_f32_16x16x32_bf16 v[152:155], a[232:235], v[72:75], v[152:155]
  ds_read_b64_tr_b16 a[204:205], v11 offset:16384
  v_mov_b32 v22, 0
  v_mfma_f32_16x16x32_bf16 v[156:159], a[232:235], v[76:79], v[156:159]
  v_mov_b32 v23, 0
  v_mfma_f32_16x16x32_bf16 v[160:163], a[232:235], v[80:83], v[160:163]
  ds_read_b64_tr_b16 a[206:207], v11 offset:17408
  v_mfma_f32_16x16x32_bf16 v[164:167], a[236:239], v[68:71], v[164:167]
  v_mov_b32 v24, 0
  v_mfma_f32_16x16x32_bf16 v[168:171], a[236:239], v[72:75], v[168:171]
  ds_read_b64_tr_b16 a[208:209], v12 offset:16384
  v_mov_b32 v25, 0
  v_mfma_f32_16x16x32_bf16 v[172:175], a[236:239], v[76:79], v[172:175]
  ds_read_b64_tr_b16 a[210:211], v12 offset:17408
  v_mfma_f32_16x16x32_bf16 v[176:179], a[236:239], v[80:83], v[176:179]
  v_mov_b32 v26, 0
  v_mfma_f32_16x16x32_bf16 v[180:183], a[240:243], v[68:71], v[180:183]
  ds_read_b64_tr_b16 a[212:213], v13 offset:16384
  v_mfma_f32_16x16x32_bf16 v[184:187], a[240:243], v[72:75], v[184:187]
  ds_read_b64_tr_b16 a[214:215], v13 offset:17408
  v_mov_b32 v27, 0
  v_mfma_f32_16x16x32_bf16 v[188:191], a[240:243], v[76:79], v[188:191]
  v_mov_b32 v28, 0
  v_mfma_f32_16x16x32_bf16 v[192:195], a[240:243], v[80:83], v[192:195]
  ds_read_b64_tr_b16 a[216:217], v14 offset:16384
  v_mfma_f32_16x16x32_bf16 v[196:199], a[244:247], v[68:71], v[196:199]
  v_mov_b32 v29, 0
  v_mfma_f32_16x16x32_bf16 v[200:203], a[244:247], v[72:75], v[200:203]
  ds_read_b64_tr_b16 a[218:219], v14 offset:17408
  v_mov_b32 v30, 0
  v_mfma_f32_16x16x32_bf16 v[204:207], a[244:247], v[76:79], v[204:207]
  ds_read_b64_tr_b16 a[220:221], v15 offset:16384
  v_mfma_f32_16x16x32_bf16 v[208:211], a[244:247], v[80:83], v[208:211]
  v_mov_b32 v31, 0
  v_mfma_f32_16x16x32_bf16 v[212:215], a[248:251], v[68:71], v[212:215]
  ds_read_b64_tr_b16 a[222:223], v15 offset:17408
  v_mov_b32 v32, 0
  v_mfma_f32_16x16x32_bf16 v[216:219], a[248:251], v[72:75], v[216:219]
  v_mfma_f32_16x16x32_bf16 v[220:223], a[248:251], v[76:79], v[220:223]
  v_mov_b32 v33, 0
  v_mfma_f32_16x16x32_bf16 v[224:227], a[248:251], v[80:83], v[224:227]
  v_mov_b32 v34, 0
  v_mfma_f32_16x16x32_bf16 v[228:231], a[252:255], v[68:71], v[228:231]
  v_mfma_f32_16x16x32_bf16 v[232:235], a[252:255], v[72:75], v[232:235]
  v_mov_b32 v35, 0
  v_mfma_f32_16x16x32_bf16 v[236:239], a[252:255], v[76:79], v[236:239]
  v_mfma_f32_16x16x32_bf16 v[240:243], a[252:255], v[80:83], v[240:243]
  s_waitcnt vmcnt(12) lgkmcnt(0)
  v_mfma_f32_16x16x32_bf16 v[116:119], a[192:195], v[84:87], v[116:119]
  ds_read_b64_tr_b16 a[224:225], v8 offset:24576
  v_mfma_f32_16x16x32_bf16 v[120:123], a[192:195], v[88:91], v[120:123]
  ds_read_b64_tr_b16 a[226:227], v8 offset:25600
  v_mfma_f32_16x16x32_bf16 v[124:127], a[192:195], v[92:95], v[124:127]
  v_mfma_f32_16x16x32_bf16 v[128:131], a[192:195], v[96:99], v[128:131]
  ds_read_b64_tr_b16 a[228:229], v9 offset:24576
  v_mfma_f32_16x16x32_bf16 v[132:135], a[196:199], v[84:87], v[132:135]
  ds_read_b64_tr_b16 a[230:231], v9 offset:25600
  v_mfma_f32_16x16x32_bf16 v[136:139], a[196:199], v[88:91], v[136:139]
  v_mfma_f32_16x16x32_bf16 v[140:143], a[196:199], v[92:95], v[140:143]
  ds_read_b64_tr_b16 a[232:233], v10 offset:24576
  v_mfma_f32_16x16x32_bf16 v[144:147], a[196:199], v[96:99], v[144:147]
  v_mfma_f32_16x16x32_bf16 v[148:151], a[200:203], v[84:87], v[148:151]
  ds_read_b64_tr_b16 a[234:235], v10 offset:25600
  v_mfma_f32_16x16x32_bf16 v[152:155], a[200:203], v[88:91], v[152:155]
  ds_read_b64_tr_b16 a[236:237], v11 offset:24576
  v_mfma_f32_16x16x32_bf16 v[156:159], a[200:203], v[92:95], v[156:159]
  v_mfma_f32_16x16x32_bf16 v[160:163], a[200:203], v[96:99], v[160:163]
  ds_read_b64_tr_b16 a[238:239], v11 offset:25600
  v_mfma_f32_16x16x32_bf16 v[164:167], a[204:207], v[84:87], v[164:167]
  v_mfma_f32_16x16x32_bf16 v[168:171], a[204:207], v[88:91], v[168:171]
  ds_read_b64_tr_b16 a[240:241], v12 offset:24576
  v_mfma_f32_16x16x32_bf16 v[172:175], a[204:207], v[92:95], v[172:175]
  ds_read_b64_tr_b16 a[242:243], v12 offset:25600
  v_mfma_f32_16x16x32_bf16 v[176:179], a[204:207], v[96:99], v[176:179]
  v_mfma_f32_16x16x32_bf16 v[180:183], a[208:211], v[84:87], v[180:183]
  ds_read_b64_tr_b16 a[244:245], v13 offset:24576
  v_mfma_f32_16x16x32_bf16 v[184:187], a[208:211], v[88:91], v[184:187]
  ds_read_b64_tr_b16 a[246:247], v13 offset:25600
  v_mfma_f32_16x16x32_bf16 v[188:191], a[208:211], v[92:95], v[188:191]
  v_mfma_f32_16x16x32_bf16 v[192:195], a[208:211], v[96:99], v[192:195]
  ds_read_b64_tr_b16 a[248:249], v14 offset:24576
  v_mfma_f32_16x16x32_bf16 v[196:199], a[212:215], v[84:87], v[196:199]
  v_mfma_f32_16x16x32_bf16 v[200:203], a[212:215], v[88:91], v[200:203]
  ds_read_b64_tr_b16 a[250:251], v14 offset:25600
  v_mfma_f32_16x16x32_bf16 v[204:207], a[212:215], v[92:95], v[204:207]
  ds_read_b64_tr_b16 a[252:253], v15 offset:24576
  v_mfma_f32_16x16x32_bf16 v[208:211], a[212:215], v[96:99], v[208:211]
  v_mfma_f32_16x16x32_bf16 v[212:215], a[216:219], v[84:87], v[212:215]
  ds_read_b64_tr_b16 a[254:255], v15 offset:25600
  v_mfma_f32_16x16x32_bf16 v[216:219], a[216:219], v[88:91], v[216:219]
  v_mfma_f32_16x16x32_bf16 v[220:223], a[216:219], v[92:95], v[220:223]
  v_mfma_f32_16x16x32_bf16 v[224:227], a[216:219], v[96:99], v[224:227]
  v_mfma_f32_16x16x32_bf16 v[228:231], a[220:223], v[84:87], v[228:231]
  v_mfma_f32_16x16x32_bf16 v[232:235], a[220:223], v[88:91], v[232:235]
  v_mfma_f32_16x16x32_bf16 v[236:239], a[220:223], v[92:95], v[236:239]
  v_mfma_f32_16x16x32_bf16 v[240:243], a[220:223], v[96:99], v[240:243]
  s_waitcnt vmcnt(0) lgkmcnt(0)
  s_barrier
  s_cmp_lg_u32 s96, 0
  s_cbranch_scc1 adaLN_cond__compressed_kv_cla__mixer_channel_mlp__prompt_kernel_rel22
adaLN_cond__compressed_kv_cla__mixer_channel_mlp__prompt_kernel_relb23:
  v_mfma_f32_16x16x32_bf16 v[116:119], a[224:227], v[100:103], v[116:119]
  s_lshl_b32 s46, s21, 7
  s_add_u32 s47, s46, 0x3f01000
  v_mfma_f32_16x16x32_bf16 v[120:123], a[224:227], v[104:107], v[120:123]
  s_lshl_b32 s46, s22, 4
  s_add_u32 s46, s46, s47
  v_mfma_f32_16x16x32_bf16 v[124:127], a[224:227], v[108:111], v[124:127]
  v_mov_b32 v250, s76
  v_mov_b32 v251, s77
  v_mfma_f32_16x16x32_bf16 v[128:131], a[224:227], v[112:115], v[128:131]
  s_or_b32 s97, s46, s96
  v_mfma_f32_16x16x32_bf16 v[132:135], a[228:231], v[100:103], v[132:135]
  buffer_store_dwordx2 v[250:251], v0, s[12:15], s97 offen
  v_mfma_f32_16x16x32_bf16 v[136:139], a[228:231], v[104:107], v[136:139]
  s_xor_b32 s97, s97, 0x10000000
  v_mfma_f32_16x16x32_bf16 v[140:143], a[228:231], v[108:111], v[140:143]
  buffer_store_dwordx2 v[250:251], v0, s[12:15], s97 offen sc1
  v_mfma_f32_16x16x32_bf16 v[144:147], a[228:231], v[112:115], v[144:147]
  s_lshl_b32 s46, s22, 3
  s_sub_u32 s47, 7, s20
  v_mfma_f32_16x16x32_bf16 v[148:151], a[232:235], v[100:103], v[148:151]
  s_add_u32 s48, s46, s20
  s_add_u32 s49, s46, s47
  v_mfma_f32_16x16x32_bf16 v[152:155], a[232:235], v[104:107], v[152:155]
  s_sub_u32 s46, 120, s46
  s_add_u32 s50, s46, s20
  v_mfma_f32_16x16x32_bf16 v[156:159], a[232:235], v[108:111], v[156:159]
  s_add_u32 s51, s46, s47
  s_lshl_b32 s46, s21, 12
  v_mfma_f32_16x16x32_bf16 v[160:163], a[232:235], v[112:115], v[160:163]
  s_add_u32 s46, s46, 0x2000000
  s_lshl_b32 s34, s48, 17
  v_mfma_f32_16x16x32_bf16 v[164:167], a[236:239], v[100:103], v[164:167]
  s_add_u32 s34, s34, s46
  s_lshl_b32 s35, s49, 17
  v_mfma_f32_16x16x32_bf16 v[168:171], a[236:239], v[104:107], v[168:171]
  s_add_u32 s35, s35, s46
  s_lshl_b32 s36, s50, 17
  v_mfma_f32_16x16x32_bf16 v[172:175], a[236:239], v[108:111], v[172:175]
  s_add_u32 s36, s36, s46
  s_lshl_b32 s37, s51, 17
  v_mfma_f32_16x16x32_bf16 v[176:179], a[236:239], v[112:115], v[176:179]
  s_add_u32 s37, s37, s46
  v_and_b32 v249, 7, v1
  v_mfma_f32_16x16x32_bf16 v[180:183], a[240:243], v[100:103], v[180:183]
  v_lshlrev_b32 v249, 4, v249
  s_lshl_b32 s46, s21, 7
  v_mfma_f32_16x16x32_bf16 v[184:187], a[240:243], v[104:107], v[184:187]
  s_add_u32 s47, s46, 0x3f01000
  v_mfma_f32_16x16x32_bf16 v[188:191], a[240:243], v[108:111], v[188:191]
  v_mfma_f32_16x16x32_bf16 v[192:195], a[240:243], v[112:115], v[192:195]
  v_mfma_f32_16x16x32_bf16 v[196:199], a[244:247], v[100:103], v[196:199]
  v_mfma_f32_16x16x32_bf16 v[200:203], a[244:247], v[104:107], v[200:203]
  v_mfma_f32_16x16x32_bf16 v[204:207], a[244:247], v[108:111], v[204:207]
  v_mfma_f32_16x16x32_bf16 v[208:211], a[244:247], v[112:115], v[208:211]
  v_mfma_f32_16x16x32_bf16 v[212:215], a[248:251], v[100:103], v[212:215]
  v_mfma_f32_16x16x32_bf16 v[216:219], a[248:251], v[104:107], v[216:219]
  v_mfma_f32_16x16x32_bf16 v[220:223], a[248:251], v[108:111], v[220:223]
  v_mfma_f32_16x16x32_bf16 v[224:227], a[248:251], v[112:115], v[224:227]
  v_mfma_f32_16x16x32_bf16 v[228:231], a[252:255], v[100:103], v[228:231]
  v_mfma_f32_16x16x32_bf16 v[232:235], a[252:255], v[104:107], v[232:235]
  v_mfma_f32_16x16x32_bf16 v[236:239], a[252:255], v[108:111], v[236:239]
  v_mfma_f32_16x16x32_bf16 v[240:243], a[252:255], v[112:115], v[240:243]
  buffer_load_dwordx2 v[250:251], v249, s[12:15], s47 offen sc1
  v_cvt_pk_bf16_f32 v52, v116, v117
  v_cvt_pk_bf16_f32 v53, v118, v119
  v_cvt_pk_bf16_f32 v54, v132, v133
  v_cvt_pk_bf16_f32 v55, v134, v135
  v_cvt_pk_bf16_f32 v56, v148, v149
  v_cvt_pk_bf16_f32 v57, v150, v151
  v_cvt_pk_bf16_f32 v58, v164, v165
  v_cvt_pk_bf16_f32 v59, v166, v167
  v_cvt_pk_bf16_f32 v60, v180, v181
  v_cvt_pk_bf16_f32 v61, v182, v183
  v_cvt_pk_bf16_f32 v62, v196, v197
  v_cvt_pk_bf16_f32 v63, v198, v199
  v_cvt_pk_bf16_f32 v64, v212, v213
  v_cvt_pk_bf16_f32 v65, v214, v215
  v_cvt_pk_bf16_f32 v66, v228, v229
  v_cvt_pk_bf16_f32 v67, v230, v231
  v_cvt_pk_bf16_f32 v68, v120, v121
  v_cvt_pk_bf16_f32 v69, v122, v123
  v_cvt_pk_bf16_f32 v70, v136, v137
  v_cvt_pk_bf16_f32 v71, v138, v139
  v_cvt_pk_bf16_f32 v72, v152, v153
  v_cvt_pk_bf16_f32 v73, v154, v155
  v_cvt_pk_bf16_f32 v74, v168, v169
  v_cvt_pk_bf16_f32 v75, v170, v171
  s_waitcnt vmcnt(0)
  s_mov_b32 s40, 0
  v_cmp_ne_u64 vcc, s[76:77], v[250:251]
  s_nop 0
  s_cbranch_vccz adaLN_cond__compressed_kv_cla__mixer_channel_mlp__prompt_kernel_ok24
adaLN_cond__compressed_kv_cla__mixer_channel_mlp__prompt_kernel_sp25:
  s_sleep 2
  buffer_load_dwordx2 v[250:251], v249, s[12:15], s47 offen sc1
  s_waitcnt vmcnt(0)
  s_add_u32 s40, s40, 1
  v_cmp_ne_u64 vcc, s[76:77], v[250:251]
  s_nop 0
  s_cbranch_vccz adaLN_cond__compressed_kv_cla__mixer_channel_mlp__prompt_kernel_ok24
  s_cmp_lt_u32 s40, 0x4000
  s_cbranch_scc1 adaLN_cond__compressed_kv_cla__mixer_channel_mlp__prompt_kernel_sp25
adaLN_cond__compressed_kv_cla__mixer_channel_mlp__prompt_kernel_ok24:
  s_and_b32 s41, s22, 1
  s_lshl_b32 s41, s41, 16
  s_xor_b32 s42, s30, s41
  s_xor_b32 s43, s31, s41
  v_xor_b32 v248, s41, v254
  s_and_b32 s44, s43, 0x10000
  s_lshl_b32 s41, s20, 11
  s_add_u32 s44, s44, s41
  s_mul_i32 s45, s21, 0x90000
  s_add_u32 s45, s45, s41
  s_add_u32 s45, s45, 0x5000000
  s_add_u32 m0, s44, 49152
  s_nop 0
  buffer_load_dwordx4 v4, s[12:15], s45 offen offset:0 sc1 lds
  buffer_load_dwordx4 v4, s[12:15], s45 offen offset:1024 sc1 lds
  s_add_u32 m0, s44, 32768
  s_add_u32 s45, s45, 8192
  buffer_load_dwordx4 v4, s[12:15], s45 offen offset:0 sc1 lds
  buffer_load_dwordx4 v4, s[12:15], s45 offen offset:1024 sc1 lds
  s_add_u32 m0, s44, 40960
  s_add_u32 s45, s45, 8192
  buffer_load_dwordx4 v4, s[12:15], s45 offen offset:0 sc1 lds
  buffer_load_dwordx4 v4, s[12:15], s45 offen offset:1024 sc1 lds
  s_add_u32 m0, s42, 0
  s_nop 0
  global_load_lds_dwordx4 v3, s[94:95] offset:-4096 sc1
  global_load_lds_dwordx4 v3, s[94:95] offset:-3072 sc1
  global_load_lds_dwordx4 v3, s[94:95] offset:-2048 sc1
  global_load_lds_dwordx4 v3, s[94:95] offset:-1024 sc1
  global_load_lds_dwordx4 v3, s[94:95] offset:0 sc1
  global_load_lds_dwordx4 v3, s[94:95] offset:1024 sc1
  global_load_lds_dwordx4 v3, s[94:95] offset:2048 sc1
  global_load_lds_dwordx4 v3, s[94:95] offset:3072 sc1
  v_add_u32 v3, 0x4000, v3
  v_cvt_pk_bf16_f32 v76, v184, v185
  v_cvt_pk_bf16_f32 v77, v186, v187
  v_cvt_pk_bf16_f32 v78, v200, v201
  v_cvt_pk_bf16_f32 v79, v202, v203
  v_cvt_pk_bf16_f32 v80, v216, v217
  v_cvt_pk_bf16_f32 v81, v218, v219
  v_cvt_pk_bf16_f32 v82, v232, v233
  v_cvt_pk_bf16_f32 v83, v234, v235
  v_cvt_pk_bf16_f32 v84, v124, v125
  v_cvt_pk_bf16_f32 v85, v126, v127
  v_cvt_pk_bf16_f32 v86, v140, v141
  v_cvt_pk_bf16_f32 v87, v142, v143
  v_cvt_pk_bf16_f32 v88, v156, v157
  v_cvt_pk_bf16_f32 v89, v158, v159
  v_cvt_pk_bf16_f32 v90, v172, v173
  v_cvt_pk_bf16_f32 v91, v174, v175
  v_cvt_pk_bf16_f32 v92, v188, v189
  v_cvt_pk_bf16_f32 v93, v190, v191
  v_cvt_pk_bf16_f32 v94, v204, v205
  v_cvt_pk_bf16_f32 v95, v206, v207
  v_cvt_pk_bf16_f32 v96, v220, v221
  v_cvt_pk_bf16_f32 v97, v222, v223
  v_cvt_pk_bf16_f32 v98, v236, v237
  v_cvt_pk_bf16_f32 v99, v238, v239
  v_cvt_pk_bf16_f32 v100, v128, v129
  v_cvt_pk_bf16_f32 v101, v130, v131
  v_cvt_pk_bf16_f32 v102, v144, v145
  v_cvt_pk_bf16_f32 v103, v146, v147
  v_cvt_pk_bf16_f32 v104, v160, v161
  v_cvt_pk_bf16_f32 v105, v162, v163
  v_cvt_pk_bf16_f32 v106, v176, v177
  v_cvt_pk_bf16_f32 v107, v178, v179
  v_cvt_pk_bf16_f32 v108, v192, v193
  v_cvt_pk_bf16_f32 v109, v194, v195
  v_cvt_pk_bf16_f32 v110, v208, v209
  v_cvt_pk_bf16_f32 v111, v210, v211
  v_cvt_pk_bf16_f32 v112, v224, v225
  v_cvt_pk_bf16_f32 v113, v226, v227
  v_cvt_pk_bf16_f32 v114, v240, v241
  v_cvt_pk_bf16_f32 v115, v242, v243
  s_mov_b32 s4, s86
  s_mov_b32 s5, s87
  s_mov_b32 s6, s88
  v_lshrrev_b32 v245, 4, v1
  v_bfe_u32 v244, v1, 1, 2
  v_xor_b32 v244, v244, v245
  v_lshlrev_b32 v244, 5, v244
  v_and_b32 v252, 1, v1
  v_lshl_add_u32 v244, v252, 4, v244
  v_lshrrev_b32 v252, 3, v1
  v_mad_u32_u24 v252, v252, s71, v244
  s_lshl_b32 s71, s71, 3
  v_bfe_u32 v253, v1, 2, 2
  v_lshl_add_u32 v253, v245, 2, v253
  v_bfe_u32 v245, v253, 1, 2
  v_lshlrev_b32 v253, 7, v253
  v_lshl_add_u32 v253, v245, 5, v253
  v_and_b32 v245, 3, v1
  v_lshl_add_u32 v253, v245, 3, v253
  s_add_u32 s67, s33, 0x20000
  v_add_u32 v253, s67, v253
  s_lshl_b32 s89, s2, 4
  s_add_u32 s89, s89, 0x3f08000
  s_mov_b32 s24, 0x3f08000
  s_lshr_b32 s40, s21, 2
  s_lshl_b32 s40, s40, 1
  s_and_b32 s41, s21, 1
  s_add_u32 s40, s40, s41
  s_sub_u32 s41, 31, s40
  s_bitcmp1_b32 s21, 1
  s_cselect_b32 s98, s41, s40
  s_lshl_b32 s40, s98, 2
  s_add_u32 s40, s40, s20
  s_lshl_b32 s41, s40, 14
  s_lshl_b32 s44, s22, 11
  s_add_u32 s41, s41, s44
  s_add_u32 s56, s41, 0x3000000
  s_lshl_b32 s41, s40, 9
  s_lshl_b32 s44, s22, 16
  s_add_u32 s41, s41, s44
  s_add_u32 s57, s41, 0x3e20000
  s_mul_i32 s41, s40, 57344
  s_mul_i32 s44, s22, 7168
  s_add_u32 s41, s41, s44
  s_add_u32 s58, s41, 0x3600000
  v_mov_b32 v250, s76
  v_mov_b32 v251, s77
  s_mov_b32 s61, s89
  s_mov_b32 s60, 0x3f08000
  s_lshl_b32 s40, s22, 9
  s_lshl_b32 s41, s21, 4
  s_add_u32 s40, s40, s41
  s_add_u32 s59, s40, 0x3f02000
  s_lshl_b32 s40, s22, 7
  v_add_u32 v249, s40, v5
  s_waitcnt vmcnt(8)
  s_barrier
  ds_read_b128 a[192:195], v248 offset:49152
  ds_read_b128 a[196:199], v248 offset:50176
  ds_read_b128 a[200:203], v248 offset:51200
  ds_read_b128 a[204:207], v248 offset:52224
  ds_read_b128 a[208:211], v248 offset:53248
  ds_read_b128 a[212:215], v248 offset:54272
  ds_read_b128 a[216:219], v248 offset:55296
  ds_read_b128 a[220:223], v248 offset:56320
  ds_read_b128 a[128:131], v248 offset:32768
  ds_read_b128 a[132:135], v248 offset:33792
  ds_read_b128 a[136:139], v248 offset:34816
  ds_read_b128 a[140:143], v248 offset:35840
  ds_read_b128 a[144:147], v248 offset:36864
  ds_read_b128 a[148:151], v248 offset:37888
  ds_read_b128 a[152:155], v248 offset:38912
  s_waitcnt lgkmcnt(7)
  v_mfma_f32_16x16x32_bf16 v[116:119], a[192:195], v[52:55], 0
  ds_read_b128 a[156:159], v248 offset:39936
  v_cmp_gt_i32_e64 s[48:49], 0, v249
  v_mfma_f32_16x16x32_bf16 v[116:119], a[196:199], v[56:59], v[116:119]
  v_cmp_gt_i32_e64 s[50:51], 1, v249
  v_cmp_gt_i32_e64 s[52:53], 2, v249
  v_mfma_f32_16x16x32_bf16 v[116:119], a[200:203], v[60:63], v[116:119]
  s_add_u32 m0, s42, 32768
  v_cmp_gt_i32_e64 s[54:55], 3, v249
  v_mfma_f32_16x16x32_bf16 v[116:119], a[204:207], v[64:67], v[116:119]
  v_mfma_f32_16x16x32_bf16 v[124:127], a[192:195], v[68:71], 0
  global_load_lds_dwordx4 v3, s[94:95] offset:-4096 sc1
  v_mfma_f32_16x16x32_bf16 v[124:127], a[196:199], v[72:75], v[124:127]
  v_mfma_f32_16x16x32_bf16 v[124:127], a[200:203], v[76:79], v[124:127]
  global_load_lds_dwordx4 v3, s[94:95] offset:-3072 sc1
  v_mfma_f32_16x16x32_bf16 v[124:127], a[204:207], v[80:83], v[124:127]
  v_mfma_f32_16x16x32_bf16 v[132:135], a[192:195], v[84:87], 0
  global_load_lds_dwordx4 v3, s[94:95] offset:-2048 sc1
  v_mfma_f32_16x16x32_bf16 v[132:135], a[196:199], v[88:91], v[132:135]
  v_mfma_f32_16x16x32_bf16 v[132:135], a[200:203], v[92:95], v[132:135]
  global_load_lds_dwordx4 v3, s[94:95] offset:-1024 sc1
  v_mfma_f32_16x16x32_bf16 v[132:135], a[204:207], v[96:99], v[132:135]
  v_mfma_f32_16x16x32_bf16 v[140:143], a[192:195], v[100:103], 0
  global_load_lds_dwordx4 v3, s[94:95] offset:0 sc1
  v_mfma_f32_16x16x32_bf16 v[140:143], a[196:199], v[104:107], v[140:143]
  v_mfma_f32_16x16x32_bf16 v[140:143], a[200:203], v[108:111], v[140:143]
  v_mfma_f32_16x16x32_bf16 v[140:143], a[204:207], v[112:115], v[140:143]
  global_load_lds_dwordx4 v3, s[94:95] offset:1024 sc1
  global_load_lds_dwordx4 v3, s[94:95] offset:2048 sc1
  v_cndmask_b32_e64 v116, v116, v7, s[48:49]
  v_cndmask_b32_e64 v117, v117, v7, s[50:51]
  v_cndmask_b32_e64 v118, v118, v7, s[52:53]
  v_cndmask_b32_e64 v119, v119, v7, s[54:55]
  v_max3_f32 v8, v116, v117, v118
  v_max_f32 v8, v8, v119
  v_max3_f32 v9, v124, v125, v126
  v_max_f32 v9, v9, v127
  global_load_lds_dwordx4 v3, s[94:95] offset:3072 sc1
  v_add_u32 v3, 0x4000, v3
  v_max3_f32 v10, v132, v133, v134
  v_max_f32 v10, v10, v135
  v_max3_f32 v11, v140, v141, v142
  v_max_f32 v11, v11, v143
  s_nop 1
  v_permlane32_swap_b32 v8, v9
  v_permlane32_swap_b32 v10, v11
  v_max_f32 v8, v8, v9
  v_max_f32 v10, v10, v11
  s_nop 1
  v_permlane16_swap_b32 v8, v10
  v_max_f32 v8, v8, v10
  v_mov_b32 v10, v8
  s_nop 1
  v_permlane16_swap_b32 v8, v10
  v_mov_b32 v9, v8
  v_mov_b32 v11, v10
  s_nop 1
  v_permlane32_swap_b32 v8, v9
  v_permlane32_swap_b32 v10, v11
  s_add_u32 m0, s43, 0
  s_nop 0
  global_load_lds_dwordx4 v3, s[94:95] offset:-4096 sc1
  v_sub_f32 v36, 0, v8
  v_sub_f32 v37, 0, v8
  v_sub_f32 v38, 0, v8
  v_sub_f32 v39, 0, v8
  v_sub_f32 v40, 0, v9
  v_sub_f32 v41, 0, v9
  v_sub_f32 v42, 0, v9
  v_sub_f32 v43, 0, v9
  v_sub_f32 v44, 0, v10
  v_sub_f32 v45, 0, v10
  v_sub_f32 v46, 0, v10
  v_sub_f32 v47, 0, v10
  v_sub_f32 v48, 0, v11
  v_sub_f32 v49, 0, v11
  v_sub_f32 v50, 0, v11
  v_sub_f32 v51, 0, v11
  v_mfma_f32_16x16x32_bf16 v[120:123], a[208:211], v[52:55], v[36:39]
  global_load_lds_dwordx4 v3, s[94:95] offset:-3072 sc1
  v_mfma_f32_16x16x32_bf16 v[120:123], a[212:215], v[56:59], v[120:123]
  v_sub_f32 v116, v116, v8
  v_sub_f32 v117, v117, v8
  v_mfma_f32_16x16x32_bf16 v[120:123], a[216:219], v[60:63], v[120:123]
  v_sub_f32 v118, v118, v8
  v_sub_f32 v119, v119, v8
  v_mfma_f32_16x16x32_bf16 v[120:123], a[220:223], v[64:67], v[120:123]
  v_sub_f32 v124, v124, v9
  v_sub_f32 v125, v125, v9
  v_mfma_f32_16x16x32_bf16 v[128:131], a[208:211], v[68:71], v[40:43]
  v_sub_f32 v126, v126, v9
  v_sub_f32 v127, v127, v9
  v_mfma_f32_16x16x32_bf16 v[128:131], a[212:215], v[72:75], v[128:131]
  global_load_lds_dwordx4 v3, s[94:95] offset:-2048 sc1
  v_mfma_f32_16x16x32_bf16 v[128:131], a[216:219], v[76:79], v[128:131]
  v_sub_f32 v132, v132, v10
  v_sub_f32 v133, v133, v10
  v_mfma_f32_16x16x32_bf16 v[128:131], a[220:223], v[80:83], v[128:131]
  v_sub_f32 v134, v134, v10
  v_sub_f32 v135, v135, v10
  v_mfma_f32_16x16x32_bf16 v[136:139], a[208:211], v[84:87], v[44:47]
  v_sub_f32 v140, v140, v11
  v_sub_f32 v141, v141, v11
  v_mfma_f32_16x16x32_bf16 v[136:139], a[212:215], v[88:91], v[136:139]
  v_sub_f32 v142, v142, v11
  v_sub_f32 v143, v143, v11
  v_mfma_f32_16x16x32_bf16 v[136:139], a[216:219], v[92:95], v[136:139]
  global_load_lds_dwordx4 v3, s[94:95] offset:-1024 sc1
  v_mfma_f32_16x16x32_bf16 v[136:139], a[220:223], v[96:99], v[136:139]
  v_mfma_f32_16x16x32_bf16 v[144:147], a[208:211], v[100:103], v[48:51]
  v_mfma_f32_16x16x32_bf16 v[144:147], a[212:215], v[104:107], v[144:147]
  v_mfma_f32_16x16x32_bf16 v[144:147], a[216:219], v[108:111], v[144:147]
  v_mfma_f32_16x16x32_bf16 v[144:147], a[220:223], v[112:115], v[144:147]
  v_mov_b32 v8, v248
  v_xor_b32 v9, 0x10000, v248
  v_mov_b32 v10, v249
  s_waitcnt lgkmcnt(0)
  v_mfma_f32_16x16x32_bf16 v[148:151], a[128:131], v[52:55], v[36:39]
  v_exp_f32 v124, v124
  v_mfma_f32_16x16x32_bf16 v[148:151], a[132:135], v[56:59], v[148:151]
  v_exp_f32 v125, v125
  v_mfma_f32_16x16x32_bf16 v[148:151], a[136:139], v[60:63], v[148:151]
  v_exp_f32 v126, v126
  v_mfma_f32_16x16x32_bf16 v[148:151], a[140:143], v[64:67], v[148:151]
  ds_read_b128 a[192:195], v8 offset:40960
  v_cvt_pk_bf16_f32 v184, v124, v125
  v_mfma_f32_16x16x32_bf16 v[156:159], a[128:131], v[68:71], v[40:43]
  v_exp_f32 v127, v127
  v_mfma_f32_16x16x32_bf16 v[156:159], a[132:135], v[72:75], v[156:159]
  ds_read_b128 a[196:199], v8 offset:41984
  v_cmp_gt_i32_e64 s[48:49], 0, v10
  v_mfma_f32_16x16x32_bf16 v[156:159], a[136:139], v[76:79], v[156:159]
  v_exp_f32 v128, v128
  v_cvt_pk_bf16_f32 v185, v126, v127
  v_cndmask_b32_e64 v116, v116, v7, s[48:49]
  s_mov_b32 m0, s43
  v_mfma_f32_16x16x32_bf16 v[156:159], a[140:143], v[80:83], v[156:159]
  v_exp_f32 v129, v129
  v_mfma_f32_16x16x32_bf16 v[164:167], a[128:131], v[84:87], v[44:47]
  v_exp_f32 v130, v130
  v_cvt_pk_bf16_f32 v186, v128, v129
  v_cmp_gt_i32_e64 s[50:51], 1, v10
  v_mfma_f32_16x16x32_bf16 v[164:167], a[132:135], v[88:91], v[164:167]
  v_exp_f32 v131, v131
  v_cndmask_b32_e64 v117, v117, v7, s[50:51]
  v_mfma_f32_16x16x32_bf16 v[164:167], a[136:139], v[92:95], v[164:167]
  v_exp_f32 v132, v132
  v_cvt_pk_bf16_f32 v187, v130, v131
  v_mfma_f32_16x16x32_bf16 v[164:167], a[140:143], v[96:99], v[164:167]
  ds_read_b128 a[200:203], v8 offset:43008
  v_cmp_gt_i32_e64 s[52:53], 2, v10
  v_exp_f32 v133, v133
  v_mfma_f32_16x16x32_bf16 v[172:175], a[128:131], v[100:103], v[48:51]
  global_load_lds_dwordx4 v3, s[94:95] offset:0 sc1
  v_exp_f32 v134, v134
  v_cvt_pk_bf16_f32 v188, v132, v133
  v_cndmask_b32_e64 v118, v118, v7, s[52:53]
  v_mfma_f32_16x16x32_bf16 v[172:175], a[132:135], v[104:107], v[172:175]
  v_exp_f32 v135, v135
  v_mfma_f32_16x16x32_bf16 v[172:175], a[136:139], v[108:111], v[172:175]
  ds_read_b128 a[204:207], v8 offset:44032
  v_cvt_pk_bf16_f32 v189, v134, v135
  v_exp_f32 v136, v136
  v_cmp_gt_i32_e64 s[54:55], 3, v10
  v_mfma_f32_16x16x32_bf16 v[172:175], a[140:143], v[112:115], v[172:175]
  v_exp_f32 v137, v137
  v_cndmask_b32_e64 v119, v119, v7, s[54:55]
  v_mfma_f32_16x16x32_bf16 v[152:155], a[144:147], v[52:55], v[36:39]
  v_exp_f32 v138, v138
  v_cvt_pk_bf16_f32 v190, v136, v137
  v_mfma_f32_16x16x32_bf16 v[152:155], a[148:151], v[56:59], v[152:155]
  global_load_lds_dwordx4 v3, s[94:95] offset:1024 sc1
  ds_read_b128 a[208:211], v8 offset:45056
  v_exp_f32 v139, v139
  v_exp_f32 v140, v140
  v_cmp_gt_i32_e64 s[48:49], 16, v10
  v_mfma_f32_16x16x32_bf16 v[152:155], a[152:155], v[60:63], v[152:155]
  v_exp_f32 v141, v141
  v_cvt_pk_bf16_f32 v191, v138, v139
  v_cndmask_b32_e64 v120, v120, v7, s[48:49]
  v_mfma_f32_16x16x32_bf16 v[152:155], a[156:159], v[64:67], v[152:155]
  v_exp_f32 v142, v142
  v_cvt_pk_bf16_f32 v192, v140, v141
  v_mfma_f32_16x16x32_bf16 v[160:163], a[144:147], v[68:71], v[40:43]
  ds_read_b128 a[212:215], v8 offset:46080
  v_cmp_gt_i32_e64 s[50:51], 17, v10
  v_exp_f32 v143, v143
  v_mfma_f32_16x16x32_bf16 v[160:163], a[148:151], v[72:75], v[160:163]
  global_load_lds_dwordx4 v3, s[94:95] offset:2048 sc1
  v_exp_f32 v144, v144
  v_cvt_pk_bf16_f32 v193, v142, v143
  v_cndmask_b32_e64 v121, v121, v7, s[50:51]
  v_mfma_f32_16x16x32_bf16 v[160:163], a[152:155], v[76:79], v[160:163]
  v_exp_f32 v145, v145
  v_mfma_f32_16x16x32_bf16 v[160:163], a[156:159], v[80:83], v[160:163]
  ds_read_b128 a[216:219], v8 offset:47104
  v_cvt_pk_bf16_f32 v194, v144, v145
  v_exp_f32 v146, v146
  v_cmp_gt_i32_e64 s[52:53], 18, v10
  v_mfma_f32_16x16x32_bf16 v[168:171], a[144:147], v[84:87], v[44:47]
  v_exp_f32 v147, v147
  v_cndmask_b32_e64 v122, v122, v7, s[52:53]
  v_mfma_f32_16x16x32_bf16 v[168:171], a[148:151], v[88:91], v[168:171]
  ds_read_b128 a[220:223], v8 offset:48128
  v_cvt_pk_bf16_f32 v195, v146, v147
  v_exp_f32 v116, v116
  v_cmp_gt_i32_e64 s[54:55], 19, v10
  v_mfma_f32_16x16x32_bf16 v[168:171], a[152:155], v[92:95], v[168:171]
  global_load_lds_dwordx4 v3, s[94:95] offset:3072 sc1
  v_exp_f32 v117, v117
  v_cndmask_b32_e64 v123, v123, v7, s[54:55]
  v_mfma_f32_16x16x32_bf16 v[168:171], a[156:159], v[96:99], v[168:171]
  v_exp_f32 v118, v118
  v_cvt_pk_bf16_f32 v180, v116, v117
  v_mfma_f32_16x16x32_bf16 v[176:179], a[144:147], v[100:103], v[48:51]
  v_exp_f32 v119, v119
  v_mfma_f32_16x16x32_bf16 v[176:179], a[148:151], v[104:107], v[176:179]
  v_exp_f32 v120, v120
  v_cvt_pk_bf16_f32 v181, v118, v119
  v_add_u32 v3, 0x4000, v3
  v_mfma_f32_16x16x32_bf16 v[176:179], a[152:155], v[108:111], v[176:179]
  s_waitcnt vmcnt(16) lgkmcnt(0)
  s_barrier
  v_mfma_f32_16x16x32_bf16 v[176:179], a[156:159], v[112:115], v[176:179]
  v_exp_f32 v121, v121
  v_exp_f32 v122, v122
  v_exp_f32 v123, v123
  v_cvt_pk_bf16_f32 v182, v120, v121
  v_cvt_pk_bf16_f32 v183, v122, v123
  v_mfma_f32_16x16x32_bf16 v[116:119], a[192:195], v[52:55], v[36:39]
  v_exp_f32 v156, v156
  v_mfma_f32_16x16x32_bf16 v[116:119], a[196:199], v[56:59], v[116:119]
  ds_read_b128 a[128:131], v9 offset:0
  ds_read_b128 a[132:135], v9 offset:1024
  v_mfma_f32_16x16x32_bf16 v[116:119], a[200:203], v[60:63], v[116:119]
  v_exp_f32 v157, v157
  v_mfma_f32_16x16x32_bf16 v[116:119], a[204:207], v[64:67], v[116:119]
  v_exp_f32 v158, v158
  v_mfma_f32_16x16x32_bf16 v[124:127], a[192:195], v[68:71], v[40:43]
  ds_read_b128 a[136:139], v9 offset:2048
  v_cvt_pk_bf16_f32 v200, v156, v157
  v_mfma_f32_16x16x32_bf16 v[124:127], a[196:199], v[72:75], v[124:127]
  v_exp_f32 v159, v159
  v_cmp_gt_i32_e64 s[48:49], 32, v10
  v_mfma_f32_16x16x32_bf16 v[124:127], a[200:203], v[76:79], v[124:127]
  v_exp_f32 v160, v160
  v_cvt_pk_bf16_f32 v201, v158, v159
  v_cndmask_b32_e64 v148, v148, v7, s[48:49]
  v_mfma_f32_16x16x32_bf16 v[124:127], a[204:207], v[80:83], v[124:127]
  v_exp_f32 v161, v161
  s_add_u32 m0, s43, 0x8000
  v_mfma_f32_16x16x32_bf16 v[132:135], a[192:195], v[84:87], v[44:47]
  ds_read_b128 a[140:143], v9 offset:3072
  v_cvt_pk_bf16_f32 v202, v160, v161
  v_exp_f32 v162, v162
  v_cmp_gt_i32_e64 s[50:51], 33, v10
  v_mfma_f32_16x16x32_bf16 v[132:135], a[196:199], v[88:91], v[132:135]
  ds_read_b128 a[144:147], v9 offset:4096
  v_cndmask_b32_e64 v149, v149, v7, s[50:51]
  v_exp_f32 v163, v163
  v_mfma_f32_16x16x32_bf16 v[132:135], a[200:203], v[92:95], v[132:135]
  v_exp_f32 v164, v164
  v_cvt_pk_bf16_f32 v203, v162, v163
  v_mfma_f32_16x16x32_bf16 v[132:135], a[204:207], v[96:99], v[132:135]
  ds_read_b128 a[148:151], v9 offset:5120
  v_cmp_gt_i32_e64 s[52:53], 34, v10
  v_exp_f32 v165, v165
  v_mfma_f32_16x16x32_bf16 v[140:143], a[192:195], v[100:103], v[48:51]
  ds_read_b128 a[152:155], v9 offset:6144
  v_cvt_pk_bf16_f32 v204, v164, v165
  v_exp_f32 v166, v166
  v_cndmask_b32_e64 v150, v150, v7, s[52:53]
  v_mfma_f32_16x16x32_bf16 v[140:143], a[196:199], v[104:107], v[140:143]
  v_exp_f32 v167, v167
  v_mfma_f32_16x16x32_bf16 v[140:143], a[200:203], v[108:111], v[140:143]
  global_load_lds_dwordx4 v3, s[94:95] offset:-4096 sc1
  ds_read_b128 a[156:159], v9 offset:7168
  v_exp_f32 v168, v168
  v_cvt_pk_bf16_f32 v205, v166, v167
  v_cmp_gt_i32_e64 s[54:55], 35, v10
  v_mfma_f32_16x16x32_bf16 v[140:143], a[204:207], v[112:115], v[140:143]
  ds_read_b128 a[160:163], v9 offset:16384
  v_cndmask_b32_e64 v151, v151, v7, s[54:55]
  v_exp_f32 v169, v169
  v_mfma_f32_16x16x32_bf16 v[120:123], a[208:211], v[52:55], v[36:39]
  v_exp_f32 v170, v170
  v_cvt_pk_bf16_f32 v206, v168, v169
  v_mfma_f32_16x16x32_bf16 v[120:123], a[212:215], v[56:59], v[120:123]
  ds_read_b128 a[164:167], v9 offset:17408
  v_cmp_gt_i32_e64 s[48:49], 48, v10
  v_exp_f32 v171, v171
  v_exp_f32 v172, v172
  v_mfma_f32_16x16x32_bf16 v[120:123], a[216:219], v[60:63], v[120:123]
  ds_read_b128 a[168:171], v9 offset:18432
  v_cvt_pk_bf16_f32 v207, v170, v171
  v_exp_f32 v173, v173
  v_cndmask_b32_e64 v152, v152, v7, s[48:49]
  v_mfma_f32_16x16x32_bf16 v[120:123], a[220:223], v[64:67], v[120:123]
  global_load_lds_dwordx4 v3, s[94:95] offset:-3072 sc1
  v_exp_f32 v174, v174
  v_cvt_pk_bf16_f32 v208, v172, v173
  v_mfma_f32_16x16x32_bf16 v[128:131], a[208:211], v[68:71], v[40:43]
  ds_read_b128 a[172:175], v9 offset:19456
  v_cmp_gt_i32_e64 s[50:51], 49, v10
  v_exp_f32 v175, v175
  v_mfma_f32_16x16x32_bf16 v[128:131], a[212:215], v[72:75], v[128:131]
  ds_read_b128 a[176:179], v9 offset:24576
  v_cvt_pk_bf16_f32 v209, v174, v175
  v_exp_f32 v176, v176
  v_cndmask_b32_e64 v153, v153, v7, s[50:51]
  v_mfma_f32_16x16x32_bf16 v[128:131], a[216:219], v[76:79], v[128:131]
  v_exp_f32 v177, v177
  v_mfma_f32_16x16x32_bf16 v[128:131], a[220:223], v[80:83], v[128:131]
  ds_read_b128 a[180:183], v9 offset:25600
  v_cvt_pk_bf16_f32 v210, v176, v177
  v_exp_f32 v178, v178
  v_cmp_gt_i32_e64 s[52:53], 50, v10
  v_mfma_f32_16x16x32_bf16 v[136:139], a[208:211], v[84:87], v[44:47]
  ds_read_b128 a[184:187], v9 offset:26624
  v_cndmask_b32_e64 v154, v154, v7, s[52:53]
  v_exp_f32 v179, v179
  v_mfma_f32_16x16x32_bf16 v[136:139], a[212:215], v[88:91], v[136:139]
  global_load_lds_dwordx4 v3, s[94:95] offset:-2048 sc1
  ds_read_b128 a[188:191], v9 offset:27648
  v_exp_f32 v148, v148
  v_cvt_pk_bf16_f32 v211, v178, v179
  v_cmp_gt_i32_e64 s[54:55], 51, v10
  v_mfma_f32_16x16x32_bf16 v[136:139], a[216:219], v[92:95], v[136:139]
  v_exp_f32 v149, v149
  v_cndmask_b32_e64 v155, v155, v7, s[54:55]
  v_mfma_f32_16x16x32_bf16 v[136:139], a[220:223], v[96:99], v[136:139]
  v_exp_f32 v150, v150
  v_cvt_pk_bf16_f32 v196, v148, v149
  v_mfma_f32_16x16x32_bf16 v[144:147], a[208:211], v[100:103], v[48:51]
  v_exp_f32 v151, v151
  v_mfma_f32_16x16x32_bf16 v[144:147], a[212:215], v[104:107], v[144:147]
  v_exp_f32 v152, v152
  v_cvt_pk_bf16_f32 v197, v150, v151
  v_mfma_f32_16x16x32_bf16 v[144:147], a[216:219], v[108:111], v[144:147]
  s_waitcnt lgkmcnt(0)
  v_mfma_f32_16x16x32_bf16 v[144:147], a[220:223], v[112:115], v[144:147]
  global_load_lds_dwordx4 v3, s[94:95] offset:-1024 sc1
  v_exp_f32 v153, v153
  v_exp_f32 v154, v154
  v_exp_f32 v155, v155
  v_cvt_pk_bf16_f32 v198, v152, v153
  v_cvt_pk_bf16_f32 v199, v154, v155
  s_sub_u32 s25, s22, 1
  s_cbranch_scc0 adaLN_cond__compressed_kv_cla__mixer_channel_mlp__prompt_kernel_p
  buffer_load_dwordx2 v[244:245], v4, s[12:15], s24 offen offset:0 sc1
  buffer_load_dwordx2 v[246:247], v4, s[12:15], s24 offen offset:1024 sc1
  s_add_u32 m0, s67, 0
  s_nop 0
  buffer_load_dwordx4 v252, s[4:7], s70 offen offset:0 lds
  s_add_u32 m0, s67, 16256
  s_nop 0
  buffer_load_dwordx4 v252, s[4:7], s70 offen offset:128 lds
  s_add_u32 s70, s70, s71
  s_add_u32 m0, s67, 1024
  s_nop 0
  buffer_load_dwordx4 v252, s[4:7], s70 offen offset:0 lds
  s_add_u32 m0, s67, 17280
  s_nop 0
  buffer_load_dwordx4 v252, s[4:7], s70 offen offset:128 lds
  s_add_u32 s70, s70, s71
  s_add_u32 m0, s67, 2048
  s_nop 0
  buffer_load_dwordx4 v252, s[4:7], s70 offen offset:0 lds
  s_add_u32 m0, s67, 18304
  s_nop 0
  buffer_load_dwordx4 v252, s[4:7], s70 offen offset:128 lds
  s_add_u32 s70, s70, s71
  s_add_u32 m0, s67, 3072
  s_nop 0
  buffer_load_dwordx4 v252, s[4:7], s70 offen offset:0 lds
  s_add_u32 m0, s67, 19328
  s_nop 0
  buffer_load_dwordx4 v252, s[4:7], s70 offen offset:128 lds
  s_add_u32 s70, s70, s71
  v_and_b32 v248, 3, v1
  v_lshlrev_b32 v248, 7, v248
  buffer_load_dword v249, v248, s[12:15], s57 offen sc1
  global_load_dword v249, v248, s[84:85]
  global_load_dword v249, v248, s[84:85] offset:512
  v_min_u32 v248, 27, v1
  v_lshlrev_b32 v248, 7, v248
  global_load_dword v249, v248, s[80:81]
  s_add_u32 m0, s43, 0x8000
  s_branch adaLN_cond__compressed_kv_cla__mixer_channel_mlp__prompt_kernel_adm
adaLN_cond__compressed_kv_cla__mixer_channel_mlp__prompt_kernel_p:
  s_lshr_b32 s25, s25, 1
  s_bitcmp1_b32 s22, 0
  s_cbranch_scc1 adaLN_cond__compressed_kv_cla__mixer_channel_mlp__prompt_kernel_a1m
  s_branch adaLN_cond__compressed_kv_cla__mixer_channel_mlp__prompt_kernel_a0m
.p2align 6
adaLN_cond__compressed_kv_cla__mixer_channel_mlp__prompt_kernel_la:
  v_mfma_f32_16x16x32_bf16 v[148:151], a[128:131], v[52:55], v[36:39]
  v_exp_f32 v116, v116
  v_mfma_f32_16x16x32_bf16 v[148:151], a[132:135], v[56:59], v[148:151]
  ds_read_b128 a[192:195], v254 offset:40960
  s_mov_b32 m0, s31
  v_mfma_f32_16x16x32_bf16 v[148:151], a[136:139], v[60:63], v[148:151]
  v_exp_f32 v117, v117
  v_mfma_f32_16x16x32_bf16 v[148:151], a[140:143], v[64:67], v[148:151]
  ds_read_b128 a[196:199], v254 offset:41984
  v_cvt_pk_bf16_f32 v180, v116, v117
  v_mfma_f32_16x16x32_bf16 v[156:159], a[128:131], v[68:71], v[40:43]
  v_exp_f32 v118, v118
  v_mfma_f32_16x16x32_bf16 v[156:159], a[132:135], v[72:75], v[156:159]
  v_mfma_f32_16x16x32_bf16 v[156:159], a[136:139], v[76:79], v[156:159]
  v_exp_f32 v119, v119
  v_mfma_f32_16x16x32_bf16 v[156:159], a[140:143], v[80:83], v[156:159]
  ds_read_b128 a[200:203], v254 offset:43008
  v_cvt_pk_bf16_f32 v181, v118, v119
  v_mfma_f32_16x16x32_bf16 v[164:167], a[128:131], v[84:87], v[44:47]
  v_exp_f32 v120, v120
  v_mfma_f32_16x16x32_bf16 v[164:167], a[132:135], v[88:91], v[164:167]
  v_mfma_f32_16x16x32_bf16 v[164:167], a[136:139], v[92:95], v[164:167]
  v_exp_f32 v121, v121
  v_mfma_f32_16x16x32_bf16 v[164:167], a[140:143], v[96:99], v[164:167]
  ds_read_b128 a[204:207], v254 offset:44032
  v_cvt_pk_bf16_f32 v182, v120, v121
  v_mfma_f32_16x16x32_bf16 v[172:175], a[128:131], v[100:103], v[48:51]
  v_exp_f32 v122, v122
  v_mfma_f32_16x16x32_bf16 v[172:175], a[132:135], v[104:107], v[172:175]
  global_load_lds_dwordx4 v3, s[94:95] offset:0 sc1
  v_mfma_f32_16x16x32_bf16 v[172:175], a[136:139], v[108:111], v[172:175]
  v_exp_f32 v123, v123
  v_mfma_f32_16x16x32_bf16 v[172:175], a[140:143], v[112:115], v[172:175]
  ds_read_b128 a[208:211], v254 offset:45056
  v_cvt_pk_bf16_f32 v183, v122, v123
  v_mfma_f32_16x16x32_bf16 v[152:155], a[144:147], v[52:55], v[36:39]
  v_exp_f32 v124, v124
  v_mfma_f32_16x16x32_bf16 v[152:155], a[148:151], v[56:59], v[152:155]
  v_mfma_f32_16x16x32_bf16 v[152:155], a[152:155], v[60:63], v[152:155]
  v_exp_f32 v125, v125
  v_mfma_f32_16x16x32_bf16 v[152:155], a[156:159], v[64:67], v[152:155]
  ds_read_b128 a[212:215], v254 offset:46080
  v_cvt_pk_bf16_f32 v184, v124, v125
  v_mfma_f32_16x16x32_bf16 v[160:163], a[144:147], v[68:71], v[40:43]
  v_exp_f32 v126, v126
  v_mfma_f32_16x16x32_bf16 v[160:163], a[148:151], v[72:75], v[160:163]
  global_load_lds_dwordx4 v3, s[94:95] offset:1024 sc1
  v_mfma_f32_16x16x32_bf16 v[160:163], a[152:155], v[76:79], v[160:163]
  v_exp_f32 v127, v127
  v_mfma_f32_16x16x32_bf16 v[160:163], a[156:159], v[80:83], v[160:163]
  ds_read_b128 a[216:219], v254 offset:47104
  v_cvt_pk_bf16_f32 v185, v126, v127
  v_mfma_f32_16x16x32_bf16 v[168:171], a[144:147], v[84:87], v[44:47]
  v_exp_f32 v128, v128
  v_mfma_f32_16x16x32_bf16 v[168:171], a[148:151], v[88:91], v[168:171]
  v_mfma_f32_16x16x32_bf16 v[168:171], a[152:155], v[92:95], v[168:171]
  v_exp_f32 v129, v129
  v_mfma_f32_16x16x32_bf16 v[168:171], a[156:159], v[96:99], v[168:171]
  ds_read_b128 a[220:223], v254 offset:48128
  v_cvt_pk_bf16_f32 v186, v128, v129
  v_mfma_f32_16x16x32_bf16 v[176:179], a[144:147], v[100:103], v[48:51]
  v_exp_f32 v130, v130
  v_mfma_f32_16x16x32_bf16 v[176:179], a[148:151], v[104:107], v[176:179]
  v_mfma_f32_16x16x32_bf16 v[176:179], a[152:155], v[108:111], v[176:179]
  v_exp_f32 v131, v131
  v_mfma_f32_16x16x32_bf16 v[176:179], a[156:159], v[112:115], v[176:179]
  ds_read_b128 a[224:227], v254 offset:53248
  v_cvt_pk_bf16_f32 v187, v130, v131
  v_mfma_f32_16x16x32_bf16 a[0:3], a[160:163], v[212:215], a[0:3]
  global_load_lds_dwordx4 v3, s[94:95] offset:2048 sc1
  v_mfma_f32_16x16x32_bf16 a[0:3], a[176:179], v[228:231], a[0:3]
  v_exp_f32 v132, v132
  v_mfma_f32_16x16x32_bf16 a[32:35], a[160:163], v[216:219], a[32:35]
  ds_read_b128 a[228:231], v254 offset:54272
  v_mfma_f32_16x16x32_bf16 a[32:35], a[176:179], v[232:235], a[32:35]
  v_exp_f32 v133, v133
  v_mfma_f32_16x16x32_bf16 a[64:67], a[160:163], v[220:223], a[64:67]
  v_cvt_pk_bf16_f32 v188, v132, v133
  v_mfma_f32_16x16x32_bf16 a[64:67], a[176:179], v[236:239], a[64:67]
  v_exp_f32 v134, v134
  v_mfma_f32_16x16x32_bf16 a[96:99], a[160:163], v[224:227], a[96:99]
  ds_read_b128 a[232:235], v254 offset:55296
  v_mfma_f32_16x16x32_bf16 a[96:99], a[176:179], v[240:243], a[96:99]
  v_exp_f32 v135, v135
  v_mfma_f32_16x16x32_bf16 a[100:103], a[164:167], v[224:227], a[100:103]
  v_cvt_pk_bf16_f32 v189, v134, v135
  v_mfma_f32_16x16x32_bf16 a[100:103], a[180:183], v[240:243], a[100:103]
  v_exp_f32 v136, v136
  v_mfma_f32_16x16x32_bf16 a[68:71], a[164:167], v[220:223], a[68:71]
  global_load_lds_dwordx4 v3, s[94:95] offset:3072 sc1
  v_mfma_f32_16x16x32_bf16 a[68:71], a[180:183], v[236:239], a[68:71]
  v_exp_f32 v137, v137
  v_mfma_f32_16x16x32_bf16 a[36:39], a[164:167], v[216:219], a[36:39]
  ds_read_b128 a[236:239], v254 offset:56320
  v_cvt_pk_bf16_f32 v190, v136, v137
  v_mfma_f32_16x16x32_bf16 a[36:39], a[180:183], v[232:235], a[36:39]
  v_exp_f32 v138, v138
  v_mfma_f32_16x16x32_bf16 a[4:7], a[164:167], v[212:215], a[4:7]
  ds_read_b128 a[240:243], v254 offset:61440
  v_mfma_f32_16x16x32_bf16 a[4:7], a[180:183], v[228:231], a[4:7]
  v_exp_f32 v139, v139
  v_mfma_f32_16x16x32_bf16 v[20:23], v[16:19], v[212:215], v[20:23]
  ds_read_b128 a[244:247], v254 offset:62464
  v_cvt_pk_bf16_f32 v191, v138, v139
  v_mfma_f32_16x16x32_bf16 v[20:23], v[16:19], v[228:231], v[20:23]
  v_exp_f32 v140, v140
  v_mfma_f32_16x16x32_bf16 a[8:11], a[168:171], v[212:215], a[8:11]
  v_mfma_f32_16x16x32_bf16 a[8:11], a[184:187], v[228:231], a[8:11]
  v_exp_f32 v141, v141
  v_mfma_f32_16x16x32_bf16 a[40:43], a[168:171], v[216:219], a[40:43]
  ds_read_b128 a[248:251], v254 offset:63488
  v_cvt_pk_bf16_f32 v192, v140, v141
  v_mfma_f32_16x16x32_bf16 a[40:43], a[184:187], v[232:235], a[40:43]
  v_exp_f32 v142, v142
  v_mfma_f32_16x16x32_bf16 a[72:75], a[168:171], v[220:223], a[72:75]
  v_add_u32 v3, 0x4000, v3
  v_mfma_f32_16x16x32_bf16 a[72:75], a[184:187], v[236:239], a[72:75]
  v_exp_f32 v143, v143
  v_mfma_f32_16x16x32_bf16 a[104:107], a[168:171], v[224:227], a[104:107]
  ds_read_b128 a[252:255], v254 offset:64512
  v_cvt_pk_bf16_f32 v193, v142, v143
  v_mfma_f32_16x16x32_bf16 a[104:107], a[184:187], v[240:243], a[104:107]
  v_exp_f32 v144, v144
  v_mfma_f32_16x16x32_bf16 v[28:31], v[16:19], v[220:223], v[28:31]
  v_mfma_f32_16x16x32_bf16 v[28:31], v[16:19], v[236:239], v[28:31]
  v_exp_f32 v145, v145
  v_mfma_f32_16x16x32_bf16 a[108:111], a[172:175], v[224:227], a[108:111]
  v_cvt_pk_bf16_f32 v194, v144, v145
  v_mfma_f32_16x16x32_bf16 a[108:111], a[188:191], v[240:243], a[108:111]
  v_exp_f32 v146, v146
  v_mfma_f32_16x16x32_bf16 a[76:79], a[172:175], v[220:223], a[76:79]
  v_mfma_f32_16x16x32_bf16 a[76:79], a[188:191], v[236:239], a[76:79]
  v_exp_f32 v147, v147
  v_mfma_f32_16x16x32_bf16 a[44:47], a[172:175], v[216:219], a[44:47]
  v_cvt_pk_bf16_f32 v195, v146, v147
  v_mfma_f32_16x16x32_bf16 a[44:47], a[188:191], v[232:235], a[44:47]
  v_mfma_f32_16x16x32_bf16 a[12:15], a[172:175], v[212:215], a[12:15]
  s_waitcnt vmcnt(16) lgkmcnt(0)
  s_barrier
  v_mfma_f32_16x16x32_bf16 a[12:15], a[188:191], v[228:231], a[12:15]
  v_mfma_f32_16x16x32_bf16 v[116:119], a[192:195], v[52:55], v[36:39]
  v_exp_f32 v148, v148
  v_mfma_f32_16x16x32_bf16 v[116:119], a[196:199], v[56:59], v[116:119]
  ds_read_b128 a[128:131], v2 offset:0
  s_add_u32 m0, s31, 0x8000
  v_mfma_f32_16x16x32_bf16 v[116:119], a[200:203], v[60:63], v[116:119]
  v_exp_f32 v149, v149
  v_mfma_f32_16x16x32_bf16 v[116:119], a[204:207], v[64:67], v[116:119]
  ds_read_b128 a[132:135], v2 offset:1024
  v_cvt_pk_bf16_f32 v196, v148, v149
  v_mfma_f32_16x16x32_bf16 v[124:127], a[192:195], v[68:71], v[40:43]
  v_exp_f32 v150, v150
  v_mfma_f32_16x16x32_bf16 v[124:127], a[196:199], v[72:75], v[124:127]
  v_mfma_f32_16x16x32_bf16 v[124:127], a[200:203], v[76:79], v[124:127]
  v_exp_f32 v151, v151
  v_mfma_f32_16x16x32_bf16 v[124:127], a[204:207], v[80:83], v[124:127]
  ds_read_b128 a[136:139], v2 offset:2048
  v_cvt_pk_bf16_f32 v197, v150, v151
  v_mfma_f32_16x16x32_bf16 v[132:135], a[192:195], v[84:87], v[44:47]
  v_exp_f32 v152, v152
  v_mfma_f32_16x16x32_bf16 v[132:135], a[196:199], v[88:91], v[132:135]
  v_mfma_f32_16x16x32_bf16 v[132:135], a[200:203], v[92:95], v[132:135]
  v_exp_f32 v153, v153
  v_mfma_f32_16x16x32_bf16 v[132:135], a[204:207], v[96:99], v[132:135]
  ds_read_b128 a[140:143], v2 offset:3072
  v_cvt_pk_bf16_f32 v198, v152, v153
  v_mfma_f32_16x16x32_bf16 v[140:143], a[192:195], v[100:103], v[48:51]
  v_exp_f32 v154, v154
  v_mfma_f32_16x16x32_bf16 v[140:143], a[196:199], v[104:107], v[140:143]
  global_load_lds_dwordx4 v3, s[94:95] offset:-4096 sc1
  v_mfma_f32_16x16x32_bf16 v[140:143], a[200:203], v[108:111], v[140:143]
  v_exp_f32 v155, v155
  v_mfma_f32_16x16x32_bf16 v[140:143], a[204:207], v[112:115], v[140:143]
  ds_read_b128 a[144:147], v2 offset:4096
  v_cvt_pk_bf16_f32 v199, v154, v155
  v_mfma_f32_16x16x32_bf16 v[120:123], a[208:211], v[52:55], v[36:39]
  v_exp_f32 v156, v156
  v_mfma_f32_16x16x32_bf16 v[120:123], a[212:215], v[56:59], v[120:123]
  v_mfma_f32_16x16x32_bf16 v[120:123], a[216:219], v[60:63], v[120:123]
  v_exp_f32 v157, v157
  v_mfma_f32_16x16x32_bf16 v[120:123], a[220:223], v[64:67], v[120:123]
  ds_read_b128 a[148:151], v2 offset:5120
  v_cvt_pk_bf16_f32 v200, v156, v157
  v_mfma_f32_16x16x32_bf16 v[128:131], a[208:211], v[68:71], v[40:43]
  v_exp_f32 v158, v158
  v_mfma_f32_16x16x32_bf16 v[128:131], a[212:215], v[72:75], v[128:131]
  v_mfma_f32_16x16x32_bf16 v[128:131], a[216:219], v[76:79], v[128:131]
  v_exp_f32 v159, v159
  v_mfma_f32_16x16x32_bf16 v[128:131], a[220:223], v[80:83], v[128:131]
  ds_read_b128 a[152:155], v2 offset:6144
  v_cvt_pk_bf16_f32 v201, v158, v159
  v_mfma_f32_16x16x32_bf16 v[136:139], a[208:211], v[84:87], v[44:47]
  v_exp_f32 v160, v160
  v_mfma_f32_16x16x32_bf16 v[136:139], a[212:215], v[88:91], v[136:139]
  global_load_lds_dwordx4 v3, s[94:95] offset:-3072 sc1
  v_mfma_f32_16x16x32_bf16 v[136:139], a[216:219], v[92:95], v[136:139]
  v_exp_f32 v161, v161
  v_mfma_f32_16x16x32_bf16 v[136:139], a[220:223], v[96:99], v[136:139]
  ds_read_b128 a[156:159], v2 offset:7168
  v_cvt_pk_bf16_f32 v202, v160, v161
  v_mfma_f32_16x16x32_bf16 v[144:147], a[208:211], v[100:103], v[48:51]
  v_exp_f32 v162, v162
  v_mfma_f32_16x16x32_bf16 v[144:147], a[212:215], v[104:107], v[144:147]
  v_mfma_f32_16x16x32_bf16 v[144:147], a[216:219], v[108:111], v[144:147]
  v_exp_f32 v163, v163
  v_mfma_f32_16x16x32_bf16 v[144:147], a[220:223], v[112:115], v[144:147]
  ds_read_b128 a[160:163], v2 offset:16384
  v_cvt_pk_bf16_f32 v203, v162, v163
  v_mfma_f32_16x16x32_bf16 a[16:19], a[224:227], v[212:215], a[16:19]
  v_mfma_f32_16x16x32_bf16 a[16:19], a[240:243], v[228:231], a[16:19]
  v_exp_f32 v164, v164
  v_mfma_f32_16x16x32_bf16 a[48:51], a[224:227], v[216:219], a[48:51]
  ds_read_b128 a[164:167], v2 offset:17408
  v_mfma_f32_16x16x32_bf16 a[48:51], a[240:243], v[232:235], a[48:51]
  v_exp_f32 v165, v165
  v_mfma_f32_16x16x32_bf16 a[80:83], a[224:227], v[220:223], a[80:83]
  v_cvt_pk_bf16_f32 v204, v164, v165
  v_mfma_f32_16x16x32_bf16 a[80:83], a[240:243], v[236:239], a[80:83]
  v_exp_f32 v166, v166
  v_mfma_f32_16x16x32_bf16 a[112:115], a[224:227], v[224:227], a[112:115]
  global_load_lds_dwordx4 v3, s[94:95] offset:-2048 sc1
  v_mfma_f32_16x16x32_bf16 a[112:115], a[240:243], v[240:243], a[112:115]
  v_exp_f32 v167, v167
  v_mfma_f32_16x16x32_bf16 a[116:119], a[228:231], v[224:227], a[116:119]
  ds_read_b128 a[168:171], v2 offset:18432
  v_cvt_pk_bf16_f32 v205, v166, v167
  v_mfma_f32_16x16x32_bf16 a[116:119], a[244:247], v[240:243], a[116:119]
  v_exp_f32 v168, v168
  v_mfma_f32_16x16x32_bf16 a[84:87], a[228:231], v[220:223], a[84:87]
  ds_read_b128 a[172:175], v2 offset:19456
  v_mfma_f32_16x16x32_bf16 a[84:87], a[244:247], v[236:239], a[84:87]
  v_exp_f32 v169, v169
  v_mfma_f32_16x16x32_bf16 a[52:55], a[228:231], v[216:219], a[52:55]
  v_cvt_pk_bf16_f32 v206, v168, v169
  v_mfma_f32_16x16x32_bf16 a[52:55], a[244:247], v[232:235], a[52:55]
  v_exp_f32 v170, v170
  v_mfma_f32_16x16x32_bf16 a[20:23], a[228:231], v[212:215], a[20:23]
  ds_read_b128 a[176:179], v2 offset:24576
  v_mfma_f32_16x16x32_bf16 a[20:23], a[244:247], v[228:231], a[20:23]
  v_exp_f32 v171, v171
  v_mfma_f32_16x16x32_bf16 v[24:27], v[16:19], v[216:219], v[24:27]
  ds_read_b128 a[180:183], v2 offset:25600
  v_cvt_pk_bf16_f32 v207, v170, v171
  v_mfma_f32_16x16x32_bf16 v[24:27], v[16:19], v[232:235], v[24:27]
  v_exp_f32 v172, v172
  v_mfma_f32_16x16x32_bf16 a[24:27], a[232:235], v[212:215], a[24:27]
  v_mfma_f32_16x16x32_bf16 a[24:27], a[248:251], v[228:231], a[24:27]
  v_exp_f32 v173, v173
  v_mfma_f32_16x16x32_bf16 a[56:59], a[232:235], v[216:219], a[56:59]
  ds_read_b128 a[184:187], v2 offset:26624
  v_cvt_pk_bf16_f32 v208, v172, v173
  v_mfma_f32_16x16x32_bf16 a[56:59], a[248:251], v[232:235], a[56:59]
  v_exp_f32 v174, v174
  v_mfma_f32_16x16x32_bf16 a[88:91], a[232:235], v[220:223], a[88:91]
  global_load_lds_dwordx4 v3, s[94:95] offset:-1024 sc1
  v_mfma_f32_16x16x32_bf16 a[88:91], a[248:251], v[236:239], a[88:91]
  v_exp_f32 v175, v175
  v_mfma_f32_16x16x32_bf16 a[120:123], a[232:235], v[224:227], a[120:123]
  ds_read_b128 a[188:191], v2 offset:27648
  v_cvt_pk_bf16_f32 v209, v174, v175
  v_mfma_f32_16x16x32_bf16 a[120:123], a[248:251], v[240:243], a[120:123]
  v_exp_f32 v176, v176
  v_mfma_f32_16x16x32_bf16 v[32:35], v[16:19], v[224:227], v[32:35]
  v_mfma_f32_16x16x32_bf16 v[32:35], v[16:19], v[240:243], v[32:35]
  v_exp_f32 v177, v177
  v_mfma_f32_16x16x32_bf16 a[124:127], a[236:239], v[224:227], a[124:127]
  v_cvt_pk_bf16_f32 v210, v176, v177
  v_mfma_f32_16x16x32_bf16 a[124:127], a[252:255], v[240:243], a[124:127]
  v_exp_f32 v178, v178
  v_mfma_f32_16x16x32_bf16 a[92:95], a[236:239], v[220:223], a[92:95]
  v_mfma_f32_16x16x32_bf16 a[92:95], a[252:255], v[236:239], a[92:95]
  v_exp_f32 v179, v179
  v_mfma_f32_16x16x32_bf16 a[60:63], a[236:239], v[216:219], a[60:63]
  v_cvt_pk_bf16_f32 v211, v178, v179
  v_mfma_f32_16x16x32_bf16 a[60:63], a[252:255], v[232:235], a[60:63]
  v_mfma_f32_16x16x32_bf16 a[28:31], a[236:239], v[212:215], a[28:31]
  s_waitcnt lgkmcnt(0)
  v_mfma_f32_16x16x32_bf16 a[28:31], a[252:255], v[228:231], a[28:31]
adaLN_cond__compressed_kv_cla__mixer_channel_mlp__prompt_kernel_a0m:
  v_mfma_f32_16x16x32_bf16 v[148:151], a[128:131], v[52:55], v[36:39]
  v_exp_f32 v116, v116
  v_mfma_f32_16x16x32_bf16 v[148:151], a[132:135], v[56:59], v[148:151]
  global_load_lds_dwordx4 v3, s[94:95] offset:0 sc1
  v_mfma_f32_16x16x32_bf16 v[148:151], a[136:139], v[60:63], v[148:151]
  v_exp_f32 v117, v117
  v_mfma_f32_16x16x32_bf16 v[148:151], a[140:143], v[64:67], v[148:151]
  ds_read_b128 a[192:195], v2 offset:8192
  v_cvt_pk_bf16_f32 v212, v116, v117
  v_mfma_f32_16x16x32_bf16 v[156:159], a[128:131], v[68:71], v[40:43]
  v_exp_f32 v118, v118
  v_mfma_f32_16x16x32_bf16 v[156:159], a[132:135], v[72:75], v[156:159]
  ds_read_b128 a[196:199], v2 offset:9216
  v_mfma_f32_16x16x32_bf16 v[156:159], a[136:139], v[76:79], v[156:159]
  v_exp_f32 v119, v119
  v_mfma_f32_16x16x32_bf16 v[156:159], a[140:143], v[80:83], v[156:159]
  ds_read_b128 a[200:203], v2 offset:10240
  v_cvt_pk_bf16_f32 v213, v118, v119
  v_mfma_f32_16x16x32_bf16 v[164:167], a[128:131], v[84:87], v[44:47]
  v_exp_f32 v120, v120
  v_mfma_f32_16x16x32_bf16 v[164:167], a[132:135], v[88:91], v[164:167]
  v_mfma_f32_16x16x32_bf16 v[164:167], a[136:139], v[92:95], v[164:167]
  v_exp_f32 v121, v121
  v_mfma_f32_16x16x32_bf16 v[164:167], a[140:143], v[96:99], v[164:167]
  ds_read_b128 a[204:207], v2 offset:11264
  v_cvt_pk_bf16_f32 v214, v120, v121
  v_mfma_f32_16x16x32_bf16 v[172:175], a[128:131], v[100:103], v[48:51]
  v_exp_f32 v122, v122
  v_mfma_f32_16x16x32_bf16 v[172:175], a[132:135], v[104:107], v[172:175]
  global_load_lds_dwordx4 v3, s[94:95] offset:1024 sc1
  v_mfma_f32_16x16x32_bf16 v[172:175], a[136:139], v[108:111], v[172:175]
  v_exp_f32 v123, v123
  v_mfma_f32_16x16x32_bf16 v[172:175], a[140:143], v[112:115], v[172:175]
  ds_read_b128 a[208:211], v2 offset:12288
  v_cvt_pk_bf16_f32 v215, v122, v123
  v_mfma_f32_16x16x32_bf16 v[152:155], a[144:147], v[52:55], v[36:39]
  v_exp_f32 v124, v124
  v_mfma_f32_16x16x32_bf16 v[152:155], a[148:151], v[56:59], v[152:155]
  v_mfma_f32_16x16x32_bf16 v[152:155], a[152:155], v[60:63], v[152:155]
  v_exp_f32 v125, v125
  v_mfma_f32_16x16x32_bf16 v[152:155], a[156:159], v[64:67], v[152:155]
  ds_read_b128 a[212:215], v2 offset:13312
  v_cvt_pk_bf16_f32 v216, v124, v125
  v_mfma_f32_16x16x32_bf16 v[160:163], a[144:147], v[68:71], v[40:43]
  v_exp_f32 v126, v126
  v_mfma_f32_16x16x32_bf16 v[160:163], a[148:151], v[72:75], v[160:163]
  v_mfma_f32_16x16x32_bf16 v[160:163], a[152:155], v[76:79], v[160:163]
  v_exp_f32 v127, v127
  v_mfma_f32_16x16x32_bf16 v[160:163], a[156:159], v[80:83], v[160:163]
  ds_read_b128 a[216:219], v2 offset:14336
  v_cvt_pk_bf16_f32 v217, v126, v127
  v_mfma_f32_16x16x32_bf16 v[168:171], a[144:147], v[84:87], v[44:47]
  v_exp_f32 v128, v128
  v_mfma_f32_16x16x32_bf16 v[168:171], a[148:151], v[88:91], v[168:171]
  global_load_lds_dwordx4 v3, s[94:95] offset:2048 sc1
  v_mfma_f32_16x16x32_bf16 v[168:171], a[152:155], v[92:95], v[168:171]
  v_exp_f32 v129, v129
  v_mfma_f32_16x16x32_bf16 v[168:171], a[156:159], v[96:99], v[168:171]
  ds_read_b128 a[220:223], v2 offset:15360
  v_cvt_pk_bf16_f32 v218, v128, v129
  v_mfma_f32_16x16x32_bf16 v[176:179], a[144:147], v[100:103], v[48:51]
  v_exp_f32 v130, v130
  v_mfma_f32_16x16x32_bf16 v[176:179], a[148:151], v[104:107], v[176:179]
  v_mfma_f32_16x16x32_bf16 v[176:179], a[152:155], v[108:111], v[176:179]
  v_exp_f32 v131, v131
  v_mfma_f32_16x16x32_bf16 v[176:179], a[156:159], v[112:115], v[176:179]
  ds_read_b128 a[224:227], v2 offset:20480
  v_cvt_pk_bf16_f32 v219, v130, v131
  v_mfma_f32_16x16x32_bf16 a[0:3], a[160:163], v[180:183], a[0:3]
  v_mfma_f32_16x16x32_bf16 a[0:3], a[176:179], v[196:199], a[0:3]
  v_exp_f32 v132, v132
  v_mfma_f32_16x16x32_bf16 a[32:35], a[160:163], v[184:187], a[32:35]
  ds_read_b128 a[228:231], v2 offset:21504
  v_mfma_f32_16x16x32_bf16 a[32:35], a[176:179], v[200:203], a[32:35]
  v_exp_f32 v133, v133
  v_mfma_f32_16x16x32_bf16 a[64:67], a[160:163], v[188:191], a[64:67]
  v_cvt_pk_bf16_f32 v220, v132, v133
  v_mfma_f32_16x16x32_bf16 a[64:67], a[176:179], v[204:207], a[64:67]
  v_exp_f32 v134, v134
  v_mfma_f32_16x16x32_bf16 a[96:99], a[160:163], v[192:195], a[96:99]
  global_load_lds_dwordx4 v3, s[94:95] offset:3072 sc1
  v_mfma_f32_16x16x32_bf16 a[96:99], a[176:179], v[208:211], a[96:99]
  v_exp_f32 v135, v135
  v_mfma_f32_16x16x32_bf16 a[100:103], a[164:167], v[192:195], a[100:103]
  ds_read_b128 a[232:235], v2 offset:22528
  v_cvt_pk_bf16_f32 v221, v134, v135
  v_mfma_f32_16x16x32_bf16 a[100:103], a[180:183], v[208:211], a[100:103]
  v_exp_f32 v136, v136
  v_mfma_f32_16x16x32_bf16 a[68:71], a[164:167], v[188:191], a[68:71]
  ds_read_b128 a[236:239], v2 offset:23552
  v_mfma_f32_16x16x32_bf16 a[68:71], a[180:183], v[204:207], a[68:71]
  v_exp_f32 v137, v137
  v_mfma_f32_16x16x32_bf16 a[36:39], a[164:167], v[184:187], a[36:39]
  v_cvt_pk_bf16_f32 v222, v136, v137
  v_mfma_f32_16x16x32_bf16 a[36:39], a[180:183], v[200:203], a[36:39]
  v_exp_f32 v138, v138
  v_mfma_f32_16x16x32_bf16 a[4:7], a[164:167], v[180:183], a[4:7]
  ds_read_b128 a[240:243], v2 offset:28672
  v_mfma_f32_16x16x32_bf16 a[4:7], a[180:183], v[196:199], a[4:7]
  v_exp_f32 v139, v139
  v_mfma_f32_16x16x32_bf16 v[20:23], v[16:19], v[180:183], v[20:23]
  ds_read_b128 a[244:247], v2 offset:29696
  v_cvt_pk_bf16_f32 v223, v138, v139
  v_mfma_f32_16x16x32_bf16 v[20:23], v[16:19], v[196:199], v[20:23]
  v_exp_f32 v140, v140
  v_mfma_f32_16x16x32_bf16 a[8:11], a[168:171], v[180:183], a[8:11]
  v_mfma_f32_16x16x32_bf16 a[8:11], a[184:187], v[196:199], a[8:11]
  v_exp_f32 v141, v141
  v_mfma_f32_16x16x32_bf16 a[40:43], a[168:171], v[184:187], a[40:43]
  ds_read_b128 a[248:251], v2 offset:30720
  v_cvt_pk_bf16_f32 v224, v140, v141
  v_mfma_f32_16x16x32_bf16 a[40:43], a[184:187], v[200:203], a[40:43]
  v_exp_f32 v142, v142
  v_mfma_f32_16x16x32_bf16 a[72:75], a[168:171], v[188:191], a[72:75]
  v_add_u32 v3, 0x4000, v3
  v_mfma_f32_16x16x32_bf16 a[72:75], a[184:187], v[204:207], a[72:75]
  v_exp_f32 v143, v143
  v_mfma_f32_16x16x32_bf16 a[104:107], a[168:171], v[192:195], a[104:107]
  ds_read_b128 a[252:255], v2 offset:31744
  v_cvt_pk_bf16_f32 v225, v142, v143
  v_mfma_f32_16x16x32_bf16 a[104:107], a[184:187], v[208:211], a[104:107]
  v_exp_f32 v144, v144
  v_mfma_f32_16x16x32_bf16 v[28:31], v[16:19], v[188:191], v[28:31]
  v_mfma_f32_16x16x32_bf16 v[28:31], v[16:19], v[204:207], v[28:31]
  v_exp_f32 v145, v145
  v_mfma_f32_16x16x32_bf16 a[108:111], a[172:175], v[192:195], a[108:111]
  v_cvt_pk_bf16_f32 v226, v144, v145
  v_mfma_f32_16x16x32_bf16 a[108:111], a[188:191], v[208:211], a[108:111]
  v_exp_f32 v146, v146
  v_mfma_f32_16x16x32_bf16 a[76:79], a[172:175], v[188:191], a[76:79]
  v_mfma_f32_16x16x32_bf16 a[76:79], a[188:191], v[204:207], a[76:79]
  v_exp_f32 v147, v147
  v_mfma_f32_16x16x32_bf16 a[44:47], a[172:175], v[184:187], a[44:47]
  v_cvt_pk_bf16_f32 v227, v146, v147
  v_mfma_f32_16x16x32_bf16 a[44:47], a[188:191], v[200:203], a[44:47]
  v_mfma_f32_16x16x32_bf16 a[12:15], a[172:175], v[180:183], a[12:15]
  s_waitcnt vmcnt(16) lgkmcnt(0)
  s_barrier
  v_mfma_f32_16x16x32_bf16 a[12:15], a[188:191], v[196:199], a[12:15]
  v_mfma_f32_16x16x32_bf16 v[116:119], a[192:195], v[52:55], v[36:39]
  v_exp_f32 v148, v148
  v_mfma_f32_16x16x32_bf16 v[116:119], a[196:199], v[56:59], v[116:119]
  ds_read_b128 a[128:131], v2 offset:32768
  s_mov_b32 m0, s30
  v_mfma_f32_16x16x32_bf16 v[116:119], a[200:203], v[60:63], v[116:119]
  v_exp_f32 v149, v149
  v_mfma_f32_16x16x32_bf16 v[116:119], a[204:207], v[64:67], v[116:119]
  ds_read_b128 a[132:135], v2 offset:33792
  v_cvt_pk_bf16_f32 v228, v148, v149
  v_mfma_f32_16x16x32_bf16 v[124:127], a[192:195], v[68:71], v[40:43]
  v_exp_f32 v150, v150
  v_mfma_f32_16x16x32_bf16 v[124:127], a[196:199], v[72:75], v[124:127]
  v_mfma_f32_16x16x32_bf16 v[124:127], a[200:203], v[76:79], v[124:127]
  v_exp_f32 v151, v151
  v_mfma_f32_16x16x32_bf16 v[124:127], a[204:207], v[80:83], v[124:127]
  ds_read_b128 a[136:139], v2 offset:34816
  v_cvt_pk_bf16_f32 v229, v150, v151
  v_mfma_f32_16x16x32_bf16 v[132:135], a[192:195], v[84:87], v[44:47]
  v_exp_f32 v152, v152
  v_mfma_f32_16x16x32_bf16 v[132:135], a[196:199], v[88:91], v[132:135]
  v_mfma_f32_16x16x32_bf16 v[132:135], a[200:203], v[92:95], v[132:135]
  v_exp_f32 v153, v153
  v_mfma_f32_16x16x32_bf16 v[132:135], a[204:207], v[96:99], v[132:135]
  ds_read_b128 a[140:143], v2 offset:35840
  v_cvt_pk_bf16_f32 v230, v152, v153
  v_mfma_f32_16x16x32_bf16 v[140:143], a[192:195], v[100:103], v[48:51]
  v_exp_f32 v154, v154
  v_mfma_f32_16x16x32_bf16 v[140:143], a[196:199], v[104:107], v[140:143]
  global_load_lds_dwordx4 v3, s[94:95] offset:-4096 sc1
  v_mfma_f32_16x16x32_bf16 v[140:143], a[200:203], v[108:111], v[140:143]
  v_exp_f32 v155, v155
  v_mfma_f32_16x16x32_bf16 v[140:143], a[204:207], v[112:115], v[140:143]
  ds_read_b128 a[144:147], v2 offset:36864
  v_cvt_pk_bf16_f32 v231, v154, v155
  v_mfma_f32_16x16x32_bf16 v[120:123], a[208:211], v[52:55], v[36:39]
  v_exp_f32 v156, v156
  v_mfma_f32_16x16x32_bf16 v[120:123], a[212:215], v[56:59], v[120:123]
  v_mfma_f32_16x16x32_bf16 v[120:123], a[216:219], v[60:63], v[120:123]
  v_exp_f32 v157, v157
  v_mfma_f32_16x16x32_bf16 v[120:123], a[220:223], v[64:67], v[120:123]
  ds_read_b128 a[148:151], v2 offset:37888
  v_cvt_pk_bf16_f32 v232, v156, v157
  v_mfma_f32_16x16x32_bf16 v[128:131], a[208:211], v[68:71], v[40:43]
  v_exp_f32 v158, v158
  v_mfma_f32_16x16x32_bf16 v[128:131], a[212:215], v[72:75], v[128:131]
  v_mfma_f32_16x16x32_bf16 v[128:131], a[216:219], v[76:79], v[128:131]
  v_exp_f32 v159, v159
  v_mfma_f32_16x16x32_bf16 v[128:131], a[220:223], v[80:83], v[128:131]
  ds_read_b128 a[152:155], v2 offset:38912
  v_cvt_pk_bf16_f32 v233, v158, v159
  v_mfma_f32_16x16x32_bf16 v[136:139], a[208:211], v[84:87], v[44:47]
  v_exp_f32 v160, v160
  v_mfma_f32_16x16x32_bf16 v[136:139], a[212:215], v[88:91], v[136:139]
  global_load_lds_dwordx4 v3, s[94:95] offset:-3072 sc1
  v_mfma_f32_16x16x32_bf16 v[136:139], a[216:219], v[92:95], v[136:139]
  v_exp_f32 v161, v161
  v_mfma_f32_16x16x32_bf16 v[136:139], a[220:223], v[96:99], v[136:139]
  ds_read_b128 a[156:159], v2 offset:39936
  v_cvt_pk_bf16_f32 v234, v160, v161
  v_mfma_f32_16x16x32_bf16 v[144:147], a[208:211], v[100:103], v[48:51]
  v_exp_f32 v162, v162
  v_mfma_f32_16x16x32_bf16 v[144:147], a[212:215], v[104:107], v[144:147]
  v_mfma_f32_16x16x32_bf16 v[144:147], a[216:219], v[108:111], v[144:147]
  v_exp_f32 v163, v163
  v_mfma_f32_16x16x32_bf16 v[144:147], a[220:223], v[112:115], v[144:147]
  ds_read_b128 a[160:163], v2 offset:49152
  v_cvt_pk_bf16_f32 v235, v162, v163
  v_mfma_f32_16x16x32_bf16 a[16:19], a[224:227], v[180:183], a[16:19]
  v_mfma_f32_16x16x32_bf16 a[16:19], a[240:243], v[196:199], a[16:19]
  v_exp_f32 v164, v164
  v_mfma_f32_16x16x32_bf16 a[48:51], a[224:227], v[184:187], a[48:51]
  ds_read_b128 a[164:167], v2 offset:50176
  v_mfma_f32_16x16x32_bf16 a[48:51], a[240:243], v[200:203], a[48:51]
  v_exp_f32 v165, v165
  v_mfma_f32_16x16x32_bf16 a[80:83], a[224:227], v[188:191], a[80:83]
  v_cvt_pk_bf16_f32 v236, v164, v165
  v_mfma_f32_16x16x32_bf16 a[80:83], a[240:243], v[204:207], a[80:83]
  v_exp_f32 v166, v166
  v_mfma_f32_16x16x32_bf16 a[112:115], a[224:227], v[192:195], a[112:115]
  global_load_lds_dwordx4 v3, s[94:95] offset:-2048 sc1
  v_mfma_f32_16x16x32_bf16 a[112:115], a[240:243], v[208:211], a[112:115]
  v_exp_f32 v167, v167
  v_mfma_f32_16x16x32_bf16 a[116:119], a[228:231], v[192:195], a[116:119]
  ds_read_b128 a[168:171], v2 offset:51200
  v_cvt_pk_bf16_f32 v237, v166, v167
  v_mfma_f32_16x16x32_bf16 a[116:119], a[244:247], v[208:211], a[116:119]
  v_exp_f32 v168, v168
  v_mfma_f32_16x16x32_bf16 a[84:87], a[228:231], v[188:191], a[84:87]
  ds_read_b128 a[172:175], v2 offset:52224
  v_mfma_f32_16x16x32_bf16 a[84:87], a[244:247], v[204:207], a[84:87]
  v_exp_f32 v169, v169
  v_mfma_f32_16x16x32_bf16 a[52:55], a[228:231], v[184:187], a[52:55]
  v_cvt_pk_bf16_f32 v238, v168, v169
  v_mfma_f32_16x16x32_bf16 a[52:55], a[244:247], v[200:203], a[52:55]
  v_exp_f32 v170, v170
  v_mfma_f32_16x16x32_bf16 a[20:23], a[228:231], v[180:183], a[20:23]
  ds_read_b128 a[176:179], v2 offset:57344
  v_mfma_f32_16x16x32_bf16 a[20:23], a[244:247], v[196:199], a[20:23]
  v_exp_f32 v171, v171
  v_mfma_f32_16x16x32_bf16 v[24:27], v[16:19], v[184:187], v[24:27]
  ds_read_b128 a[180:183], v2 offset:58368
  v_cvt_pk_bf16_f32 v239, v170, v171
  v_mfma_f32_16x16x32_bf16 v[24:27], v[16:19], v[200:203], v[24:27]
  v_exp_f32 v172, v172
  v_mfma_f32_16x16x32_bf16 a[24:27], a[232:235], v[180:183], a[24:27]
  v_mfma_f32_16x16x32_bf16 a[24:27], a[248:251], v[196:199], a[24:27]
  v_exp_f32 v173, v173
  v_mfma_f32_16x16x32_bf16 a[56:59], a[232:235], v[184:187], a[56:59]
  ds_read_b128 a[184:187], v2 offset:59392
  v_cvt_pk_bf16_f32 v240, v172, v173
  v_mfma_f32_16x16x32_bf16 a[56:59], a[248:251], v[200:203], a[56:59]
  v_exp_f32 v174, v174
  v_mfma_f32_16x16x32_bf16 a[88:91], a[232:235], v[188:191], a[88:91]
  global_load_lds_dwordx4 v3, s[94:95] offset:-1024 sc1
  v_mfma_f32_16x16x32_bf16 a[88:91], a[248:251], v[204:207], a[88:91]
  v_exp_f32 v175, v175
  v_mfma_f32_16x16x32_bf16 a[120:123], a[232:235], v[192:195], a[120:123]
  ds_read_b128 a[188:191], v2 offset:60416
  v_cvt_pk_bf16_f32 v241, v174, v175
  v_mfma_f32_16x16x32_bf16 a[120:123], a[248:251], v[208:211], a[120:123]
  v_exp_f32 v176, v176
  v_mfma_f32_16x16x32_bf16 v[32:35], v[16:19], v[192:195], v[32:35]
  v_mfma_f32_16x16x32_bf16 v[32:35], v[16:19], v[208:211], v[32:35]
  v_exp_f32 v177, v177
  v_mfma_f32_16x16x32_bf16 a[124:127], a[236:239], v[192:195], a[124:127]
  v_cvt_pk_bf16_f32 v242, v176, v177
  v_mfma_f32_16x16x32_bf16 a[124:127], a[252:255], v[208:211], a[124:127]
  v_exp_f32 v178, v178
  v_mfma_f32_16x16x32_bf16 a[92:95], a[236:239], v[188:191], a[92:95]
  v_mfma_f32_16x16x32_bf16 a[92:95], a[252:255], v[204:207], a[92:95]
  v_exp_f32 v179, v179
  v_mfma_f32_16x16x32_bf16 a[60:63], a[236:239], v[184:187], a[60:63]
  v_cvt_pk_bf16_f32 v243, v178, v179
  v_mfma_f32_16x16x32_bf16 a[60:63], a[252:255], v[200:203], a[60:63]
  v_mfma_f32_16x16x32_bf16 a[28:31], a[236:239], v[180:183], a[28:31]
  s_waitcnt lgkmcnt(0)
  v_mfma_f32_16x16x32_bf16 a[28:31], a[252:255], v[196:199], a[28:31]
adaLN_cond__compressed_kv_cla__mixer_channel_mlp__prompt_kernel_la1:
  v_mfma_f32_16x16x32_bf16 v[148:151], a[128:131], v[52:55], v[36:39]
  v_exp_f32 v116, v116
  v_mfma_f32_16x16x32_bf16 v[148:151], a[132:135], v[56:59], v[148:151]
  ds_read_b128 a[192:195], v2 offset:40960
  s_mov_b32 m0, s30
  v_mfma_f32_16x16x32_bf16 v[148:151], a[136:139], v[60:63], v[148:151]
  v_exp_f32 v117, v117
  v_mfma_f32_16x16x32_bf16 v[148:151], a[140:143], v[64:67], v[148:151]
  ds_read_b128 a[196:199], v2 offset:41984
  v_cvt_pk_bf16_f32 v180, v116, v117
  v_mfma_f32_16x16x32_bf16 v[156:159], a[128:131], v[68:71], v[40:43]
  v_exp_f32 v118, v118
  v_mfma_f32_16x16x32_bf16 v[156:159], a[132:135], v[72:75], v[156:159]
  v_mfma_f32_16x16x32_bf16 v[156:159], a[136:139], v[76:79], v[156:159]
  v_exp_f32 v119, v119
  v_mfma_f32_16x16x32_bf16 v[156:159], a[140:143], v[80:83], v[156:159]
  ds_read_b128 a[200:203], v2 offset:43008
  v_cvt_pk_bf16_f32 v181, v118, v119
  v_mfma_f32_16x16x32_bf16 v[164:167], a[128:131], v[84:87], v[44:47]
  v_exp_f32 v120, v120
  v_mfma_f32_16x16x32_bf16 v[164:167], a[132:135], v[88:91], v[164:167]
  v_mfma_f32_16x16x32_bf16 v[164:167], a[136:139], v[92:95], v[164:167]
  v_exp_f32 v121, v121
  v_mfma_f32_16x16x32_bf16 v[164:167], a[140:143], v[96:99], v[164:167]
  ds_read_b128 a[204:207], v2 offset:44032
  v_cvt_pk_bf16_f32 v182, v120, v121
  v_mfma_f32_16x16x32_bf16 v[172:175], a[128:131], v[100:103], v[48:51]
  v_exp_f32 v122, v122
  v_mfma_f32_16x16x32_bf16 v[172:175], a[132:135], v[104:107], v[172:175]
  global_load_lds_dwordx4 v3, s[94:95] offset:0 sc1
  v_mfma_f32_16x16x32_bf16 v[172:175], a[136:139], v[108:111], v[172:175]
  v_exp_f32 v123, v123
  v_mfma_f32_16x16x32_bf16 v[172:175], a[140:143], v[112:115], v[172:175]
  ds_read_b128 a[208:211], v2 offset:45056
  v_cvt_pk_bf16_f32 v183, v122, v123
  v_mfma_f32_16x16x32_bf16 v[152:155], a[144:147], v[52:55], v[36:39]
  v_exp_f32 v124, v124
  v_mfma_f32_16x16x32_bf16 v[152:155], a[148:151], v[56:59], v[152:155]
  v_mfma_f32_16x16x32_bf16 v[152:155], a[152:155], v[60:63], v[152:155]
  v_exp_f32 v125, v125
  v_mfma_f32_16x16x32_bf16 v[152:155], a[156:159], v[64:67], v[152:155]
  ds_read_b128 a[212:215], v2 offset:46080
  v_cvt_pk_bf16_f32 v184, v124, v125
  v_mfma_f32_16x16x32_bf16 v[160:163], a[144:147], v[68:71], v[40:43]
  v_exp_f32 v126, v126
  v_mfma_f32_16x16x32_bf16 v[160:163], a[148:151], v[72:75], v[160:163]
  global_load_lds_dwordx4 v3, s[94:95] offset:1024 sc1
  v_mfma_f32_16x16x32_bf16 v[160:163], a[152:155], v[76:79], v[160:163]
  v_exp_f32 v127, v127
  v_mfma_f32_16x16x32_bf16 v[160:163], a[156:159], v[80:83], v[160:163]
  ds_read_b128 a[216:219], v2 offset:47104
  v_cvt_pk_bf16_f32 v185, v126, v127
  v_mfma_f32_16x16x32_bf16 v[168:171], a[144:147], v[84:87], v[44:47]
  v_exp_f32 v128, v128
  v_mfma_f32_16x16x32_bf16 v[168:171], a[148:151], v[88:91], v[168:171]
  v_mfma_f32_16x16x32_bf16 v[168:171], a[152:155], v[92:95], v[168:171]
  v_exp_f32 v129, v129
  v_mfma_f32_16x16x32_bf16 v[168:171], a[156:159], v[96:99], v[168:171]
  ds_read_b128 a[220:223], v2 offset:48128
  v_cvt_pk_bf16_f32 v186, v128, v129
  v_mfma_f32_16x16x32_bf16 v[176:179], a[144:147], v[100:103], v[48:51]
  v_exp_f32 v130, v130
  v_mfma_f32_16x16x32_bf16 v[176:179], a[148:151], v[104:107], v[176:179]
  v_mfma_f32_16x16x32_bf16 v[176:179], a[152:155], v[108:111], v[176:179]
  v_exp_f32 v131, v131
  v_mfma_f32_16x16x32_bf16 v[176:179], a[156:159], v[112:115], v[176:179]
  ds_read_b128 a[224:227], v2 offset:53248
  v_cvt_pk_bf16_f32 v187, v130, v131
  v_mfma_f32_16x16x32_bf16 a[0:3], a[160:163], v[212:215], a[0:3]
  global_load_lds_dwordx4 v3, s[94:95] offset:2048 sc1
  v_mfma_f32_16x16x32_bf16 a[0:3], a[176:179], v[228:231], a[0:3]
  v_exp_f32 v132, v132
  v_mfma_f32_16x16x32_bf16 a[32:35], a[160:163], v[216:219], a[32:35]
  ds_read_b128 a[228:231], v2 offset:54272
  v_mfma_f32_16x16x32_bf16 a[32:35], a[176:179], v[232:235], a[32:35]
  v_exp_f32 v133, v133
  v_mfma_f32_16x16x32_bf16 a[64:67], a[160:163], v[220:223], a[64:67]
  v_cvt_pk_bf16_f32 v188, v132, v133
  v_mfma_f32_16x16x32_bf16 a[64:67], a[176:179], v[236:239], a[64:67]
  v_exp_f32 v134, v134
  v_mfma_f32_16x16x32_bf16 a[96:99], a[160:163], v[224:227], a[96:99]
  ds_read_b128 a[232:235], v2 offset:55296
  v_mfma_f32_16x16x32_bf16 a[96:99], a[176:179], v[240:243], a[96:99]
  v_exp_f32 v135, v135
  v_mfma_f32_16x16x32_bf16 a[100:103], a[164:167], v[224:227], a[100:103]
  v_cvt_pk_bf16_f32 v189, v134, v135
  v_mfma_f32_16x16x32_bf16 a[100:103], a[180:183], v[240:243], a[100:103]
  v_exp_f32 v136, v136
  v_mfma_f32_16x16x32_bf16 a[68:71], a[164:167], v[220:223], a[68:71]
  global_load_lds_dwordx4 v3, s[94:95] offset:3072 sc1
  v_mfma_f32_16x16x32_bf16 a[68:71], a[180:183], v[236:239], a[68:71]
  v_exp_f32 v137, v137
  v_mfma_f32_16x16x32_bf16 a[36:39], a[164:167], v[216:219], a[36:39]
  ds_read_b128 a[236:239], v2 offset:56320
  v_cvt_pk_bf16_f32 v190, v136, v137
  v_mfma_f32_16x16x32_bf16 a[36:39], a[180:183], v[232:235], a[36:39]
  v_exp_f32 v138, v138
  v_mfma_f32_16x16x32_bf16 a[4:7], a[164:167], v[212:215], a[4:7]
  ds_read_b128 a[240:243], v2 offset:61440
  v_mfma_f32_16x16x32_bf16 a[4:7], a[180:183], v[228:231], a[4:7]
  v_exp_f32 v139, v139
  v_mfma_f32_16x16x32_bf16 v[20:23], v[16:19], v[212:215], v[20:23]
  ds_read_b128 a[244:247], v2 offset:62464
  v_cvt_pk_bf16_f32 v191, v138, v139
  v_mfma_f32_16x16x32_bf16 v[20:23], v[16:19], v[228:231], v[20:23]
  v_exp_f32 v140, v140
  v_mfma_f32_16x16x32_bf16 a[8:11], a[168:171], v[212:215], a[8:11]
  v_mfma_f32_16x16x32_bf16 a[8:11], a[184:187], v[228:231], a[8:11]
  v_exp_f32 v141, v141
  v_mfma_f32_16x16x32_bf16 a[40:43], a[168:171], v[216:219], a[40:43]
  ds_read_b128 a[248:251], v2 offset:63488
  v_cvt_pk_bf16_f32 v192, v140, v141
  v_mfma_f32_16x16x32_bf16 a[40:43], a[184:187], v[232:235], a[40:43]
  v_exp_f32 v142, v142
  v_mfma_f32_16x16x32_bf16 a[72:75], a[168:171], v[220:223], a[72:75]
  v_add_u32 v3, 0x4000, v3
  v_mfma_f32_16x16x32_bf16 a[72:75], a[184:187], v[236:239], a[72:75]
  v_exp_f32 v143, v143
  v_mfma_f32_16x16x32_bf16 a[104:107], a[168:171], v[224:227], a[104:107]
  ds_read_b128 a[252:255], v2 offset:64512
  v_cvt_pk_bf16_f32 v193, v142, v143
  v_mfma_f32_16x16x32_bf16 a[104:107], a[184:187], v[240:243], a[104:107]
  v_exp_f32 v144, v144
  v_mfma_f32_16x16x32_bf16 v[28:31], v[16:19], v[220:223], v[28:31]
  v_mfma_f32_16x16x32_bf16 v[28:31], v[16:19], v[236:239], v[28:31]
  v_exp_f32 v145, v145
  v_mfma_f32_16x16x32_bf16 a[108:111], a[172:175], v[224:227], a[108:111]
  v_cvt_pk_bf16_f32 v194, v144, v145
  v_mfma_f32_16x16x32_bf16 a[108:111], a[188:191], v[240:243], a[108:111]
  v_exp_f32 v146, v146
  v_mfma_f32_16x16x32_bf16 a[76:79], a[172:175], v[220:223], a[76:79]
  v_mfma_f32_16x16x32_bf16 a[76:79], a[188:191], v[236:239], a[76:79]
  v_exp_f32 v147, v147
  v_mfma_f32_16x16x32_bf16 a[44:47], a[172:175], v[216:219], a[44:47]
  v_cvt_pk_bf16_f32 v195, v146, v147
  v_mfma_f32_16x16x32_bf16 a[44:47], a[188:191], v[232:235], a[44:47]
  v_mfma_f32_16x16x32_bf16 a[12:15], a[172:175], v[212:215], a[12:15]
  s_waitcnt vmcnt(16) lgkmcnt(0)
  s_barrier
  v_mfma_f32_16x16x32_bf16 a[12:15], a[188:191], v[228:231], a[12:15]
  v_mfma_f32_16x16x32_bf16 v[116:119], a[192:195], v[52:55], v[36:39]
  v_exp_f32 v148, v148
  v_mfma_f32_16x16x32_bf16 v[116:119], a[196:199], v[56:59], v[116:119]
  ds_read_b128 a[128:131], v254 offset:0
  s_add_u32 m0, s30, 0x8000
  v_mfma_f32_16x16x32_bf16 v[116:119], a[200:203], v[60:63], v[116:119]
  v_exp_f32 v149, v149
  v_mfma_f32_16x16x32_bf16 v[116:119], a[204:207], v[64:67], v[116:119]
  ds_read_b128 a[132:135], v254 offset:1024
  v_cvt_pk_bf16_f32 v196, v148, v149
  v_mfma_f32_16x16x32_bf16 v[124:127], a[192:195], v[68:71], v[40:43]
  v_exp_f32 v150, v150
  v_mfma_f32_16x16x32_bf16 v[124:127], a[196:199], v[72:75], v[124:127]
  v_mfma_f32_16x16x32_bf16 v[124:127], a[200:203], v[76:79], v[124:127]
  v_exp_f32 v151, v151
  v_mfma_f32_16x16x32_bf16 v[124:127], a[204:207], v[80:83], v[124:127]
  ds_read_b128 a[136:139], v254 offset:2048
  v_cvt_pk_bf16_f32 v197, v150, v151
  v_mfma_f32_16x16x32_bf16 v[132:135], a[192:195], v[84:87], v[44:47]
  v_exp_f32 v152, v152
  v_mfma_f32_16x16x32_bf16 v[132:135], a[196:199], v[88:91], v[132:135]
  v_mfma_f32_16x16x32_bf16 v[132:135], a[200:203], v[92:95], v[132:135]
  v_exp_f32 v153, v153
  v_mfma_f32_16x16x32_bf16 v[132:135], a[204:207], v[96:99], v[132:135]
  ds_read_b128 a[140:143], v254 offset:3072
  v_cvt_pk_bf16_f32 v198, v152, v153
  v_mfma_f32_16x16x32_bf16 v[140:143], a[192:195], v[100:103], v[48:51]
  v_exp_f32 v154, v154
  v_mfma_f32_16x16x32_bf16 v[140:143], a[196:199], v[104:107], v[140:143]
  global_load_lds_dwordx4 v3, s[94:95] offset:-4096 sc1
  v_mfma_f32_16x16x32_bf16 v[140:143], a[200:203], v[108:111], v[140:143]
  v_exp_f32 v155, v155
  v_mfma_f32_16x16x32_bf16 v[140:143], a[204:207], v[112:115], v[140:143]
  ds_read_b128 a[144:147], v254 offset:4096
  v_cvt_pk_bf16_f32 v199, v154, v155
  v_mfma_f32_16x16x32_bf16 v[120:123], a[208:211], v[52:55], v[36:39]
  v_exp_f32 v156, v156
  v_mfma_f32_16x16x32_bf16 v[120:123], a[212:215], v[56:59], v[120:123]
  v_mfma_f32_16x16x32_bf16 v[120:123], a[216:219], v[60:63], v[120:123]
  v_exp_f32 v157, v157
  v_mfma_f32_16x16x32_bf16 v[120:123], a[220:223], v[64:67], v[120:123]
  ds_read_b128 a[148:151], v254 offset:5120
  v_cvt_pk_bf16_f32 v200, v156, v157
  v_mfma_f32_16x16x32_bf16 v[128:131], a[208:211], v[68:71], v[40:43]
  v_exp_f32 v158, v158
  v_mfma_f32_16x16x32_bf16 v[128:131], a[212:215], v[72:75], v[128:131]
  v_mfma_f32_16x16x32_bf16 v[128:131], a[216:219], v[76:79], v[128:131]
  v_exp_f32 v159, v159
  v_mfma_f32_16x16x32_bf16 v[128:131], a[220:223], v[80:83], v[128:131]
  ds_read_b128 a[152:155], v254 offset:6144
  v_cvt_pk_bf16_f32 v201, v158, v159
  v_mfma_f32_16x16x32_bf16 v[136:139], a[208:211], v[84:87], v[44:47]
  v_exp_f32 v160, v160
  v_mfma_f32_16x16x32_bf16 v[136:139], a[212:215], v[88:91], v[136:139]
  global_load_lds_dwordx4 v3, s[94:95] offset:-3072 sc1
  v_mfma_f32_16x16x32_bf16 v[136:139], a[216:219], v[92:95], v[136:139]
  v_exp_f32 v161, v161
  v_mfma_f32_16x16x32_bf16 v[136:139], a[220:223], v[96:99], v[136:139]
  ds_read_b128 a[156:159], v254 offset:7168
  v_cvt_pk_bf16_f32 v202, v160, v161
  v_mfma_f32_16x16x32_bf16 v[144:147], a[208:211], v[100:103], v[48:51]
  v_exp_f32 v162, v162
  v_mfma_f32_16x16x32_bf16 v[144:147], a[212:215], v[104:107], v[144:147]
  v_mfma_f32_16x16x32_bf16 v[144:147], a[216:219], v[108:111], v[144:147]
  v_exp_f32 v163, v163
  v_mfma_f32_16x16x32_bf16 v[144:147], a[220:223], v[112:115], v[144:147]
  ds_read_b128 a[160:163], v254 offset:16384
  v_cvt_pk_bf16_f32 v203, v162, v163
  v_mfma_f32_16x16x32_bf16 a[16:19], a[224:227], v[212:215], a[16:19]
  v_mfma_f32_16x16x32_bf16 a[16:19], a[240:243], v[228:231], a[16:19]
  v_exp_f32 v164, v164
  v_mfma_f32_16x16x32_bf16 a[48:51], a[224:227], v[216:219], a[48:51]
  ds_read_b128 a[164:167], v254 offset:17408
  v_mfma_f32_16x16x32_bf16 a[48:51], a[240:243], v[232:235], a[48:51]
  v_exp_f32 v165, v165
  v_mfma_f32_16x16x32_bf16 a[80:83], a[224:227], v[220:223], a[80:83]
  v_cvt_pk_bf16_f32 v204, v164, v165
  v_mfma_f32_16x16x32_bf16 a[80:83], a[240:243], v[236:239], a[80:83]
  v_exp_f32 v166, v166
  v_mfma_f32_16x16x32_bf16 a[112:115], a[224:227], v[224:227], a[112:115]
  global_load_lds_dwordx4 v3, s[94:95] offset:-2048 sc1
  v_mfma_f32_16x16x32_bf16 a[112:115], a[240:243], v[240:243], a[112:115]
  v_exp_f32 v167, v167
  v_mfma_f32_16x16x32_bf16 a[116:119], a[228:231], v[224:227], a[116:119]
  ds_read_b128 a[168:171], v254 offset:18432
  v_cvt_pk_bf16_f32 v205, v166, v167
  v_mfma_f32_16x16x32_bf16 a[116:119], a[244:247], v[240:243], a[116:119]
  v_exp_f32 v168, v168
  v_mfma_f32_16x16x32_bf16 a[84:87], a[228:231], v[220:223], a[84:87]
  ds_read_b128 a[172:175], v254 offset:19456
  v_mfma_f32_16x16x32_bf16 a[84:87], a[244:247], v[236:239], a[84:87]
  v_exp_f32 v169, v169
  v_mfma_f32_16x16x32_bf16 a[52:55], a[228:231], v[216:219], a[52:55]
  v_cvt_pk_bf16_f32 v206, v168, v169
  v_mfma_f32_16x16x32_bf16 a[52:55], a[244:247], v[232:235], a[52:55]
  v_exp_f32 v170, v170
  v_mfma_f32_16x16x32_bf16 a[20:23], a[228:231], v[212:215], a[20:23]
  ds_read_b128 a[176:179], v254 offset:24576
  v_mfma_f32_16x16x32_bf16 a[20:23], a[244:247], v[228:231], a[20:23]
  v_exp_f32 v171, v171
  v_mfma_f32_16x16x32_bf16 v[24:27], v[16:19], v[216:219], v[24:27]
  ds_read_b128 a[180:183], v254 offset:25600
  v_cvt_pk_bf16_f32 v207, v170, v171
  v_mfma_f32_16x16x32_bf16 v[24:27], v[16:19], v[232:235], v[24:27]
  v_exp_f32 v172, v172
  v_mfma_f32_16x16x32_bf16 a[24:27], a[232:235], v[212:215], a[24:27]
  v_mfma_f32_16x16x32_bf16 a[24:27], a[248:251], v[228:231], a[24:27]
  v_exp_f32 v173, v173
  v_mfma_f32_16x16x32_bf16 a[56:59], a[232:235], v[216:219], a[56:59]
  ds_read_b128 a[184:187], v254 offset:26624
  v_cvt_pk_bf16_f32 v208, v172, v173
  v_mfma_f32_16x16x32_bf16 a[56:59], a[248:251], v[232:235], a[56:59]
  v_exp_f32 v174, v174
  v_mfma_f32_16x16x32_bf16 a[88:91], a[232:235], v[220:223], a[88:91]
  global_load_lds_dwordx4 v3, s[94:95] offset:-1024 sc1
  v_mfma_f32_16x16x32_bf16 a[88:91], a[248:251], v[236:239], a[88:91]
  v_exp_f32 v175, v175
  v_mfma_f32_16x16x32_bf16 a[120:123], a[232:235], v[224:227], a[120:123]
  ds_read_b128 a[188:191], v254 offset:27648
  v_cvt_pk_bf16_f32 v209, v174, v175
  v_mfma_f32_16x16x32_bf16 a[120:123], a[248:251], v[240:243], a[120:123]
  v_exp_f32 v176, v176
  v_mfma_f32_16x16x32_bf16 v[32:35], v[16:19], v[224:227], v[32:35]
  v_mfma_f32_16x16x32_bf16 v[32:35], v[16:19], v[240:243], v[32:35]
  v_exp_f32 v177, v177
  v_mfma_f32_16x16x32_bf16 a[124:127], a[236:239], v[224:227], a[124:127]
  v_cvt_pk_bf16_f32 v210, v176, v177
  v_mfma_f32_16x16x32_bf16 a[124:127], a[252:255], v[240:243], a[124:127]
  v_exp_f32 v178, v178
  v_mfma_f32_16x16x32_bf16 a[92:95], a[236:239], v[220:223], a[92:95]
  v_mfma_f32_16x16x32_bf16 a[92:95], a[252:255], v[236:239], a[92:95]
  v_exp_f32 v179, v179
  v_mfma_f32_16x16x32_bf16 a[60:63], a[236:239], v[216:219], a[60:63]
  v_cvt_pk_bf16_f32 v211, v178, v179
  v_mfma_f32_16x16x32_bf16 a[60:63], a[252:255], v[232:235], a[60:63]
  v_mfma_f32_16x16x32_bf16 a[28:31], a[236:239], v[212:215], a[28:31]
  s_waitcnt lgkmcnt(0)
  v_mfma_f32_16x16x32_bf16 a[28:31], a[252:255], v[228:231], a[28:31]
adaLN_cond__compressed_kv_cla__mixer_channel_mlp__prompt_kernel_a1m:
  v_mfma_f32_16x16x32_bf16 v[148:151], a[128:131], v[52:55], v[36:39]
  v_exp_f32 v116, v116
  v_mfma_f32_16x16x32_bf16 v[148:151], a[132:135], v[56:59], v[148:151]
  global_load_lds_dwordx4 v3, s[94:95] offset:0 sc1
  v_mfma_f32_16x16x32_bf16 v[148:151], a[136:139], v[60:63], v[148:151]
  v_exp_f32 v117, v117
  v_mfma_f32_16x16x32_bf16 v[148:151], a[140:143], v[64:67], v[148:151]
  ds_read_b128 a[192:195], v254 offset:8192
  v_cvt_pk_bf16_f32 v212, v116, v117
  v_mfma_f32_16x16x32_bf16 v[156:159], a[128:131], v[68:71], v[40:43]
  v_exp_f32 v118, v118
  v_mfma_f32_16x16x32_bf16 v[156:159], a[132:135], v[72:75], v[156:159]
  ds_read_b128 a[196:199], v254 offset:9216
  v_mfma_f32_16x16x32_bf16 v[156:159], a[136:139], v[76:79], v[156:159]
  v_exp_f32 v119, v119
  v_mfma_f32_16x16x32_bf16 v[156:159], a[140:143], v[80:83], v[156:159]
  ds_read_b128 a[200:203], v254 offset:10240
  v_cvt_pk_bf16_f32 v213, v118, v119
  v_mfma_f32_16x16x32_bf16 v[164:167], a[128:131], v[84:87], v[44:47]
  v_exp_f32 v120, v120
  v_mfma_f32_16x16x32_bf16 v[164:167], a[132:135], v[88:91], v[164:167]
  v_mfma_f32_16x16x32_bf16 v[164:167], a[136:139], v[92:95], v[164:167]
  v_exp_f32 v121, v121
  v_mfma_f32_16x16x32_bf16 v[164:167], a[140:143], v[96:99], v[164:167]
  ds_read_b128 a[204:207], v254 offset:11264
  v_cvt_pk_bf16_f32 v214, v120, v121
  v_mfma_f32_16x16x32_bf16 v[172:175], a[128:131], v[100:103], v[48:51]
  v_exp_f32 v122, v122
  v_mfma_f32_16x16x32_bf16 v[172:175], a[132:135], v[104:107], v[172:175]
  global_load_lds_dwordx4 v3, s[94:95] offset:1024 sc1
  v_mfma_f32_16x16x32_bf16 v[172:175], a[136:139], v[108:111], v[172:175]
  v_exp_f32 v123, v123
  v_mfma_f32_16x16x32_bf16 v[172:175], a[140:143], v[112:115], v[172:175]
  ds_read_b128 a[208:211], v254 offset:12288
  v_cvt_pk_bf16_f32 v215, v122, v123
  v_mfma_f32_16x16x32_bf16 v[152:155], a[144:147], v[52:55], v[36:39]
  v_exp_f32 v124, v124
  v_mfma_f32_16x16x32_bf16 v[152:155], a[148:151], v[56:59], v[152:155]
  v_mfma_f32_16x16x32_bf16 v[152:155], a[152:155], v[60:63], v[152:155]
  v_exp_f32 v125, v125
  v_mfma_f32_16x16x32_bf16 v[152:155], a[156:159], v[64:67], v[152:155]
  ds_read_b128 a[212:215], v254 offset:13312
  v_cvt_pk_bf16_f32 v216, v124, v125
  v_mfma_f32_16x16x32_bf16 v[160:163], a[144:147], v[68:71], v[40:43]
  v_exp_f32 v126, v126
  v_mfma_f32_16x16x32_bf16 v[160:163], a[148:151], v[72:75], v[160:163]
  global_load_lds_dwordx4 v3, s[94:95] offset:2048 sc1
  v_mfma_f32_16x16x32_bf16 v[160:163], a[152:155], v[76:79], v[160:163]
  v_exp_f32 v127, v127
  v_mfma_f32_16x16x32_bf16 v[160:163], a[156:159], v[80:83], v[160:163]
  ds_read_b128 a[216:219], v254 offset:14336
  v_cvt_pk_bf16_f32 v217, v126, v127
  v_mfma_f32_16x16x32_bf16 v[168:171], a[144:147], v[84:87], v[44:47]
  v_exp_f32 v128, v128
  v_mfma_f32_16x16x32_bf16 v[168:171], a[148:151], v[88:91], v[168:171]
  v_mfma_f32_16x16x32_bf16 v[168:171], a[152:155], v[92:95], v[168:171]
  v_exp_f32 v129, v129
  v_mfma_f32_16x16x32_bf16 v[168:171], a[156:159], v[96:99], v[168:171]
  ds_read_b128 a[220:223], v254 offset:15360
  v_cvt_pk_bf16_f32 v218, v128, v129
  v_mfma_f32_16x16x32_bf16 v[176:179], a[144:147], v[100:103], v[48:51]
  v_exp_f32 v130, v130
  v_mfma_f32_16x16x32_bf16 v[176:179], a[148:151], v[104:107], v[176:179]
  v_mfma_f32_16x16x32_bf16 v[176:179], a[152:155], v[108:111], v[176:179]
  v_exp_f32 v131, v131
  v_mfma_f32_16x16x32_bf16 v[176:179], a[156:159], v[112:115], v[176:179]
  ds_read_b128 a[224:227], v254 offset:20480
  v_cvt_pk_bf16_f32 v219, v130, v131
  v_mfma_f32_16x16x32_bf16 a[0:3], a[160:163], v[180:183], a[0:3]
  global_load_lds_dwordx4 v3, s[94:95] offset:3072 sc1
  v_mfma_f32_16x16x32_bf16 a[0:3], a[176:179], v[196:199], a[0:3]
  v_exp_f32 v132, v132
  v_mfma_f32_16x16x32_bf16 a[32:35], a[160:163], v[184:187], a[32:35]
  ds_read_b128 a[228:231], v254 offset:21504
  v_mfma_f32_16x16x32_bf16 a[32:35], a[176:179], v[200:203], a[32:35]
  v_exp_f32 v133, v133
  v_mfma_f32_16x16x32_bf16 a[64:67], a[160:163], v[188:191], a[64:67]
  v_cvt_pk_bf16_f32 v220, v132, v133
  v_mfma_f32_16x16x32_bf16 a[64:67], a[176:179], v[204:207], a[64:67]
  v_exp_f32 v134, v134
  v_mfma_f32_16x16x32_bf16 a[96:99], a[160:163], v[192:195], a[96:99]
  ds_read_b128 a[232:235], v254 offset:22528
  v_mfma_f32_16x16x32_bf16 a[96:99], a[176:179], v[208:211], a[96:99]
  v_exp_f32 v135, v135
  v_mfma_f32_16x16x32_bf16 a[100:103], a[164:167], v[192:195], a[100:103]
  v_cvt_pk_bf16_f32 v221, v134, v135
  v_mfma_f32_16x16x32_bf16 a[100:103], a[180:183], v[208:211], a[100:103]
  v_exp_f32 v136, v136
  v_mfma_f32_16x16x32_bf16 a[68:71], a[164:167], v[188:191], a[68:71]
  ds_read_b128 a[236:239], v254 offset:23552
  v_add_u32 v3, 0x4000, v3
  v_mfma_f32_16x16x32_bf16 a[68:71], a[180:183], v[204:207], a[68:71]
  v_exp_f32 v137, v137
  v_mfma_f32_16x16x32_bf16 a[36:39], a[164:167], v[184:187], a[36:39]
  v_cvt_pk_bf16_f32 v222, v136, v137
  v_mfma_f32_16x16x32_bf16 a[36:39], a[180:183], v[200:203], a[36:39]
  v_exp_f32 v138, v138
  v_mfma_f32_16x16x32_bf16 a[4:7], a[164:167], v[180:183], a[4:7]
  ds_read_b128 a[240:243], v254 offset:28672
  v_mfma_f32_16x16x32_bf16 a[4:7], a[180:183], v[196:199], a[4:7]
  v_exp_f32 v139, v139
  v_mfma_f32_16x16x32_bf16 v[20:23], v[16:19], v[180:183], v[20:23]
  ds_read_b128 a[244:247], v254 offset:29696
  v_cvt_pk_bf16_f32 v223, v138, v139
  v_mfma_f32_16x16x32_bf16 v[20:23], v[16:19], v[196:199], v[20:23]
  v_exp_f32 v140, v140
  v_mfma_f32_16x16x32_bf16 a[8:11], a[168:171], v[180:183], a[8:11]
  v_mfma_f32_16x16x32_bf16 a[8:11], a[184:187], v[196:199], a[8:11]
  v_exp_f32 v141, v141
  v_mfma_f32_16x16x32_bf16 a[40:43], a[168:171], v[184:187], a[40:43]
  ds_read_b128 a[248:251], v254 offset:30720
  v_cvt_pk_bf16_f32 v224, v140, v141
  v_mfma_f32_16x16x32_bf16 a[40:43], a[184:187], v[200:203], a[40:43]
  v_exp_f32 v142, v142
  v_mfma_f32_16x16x32_bf16 a[72:75], a[168:171], v[188:191], a[72:75]
  s_sub_u32 s25, s25, 1
  v_mfma_f32_16x16x32_bf16 a[72:75], a[184:187], v[204:207], a[72:75]
  v_exp_f32 v143, v143
  v_mfma_f32_16x16x32_bf16 a[104:107], a[168:171], v[192:195], a[104:107]
  ds_read_b128 a[252:255], v254 offset:31744
  v_cvt_pk_bf16_f32 v225, v142, v143
  v_mfma_f32_16x16x32_bf16 a[104:107], a[184:187], v[208:211], a[104:107]
  v_exp_f32 v144, v144
  v_mfma_f32_16x16x32_bf16 v[28:31], v[16:19], v[188:191], v[28:31]
  v_mfma_f32_16x16x32_bf16 v[28:31], v[16:19], v[204:207], v[28:31]
  v_exp_f32 v145, v145
  v_mfma_f32_16x16x32_bf16 a[108:111], a[172:175], v[192:195], a[108:111]
  v_cvt_pk_bf16_f32 v226, v144, v145
  v_mfma_f32_16x16x32_bf16 a[108:111], a[188:191], v[208:211], a[108:111]
  v_exp_f32 v146, v146
  v_mfma_f32_16x16x32_bf16 a[76:79], a[172:175], v[188:191], a[76:79]
  v_mfma_f32_16x16x32_bf16 a[76:79], a[188:191], v[204:207], a[76:79]
  v_exp_f32 v147, v147
  v_mfma_f32_16x16x32_bf16 a[44:47], a[172:175], v[184:187], a[44:47]
  v_cvt_pk_bf16_f32 v227, v146, v147
  v_mfma_f32_16x16x32_bf16 a[44:47], a[188:191], v[200:203], a[44:47]
  v_mfma_f32_16x16x32_bf16 a[12:15], a[172:175], v[180:183], a[12:15]
  s_waitcnt vmcnt(16) lgkmcnt(0)
  s_barrier
  v_mfma_f32_16x16x32_bf16 a[12:15], a[188:191], v[196:199], a[12:15]
  v_mfma_f32_16x16x32_bf16 v[116:119], a[192:195], v[52:55], v[36:39]
  v_exp_f32 v148, v148
  v_mfma_f32_16x16x32_bf16 v[116:119], a[196:199], v[56:59], v[116:119]
  ds_read_b128 a[128:131], v254 offset:32768
  s_mov_b32 m0, s31
  v_mfma_f32_16x16x32_bf16 v[116:119], a[200:203], v[60:63], v[116:119]
  v_exp_f32 v149, v149
  v_mfma_f32_16x16x32_bf16 v[116:119], a[204:207], v[64:67], v[116:119]
  ds_read_b128 a[132:135], v254 offset:33792
  v_cvt_pk_bf16_f32 v228, v148, v149
  v_mfma_f32_16x16x32_bf16 v[124:127], a[192:195], v[68:71], v[40:43]
  v_exp_f32 v150, v150
  v_mfma_f32_16x16x32_bf16 v[124:127], a[196:199], v[72:75], v[124:127]
  v_exp_f32 v151, v151
  v_mfma_f32_16x16x32_bf16 v[124:127], a[200:203], v[76:79], v[124:127]
  v_cvt_pk_bf16_f32 v229, v150, v151
  v_mfma_f32_16x16x32_bf16 v[124:127], a[204:207], v[80:83], v[124:127]
  v_exp_f32 v152, v152
  v_mfma_f32_16x16x32_bf16 v[132:135], a[192:195], v[84:87], v[44:47]
  ds_read_b128 a[136:139], v254 offset:34816
  v_mfma_f32_16x16x32_bf16 v[132:135], a[196:199], v[88:91], v[132:135]
  v_exp_f32 v153, v153
  v_mfma_f32_16x16x32_bf16 v[132:135], a[200:203], v[92:95], v[132:135]
  v_cvt_pk_bf16_f32 v230, v152, v153
  v_mfma_f32_16x16x32_bf16 v[132:135], a[204:207], v[96:99], v[132:135]
  v_exp_f32 v154, v154
  v_mfma_f32_16x16x32_bf16 v[140:143], a[192:195], v[100:103], v[48:51]
  global_load_lds_dwordx4 v3, s[94:95] offset:-4096 sc1
  v_mfma_f32_16x16x32_bf16 v[140:143], a[196:199], v[104:107], v[140:143]
  v_exp_f32 v155, v155
  v_mfma_f32_16x16x32_bf16 v[140:143], a[200:203], v[108:111], v[140:143]
  ds_read_b128 a[140:143], v254 offset:35840
  v_cvt_pk_bf16_f32 v231, v154, v155
  v_mfma_f32_16x16x32_bf16 v[140:143], a[204:207], v[112:115], v[140:143]
  v_exp_f32 v156, v156
  v_mfma_f32_16x16x32_bf16 v[120:123], a[208:211], v[52:55], v[36:39]
  ds_read_b128 a[144:147], v254 offset:36864
  v_mfma_f32_16x16x32_bf16 v[120:123], a[212:215], v[56:59], v[120:123]
  v_exp_f32 v157, v157
  v_mfma_f32_16x16x32_bf16 v[120:123], a[216:219], v[60:63], v[120:123]
  ds_read_b128 a[148:151], v254 offset:37888
  v_cvt_pk_bf16_f32 v232, v156, v157
  v_mfma_f32_16x16x32_bf16 v[120:123], a[220:223], v[64:67], v[120:123]
  v_exp_f32 v158, v158
  v_mfma_f32_16x16x32_bf16 v[128:131], a[208:211], v[68:71], v[40:43]
  v_mfma_f32_16x16x32_bf16 v[128:131], a[212:215], v[72:75], v[128:131]
  v_exp_f32 v159, v159
  v_mfma_f32_16x16x32_bf16 v[128:131], a[216:219], v[76:79], v[128:131]
  ds_read_b128 a[152:155], v254 offset:38912
  v_cvt_pk_bf16_f32 v233, v158, v159
  v_mfma_f32_16x16x32_bf16 v[128:131], a[220:223], v[80:83], v[128:131]
  v_exp_f32 v160, v160
  v_mfma_f32_16x16x32_bf16 v[136:139], a[208:211], v[84:87], v[44:47]
  v_mfma_f32_16x16x32_bf16 v[136:139], a[212:215], v[88:91], v[136:139]
  v_exp_f32 v161, v161
  v_mfma_f32_16x16x32_bf16 v[136:139], a[216:219], v[92:95], v[136:139]
  ds_read_b128 a[156:159], v254 offset:39936
  v_cvt_pk_bf16_f32 v234, v160, v161
  v_mfma_f32_16x16x32_bf16 v[136:139], a[220:223], v[96:99], v[136:139]
  v_exp_f32 v162, v162
  v_mfma_f32_16x16x32_bf16 v[144:147], a[208:211], v[100:103], v[48:51]
  global_load_lds_dwordx4 v3, s[94:95] offset:-3072 sc1
  v_mfma_f32_16x16x32_bf16 v[144:147], a[212:215], v[104:107], v[144:147]
  v_exp_f32 v163, v163
  v_mfma_f32_16x16x32_bf16 v[144:147], a[216:219], v[108:111], v[144:147]
  ds_read_b128 a[160:163], v254 offset:49152
  v_cvt_pk_bf16_f32 v235, v162, v163
  v_mfma_f32_16x16x32_bf16 v[144:147], a[220:223], v[112:115], v[144:147]
  v_exp_f32 v164, v164
  v_mfma_f32_16x16x32_bf16 a[16:19], a[224:227], v[180:183], a[16:19]
  v_exp_f32 v165, v165
  v_mfma_f32_16x16x32_bf16 a[16:19], a[240:243], v[196:199], a[16:19]
  ds_read_b128 a[164:167], v254 offset:50176
  v_cvt_pk_bf16_f32 v236, v164, v165
  v_mfma_f32_16x16x32_bf16 a[48:51], a[224:227], v[184:187], a[48:51]
  v_exp_f32 v166, v166
  v_mfma_f32_16x16x32_bf16 a[48:51], a[240:243], v[200:203], a[48:51]
  v_mfma_f32_16x16x32_bf16 a[80:83], a[224:227], v[188:191], a[80:83]
  v_exp_f32 v167, v167
  v_mfma_f32_16x16x32_bf16 a[80:83], a[240:243], v[204:207], a[80:83]
  ds_read_b128 a[168:171], v254 offset:51200
  v_cvt_pk_bf16_f32 v237, v166, v167
  v_mfma_f32_16x16x32_bf16 a[112:115], a[224:227], v[192:195], a[112:115]
  v_exp_f32 v168, v168
  v_mfma_f32_16x16x32_bf16 a[112:115], a[240:243], v[208:211], a[112:115]
  global_load_lds_dwordx4 v3, s[94:95] offset:-2048 sc1
  v_mfma_f32_16x16x32_bf16 a[116:119], a[228:231], v[192:195], a[116:119]
  v_exp_f32 v169, v169
  v_mfma_f32_16x16x32_bf16 a[116:119], a[244:247], v[208:211], a[116:119]
  ds_read_b128 a[172:175], v254 offset:52224
  v_cvt_pk_bf16_f32 v238, v168, v169
  v_mfma_f32_16x16x32_bf16 a[84:87], a[228:231], v[188:191], a[84:87]
  v_exp_f32 v170, v170
  v_mfma_f32_16x16x32_bf16 a[84:87], a[244:247], v[204:207], a[84:87]
  v_mfma_f32_16x16x32_bf16 a[52:55], a[228:231], v[184:187], a[52:55]
  v_exp_f32 v171, v171
  v_mfma_f32_16x16x32_bf16 a[52:55], a[244:247], v[200:203], a[52:55]
  ds_read_b128 a[176:179], v254 offset:57344
  v_cvt_pk_bf16_f32 v239, v170, v171
  v_mfma_f32_16x16x32_bf16 a[20:23], a[228:231], v[180:183], a[20:23]
  v_exp_f32 v172, v172
  v_mfma_f32_16x16x32_bf16 a[20:23], a[244:247], v[196:199], a[20:23]
  v_mfma_f32_16x16x32_bf16 v[24:27], v[16:19], v[184:187], v[24:27]
  v_exp_f32 v173, v173
  v_mfma_f32_16x16x32_bf16 v[24:27], v[16:19], v[200:203], v[24:27]
  ds_read_b128 a[180:183], v254 offset:58368
  v_cvt_pk_bf16_f32 v240, v172, v173
  v_mfma_f32_16x16x32_bf16 a[24:27], a[232:235], v[180:183], a[24:27]
  v_exp_f32 v174, v174
  v_mfma_f32_16x16x32_bf16 a[24:27], a[248:251], v[196:199], a[24:27]
  global_load_lds_dwordx4 v3, s[94:95] offset:-1024 sc1
  v_mfma_f32_16x16x32_bf16 a[56:59], a[232:235], v[184:187], a[56:59]
  v_exp_f32 v175, v175
  v_mfma_f32_16x16x32_bf16 a[56:59], a[248:251], v[200:203], a[56:59]
  ds_read_b128 a[184:187], v254 offset:59392
  v_cvt_pk_bf16_f32 v241, v174, v175
  v_mfma_f32_16x16x32_bf16 a[88:91], a[232:235], v[188:191], a[88:91]
  v_exp_f32 v176, v176
  v_mfma_f32_16x16x32_bf16 a[88:91], a[248:251], v[204:207], a[88:91]
  v_mfma_f32_16x16x32_bf16 a[120:123], a[232:235], v[192:195], a[120:123]
  v_exp_f32 v177, v177
  v_mfma_f32_16x16x32_bf16 a[120:123], a[248:251], v[208:211], a[120:123]
  ds_read_b128 a[188:191], v254 offset:60416
  v_cvt_pk_bf16_f32 v242, v176, v177
  v_mfma_f32_16x16x32_bf16 v[32:35], v[16:19], v[192:195], v[32:35]
  v_exp_f32 v178, v178
  v_mfma_f32_16x16x32_bf16 v[32:35], v[16:19], v[208:211], v[32:35]
  v_mfma_f32_16x16x32_bf16 a[124:127], a[236:239], v[192:195], a[124:127]
  v_exp_f32 v179, v179
  v_mfma_f32_16x16x32_bf16 a[124:127], a[252:255], v[208:211], a[124:127]
  v_cvt_pk_bf16_f32 v243, v178, v179
  v_mfma_f32_16x16x32_bf16 a[92:95], a[236:239], v[188:191], a[92:95]
  v_mfma_f32_16x16x32_bf16 a[92:95], a[252:255], v[204:207], a[92:95]
  v_mfma_f32_16x16x32_bf16 a[60:63], a[236:239], v[184:187], a[60:63]
  v_mfma_f32_16x16x32_bf16 a[60:63], a[252:255], v[200:203], a[60:63]
  v_mfma_f32_16x16x32_bf16 a[28:31], a[236:239], v[180:183], a[28:31]
  s_waitcnt lgkmcnt(0)
  v_mfma_f32_16x16x32_bf16 a[28:31], a[252:255], v[196:199], a[28:31]
  s_cbranch_scc0 adaLN_cond__compressed_kv_cla__mixer_channel_mlp__prompt_kernel_la
adaLN_cond__compressed_kv_cla__mixer_channel_mlp__prompt_kernel_ad:
  buffer_load_dwordx2 v[244:245], v4, s[12:15], s24 offen offset:0 sc1
  buffer_load_dwordx2 v[246:247], v4, s[12:15], s24 offen offset:1024 sc1
  s_add_u32 m0, s67, 0
  s_nop 0
  buffer_load_dwordx4 v252, s[4:7], s70 offen offset:0 lds
  s_add_u32 m0, s67, 16256
  s_nop 0
  buffer_load_dwordx4 v252, s[4:7], s70 offen offset:128 lds
  s_add_u32 s70, s70, s71
  s_add_u32 m0, s67, 1024
  s_nop 0
  buffer_load_dwordx4 v252, s[4:7], s70 offen offset:0 lds
  s_add_u32 m0, s67, 17280
  s_nop 0
  buffer_load_dwordx4 v252, s[4:7], s70 offen offset:128 lds
  s_add_u32 s70, s70, s71
  s_add_u32 m0, s67, 2048
  s_nop 0
  buffer_load_dwordx4 v252, s[4:7], s70 offen offset:0 lds
  s_add_u32 m0, s67, 18304
  s_nop 0
  buffer_load_dwordx4 v252, s[4:7], s70 offen offset:128 lds
  s_add_u32 s70, s70, s71
  s_add_u32 m0, s67, 3072
  s_nop 0
  buffer_load_dwordx4 v252, s[4:7], s70 offen offset:0 lds
  s_add_u32 m0, s67, 19328
  s_nop 0
  buffer_load_dwordx4 v252, s[4:7], s70 offen offset:128 lds
  s_add_u32 s70, s70, s71
  v_and_b32 v248, 3, v1
  v_lshlrev_b32 v248, 7, v248
  buffer_load_dword v249, v248, s[12:15], s57 offen sc1
  global_load_dword v249, v248, s[84:85]
  global_load_dword v249, v248, s[84:85] offset:512
  v_min_u32 v248, 27, v1
  v_lshlrev_b32 v248, 7, v248
  global_load_dword v249, v248, s[80:81]
  v_mfma_f32_16x16x32_bf16 v[148:151], a[128:131], v[52:55], v[36:39]
  v_exp_f32 v124, v124
  v_mfma_f32_16x16x32_bf16 v[148:151], a[132:135], v[56:59], v[148:151]
  ds_read_b128 a[192:195], v254 offset:40960
  v_cmp_gt_i32_e64 s[48:49], 0, v5
  v_mfma_f32_16x16x32_bf16 v[148:151], a[136:139], v[60:63], v[148:151]
  v_exp_f32 v125, v125
  v_mfma_f32_16x16x32_bf16 v[148:151], a[140:143], v[64:67], v[148:151]
  ds_read_b128 a[196:199], v254 offset:41984
  v_cvt_pk_bf16_f32 v184, v124, v125
  v_mfma_f32_16x16x32_bf16 v[156:159], a[128:131], v[68:71], v[40:43]
  v_exp_f32 v126, v126
  v_mfma_f32_16x16x32_bf16 v[156:159], a[132:135], v[72:75], v[156:159]
  v_cndmask_b32_e64 v116, v116, v7, s[48:49]
  s_mov_b32 m0, s31
  v_mfma_f32_16x16x32_bf16 v[156:159], a[136:139], v[76:79], v[156:159]
  v_exp_f32 v127, v127
  v_mfma_f32_16x16x32_bf16 v[156:159], a[140:143], v[80:83], v[156:159]
  ds_read_b128 a[200:203], v254 offset:43008
  v_cvt_pk_bf16_f32 v185, v126, v127
  v_mfma_f32_16x16x32_bf16 v[164:167], a[128:131], v[84:87], v[44:47]
  v_exp_f32 v128, v128
  v_mfma_f32_16x16x32_bf16 v[164:167], a[132:135], v[88:91], v[164:167]
  v_cmp_gt_i32_e64 s[50:51], 1, v5
  v_mfma_f32_16x16x32_bf16 v[164:167], a[136:139], v[92:95], v[164:167]
  v_exp_f32 v129, v129
  v_mfma_f32_16x16x32_bf16 v[164:167], a[140:143], v[96:99], v[164:167]
  ds_read_b128 a[204:207], v254 offset:44032
  v_cvt_pk_bf16_f32 v186, v128, v129
  v_mfma_f32_16x16x32_bf16 v[172:175], a[128:131], v[100:103], v[48:51]
  v_cndmask_b32_e64 v117, v117, v7, s[50:51]
  v_cmp_gt_i32_e64 s[52:53], 2, v5
  v_mfma_f32_16x16x32_bf16 v[172:175], a[132:135], v[104:107], v[172:175]
  v_exp_f32 v130, v130
  v_mfma_f32_16x16x32_bf16 v[172:175], a[136:139], v[108:111], v[172:175]
  v_exp_f32 v131, v131
  v_mfma_f32_16x16x32_bf16 v[172:175], a[140:143], v[112:115], v[172:175]
  ds_read_b128 a[208:211], v254 offset:45056
  v_cvt_pk_bf16_f32 v187, v130, v131
  v_mfma_f32_16x16x32_bf16 v[152:155], a[144:147], v[52:55], v[36:39]
  v_exp_f32 v132, v132
  v_mfma_f32_16x16x32_bf16 v[152:155], a[148:151], v[56:59], v[152:155]
  global_load_lds_dwordx4 v3, s[94:95] offset:0 sc1
  v_mfma_f32_16x16x32_bf16 v[152:155], a[152:155], v[60:63], v[152:155]
  v_exp_f32 v133, v133
  v_mfma_f32_16x16x32_bf16 v[152:155], a[156:159], v[64:67], v[152:155]
  ds_read_b128 a[212:215], v254 offset:46080
  v_cndmask_b32_e64 v118, v118, v7, s[52:53]
  v_mfma_f32_16x16x32_bf16 v[160:163], a[144:147], v[68:71], v[40:43]
  v_cvt_pk_bf16_f32 v188, v132, v133
  v_cmp_gt_i32_e64 s[54:55], 3, v5
  v_mfma_f32_16x16x32_bf16 v[160:163], a[148:151], v[72:75], v[160:163]
  v_exp_f32 v134, v134
  v_mfma_f32_16x16x32_bf16 v[160:163], a[152:155], v[76:79], v[160:163]
  v_exp_f32 v135, v135
  v_mfma_f32_16x16x32_bf16 v[160:163], a[156:159], v[80:83], v[160:163]
  ds_read_b128 a[216:219], v254 offset:47104
  v_cvt_pk_bf16_f32 v189, v134, v135
  v_mfma_f32_16x16x32_bf16 v[168:171], a[144:147], v[84:87], v[44:47]
  v_exp_f32 v136, v136
  v_mfma_f32_16x16x32_bf16 v[168:171], a[148:151], v[88:91], v[168:171]
  v_cndmask_b32_e64 v119, v119, v7, s[54:55]
  v_cmp_gt_i32_e64 s[48:49], 16, v5
  v_mfma_f32_16x16x32_bf16 v[168:171], a[152:155], v[92:95], v[168:171]
  v_exp_f32 v137, v137
  v_mfma_f32_16x16x32_bf16 v[168:171], a[156:159], v[96:99], v[168:171]
  ds_read_b128 a[220:223], v254 offset:48128
  v_cvt_pk_bf16_f32 v190, v136, v137
  v_mfma_f32_16x16x32_bf16 v[176:179], a[144:147], v[100:103], v[48:51]
  v_exp_f32 v138, v138
  v_mfma_f32_16x16x32_bf16 v[176:179], a[148:151], v[104:107], v[176:179]
  global_load_lds_dwordx4 v3, s[94:95] offset:1024 sc1
  v_mfma_f32_16x16x32_bf16 v[176:179], a[152:155], v[108:111], v[176:179]
  ds_read_b128 a[224:227], v254 offset:53248
  v_cndmask_b32_e64 v120, v120, v7, s[48:49]
  v_mfma_f32_16x16x32_bf16 v[176:179], a[156:159], v[112:115], v[176:179]
  v_exp_f32 v139, v139
  v_mfma_f32_16x16x32_bf16 a[0:3], a[160:163], v[212:215], a[0:3]
  v_cvt_pk_bf16_f32 v191, v138, v139
  v_cmp_gt_i32_e64 s[50:51], 17, v5
  v_mfma_f32_16x16x32_bf16 a[0:3], a[176:179], v[228:231], a[0:3]
  v_exp_f32 v140, v140
  v_mfma_f32_16x16x32_bf16 a[32:35], a[160:163], v[216:219], a[32:35]
  ds_read_b128 a[228:231], v254 offset:54272
  v_cndmask_b32_e64 v121, v121, v7, s[50:51]
  v_mfma_f32_16x16x32_bf16 a[32:35], a[176:179], v[232:235], a[32:35]
  v_exp_f32 v141, v141
  v_mfma_f32_16x16x32_bf16 a[64:67], a[160:163], v[220:223], a[64:67]
  global_load_lds_dwordx4 v3, s[94:95] offset:2048 sc1
  v_mfma_f32_16x16x32_bf16 a[64:67], a[176:179], v[236:239], a[64:67]
  ds_read_b128 a[232:235], v254 offset:55296
  v_cvt_pk_bf16_f32 v192, v140, v141
  v_mfma_f32_16x16x32_bf16 a[96:99], a[160:163], v[224:227], a[96:99]
  v_exp_f32 v142, v142
  v_mfma_f32_16x16x32_bf16 a[96:99], a[176:179], v[240:243], a[96:99]
  v_exp_f32 v143, v143
  v_mfma_f32_16x16x32_bf16 a[100:103], a[164:167], v[224:227], a[100:103]
  v_cvt_pk_bf16_f32 v193, v142, v143
  v_cmp_gt_i32_e64 s[52:53], 18, v5
  v_mfma_f32_16x16x32_bf16 a[100:103], a[180:183], v[240:243], a[100:103]
  v_exp_f32 v144, v144
  v_mfma_f32_16x16x32_bf16 a[68:71], a[164:167], v[220:223], a[68:71]
  ds_read_b128 a[236:239], v254 offset:56320
  v_cndmask_b32_e64 v122, v122, v7, s[52:53]
  v_mfma_f32_16x16x32_bf16 a[68:71], a[180:183], v[236:239], a[68:71]
  v_exp_f32 v145, v145
  v_mfma_f32_16x16x32_bf16 a[36:39], a[164:167], v[216:219], a[36:39]
  v_cvt_pk_bf16_f32 v194, v144, v145
  v_cmp_gt_i32_e64 s[54:55], 19, v5
  v_mfma_f32_16x16x32_bf16 a[36:39], a[180:183], v[232:235], a[36:39]
  v_exp_f32 v146, v146
  v_mfma_f32_16x16x32_bf16 a[4:7], a[164:167], v[212:215], a[4:7]
  ds_read_b128 a[240:243], v254 offset:61440
  v_cndmask_b32_e64 v123, v123, v7, s[54:55]
  v_mfma_f32_16x16x32_bf16 a[4:7], a[180:183], v[228:231], a[4:7]
  v_exp_f32 v147, v147
  v_mfma_f32_16x16x32_bf16 v[20:23], v[16:19], v[212:215], v[20:23]
  ds_read_b128 a[244:247], v254 offset:62464
  v_cvt_pk_bf16_f32 v195, v146, v147
  v_mfma_f32_16x16x32_bf16 v[20:23], v[16:19], v[228:231], v[20:23]
  v_exp_f32 v116, v116
  v_mfma_f32_16x16x32_bf16 a[8:11], a[168:171], v[212:215], a[8:11]
  global_load_lds_dwordx4 v3, s[94:95] offset:3072 sc1
  v_mfma_f32_16x16x32_bf16 a[8:11], a[184:187], v[228:231], a[8:11]
  v_exp_f32 v117, v117
  v_mfma_f32_16x16x32_bf16 a[40:43], a[168:171], v[216:219], a[40:43]
  ds_read_b128 a[248:251], v254 offset:63488
  v_cvt_pk_bf16_f32 v180, v116, v117
  v_mfma_f32_16x16x32_bf16 a[40:43], a[184:187], v[232:235], a[40:43]
  v_exp_f32 v118, v118
  v_mfma_f32_16x16x32_bf16 a[72:75], a[168:171], v[220:223], a[72:75]
  v_add_u32 v3, 0x4000, v3
  v_mfma_f32_16x16x32_bf16 a[72:75], a[184:187], v[236:239], a[72:75]
  v_exp_f32 v119, v119
  v_mfma_f32_16x16x32_bf16 a[104:107], a[168:171], v[224:227], a[104:107]
  ds_read_b128 a[252:255], v254 offset:64512
  v_cvt_pk_bf16_f32 v181, v118, v119
  v_mfma_f32_16x16x32_bf16 a[104:107], a[184:187], v[240:243], a[104:107]
  v_exp_f32 v120, v120
  v_mfma_f32_16x16x32_bf16 v[28:31], v[16:19], v[220:223], v[28:31]
  v_mfma_f32_16x16x32_bf16 v[28:31], v[16:19], v[236:239], v[28:31]
  v_exp_f32 v121, v121
  v_mfma_f32_16x16x32_bf16 a[108:111], a[172:175], v[224:227], a[108:111]
  v_cvt_pk_bf16_f32 v182, v120, v121
  v_mfma_f32_16x16x32_bf16 a[108:111], a[188:191], v[240:243], a[108:111]
  v_exp_f32 v122, v122
  v_mfma_f32_16x16x32_bf16 a[76:79], a[172:175], v[220:223], a[76:79]
  v_mfma_f32_16x16x32_bf16 a[76:79], a[188:191], v[236:239], a[76:79]
  v_exp_f32 v123, v123
  v_mfma_f32_16x16x32_bf16 a[44:47], a[172:175], v[216:219], a[44:47]
  v_cvt_pk_bf16_f32 v183, v122, v123
  v_mfma_f32_16x16x32_bf16 a[44:47], a[188:191], v[232:235], a[44:47]
  v_mfma_f32_16x16x32_bf16 a[12:15], a[172:175], v[212:215], a[12:15]
  s_waitcnt vmcnt(16) lgkmcnt(0)
  s_barrier
  v_mfma_f32_16x16x32_bf16 a[12:15], a[188:191], v[228:231], a[12:15]
  v_mfma_f32_16x16x32_bf16 v[124:127], a[192:195], v[68:71], v[40:43]
  v_exp_f32 v156, v156
  v_mfma_f32_16x16x32_bf16 v[124:127], a[196:199], v[72:75], v[124:127]
  ds_read_b128 a[128:131], v2 offset:0
  v_cmp_gt_i32_e64 s[48:49], 32, v5
  v_mfma_f32_16x16x32_bf16 v[124:127], a[200:203], v[76:79], v[124:127]
  v_exp_f32 v157, v157
  v_mfma_f32_16x16x32_bf16 v[124:127], a[204:207], v[80:83], v[124:127]
  ds_read_b128 a[132:135], v2 offset:1024
  v_cvt_pk_bf16_f32 v200, v156, v157
  v_mfma_f32_16x16x32_bf16 v[132:135], a[192:195], v[84:87], v[44:47]
  v_exp_f32 v158, v158
  v_mfma_f32_16x16x32_bf16 v[132:135], a[196:199], v[88:91], v[132:135]
  v_cndmask_b32_e64 v148, v148, v7, s[48:49]
  v_cmp_gt_i32_e64 s[50:51], 33, v5
  v_mfma_f32_16x16x32_bf16 v[132:135], a[200:203], v[92:95], v[132:135]
  v_exp_f32 v159, v159
  v_mfma_f32_16x16x32_bf16 v[132:135], a[204:207], v[96:99], v[132:135]
  ds_read_b128 a[136:139], v2 offset:2048
  v_cvt_pk_bf16_f32 v201, v158, v159
  v_mfma_f32_16x16x32_bf16 v[140:143], a[192:195], v[100:103], v[48:51]
  v_exp_f32 v160, v160
  v_mfma_f32_16x16x32_bf16 v[140:143], a[196:199], v[104:107], v[140:143]
  v_exp_f32 v161, v161
  v_mfma_f32_16x16x32_bf16 v[140:143], a[200:203], v[108:111], v[140:143]
  ds_read_b128 a[140:143], v2 offset:3072
  v_cvt_pk_bf16_f32 v202, v160, v161
  v_mfma_f32_16x16x32_bf16 v[140:143], a[204:207], v[112:115], v[140:143]
  s_add_u32 m0, s31, 0x8000
  v_cndmask_b32_e64 v149, v149, v7, s[50:51]
  v_mfma_f32_16x16x32_bf16 v[128:131], a[208:211], v[68:71], v[40:43]
  v_exp_f32 v162, v162
  v_mfma_f32_16x16x32_bf16 v[128:131], a[212:215], v[72:75], v[128:131]
  v_exp_f32 v163, v163
  v_mfma_f32_16x16x32_bf16 v[128:131], a[216:219], v[76:79], v[128:131]
  ds_read_b128 a[144:147], v2 offset:4096
  v_cvt_pk_bf16_f32 v203, v162, v163
  v_mfma_f32_16x16x32_bf16 v[128:131], a[220:223], v[80:83], v[128:131]
  v_exp_f32 v164, v164
  v_mfma_f32_16x16x32_bf16 v[136:139], a[208:211], v[84:87], v[44:47]
  ds_read_b128 a[148:151], v2 offset:5120
  v_cmp_gt_i32_e64 s[52:53], 34, v5
  v_mfma_f32_16x16x32_bf16 v[136:139], a[212:215], v[88:91], v[136:139]
  v_exp_f32 v165, v165
  v_mfma_f32_16x16x32_bf16 v[136:139], a[216:219], v[92:95], v[136:139]
  v_cndmask_b32_e64 v150, v150, v7, s[52:53]
  v_cvt_pk_bf16_f32 v204, v164, v165
  v_mfma_f32_16x16x32_bf16 v[136:139], a[220:223], v[96:99], v[136:139]
  v_exp_f32 v166, v166
  v_mfma_f32_16x16x32_bf16 v[144:147], a[208:211], v[100:103], v[48:51]
  v_exp_f32 v167, v167
  v_mfma_f32_16x16x32_bf16 v[144:147], a[212:215], v[104:107], v[144:147]
  ds_read_b128 a[152:155], v2 offset:6144
  v_cvt_pk_bf16_f32 v205, v166, v167
  v_mfma_f32_16x16x32_bf16 v[144:147], a[216:219], v[108:111], v[144:147]
  ds_read_b128 a[156:159], v2 offset:7168
  v_cmp_gt_i32_e64 s[54:55], 35, v5
  v_mfma_f32_16x16x32_bf16 v[144:147], a[220:223], v[112:115], v[144:147]
  global_load_lds_dwordx4 v3, s[94:95] offset:-4096 sc1
  v_mfma_f32_16x16x32_bf16 a[16:19], a[224:227], v[212:215], a[16:19]
  v_exp_f32 v168, v168
  v_mfma_f32_16x16x32_bf16 a[16:19], a[240:243], v[228:231], a[16:19]
  v_cndmask_b32_e64 v151, v151, v7, s[54:55]
  v_cmp_gt_i32_e64 s[48:49], 48, v5
  v_mfma_f32_16x16x32_bf16 a[48:51], a[224:227], v[216:219], a[48:51]
  v_exp_f32 v169, v169
  v_mfma_f32_16x16x32_bf16 a[48:51], a[240:243], v[232:235], a[48:51]
  ds_read_b128 a[160:163], v2 offset:16384
  v_cvt_pk_bf16_f32 v206, v168, v169
  v_mfma_f32_16x16x32_bf16 a[80:83], a[224:227], v[220:223], a[80:83]
  v_exp_f32 v170, v170
  v_mfma_f32_16x16x32_bf16 a[80:83], a[240:243], v[236:239], a[80:83]
  v_exp_f32 v171, v171
  v_mfma_f32_16x16x32_bf16 a[112:115], a[224:227], v[224:227], a[112:115]
  ds_read_b128 a[164:167], v2 offset:17408
  v_cndmask_b32_e64 v152, v152, v7, s[48:49]
  v_mfma_f32_16x16x32_bf16 a[112:115], a[240:243], v[240:243], a[112:115]
  v_exp_f32 v172, v172
  v_mfma_f32_16x16x32_bf16 a[116:119], a[228:231], v[224:227], a[116:119]
  ds_read_b128 a[168:171], v2 offset:18432
  v_cvt_pk_bf16_f32 v207, v170, v171
  v_mfma_f32_16x16x32_bf16 a[116:119], a[244:247], v[240:243], a[116:119]
  v_exp_f32 v173, v173
  v_mfma_f32_16x16x32_bf16 a[84:87], a[228:231], v[220:223], a[84:87]
  v_cvt_pk_bf16_f32 v208, v172, v173
  v_cmp_gt_i32_e64 s[50:51], 49, v5
  v_mfma_f32_16x16x32_bf16 a[84:87], a[244:247], v[236:239], a[84:87]
  global_load_lds_dwordx4 v3, s[94:95] offset:-3072 sc1
  v_mfma_f32_16x16x32_bf16 a[52:55], a[228:231], v[216:219], a[52:55]
  v_exp_f32 v174, v174
  v_cndmask_b32_e64 v153, v153, v7, s[50:51]
  v_mfma_f32_16x16x32_bf16 a[52:55], a[244:247], v[232:235], a[52:55]
  v_exp_f32 v175, v175
  v_mfma_f32_16x16x32_bf16 a[20:23], a[228:231], v[212:215], a[20:23]
  ds_read_b128 a[172:175], v2 offset:19456
  v_cvt_pk_bf16_f32 v209, v174, v175
  v_mfma_f32_16x16x32_bf16 a[20:23], a[244:247], v[228:231], a[20:23]
  v_exp_f32 v176, v176
  v_mfma_f32_16x16x32_bf16 v[24:27], v[16:19], v[216:219], v[24:27]
  v_exp_f32 v177, v177
  v_mfma_f32_16x16x32_bf16 v[24:27], v[16:19], v[232:235], v[24:27]
  ds_read_b128 a[176:179], v2 offset:24576
  v_cmp_gt_i32_e64 s[52:53], 50, v5
  v_mfma_f32_16x16x32_bf16 a[24:27], a[232:235], v[212:215], a[24:27]
  ds_read_b128 a[180:183], v2 offset:25600
  v_cvt_pk_bf16_f32 v210, v176, v177
  v_cndmask_b32_e64 v154, v154, v7, s[52:53]
  v_mfma_f32_16x16x32_bf16 a[24:27], a[248:251], v[228:231], a[24:27]
  v_exp_f32 v178, v178
  v_mfma_f32_16x16x32_bf16 a[56:59], a[232:235], v[216:219], a[56:59]
  v_exp_f32 v179, v179
  v_mfma_f32_16x16x32_bf16 a[56:59], a[248:251], v[232:235], a[56:59]
  ds_read_b128 a[184:187], v2 offset:26624
  v_cvt_pk_bf16_f32 v211, v178, v179
  v_mfma_f32_16x16x32_bf16 a[88:91], a[232:235], v[220:223], a[88:91]
  v_cmp_gt_i32_e64 s[54:55], 51, v5
  v_mfma_f32_16x16x32_bf16 a[88:91], a[248:251], v[236:239], a[88:91]
  global_load_lds_dwordx4 v3, s[94:95] offset:-2048 sc1
  v_exp_f32 v148, v148
  v_cndmask_b32_e64 v155, v155, v7, s[54:55]
  v_mfma_f32_16x16x32_bf16 a[120:123], a[232:235], v[224:227], a[120:123]
  v_exp_f32 v149, v149
  v_mfma_f32_16x16x32_bf16 a[120:123], a[248:251], v[240:243], a[120:123]
  v_exp_f32 v150, v150
  v_mfma_f32_16x16x32_bf16 v[32:35], v[16:19], v[224:227], v[32:35]
  ds_read_b128 a[188:191], v2 offset:27648
  v_cvt_pk_bf16_f32 v196, v148, v149
  v_mfma_f32_16x16x32_bf16 v[32:35], v[16:19], v[240:243], v[32:35]
  v_exp_f32 v151, v151
  v_mfma_f32_16x16x32_bf16 a[124:127], a[236:239], v[224:227], a[124:127]
  v_cvt_pk_bf16_f32 v197, v150, v151
  v_mfma_f32_16x16x32_bf16 a[124:127], a[252:255], v[240:243], a[124:127]
  v_exp_f32 v152, v152
  v_mfma_f32_16x16x32_bf16 a[92:95], a[236:239], v[220:223], a[92:95]
  v_exp_f32 v153, v153
  v_mfma_f32_16x16x32_bf16 a[92:95], a[252:255], v[236:239], a[92:95]
  global_load_lds_dwordx4 v3, s[94:95] offset:-1024 sc1
  v_mfma_f32_16x16x32_bf16 a[60:63], a[236:239], v[216:219], a[60:63]
  v_cvt_pk_bf16_f32 v198, v152, v153
  v_mfma_f32_16x16x32_bf16 a[60:63], a[252:255], v[232:235], a[60:63]
  v_exp_f32 v154, v154
  v_mfma_f32_16x16x32_bf16 a[28:31], a[236:239], v[212:215], a[28:31]
  s_waitcnt lgkmcnt(0)
  v_mfma_f32_16x16x32_bf16 a[28:31], a[252:255], v[228:231], a[28:31]
  v_exp_f32 v155, v155
  s_nop 0
  v_cvt_pk_bf16_f32 v199, v154, v155
adaLN_cond__compressed_kv_cla__mixer_channel_mlp__prompt_kernel_adm:
  v_mfma_f32_16x16x32_bf16 v[156:159], a[128:131], v[68:71], v[40:43]
  v_exp_f32 v132, v132
  v_mfma_f32_16x16x32_bf16 v[156:159], a[132:135], v[72:75], v[156:159]
  ds_read_b128 a[192:195], v2 offset:8192
  v_cmp_gt_i32_e64 s[48:49], 0, v6
  v_mfma_f32_16x16x32_bf16 v[156:159], a[136:139], v[76:79], v[156:159]
  v_exp_f32 v133, v133
  v_mfma_f32_16x16x32_bf16 v[156:159], a[140:143], v[80:83], v[156:159]
  ds_read_b128 a[196:199], v2 offset:9216
  v_cvt_pk_bf16_f32 v220, v132, v133
  v_mfma_f32_16x16x32_bf16 v[164:167], a[128:131], v[84:87], v[44:47]
  v_exp_f32 v134, v134
  v_mfma_f32_16x16x32_bf16 v[164:167], a[132:135], v[88:91], v[164:167]
  v_cndmask_b32_e64 v124, v124, v7, s[48:49]
  v_cmp_gt_i32_e64 s[50:51], 1, v6
  v_mfma_f32_16x16x32_bf16 v[164:167], a[136:139], v[92:95], v[164:167]
  global_load_lds_dwordx4 v3, s[94:95] offset:0 sc1
  v_mfma_f32_16x16x32_bf16 v[164:167], a[140:143], v[96:99], v[164:167]
  ds_read_b128 a[200:203], v2 offset:10240
  v_cndmask_b32_e64 v125, v125, v7, s[50:51]
  v_mfma_f32_16x16x32_bf16 v[172:175], a[128:131], v[100:103], v[48:51]
  v_exp_f32 v135, v135
  v_mfma_f32_16x16x32_bf16 v[172:175], a[132:135], v[104:107], v[172:175]
  ds_read_b128 a[204:207], v2 offset:11264
  v_cvt_pk_bf16_f32 v221, v134, v135
  v_mfma_f32_16x16x32_bf16 v[172:175], a[136:139], v[108:111], v[172:175]
  v_exp_f32 v136, v136
  v_mfma_f32_16x16x32_bf16 v[172:175], a[140:143], v[112:115], v[172:175]
  global_load_lds_dwordx4 v3, s[94:95] offset:1024 sc1
  v_mfma_f32_16x16x32_bf16 v[160:163], a[144:147], v[68:71], v[40:43]
  v_exp_f32 v137, v137
  v_mfma_f32_16x16x32_bf16 v[160:163], a[148:151], v[72:75], v[160:163]
  ds_read_b128 a[208:211], v2 offset:12288
  v_cvt_pk_bf16_f32 v222, v136, v137
  v_mfma_f32_16x16x32_bf16 v[160:163], a[152:155], v[76:79], v[160:163]
  v_exp_f32 v138, v138
  v_mfma_f32_16x16x32_bf16 v[160:163], a[156:159], v[80:83], v[160:163]
  v_cmp_gt_i32_e64 s[52:53], 2, v6
  v_cmp_gt_i32_e64 s[54:55], 3, v6
  v_mfma_f32_16x16x32_bf16 v[168:171], a[144:147], v[84:87], v[44:47]
  ds_read_b128 a[212:215], v2 offset:13312
  v_cndmask_b32_e64 v126, v126, v7, s[52:53]
  v_mfma_f32_16x16x32_bf16 v[168:171], a[148:151], v[88:91], v[168:171]
  v_exp_f32 v139, v139
  v_mfma_f32_16x16x32_bf16 v[168:171], a[152:155], v[92:95], v[168:171]
  v_cvt_pk_bf16_f32 v223, v138, v139
  v_cndmask_b32_e64 v127, v127, v7, s[54:55]
  v_mfma_f32_16x16x32_bf16 v[168:171], a[156:159], v[96:99], v[168:171]
  v_exp_f32 v140, v140
  v_mfma_f32_16x16x32_bf16 v[176:179], a[144:147], v[100:103], v[48:51]
  ds_read_b128 a[216:219], v2 offset:14336
  v_cmp_gt_i32_e64 s[48:49], 16, v6
  v_mfma_f32_16x16x32_bf16 v[176:179], a[148:151], v[104:107], v[176:179]
  v_exp_f32 v141, v141
  v_mfma_f32_16x16x32_bf16 v[176:179], a[152:155], v[108:111], v[176:179]
  ds_read_b128 a[220:223], v2 offset:15360
  v_cvt_pk_bf16_f32 v224, v140, v141
  v_mfma_f32_16x16x32_bf16 v[176:179], a[156:159], v[112:115], v[176:179]
  global_load_lds_dwordx4 v3, s[94:95] offset:2048 sc1
  v_mfma_f32_16x16x32_bf16 a[0:3], a[160:163], v[180:183], a[0:3]
  v_exp_f32 v142, v142
  v_mfma_f32_16x16x32_bf16 a[0:3], a[176:179], v[196:199], a[0:3]
  v_cndmask_b32_e64 v128, v128, v7, s[48:49]
  v_cmp_gt_i32_e64 s[50:51], 17, v6
  v_mfma_f32_16x16x32_bf16 a[32:35], a[160:163], v[184:187], a[32:35]
  v_exp_f32 v143, v143
  v_mfma_f32_16x16x32_bf16 a[32:35], a[176:179], v[200:203], a[32:35]
  ds_read_b128 a[224:227], v2 offset:20480
  v_cvt_pk_bf16_f32 v225, v142, v143
  v_mfma_f32_16x16x32_bf16 a[64:67], a[160:163], v[188:191], a[64:67]
  v_cndmask_b32_e64 v129, v129, v7, s[50:51]
  v_mfma_f32_16x16x32_bf16 a[64:67], a[176:179], v[204:207], a[64:67]
  v_exp_f32 v144, v144
  v_mfma_f32_16x16x32_bf16 a[96:99], a[160:163], v[192:195], a[96:99]
  ds_read_b128 a[228:231], v2 offset:21504
  v_cmp_gt_i32_e64 s[52:53], 18, v6
  v_mfma_f32_16x16x32_bf16 a[96:99], a[176:179], v[208:211], a[96:99]
  v_exp_f32 v145, v145
  v_mfma_f32_16x16x32_bf16 a[100:103], a[164:167], v[192:195], a[100:103]
  ds_read_b128 a[232:235], v2 offset:22528
  v_cvt_pk_bf16_f32 v226, v144, v145
  v_mfma_f32_16x16x32_bf16 a[100:103], a[180:183], v[208:211], a[100:103]
  v_exp_f32 v146, v146
  v_mfma_f32_16x16x32_bf16 a[68:71], a[164:167], v[188:191], a[68:71]
  global_load_lds_dwordx4 v3, s[94:95] offset:3072 sc1
  v_mfma_f32_16x16x32_bf16 a[68:71], a[180:183], v[204:207], a[68:71]
  ds_read_b128 a[236:239], v2 offset:23552
  v_cndmask_b32_e64 v130, v130, v7, s[52:53]
  v_mfma_f32_16x16x32_bf16 a[36:39], a[164:167], v[184:187], a[36:39]
  v_exp_f32 v147, v147
  v_mfma_f32_16x16x32_bf16 a[36:39], a[180:183], v[200:203], a[36:39]
  v_cvt_pk_bf16_f32 v227, v146, v147
  v_cmp_gt_i32_e64 s[54:55], 19, v6
  v_mfma_f32_16x16x32_bf16 a[4:7], a[164:167], v[180:183], a[4:7]
  v_exp_f32 v124, v124
  v_mfma_f32_16x16x32_bf16 a[4:7], a[180:183], v[196:199], a[4:7]
  ds_read_b128 a[240:243], v2 offset:28672
  v_cndmask_b32_e64 v131, v131, v7, s[54:55]
  v_mfma_f32_16x16x32_bf16 v[20:23], v[16:19], v[180:183], v[20:23]
  v_mfma_f32_16x16x32_bf16 v[20:23], v[16:19], v[196:199], v[20:23]
  v_exp_f32 v125, v125
  v_mfma_f32_16x16x32_bf16 a[8:11], a[168:171], v[180:183], a[8:11]
  ds_read_b128 a[244:247], v2 offset:29696
  v_cvt_pk_bf16_f32 v216, v124, v125
  v_mfma_f32_16x16x32_bf16 a[8:11], a[184:187], v[196:199], a[8:11]
  v_exp_f32 v126, v126
  v_mfma_f32_16x16x32_bf16 a[40:43], a[168:171], v[184:187], a[40:43]
  v_add_u32 v3, 0x4000, v3
  v_mfma_f32_16x16x32_bf16 a[40:43], a[184:187], v[200:203], a[40:43]
  v_exp_f32 v127, v127
  v_mfma_f32_16x16x32_bf16 a[72:75], a[168:171], v[188:191], a[72:75]
  ds_read_b128 a[248:251], v2 offset:30720
  v_cvt_pk_bf16_f32 v217, v126, v127
  v_mfma_f32_16x16x32_bf16 a[72:75], a[184:187], v[204:207], a[72:75]
  v_mfma_f32_16x16x32_bf16 a[104:107], a[168:171], v[192:195], a[104:107]
  v_exp_f32 v128, v128
  v_mfma_f32_16x16x32_bf16 a[104:107], a[184:187], v[208:211], a[104:107]
  ds_read_b128 a[252:255], v2 offset:31744
  v_mfma_f32_16x16x32_bf16 v[28:31], v[16:19], v[188:191], v[28:31]
  v_exp_f32 v129, v129
  v_mfma_f32_16x16x32_bf16 v[28:31], v[16:19], v[204:207], v[28:31]
  v_cvt_pk_bf16_f32 v218, v128, v129
  v_mfma_f32_16x16x32_bf16 a[108:111], a[172:175], v[192:195], a[108:111]
  v_mfma_f32_16x16x32_bf16 a[108:111], a[188:191], v[208:211], a[108:111]
  v_exp_f32 v130, v130
  v_mfma_f32_16x16x32_bf16 a[76:79], a[172:175], v[188:191], a[76:79]
  v_mfma_f32_16x16x32_bf16 a[76:79], a[188:191], v[204:207], a[76:79]
  v_exp_f32 v131, v131
  v_mfma_f32_16x16x32_bf16 a[44:47], a[172:175], v[184:187], a[44:47]
  v_cvt_pk_bf16_f32 v219, v130, v131
  v_mfma_f32_16x16x32_bf16 a[44:47], a[188:191], v[200:203], a[44:47]
  v_mfma_f32_16x16x32_bf16 a[12:15], a[172:175], v[180:183], a[12:15]
  s_waitcnt vmcnt(16) lgkmcnt(0)
  s_barrier
  v_mfma_f32_16x16x32_bf16 a[12:15], a[188:191], v[196:199], a[12:15]
  v_mfma_f32_16x16x32_bf16 v[132:135], a[192:195], v[84:87], v[44:47]
  ds_read_b128 a[128:131], v2 offset:32768
  v_cmp_gt_i32_e64 s[48:49], 32, v6
  v_mfma_f32_16x16x32_bf16 v[132:135], a[196:199], v[88:91], v[132:135]
  v_exp_f32 v164, v164
  v_mfma_f32_16x16x32_bf16 v[132:135], a[200:203], v[92:95], v[132:135]
  v_exp_f32 v165, v165
  v_mfma_f32_16x16x32_bf16 v[132:135], a[204:207], v[96:99], v[132:135]
  ds_read_b128 a[132:135], v2 offset:33792
  v_cvt_pk_bf16_f32 v236, v164, v165
  v_mfma_f32_16x16x32_bf16 v[140:143], a[192:195], v[100:103], v[48:51]
  v_cndmask_b32_e64 v156, v156, v7, s[48:49]
  v_cmp_gt_i32_e64 s[50:51], 33, v6
  v_mfma_f32_16x16x32_bf16 v[140:143], a[196:199], v[104:107], v[140:143]
  v_exp_f32 v166, v166
  v_mfma_f32_16x16x32_bf16 v[140:143], a[200:203], v[108:111], v[140:143]
  ds_read_b128 a[136:139], v2 offset:34816
  v_cndmask_b32_e64 v157, v157, v7, s[50:51]
  v_mfma_f32_16x16x32_bf16 v[140:143], a[204:207], v[112:115], v[140:143]
  v_exp_f32 v167, v167
  v_mfma_f32_16x16x32_bf16 v[136:139], a[208:211], v[84:87], v[44:47]
  ds_read_b128 a[140:143], v2 offset:35840
  v_cvt_pk_bf16_f32 v237, v166, v167
  v_mfma_f32_16x16x32_bf16 v[136:139], a[212:215], v[88:91], v[136:139]
  s_mov_b32 m0, s30
  v_cmp_gt_i32_e64 s[52:53], 34, v6
  v_mfma_f32_16x16x32_bf16 v[136:139], a[216:219], v[92:95], v[136:139]
  v_exp_f32 v168, v168
  v_mfma_f32_16x16x32_bf16 v[136:139], a[220:223], v[96:99], v[136:139]
  v_exp_f32 v169, v169
  v_mfma_f32_16x16x32_bf16 v[144:147], a[208:211], v[100:103], v[48:51]
  ds_read_b128 a[144:147], v2 offset:36864
  v_cvt_pk_bf16_f32 v238, v168, v169
  v_mfma_f32_16x16x32_bf16 v[144:147], a[212:215], v[104:107], v[144:147]
  ds_read_b128 a[148:151], v2 offset:37888
  v_cndmask_b32_e64 v158, v158, v7, s[52:53]
  v_mfma_f32_16x16x32_bf16 v[144:147], a[216:219], v[108:111], v[144:147]
  v_exp_f32 v170, v170
  v_mfma_f32_16x16x32_bf16 v[144:147], a[220:223], v[112:115], v[144:147]
  v_exp_f32 v171, v171
  v_mfma_f32_16x16x32_bf16 a[16:19], a[224:227], v[180:183], a[16:19]
  ds_read_b128 a[152:155], v2 offset:38912
  v_cvt_pk_bf16_f32 v239, v170, v171
  v_mfma_f32_16x16x32_bf16 a[16:19], a[240:243], v[196:199], a[16:19]
  v_exp_f32 v172, v172
  v_mfma_f32_16x16x32_bf16 a[48:51], a[224:227], v[184:187], a[48:51]
  v_cmp_gt_i32_e64 s[54:55], 35, v6
  v_cmp_gt_i32_e64 s[48:49], 48, v6
  v_mfma_f32_16x16x32_bf16 a[48:51], a[240:243], v[200:203], a[48:51]
  ds_read_b128 a[156:159], v2 offset:39936
  v_cndmask_b32_e64 v159, v159, v7, s[54:55]
  v_mfma_f32_16x16x32_bf16 a[80:83], a[224:227], v[188:191], a[80:83]
  global_load_lds_dwordx4 v3, s[94:95] offset:-4096 sc1
  v_mfma_f32_16x16x32_bf16 a[80:83], a[240:243], v[204:207], a[80:83]
  v_exp_f32 v173, v173
  v_mfma_f32_16x16x32_bf16 a[112:115], a[224:227], v[192:195], a[112:115]
  ds_read_b128 a[160:163], v2 offset:49152
  v_cvt_pk_bf16_f32 v240, v172, v173
  v_mfma_f32_16x16x32_bf16 a[112:115], a[240:243], v[208:211], a[112:115]
  v_exp_f32 v174, v174
  v_mfma_f32_16x16x32_bf16 a[116:119], a[228:231], v[192:195], a[116:119]
  ds_read_b128 a[164:167], v2 offset:50176
  v_cndmask_b32_e64 v160, v160, v7, s[48:49]
  v_mfma_f32_16x16x32_bf16 a[116:119], a[244:247], v[208:211], a[116:119]
  v_exp_f32 v175, v175
  v_mfma_f32_16x16x32_bf16 a[84:87], a[228:231], v[188:191], a[84:87]
  v_cmp_gt_i32_e64 s[50:51], 49, v6
  v_cvt_pk_bf16_f32 v241, v174, v175
  v_mfma_f32_16x16x32_bf16 a[84:87], a[244:247], v[204:207], a[84:87]
  ds_read_b128 a[168:171], v2 offset:51200
  v_cndmask_b32_e64 v161, v161, v7, s[50:51]
  v_mfma_f32_16x16x32_bf16 a[52:55], a[228:231], v[184:187], a[52:55]
  v_exp_f32 v176, v176
  v_mfma_f32_16x16x32_bf16 a[52:55], a[244:247], v[200:203], a[52:55]
  global_load_lds_dwordx4 v3, s[94:95] offset:-3072 sc1
  v_mfma_f32_16x16x32_bf16 a[20:23], a[228:231], v[180:183], a[20:23]
  v_exp_f32 v177, v177
  v_mfma_f32_16x16x32_bf16 a[20:23], a[244:247], v[196:199], a[20:23]
  ds_read_b128 a[172:175], v2 offset:52224
  v_cmp_gt_i32_e64 s[52:53], 50, v6
  v_mfma_f32_16x16x32_bf16 v[24:27], v[16:19], v[184:187], v[24:27]
  v_cvt_pk_bf16_f32 v242, v176, v177
  v_cndmask_b32_e64 v162, v162, v7, s[52:53]
  v_mfma_f32_16x16x32_bf16 v[24:27], v[16:19], v[200:203], v[24:27]
  v_exp_f32 v178, v178
  v_mfma_f32_16x16x32_bf16 a[24:27], a[232:235], v[180:183], a[24:27]
  v_exp_f32 v179, v179
  v_mfma_f32_16x16x32_bf16 a[24:27], a[248:251], v[196:199], a[24:27]
  ds_read_b128 a[176:179], v2 offset:57344
  v_cmp_gt_i32_e64 s[54:55], 51, v6
  v_mfma_f32_16x16x32_bf16 a[56:59], a[232:235], v[184:187], a[56:59]
  ds_read_b128 a[180:183], v2 offset:58368
  v_cvt_pk_bf16_f32 v243, v178, v179
  v_cndmask_b32_e64 v163, v163, v7, s[54:55]
  v_mfma_f32_16x16x32_bf16 a[56:59], a[248:251], v[200:203], a[56:59]
  v_exp_f32 v156, v156
  v_mfma_f32_16x16x32_bf16 a[88:91], a[232:235], v[188:191], a[88:91]
  v_exp_f32 v157, v157
  v_mfma_f32_16x16x32_bf16 a[88:91], a[248:251], v[204:207], a[88:91]
  ds_read_b128 a[184:187], v2 offset:59392
  v_cvt_pk_bf16_f32 v232, v156, v157
  v_mfma_f32_16x16x32_bf16 a[120:123], a[232:235], v[192:195], a[120:123]
  global_load_lds_dwordx4 v3, s[94:95] offset:-2048 sc1
  v_mfma_f32_16x16x32_bf16 a[120:123], a[248:251], v[208:211], a[120:123]
  v_exp_f32 v158, v158
  v_mfma_f32_16x16x32_bf16 v[32:35], v[16:19], v[192:195], v[32:35]
  v_exp_f32 v159, v159
  v_mfma_f32_16x16x32_bf16 v[32:35], v[16:19], v[208:211], v[32:35]
  ds_read_b128 a[188:191], v2 offset:60416
  v_cvt_pk_bf16_f32 v233, v158, v159
  v_mfma_f32_16x16x32_bf16 a[124:127], a[236:239], v[192:195], a[124:127]
  v_exp_f32 v160, v160
  v_mfma_f32_16x16x32_bf16 a[124:127], a[252:255], v[208:211], a[124:127]
  v_exp_f32 v161, v161
  v_mfma_f32_16x16x32_bf16 a[92:95], a[236:239], v[188:191], a[92:95]
  v_exp_f32 v162, v162
  v_mfma_f32_16x16x32_bf16 a[92:95], a[252:255], v[204:207], a[92:95]
  v_cvt_pk_bf16_f32 v234, v160, v161
  v_mfma_f32_16x16x32_bf16 a[60:63], a[236:239], v[184:187], a[60:63]
  global_load_lds_dwordx4 v3, s[94:95] offset:-1024 sc1
  v_mfma_f32_16x16x32_bf16 a[60:63], a[252:255], v[200:203], a[60:63]
  v_exp_f32 v163, v163
  v_mfma_f32_16x16x32_bf16 a[28:31], a[236:239], v[180:183], a[28:31]
  s_waitcnt lgkmcnt(0)
  v_cvt_pk_bf16_f32 v235, v162, v163
  v_mfma_f32_16x16x32_bf16 a[28:31], a[252:255], v[196:199], a[28:31]
  ds_read_b128 a[224:227], v2 offset:53248
  ds_read_b128 a[228:231], v2 offset:54272
  ds_read_b128 a[232:235], v2 offset:55296
  ds_read_b128 a[236:239], v2 offset:56320
  ds_read_b128 a[240:243], v2 offset:61440
  ds_read_b128 a[244:247], v2 offset:62464
  ds_read_b128 a[248:251], v2 offset:63488
  ds_read_b128 a[252:255], v2 offset:64512
  v_mfma_f32_16x16x32_bf16 a[32:35], a[160:163], v[216:219], a[32:35]
  v_mfma_f32_16x16x32_bf16 a[32:35], a[176:179], v[232:235], a[32:35]
  v_mfma_f32_16x16x32_bf16 a[36:39], a[164:167], v[216:219], a[36:39]
  v_mfma_f32_16x16x32_bf16 a[36:39], a[180:183], v[232:235], a[36:39]
  v_mfma_f32_16x16x32_bf16 v[24:27], v[16:19], v[216:219], v[24:27]
  v_mfma_f32_16x16x32_bf16 v[24:27], v[16:19], v[232:235], v[24:27]
  v_mfma_f32_16x16x32_bf16 a[40:43], a[168:171], v[216:219], a[40:43]
  v_mfma_f32_16x16x32_bf16 a[40:43], a[184:187], v[232:235], a[40:43]
  v_mfma_f32_16x16x32_bf16 a[44:47], a[172:175], v[216:219], a[44:47]
  v_mfma_f32_16x16x32_bf16 a[44:47], a[188:191], v[232:235], a[44:47]
  s_waitcnt lgkmcnt(0)
  v_mfma_f32_16x16x32_bf16 a[48:51], a[224:227], v[216:219], a[48:51]
  v_mfma_f32_16x16x32_bf16 a[48:51], a[240:243], v[232:235], a[48:51]
  v_mfma_f32_16x16x32_bf16 a[52:55], a[228:231], v[216:219], a[52:55]
  v_mfma_f32_16x16x32_bf16 a[52:55], a[244:247], v[232:235], a[52:55]
  v_mfma_f32_16x16x32_bf16 a[56:59], a[232:235], v[216:219], a[56:59]
  v_mfma_f32_16x16x32_bf16 a[56:59], a[248:251], v[232:235], a[56:59]
  v_mfma_f32_16x16x32_bf16 a[60:63], a[236:239], v[216:219], a[60:63]
  v_mfma_f32_16x16x32_bf16 a[60:63], a[252:255], v[232:235], a[60:63]
  s_waitcnt vmcnt(8)
  s_mov_b32 s40, 0x5f800000
  s_mov_b32 s41, 0x1f800000
  s_nop 5
  v_cmp_nlt_f32_e64 s[42:43], v20, s40
  v_cmp_nlt_f32_e64 s[44:45], v24, s40
  v_cmp_ngt_f32_e64 s[46:47], v20, s41
  v_cmp_ngt_f32_e64 s[48:49], v24, s41
  s_nop 1
  s_or_b64 s[42:43], s[42:43], s[44:45]
  s_or_b64 s[46:47], s[46:47], s[48:49]
  s_or_b64 s[42:43], s[42:43], s[46:47]
  s_cbranch_scc1 adaLN_cond__compressed_kv_cla__mixer_channel_mlp__prompt_kernel_slowlo
adaLN_cond__compressed_kv_cla__mixer_channel_mlp__prompt_kernel_loep:
  v_rcp_f32 v248, v20
  v_rcp_f32 v249, v24
  v_accvgpr_read_b32 v8, a0
  v_accvgpr_read_b32 v9, a1
  v_accvgpr_read_b32 v10, a2
  v_accvgpr_read_b32 v11, a3
  v_accvgpr_read_b32 v12, a4
  v_accvgpr_read_b32 v13, a5
  v_accvgpr_read_b32 v14, a6
  v_accvgpr_read_b32 v15, a7
  v_pk_mul_f32 v[8:9], v[8:9], v[248:249] op_sel:[0,0] op_sel_hi:[1,0]
  v_pk_mul_f32 v[10:11], v[10:11], v[248:249] op_sel:[0,0] op_sel_hi:[1,0]
  v_pk_mul_f32 v[12:13], v[12:13], v[248:249] op_sel:[0,0] op_sel_hi:[1,0]
  v_pk_mul_f32 v[14:15], v[14:15], v[248:249] op_sel:[0,0] op_sel_hi:[1,0]
  v_cvt_pk_bf16_f32 v8, v8, v9
  v_cvt_pk_bf16_f32 v9, v10, v11
  v_cvt_pk_bf16_f32 v10, v12, v13
  v_cvt_pk_bf16_f32 v11, v14, v15
  buffer_store_dwordx4 v[8:11], v4, s[12:15], s34 offen offset:0 sc1
  v_accvgpr_read_b32 v212, a8
  v_accvgpr_read_b32 v213, a9
  v_accvgpr_read_b32 v214, a10
  v_accvgpr_read_b32 v215, a11
  v_accvgpr_read_b32 v216, a12
  v_accvgpr_read_b32 v217, a13
  v_accvgpr_read_b32 v218, a14
  v_accvgpr_read_b32 v219, a15
  v_pk_mul_f32 v[212:213], v[212:213], v[248:249] op_sel:[0,0] op_sel_hi:[1,0]
  v_pk_mul_f32 v[214:215], v[214:215], v[248:249] op_sel:[0,0] op_sel_hi:[1,0]
  v_pk_mul_f32 v[216:217], v[216:217], v[248:249] op_sel:[0,0] op_sel_hi:[1,0]
  v_pk_mul_f32 v[218:219], v[218:219], v[248:249] op_sel:[0,0] op_sel_hi:[1,0]
  v_cvt_pk_bf16_f32 v212, v212, v213
  v_cvt_pk_bf16_f32 v213, v214, v215
  v_cvt_pk_bf16_f32 v214, v216, v217
  v_cvt_pk_bf16_f32 v215, v218, v219
  buffer_store_dwordx4 v[212:215], v4, s[12:15], s34 offen offset:1024 sc1
  v_accvgpr_read_b32 v8, a16
  v_accvgpr_read_b32 v9, a17
  v_accvgpr_read_b32 v10, a18
  v_accvgpr_read_b32 v11, a19
  v_accvgpr_read_b32 v12, a20
  v_accvgpr_read_b32 v13, a21
  v_accvgpr_read_b32 v14, a22
  v_accvgpr_read_b32 v15, a23
  v_pk_mul_f32 v[8:9], v[8:9], v[248:249] op_sel:[0,0] op_sel_hi:[1,0]
  v_pk_mul_f32 v[10:11], v[10:11], v[248:249] op_sel:[0,0] op_sel_hi:[1,0]
  v_pk_mul_f32 v[12:13], v[12:13], v[248:249] op_sel:[0,0] op_sel_hi:[1,0]
  v_pk_mul_f32 v[14:15], v[14:15], v[248:249] op_sel:[0,0] op_sel_hi:[1,0]
  v_cvt_pk_bf16_f32 v8, v8, v9
  v_cvt_pk_bf16_f32 v9, v10, v11
  v_cvt_pk_bf16_f32 v10, v12, v13
  v_cvt_pk_bf16_f32 v11, v14, v15
  buffer_store_dwordx4 v[8:11], v4, s[12:15], s34 offen offset:2048 sc1
  v_accvgpr_read_b32 v212, a24
  v_accvgpr_read_b32 v213, a25
  v_accvgpr_read_b32 v214, a26
  v_accvgpr_read_b32 v215, a27
  v_accvgpr_read_b32 v216, a28
  v_accvgpr_read_b32 v217, a29
  v_accvgpr_read_b32 v218, a30
  v_accvgpr_read_b32 v219, a31
  v_pk_mul_f32 v[212:213], v[212:213], v[248:249] op_sel:[0,0] op_sel_hi:[1,0]
  v_pk_mul_f32 v[214:215], v[214:215], v[248:249] op_sel:[0,0] op_sel_hi:[1,0]
  v_pk_mul_f32 v[216:217], v[216:217], v[248:249] op_sel:[0,0] op_sel_hi:[1,0]
  v_pk_mul_f32 v[218:219], v[218:219], v[248:249] op_sel:[0,0] op_sel_hi:[1,0]
  v_cvt_pk_bf16_f32 v212, v212, v213
  v_cvt_pk_bf16_f32 v213, v214, v215
  v_cvt_pk_bf16_f32 v214, v216, v217
  v_cvt_pk_bf16_f32 v215, v218, v219
  buffer_store_dwordx4 v[212:215], v4, s[12:15], s34 offen offset:3072 sc1
  v_accvgpr_read_b32 v8, a32
  v_accvgpr_read_b32 v9, a33
  v_accvgpr_read_b32 v10, a34
  v_accvgpr_read_b32 v11, a35
  v_accvgpr_read_b32 v12, a36
  v_accvgpr_read_b32 v13, a37
  v_accvgpr_read_b32 v14, a38
  v_accvgpr_read_b32 v15, a39
  v_pk_mul_f32 v[8:9], v[8:9], v[248:249] op_sel:[0,1] op_sel_hi:[1,1]
  v_pk_mul_f32 v[10:11], v[10:11], v[248:249] op_sel:[0,1] op_sel_hi:[1,1]
  v_pk_mul_f32 v[12:13], v[12:13], v[248:249] op_sel:[0,1] op_sel_hi:[1,1]
  v_pk_mul_f32 v[14:15], v[14:15], v[248:249] op_sel:[0,1] op_sel_hi:[1,1]
  v_cvt_pk_bf16_f32 v8, v8, v9
  v_cvt_pk_bf16_f32 v9, v10, v11
  v_cvt_pk_bf16_f32 v10, v12, v13
  v_cvt_pk_bf16_f32 v11, v14, v15
  buffer_store_dwordx4 v[8:11], v4, s[12:15], s35 offen offset:0 sc1
  v_accvgpr_read_b32 v212, a40
  v_accvgpr_read_b32 v213, a41
  v_accvgpr_read_b32 v214, a42
  v_accvgpr_read_b32 v215, a43
  v_accvgpr_read_b32 v216, a44
  v_accvgpr_read_b32 v217, a45
  v_accvgpr_read_b32 v218, a46
  v_accvgpr_read_b32 v219, a47
  v_pk_mul_f32 v[212:213], v[212:213], v[248:249] op_sel:[0,1] op_sel_hi:[1,1]
  v_pk_mul_f32 v[214:215], v[214:215], v[248:249] op_sel:[0,1] op_sel_hi:[1,1]
  v_pk_mul_f32 v[216:217], v[216:217], v[248:249] op_sel:[0,1] op_sel_hi:[1,1]
  v_pk_mul_f32 v[218:219], v[218:219], v[248:249] op_sel:[0,1] op_sel_hi:[1,1]
  v_cvt_pk_bf16_f32 v212, v212, v213
  v_cvt_pk_bf16_f32 v213, v214, v215
  v_cvt_pk_bf16_f32 v214, v216, v217
  v_cvt_pk_bf16_f32 v215, v218, v219
  buffer_store_dwordx4 v[212:215], v4, s[12:15], s35 offen offset:1024 sc1
  v_accvgpr_read_b32 v8, a48
  v_accvgpr_read_b32 v9, a49
  v_accvgpr_read_b32 v10, a50
  v_accvgpr_read_b32 v11, a51
  v_accvgpr_read_b32 v12, a52
  v_accvgpr_read_b32 v13, a53
  v_accvgpr_read_b32 v14, a54
  v_accvgpr_read_b32 v15, a55
  v_pk_mul_f32 v[8:9], v[8:9], v[248:249] op_sel:[0,1] op_sel_hi:[1,1]
  v_pk_mul_f32 v[10:11], v[10:11], v[248:249] op_sel:[0,1] op_sel_hi:[1,1]
  v_pk_mul_f32 v[12:13], v[12:13], v[248:249] op_sel:[0,1] op_sel_hi:[1,1]
  v_pk_mul_f32 v[14:15], v[14:15], v[248:249] op_sel:[0,1] op_sel_hi:[1,1]
  v_cvt_pk_bf16_f32 v8, v8, v9
  v_cvt_pk_bf16_f32 v9, v10, v11
  v_cvt_pk_bf16_f32 v10, v12, v13
  v_cvt_pk_bf16_f32 v11, v14, v15
  buffer_store_dwordx4 v[8:11], v4, s[12:15], s35 offen offset:2048 sc1
  v_accvgpr_read_b32 v212, a56
  v_accvgpr_read_b32 v213, a57
  v_accvgpr_read_b32 v214, a58
  v_accvgpr_read_b32 v215, a59
  v_accvgpr_read_b32 v216, a60
  v_accvgpr_read_b32 v217, a61
  v_accvgpr_read_b32 v218, a62
  v_accvgpr_read_b32 v219, a63
  v_pk_mul_f32 v[212:213], v[212:213], v[248:249] op_sel:[0,1] op_sel_hi:[1,1]
  v_pk_mul_f32 v[214:215], v[214:215], v[248:249] op_sel:[0,1] op_sel_hi:[1,1]
  v_pk_mul_f32 v[216:217], v[216:217], v[248:249] op_sel:[0,1] op_sel_hi:[1,1]
  v_pk_mul_f32 v[218:219], v[218:219], v[248:249] op_sel:[0,1] op_sel_hi:[1,1]
  v_cvt_pk_bf16_f32 v212, v212, v213
  v_cvt_pk_bf16_f32 v213, v214, v215
  v_cvt_pk_bf16_f32 v214, v216, v217
  v_cvt_pk_bf16_f32 v215, v218, v219
  buffer_store_dwordx4 v[212:215], v4, s[12:15], s35 offen offset:3072 sc1
  v_xor_b32 v252, 0, v253
  ds_read_b64_tr_b16 a[0:1], v252 offset:0
  ds_read_b64_tr_b16 a[2:3], v252 offset:2048
  ds_read_b64_tr_b16 a[16:17], v252 offset:16384
  ds_read_b64_tr_b16 a[18:19], v252 offset:18432
  v_xor_b32 v252, 32, v253
  ds_read_b64_tr_b16 a[4:5], v252 offset:0
  ds_read_b64_tr_b16 a[6:7], v252 offset:2048
  ds_read_b64_tr_b16 a[20:21], v252 offset:16384
  ds_read_b64_tr_b16 a[22:23], v252 offset:18432
  v_xor_b32 v252, 64, v253
  ds_read_b64_tr_b16 a[8:9], v252 offset:0
  ds_read_b64_tr_b16 a[10:11], v252 offset:2048
  ds_read_b64_tr_b16 a[24:25], v252 offset:16384
  ds_read_b64_tr_b16 a[26:27], v252 offset:18432
  v_xor_b32 v252, 96, v253
  ds_read_b64_tr_b16 a[12:13], v252 offset:0
  ds_read_b64_tr_b16 a[14:15], v252 offset:2048
  ds_read_b64_tr_b16 a[28:29], v252 offset:16384
  ds_read_b64_tr_b16 a[30:31], v252 offset:18432
  s_waitcnt lgkmcnt(0)
  buffer_store_dwordx4 a[0:3], v4, s[12:15], s72 offen offset:0 sc1
  buffer_store_dwordx4 a[4:7], v4, s[12:15], s72 offen offset:1024 sc1
  buffer_store_dwordx4 a[8:11], v4, s[12:15], s73 offen offset:0 sc1
  buffer_store_dwordx4 a[12:15], v4, s[12:15], s73 offen offset:1024 sc1
  s_add_u32 s72, s72, s66
  s_add_u32 s73, s73, s66
  buffer_store_dwordx4 a[16:19], v4, s[12:15], s72 offen offset:0 sc1
  buffer_store_dwordx4 a[20:23], v4, s[12:15], s72 offen offset:1024 sc1
  buffer_store_dwordx4 a[24:27], v4, s[12:15], s73 offen offset:0 sc1
  buffer_store_dwordx4 a[28:31], v4, s[12:15], s73 offen offset:1024 sc1
  s_sub_u32 s25, 6, s22
  s_cbranch_scc1 adaLN_cond__compressed_kv_cla__mixer_channel_mlp__prompt_kernel_bd
.p2align 6
adaLN_cond__compressed_kv_cla__mixer_channel_mlp__prompt_kernel_lb:
  v_mfma_f32_16x16x32_bf16 v[164:167], a[128:131], v[84:87], v[44:47]
  ds_read_b128 a[192:195], v2 offset:40960
  s_mov_b32 m0, s30
  v_mfma_f32_16x16x32_bf16 v[164:167], a[132:135], v[88:91], v[164:167]
  v_exp_f32 v132, v132
  v_mfma_f32_16x16x32_bf16 v[164:167], a[136:139], v[92:95], v[164:167]
  v_exp_f32 v133, v133
  v_mfma_f32_16x16x32_bf16 v[164:167], a[140:143], v[96:99], v[164:167]
  ds_read_b128 a[196:199], v2 offset:41984
  ds_read_b128 a[200:203], v2 offset:43008
  v_mfma_f32_16x16x32_bf16 v[172:175], a[128:131], v[100:103], v[48:51]
  ds_read_b128 a[204:207], v2 offset:44032
  v_cvt_pk_bf16_f32 v188, v132, v133
  v_mfma_f32_16x16x32_bf16 v[172:175], a[132:135], v[104:107], v[172:175]
  v_exp_f32 v134, v134
  v_mfma_f32_16x16x32_bf16 v[172:175], a[136:139], v[108:111], v[172:175]
  v_exp_f32 v135, v135
  v_mfma_f32_16x16x32_bf16 v[172:175], a[140:143], v[112:115], v[172:175]
  ds_read_b128 a[208:211], v2 offset:45056
  v_cvt_pk_bf16_f32 v189, v134, v135
  v_mfma_f32_16x16x32_bf16 v[168:171], a[144:147], v[84:87], v[44:47]
  v_exp_f32 v136, v136
  v_mfma_f32_16x16x32_bf16 v[168:171], a[148:151], v[88:91], v[168:171]
  ds_read_b128 a[212:215], v2 offset:46080
  ds_read_b128 a[216:219], v2 offset:47104
  v_mfma_f32_16x16x32_bf16 v[168:171], a[152:155], v[92:95], v[168:171]
  global_load_lds_dwordx4 v3, s[94:95] offset:0 sc1
  v_mfma_f32_16x16x32_bf16 v[168:171], a[156:159], v[96:99], v[168:171]
  v_exp_f32 v137, v137
  v_mfma_f32_16x16x32_bf16 v[176:179], a[144:147], v[100:103], v[48:51]
  ds_read_b128 a[220:223], v2 offset:48128
  v_cvt_pk_bf16_f32 v190, v136, v137
  v_mfma_f32_16x16x32_bf16 v[176:179], a[148:151], v[104:107], v[176:179]
  v_exp_f32 v138, v138
  v_mfma_f32_16x16x32_bf16 v[176:179], a[152:155], v[108:111], v[176:179]
  ds_read_b128 a[224:227], v2 offset:53248
  ds_read_b128 a[228:231], v2 offset:54272
  v_mfma_f32_16x16x32_bf16 v[176:179], a[156:159], v[112:115], v[176:179]
  global_load_lds_dwordx4 v3, s[94:95] offset:1024 sc1
  v_mfma_f32_16x16x32_bf16 a[64:67], a[160:163], v[220:223], a[64:67]
  v_exp_f32 v139, v139
  v_mfma_f32_16x16x32_bf16 a[64:67], a[176:179], v[236:239], a[64:67]
  ds_read_b128 a[232:235], v2 offset:55296
  v_cvt_pk_bf16_f32 v191, v138, v139
  v_mfma_f32_16x16x32_bf16 a[96:99], a[160:163], v[224:227], a[96:99]
  v_exp_f32 v140, v140
  v_mfma_f32_16x16x32_bf16 a[96:99], a[176:179], v[240:243], a[96:99]
  ds_read_b128 a[236:239], v2 offset:56320
  ds_read_b128 a[240:243], v2 offset:61440
  v_mfma_f32_16x16x32_bf16 a[100:103], a[164:167], v[224:227], a[100:103]
  v_exp_f32 v141, v141
  v_mfma_f32_16x16x32_bf16 a[100:103], a[180:183], v[240:243], a[100:103]
  global_load_lds_dwordx4 v3, s[94:95] offset:2048 sc1
  v_mfma_f32_16x16x32_bf16 a[68:71], a[164:167], v[220:223], a[68:71]
  ds_read_b128 a[244:247], v2 offset:62464
  v_cvt_pk_bf16_f32 v192, v140, v141
  v_mfma_f32_16x16x32_bf16 a[68:71], a[180:183], v[236:239], a[68:71]
  v_exp_f32 v142, v142
  v_mfma_f32_16x16x32_bf16 v[28:31], v[16:19], v[220:223], v[28:31]
  ds_read_b128 a[248:251], v2 offset:63488
  ds_read_b128 a[252:255], v2 offset:64512
  v_mfma_f32_16x16x32_bf16 v[28:31], v[16:19], v[236:239], v[28:31]
  v_exp_f32 v143, v143
  v_mfma_f32_16x16x32_bf16 a[72:75], a[168:171], v[220:223], a[72:75]
  v_cvt_pk_bf16_f32 v193, v142, v143
  v_mfma_f32_16x16x32_bf16 a[72:75], a[184:187], v[236:239], a[72:75]
  global_load_lds_dwordx4 v3, s[94:95] offset:3072 sc1
  v_mfma_f32_16x16x32_bf16 a[104:107], a[168:171], v[224:227], a[104:107]
  v_exp_f32 v144, v144
  v_mfma_f32_16x16x32_bf16 a[104:107], a[184:187], v[240:243], a[104:107]
  v_exp_f32 v145, v145
  v_mfma_f32_16x16x32_bf16 a[108:111], a[172:175], v[224:227], a[108:111]
  v_cvt_pk_bf16_f32 v194, v144, v145
  v_add_u32 v3, 0x4000, v3
  v_mfma_f32_16x16x32_bf16 a[108:111], a[188:191], v[240:243], a[108:111]
  v_exp_f32 v146, v146
  v_mfma_f32_16x16x32_bf16 a[76:79], a[172:175], v[220:223], a[76:79]
  s_waitcnt vmcnt(16) lgkmcnt(0)
  s_barrier
  v_mfma_f32_16x16x32_bf16 a[76:79], a[188:191], v[236:239], a[76:79]
  v_exp_f32 v147, v147
  s_nop 0
  v_cvt_pk_bf16_f32 v195, v146, v147
  v_mfma_f32_16x16x32_bf16 v[132:135], a[192:195], v[84:87], v[44:47]
  ds_read_b128 a[128:131], v254 offset:0
  s_add_u32 m0, s30, 0x8000
  v_mfma_f32_16x16x32_bf16 v[132:135], a[196:199], v[88:91], v[132:135]
  v_exp_f32 v164, v164
  v_mfma_f32_16x16x32_bf16 v[132:135], a[200:203], v[92:95], v[132:135]
  v_exp_f32 v165, v165
  v_mfma_f32_16x16x32_bf16 v[132:135], a[204:207], v[96:99], v[132:135]
  ds_read_b128 a[132:135], v254 offset:1024
  ds_read_b128 a[136:139], v254 offset:2048
  v_mfma_f32_16x16x32_bf16 v[140:143], a[192:195], v[100:103], v[48:51]
  ds_read_b128 a[140:143], v254 offset:3072
  v_cvt_pk_bf16_f32 v204, v164, v165
  v_mfma_f32_16x16x32_bf16 v[140:143], a[196:199], v[104:107], v[140:143]
  v_exp_f32 v166, v166
  v_mfma_f32_16x16x32_bf16 v[140:143], a[200:203], v[108:111], v[140:143]
  v_exp_f32 v167, v167
  v_mfma_f32_16x16x32_bf16 v[140:143], a[204:207], v[112:115], v[140:143]
  ds_read_b128 a[144:147], v254 offset:4096
  v_cvt_pk_bf16_f32 v205, v166, v167
  v_mfma_f32_16x16x32_bf16 v[136:139], a[208:211], v[84:87], v[44:47]
  v_exp_f32 v168, v168
  v_mfma_f32_16x16x32_bf16 v[136:139], a[212:215], v[88:91], v[136:139]
  ds_read_b128 a[148:151], v254 offset:5120
  ds_read_b128 a[152:155], v254 offset:6144
  v_mfma_f32_16x16x32_bf16 v[136:139], a[216:219], v[92:95], v[136:139]
  v_exp_f32 v169, v169
  v_mfma_f32_16x16x32_bf16 v[136:139], a[220:223], v[96:99], v[136:139]
  global_load_lds_dwordx4 v3, s[94:95] offset:-4096 sc1
  v_mfma_f32_16x16x32_bf16 v[144:147], a[208:211], v[100:103], v[48:51]
  ds_read_b128 a[156:159], v254 offset:7168
  v_cvt_pk_bf16_f32 v206, v168, v169
  v_mfma_f32_16x16x32_bf16 v[144:147], a[212:215], v[104:107], v[144:147]
  v_exp_f32 v170, v170
  v_mfma_f32_16x16x32_bf16 v[144:147], a[216:219], v[108:111], v[144:147]
  ds_read_b128 a[160:163], v254 offset:16384
  ds_read_b128 a[164:167], v254 offset:17408
  v_mfma_f32_16x16x32_bf16 v[144:147], a[220:223], v[112:115], v[144:147]
  v_exp_f32 v171, v171
  v_mfma_f32_16x16x32_bf16 a[80:83], a[224:227], v[220:223], a[80:83]
  ds_read_b128 a[168:171], v254 offset:18432
  v_cvt_pk_bf16_f32 v207, v170, v171
  v_mfma_f32_16x16x32_bf16 a[80:83], a[240:243], v[236:239], a[80:83]
  v_exp_f32 v172, v172
  v_mfma_f32_16x16x32_bf16 a[112:115], a[224:227], v[224:227], a[112:115]
  global_load_lds_dwordx4 v3, s[94:95] offset:-3072 sc1
  v_mfma_f32_16x16x32_bf16 a[112:115], a[240:243], v[240:243], a[112:115]
  ds_read_b128 a[172:175], v254 offset:19456
  ds_read_b128 a[176:179], v254 offset:24576
  v_mfma_f32_16x16x32_bf16 a[116:119], a[228:231], v[224:227], a[116:119]
  v_exp_f32 v173, v173
  v_mfma_f32_16x16x32_bf16 a[116:119], a[244:247], v[240:243], a[116:119]
  ds_read_b128 a[180:183], v254 offset:25600
  v_cvt_pk_bf16_f32 v208, v172, v173
  v_mfma_f32_16x16x32_bf16 a[84:87], a[228:231], v[220:223], a[84:87]
  v_exp_f32 v174, v174
  v_mfma_f32_16x16x32_bf16 a[84:87], a[244:247], v[236:239], a[84:87]
  v_exp_f32 v175, v175
  v_mfma_f32_16x16x32_bf16 v[32:35], v[16:19], v[224:227], v[32:35]
  ds_read_b128 a[184:187], v254 offset:26624
  ds_read_b128 a[188:191], v254 offset:27648
  v_mfma_f32_16x16x32_bf16 v[32:35], v[16:19], v[240:243], v[32:35]
  global_load_lds_dwordx4 v3, s[94:95] offset:-2048 sc1
  v_mfma_f32_16x16x32_bf16 a[88:91], a[232:235], v[220:223], a[88:91]
  v_cvt_pk_bf16_f32 v209, v174, v175
  v_mfma_f32_16x16x32_bf16 a[88:91], a[248:251], v[236:239], a[88:91]
  v_exp_f32 v176, v176
  v_mfma_f32_16x16x32_bf16 a[120:123], a[232:235], v[224:227], a[120:123]
  v_exp_f32 v177, v177
  v_mfma_f32_16x16x32_bf16 a[120:123], a[248:251], v[240:243], a[120:123]
  global_load_lds_dwordx4 v3, s[94:95] offset:-1024 sc1
  v_mfma_f32_16x16x32_bf16 a[124:127], a[236:239], v[224:227], a[124:127]
  v_cvt_pk_bf16_f32 v210, v176, v177
  v_mfma_f32_16x16x32_bf16 a[124:127], a[252:255], v[240:243], a[124:127]
  v_exp_f32 v178, v178
  v_mfma_f32_16x16x32_bf16 a[92:95], a[236:239], v[220:223], a[92:95]
  s_waitcnt lgkmcnt(0)
  v_mfma_f32_16x16x32_bf16 a[92:95], a[252:255], v[236:239], a[92:95]
  v_exp_f32 v179, v179
  s_nop 0
  v_cvt_pk_bf16_f32 v211, v178, v179
  v_mfma_f32_16x16x32_bf16 v[164:167], a[128:131], v[84:87], v[44:47]
  v_exp_f32 v132, v132
  v_mfma_f32_16x16x32_bf16 v[164:167], a[132:135], v[88:91], v[164:167]
  ds_read_b128 a[192:195], v254 offset:8192
  ds_read_b128 a[196:199], v254 offset:9216
  v_mfma_f32_16x16x32_bf16 v[164:167], a[136:139], v[92:95], v[164:167]
  v_exp_f32 v133, v133
  v_mfma_f32_16x16x32_bf16 v[164:167], a[140:143], v[96:99], v[164:167]
  ds_read_b128 a[200:203], v254 offset:10240
  v_cvt_pk_bf16_f32 v220, v132, v133
  v_mfma_f32_16x16x32_bf16 v[172:175], a[128:131], v[100:103], v[48:51]
  v_exp_f32 v134, v134
  v_mfma_f32_16x16x32_bf16 v[172:175], a[132:135], v[104:107], v[172:175]
  global_load_lds_dwordx4 v3, s[94:95] offset:0 sc1
  v_mfma_f32_16x16x32_bf16 v[172:175], a[136:139], v[108:111], v[172:175]
  ds_read_b128 a[204:207], v254 offset:11264
  ds_read_b128 a[208:211], v254 offset:12288
  v_mfma_f32_16x16x32_bf16 v[172:175], a[140:143], v[112:115], v[172:175]
  v_exp_f32 v135, v135
  v_mfma_f32_16x16x32_bf16 v[168:171], a[144:147], v[84:87], v[44:47]
  ds_read_b128 a[212:215], v254 offset:13312
  v_cvt_pk_bf16_f32 v221, v134, v135
  v_mfma_f32_16x16x32_bf16 v[168:171], a[148:151], v[88:91], v[168:171]
  v_exp_f32 v136, v136
  v_mfma_f32_16x16x32_bf16 v[168:171], a[152:155], v[92:95], v[168:171]
  v_exp_f32 v137, v137
  v_mfma_f32_16x16x32_bf16 v[168:171], a[156:159], v[96:99], v[168:171]
  ds_read_b128 a[216:219], v254 offset:14336
  ds_read_b128 a[220:223], v254 offset:15360
  v_mfma_f32_16x16x32_bf16 v[176:179], a[144:147], v[100:103], v[48:51]
  global_load_lds_dwordx4 v3, s[94:95] offset:1024 sc1
  v_mfma_f32_16x16x32_bf16 v[176:179], a[148:151], v[104:107], v[176:179]
  ds_read_b128 a[224:227], v254 offset:20480
  v_cvt_pk_bf16_f32 v222, v136, v137
  v_mfma_f32_16x16x32_bf16 v[176:179], a[152:155], v[108:111], v[176:179]
  v_exp_f32 v138, v138
  v_mfma_f32_16x16x32_bf16 v[176:179], a[156:159], v[112:115], v[176:179]
  v_exp_f32 v139, v139
  v_mfma_f32_16x16x32_bf16 a[64:67], a[160:163], v[188:191], a[64:67]
  ds_read_b128 a[228:231], v254 offset:21504
  ds_read_b128 a[232:235], v254 offset:22528
  v_mfma_f32_16x16x32_bf16 a[64:67], a[176:179], v[204:207], a[64:67]
  ds_read_b128 a[236:239], v254 offset:23552
  v_cvt_pk_bf16_f32 v223, v138, v139
  v_mfma_f32_16x16x32_bf16 a[96:99], a[160:163], v[192:195], a[96:99]
  v_exp_f32 v140, v140
  v_mfma_f32_16x16x32_bf16 a[96:99], a[176:179], v[208:211], a[96:99]
  global_load_lds_dwordx4 v3, s[94:95] offset:2048 sc1
  v_mfma_f32_16x16x32_bf16 a[100:103], a[164:167], v[192:195], a[100:103]
  v_exp_f32 v141, v141
  v_mfma_f32_16x16x32_bf16 a[100:103], a[180:183], v[208:211], a[100:103]
  ds_read_b128 a[240:243], v254 offset:28672
  v_cvt_pk_bf16_f32 v224, v140, v141
  v_mfma_f32_16x16x32_bf16 a[68:71], a[164:167], v[188:191], a[68:71]
  ds_read_b128 a[244:247], v254 offset:29696
  ds_read_b128 a[248:251], v254 offset:30720
  v_mfma_f32_16x16x32_bf16 a[68:71], a[180:183], v[204:207], a[68:71]
  v_exp_f32 v142, v142
  v_mfma_f32_16x16x32_bf16 v[28:31], v[16:19], v[188:191], v[28:31]
  v_exp_f32 v143, v143
  v_mfma_f32_16x16x32_bf16 v[28:31], v[16:19], v[204:207], v[28:31]
  global_load_lds_dwordx4 v3, s[94:95] offset:3072 sc1
  v_mfma_f32_16x16x32_bf16 a[72:75], a[168:171], v[188:191], a[72:75]
  ds_read_b128 a[252:255], v254 offset:31744
  v_cvt_pk_bf16_f32 v225, v142, v143
  v_mfma_f32_16x16x32_bf16 a[72:75], a[184:187], v[204:207], a[72:75]
  v_exp_f32 v144, v144
  v_mfma_f32_16x16x32_bf16 a[104:107], a[168:171], v[192:195], a[104:107]
  v_exp_f32 v145, v145
  v_mfma_f32_16x16x32_bf16 a[104:107], a[184:187], v[208:211], a[104:107]
  v_cvt_pk_bf16_f32 v226, v144, v145
  v_add_u32 v3, 0x4000, v3
  v_mfma_f32_16x16x32_bf16 a[108:111], a[172:175], v[192:195], a[108:111]
  v_exp_f32 v146, v146
  v_mfma_f32_16x16x32_bf16 a[108:111], a[188:191], v[208:211], a[108:111]
  v_exp_f32 v147, v147
  v_mfma_f32_16x16x32_bf16 a[76:79], a[172:175], v[188:191], a[76:79]
  s_waitcnt vmcnt(16) lgkmcnt(0)
  s_barrier
  v_mfma_f32_16x16x32_bf16 a[76:79], a[188:191], v[204:207], a[76:79]
  v_cvt_pk_bf16_f32 v227, v146, v147
  v_mfma_f32_16x16x32_bf16 v[132:135], a[192:195], v[84:87], v[44:47]
  ds_read_b128 a[128:131], v254 offset:32768
  s_mov_b32 m0, s31
  v_mfma_f32_16x16x32_bf16 v[132:135], a[196:199], v[88:91], v[132:135]
  v_exp_f32 v164, v164
  v_mfma_f32_16x16x32_bf16 v[132:135], a[200:203], v[92:95], v[132:135]
  v_exp_f32 v165, v165
  v_mfma_f32_16x16x32_bf16 v[132:135], a[204:207], v[96:99], v[132:135]
  ds_read_b128 a[132:135], v254 offset:33792
  ds_read_b128 a[136:139], v254 offset:34816
  v_mfma_f32_16x16x32_bf16 v[140:143], a[192:195], v[100:103], v[48:51]
  ds_read_b128 a[140:143], v254 offset:35840
  v_cvt_pk_bf16_f32 v236, v164, v165
  v_mfma_f32_16x16x32_bf16 v[140:143], a[196:199], v[104:107], v[140:143]
  v_exp_f32 v166, v166
  v_mfma_f32_16x16x32_bf16 v[140:143], a[200:203], v[108:111], v[140:143]
  v_exp_f32 v167, v167
  v_mfma_f32_16x16x32_bf16 v[140:143], a[204:207], v[112:115], v[140:143]
  ds_read_b128 a[144:147], v254 offset:36864
  v_cvt_pk_bf16_f32 v237, v166, v167
  v_mfma_f32_16x16x32_bf16 v[136:139], a[208:211], v[84:87], v[44:47]
  v_exp_f32 v168, v168
  v_mfma_f32_16x16x32_bf16 v[136:139], a[212:215], v[88:91], v[136:139]
  ds_read_b128 a[148:151], v254 offset:37888
  ds_read_b128 a[152:155], v254 offset:38912
  v_mfma_f32_16x16x32_bf16 v[136:139], a[216:219], v[92:95], v[136:139]
  v_exp_f32 v169, v169
  v_mfma_f32_16x16x32_bf16 v[136:139], a[220:223], v[96:99], v[136:139]
  global_load_lds_dwordx4 v3, s[94:95] offset:-4096 sc1
  v_mfma_f32_16x16x32_bf16 v[144:147], a[208:211], v[100:103], v[48:51]
  ds_read_b128 a[156:159], v254 offset:39936
  v_cvt_pk_bf16_f32 v238, v168, v169
  v_mfma_f32_16x16x32_bf16 v[144:147], a[212:215], v[104:107], v[144:147]
  v_exp_f32 v170, v170
  v_mfma_f32_16x16x32_bf16 v[144:147], a[216:219], v[108:111], v[144:147]
  ds_read_b128 a[160:163], v254 offset:49152
  ds_read_b128 a[164:167], v254 offset:50176
  v_mfma_f32_16x16x32_bf16 v[144:147], a[220:223], v[112:115], v[144:147]
  v_exp_f32 v171, v171
  v_mfma_f32_16x16x32_bf16 a[80:83], a[224:227], v[188:191], a[80:83]
  ds_read_b128 a[168:171], v254 offset:51200
  v_cvt_pk_bf16_f32 v239, v170, v171
  v_mfma_f32_16x16x32_bf16 a[80:83], a[240:243], v[204:207], a[80:83]
  v_exp_f32 v172, v172
  v_mfma_f32_16x16x32_bf16 a[112:115], a[224:227], v[192:195], a[112:115]
  global_load_lds_dwordx4 v3, s[94:95] offset:-3072 sc1
  v_mfma_f32_16x16x32_bf16 a[112:115], a[240:243], v[208:211], a[112:115]
  ds_read_b128 a[172:175], v254 offset:52224
  ds_read_b128 a[176:179], v254 offset:57344
  v_mfma_f32_16x16x32_bf16 a[116:119], a[228:231], v[192:195], a[116:119]
  v_exp_f32 v173, v173
  v_mfma_f32_16x16x32_bf16 a[116:119], a[244:247], v[208:211], a[116:119]
  ds_read_b128 a[180:183], v254 offset:58368
  v_cvt_pk_bf16_f32 v240, v172, v173
  v_mfma_f32_16x16x32_bf16 a[84:87], a[228:231], v[188:191], a[84:87]
  v_exp_f32 v174, v174
  v_mfma_f32_16x16x32_bf16 a[84:87], a[244:247], v[204:207], a[84:87]
  v_exp_f32 v175, v175
  v_mfma_f32_16x16x32_bf16 v[32:35], v[16:19], v[192:195], v[32:35]
  ds_read_b128 a[184:187], v254 offset:59392
  ds_read_b128 a[188:191], v254 offset:60416
  v_mfma_f32_16x16x32_bf16 v[32:35], v[16:19], v[208:211], v[32:35]
  global_load_lds_dwordx4 v3, s[94:95] offset:-2048 sc1
  v_mfma_f32_16x16x32_bf16 a[88:91], a[232:235], v[188:191], a[88:91]
  v_cvt_pk_bf16_f32 v241, v174, v175
  v_mfma_f32_16x16x32_bf16 a[88:91], a[248:251], v[204:207], a[88:91]
  v_exp_f32 v176, v176
  v_mfma_f32_16x16x32_bf16 a[120:123], a[232:235], v[192:195], a[120:123]
  v_exp_f32 v177, v177
  v_mfma_f32_16x16x32_bf16 a[120:123], a[248:251], v[208:211], a[120:123]
  global_load_lds_dwordx4 v3, s[94:95] offset:-1024 sc1
  v_mfma_f32_16x16x32_bf16 a[124:127], a[236:239], v[192:195], a[124:127]
  v_cvt_pk_bf16_f32 v242, v176, v177
  v_mfma_f32_16x16x32_bf16 a[124:127], a[252:255], v[208:211], a[124:127]
  v_exp_f32 v178, v178
  v_mfma_f32_16x16x32_bf16 a[92:95], a[236:239], v[188:191], a[92:95]
  s_waitcnt lgkmcnt(0)
  v_mfma_f32_16x16x32_bf16 a[92:95], a[252:255], v[204:207], a[92:95]
  v_exp_f32 v179, v179
  s_nop 0
  v_cvt_pk_bf16_f32 v243, v178, v179
  v_mfma_f32_16x16x32_bf16 v[164:167], a[128:131], v[84:87], v[44:47]
  ds_read_b128 a[192:195], v254 offset:40960
  s_mov_b32 m0, s31
  v_mfma_f32_16x16x32_bf16 v[164:167], a[132:135], v[88:91], v[164:167]
  v_exp_f32 v132, v132
  v_mfma_f32_16x16x32_bf16 v[164:167], a[136:139], v[92:95], v[164:167]
  v_exp_f32 v133, v133
  v_mfma_f32_16x16x32_bf16 v[164:167], a[140:143], v[96:99], v[164:167]
  ds_read_b128 a[196:199], v254 offset:41984
  ds_read_b128 a[200:203], v254 offset:43008
  v_mfma_f32_16x16x32_bf16 v[172:175], a[128:131], v[100:103], v[48:51]
  ds_read_b128 a[204:207], v254 offset:44032
  v_cvt_pk_bf16_f32 v188, v132, v133
  v_mfma_f32_16x16x32_bf16 v[172:175], a[132:135], v[104:107], v[172:175]
  v_exp_f32 v134, v134
  v_mfma_f32_16x16x32_bf16 v[172:175], a[136:139], v[108:111], v[172:175]
  v_exp_f32 v135, v135
  v_mfma_f32_16x16x32_bf16 v[172:175], a[140:143], v[112:115], v[172:175]
  ds_read_b128 a[208:211], v254 offset:45056
  v_cvt_pk_bf16_f32 v189, v134, v135
  v_mfma_f32_16x16x32_bf16 v[168:171], a[144:147], v[84:87], v[44:47]
  v_exp_f32 v136, v136
  v_mfma_f32_16x16x32_bf16 v[168:171], a[148:151], v[88:91], v[168:171]
  ds_read_b128 a[212:215], v254 offset:46080
  ds_read_b128 a[216:219], v254 offset:47104
  v_mfma_f32_16x16x32_bf16 v[168:171], a[152:155], v[92:95], v[168:171]
  global_load_lds_dwordx4 v3, s[94:95] offset:0 sc1
  v_mfma_f32_16x16x32_bf16 v[168:171], a[156:159], v[96:99], v[168:171]
  v_exp_f32 v137, v137
  v_mfma_f32_16x16x32_bf16 v[176:179], a[144:147], v[100:103], v[48:51]
  ds_read_b128 a[220:223], v254 offset:48128
  v_cvt_pk_bf16_f32 v190, v136, v137
  v_mfma_f32_16x16x32_bf16 v[176:179], a[148:151], v[104:107], v[176:179]
  v_exp_f32 v138, v138
  v_mfma_f32_16x16x32_bf16 v[176:179], a[152:155], v[108:111], v[176:179]
  ds_read_b128 a[224:227], v254 offset:53248
  ds_read_b128 a[228:231], v254 offset:54272
  v_mfma_f32_16x16x32_bf16 v[176:179], a[156:159], v[112:115], v[176:179]
  global_load_lds_dwordx4 v3, s[94:95] offset:1024 sc1
  v_mfma_f32_16x16x32_bf16 a[64:67], a[160:163], v[220:223], a[64:67]
  v_exp_f32 v139, v139
  v_mfma_f32_16x16x32_bf16 a[64:67], a[176:179], v[236:239], a[64:67]
  ds_read_b128 a[232:235], v254 offset:55296
  v_cvt_pk_bf16_f32 v191, v138, v139
  v_mfma_f32_16x16x32_bf16 a[96:99], a[160:163], v[224:227], a[96:99]
  v_exp_f32 v140, v140
  v_mfma_f32_16x16x32_bf16 a[96:99], a[176:179], v[240:243], a[96:99]
  ds_read_b128 a[236:239], v254 offset:56320
  ds_read_b128 a[240:243], v254 offset:61440
  v_mfma_f32_16x16x32_bf16 a[100:103], a[164:167], v[224:227], a[100:103]
  v_exp_f32 v141, v141
  v_mfma_f32_16x16x32_bf16 a[100:103], a[180:183], v[240:243], a[100:103]
  global_load_lds_dwordx4 v3, s[94:95] offset:2048 sc1
  v_mfma_f32_16x16x32_bf16 a[68:71], a[164:167], v[220:223], a[68:71]
  ds_read_b128 a[244:247], v254 offset:62464
  v_cvt_pk_bf16_f32 v192, v140, v141
  v_mfma_f32_16x16x32_bf16 a[68:71], a[180:183], v[236:239], a[68:71]
  v_exp_f32 v142, v142
  v_mfma_f32_16x16x32_bf16 v[28:31], v[16:19], v[220:223], v[28:31]
  ds_read_b128 a[248:251], v254 offset:63488
  ds_read_b128 a[252:255], v254 offset:64512
  v_mfma_f32_16x16x32_bf16 v[28:31], v[16:19], v[236:239], v[28:31]
  v_exp_f32 v143, v143
  v_mfma_f32_16x16x32_bf16 a[72:75], a[168:171], v[220:223], a[72:75]
  v_cvt_pk_bf16_f32 v193, v142, v143
  v_mfma_f32_16x16x32_bf16 a[72:75], a[184:187], v[236:239], a[72:75]
  global_load_lds_dwordx4 v3, s[94:95] offset:3072 sc1
  v_mfma_f32_16x16x32_bf16 a[104:107], a[168:171], v[224:227], a[104:107]
  v_exp_f32 v144, v144
  v_mfma_f32_16x16x32_bf16 a[104:107], a[184:187], v[240:243], a[104:107]
  v_exp_f32 v145, v145
  v_mfma_f32_16x16x32_bf16 a[108:111], a[172:175], v[224:227], a[108:111]
  v_cvt_pk_bf16_f32 v194, v144, v145
  v_add_u32 v3, 0x4000, v3
  v_mfma_f32_16x16x32_bf16 a[108:111], a[188:191], v[240:243], a[108:111]
  v_exp_f32 v146, v146
  v_mfma_f32_16x16x32_bf16 a[76:79], a[172:175], v[220:223], a[76:79]
  s_waitcnt vmcnt(16) lgkmcnt(0)
  s_barrier
  v_mfma_f32_16x16x32_bf16 a[76:79], a[188:191], v[236:239], a[76:79]
  v_exp_f32 v147, v147
  s_nop 0
  v_cvt_pk_bf16_f32 v195, v146, v147
  v_mfma_f32_16x16x32_bf16 v[132:135], a[192:195], v[84:87], v[44:47]
  v_exp_f32 v164, v164
  v_mfma_f32_16x16x32_bf16 v[132:135], a[196:199], v[88:91], v[132:135]
  ds_read_b128 a[128:131], v2 offset:0
  ds_read_b128 a[132:135], v2 offset:1024
  v_mfma_f32_16x16x32_bf16 v[132:135], a[200:203], v[92:95], v[132:135]
  buffer_store_dwordx2 v[250:251], v0, s[12:15], s59 offen sc1
  v_mfma_f32_16x16x32_bf16 v[132:135], a[204:207], v[96:99], v[132:135]
  ds_read_b128 a[136:139], v2 offset:2048
  s_mov_b32 s59, 0x10000000
  v_mfma_f32_16x16x32_bf16 v[140:143], a[192:195], v[100:103], v[48:51]
  v_exp_f32 v165, v165
  v_mfma_f32_16x16x32_bf16 v[140:143], a[196:199], v[104:107], v[140:143]
  ds_read_b128 a[140:143], v2 offset:3072
  v_cvt_pk_bf16_f32 v204, v164, v165
  v_mfma_f32_16x16x32_bf16 v[140:143], a[200:203], v[108:111], v[140:143]
  v_exp_f32 v166, v166
  v_mfma_f32_16x16x32_bf16 v[140:143], a[204:207], v[112:115], v[140:143]
  buffer_store_dwordx2 v[250:251], v0, s[12:15], s61 offen sc1
  v_mfma_f32_16x16x32_bf16 v[136:139], a[208:211], v[84:87], v[44:47]
  ds_read_b128 a[144:147], v2 offset:4096
  ds_read_b128 a[148:151], v2 offset:5120
  v_mfma_f32_16x16x32_bf16 v[136:139], a[212:215], v[88:91], v[136:139]
  v_exp_f32 v167, v167
  v_mfma_f32_16x16x32_bf16 v[136:139], a[216:219], v[92:95], v[136:139]
  ds_read_b128 a[152:155], v2 offset:6144
  v_cvt_pk_bf16_f32 v205, v166, v167
  v_mfma_f32_16x16x32_bf16 v[136:139], a[220:223], v[96:99], v[136:139]
  ds_read_b128 a[156:159], v2 offset:7168
  s_mov_b32 s61, 0x10000000
  v_mfma_f32_16x16x32_bf16 v[144:147], a[208:211], v[100:103], v[48:51]
  v_exp_f32 v168, v168
  v_mfma_f32_16x16x32_bf16 v[144:147], a[212:215], v[104:107], v[144:147]
  ds_read_b128 a[160:163], v2 offset:16384
  s_cmp_eq_u32 s25, 0
  v_mfma_f32_16x16x32_bf16 v[144:147], a[216:219], v[108:111], v[144:147]
  v_exp_f32 v169, v169
  v_mfma_f32_16x16x32_bf16 v[144:147], a[220:223], v[112:115], v[144:147]
  ds_read_b128 a[164:167], v2 offset:17408
  v_cvt_pk_bf16_f32 v206, v168, v169
  s_cselect_b32 s24, s60, s61
  v_mfma_f32_16x16x32_bf16 a[80:83], a[224:227], v[220:223], a[80:83]
  v_exp_f32 v170, v170
  v_mfma_f32_16x16x32_bf16 a[80:83], a[240:243], v[236:239], a[80:83]
  v_exp_f32 v171, v171
  v_mfma_f32_16x16x32_bf16 a[112:115], a[224:227], v[224:227], a[112:115]
  buffer_load_dwordx2 v[244:245], v4, s[12:15], s24 offen offset:0 sc1
  v_mfma_f32_16x16x32_bf16 a[112:115], a[240:243], v[240:243], a[112:115]
  ds_read_b128 a[168:171], v2 offset:18432
  v_cvt_pk_bf16_f32 v207, v170, v171
  v_mfma_f32_16x16x32_bf16 a[116:119], a[228:231], v[224:227], a[116:119]
  v_exp_f32 v172, v172
  v_mfma_f32_16x16x32_bf16 a[116:119], a[244:247], v[240:243], a[116:119]
  buffer_load_dwordx2 v[246:247], v4, s[12:15], s24 offen offset:1024 sc1
  ds_read_b128 a[172:175], v2 offset:19456
  v_mfma_f32_16x16x32_bf16 a[84:87], a[228:231], v[220:223], a[84:87]
  v_exp_f32 v173, v173
  s_add_u32 m0, s31, 0x8000
  v_mfma_f32_16x16x32_bf16 a[84:87], a[244:247], v[236:239], a[84:87]
  ds_read_b128 a[176:179], v2 offset:24576
  v_cvt_pk_bf16_f32 v208, v172, v173
  v_mfma_f32_16x16x32_bf16 v[32:35], v[16:19], v[224:227], v[32:35]
  ds_read_b128 a[180:183], v2 offset:25600
  ds_read_b128 a[184:187], v2 offset:26624
  v_exp_f32 v174, v174
  v_mfma_f32_16x16x32_bf16 v[32:35], v[16:19], v[240:243], v[32:35]
  global_load_lds_dwordx4 v3, s[94:95] offset:-4096 sc1
  v_mfma_f32_16x16x32_bf16 a[88:91], a[232:235], v[220:223], a[88:91]
  v_exp_f32 v175, v175
  v_mfma_f32_16x16x32_bf16 a[88:91], a[248:251], v[236:239], a[88:91]
  ds_read_b128 a[188:191], v2 offset:27648
  v_cvt_pk_bf16_f32 v209, v174, v175
  v_mfma_f32_16x16x32_bf16 a[120:123], a[232:235], v[224:227], a[120:123]
  global_load_lds_dwordx4 v3, s[94:95] offset:-3072 sc1
  v_exp_f32 v176, v176
  v_mfma_f32_16x16x32_bf16 a[120:123], a[248:251], v[240:243], a[120:123]
  global_load_lds_dwordx4 v3, s[94:95] offset:-2048 sc1
  v_mfma_f32_16x16x32_bf16 a[124:127], a[236:239], v[224:227], a[124:127]
  v_exp_f32 v177, v177
  v_mfma_f32_16x16x32_bf16 a[124:127], a[252:255], v[240:243], a[124:127]
  v_cvt_pk_bf16_f32 v210, v176, v177
  v_mfma_f32_16x16x32_bf16 a[92:95], a[236:239], v[220:223], a[92:95]
  s_waitcnt lgkmcnt(0)
  v_mfma_f32_16x16x32_bf16 a[92:95], a[252:255], v[236:239], a[92:95]
  global_load_lds_dwordx4 v3, s[94:95] offset:-1024 sc1
  v_exp_f32 v178, v178
  v_exp_f32 v179, v179
  s_nop 0
  v_cvt_pk_bf16_f32 v211, v178, v179
  v_mfma_f32_16x16x32_bf16 v[164:167], a[128:131], v[84:87], v[44:47]
  v_exp_f32 v132, v132
  v_mfma_f32_16x16x32_bf16 v[164:167], a[132:135], v[88:91], v[164:167]
  ds_read_b128 a[192:195], v2 offset:8192
  ds_read_b128 a[196:199], v2 offset:9216
  v_mfma_f32_16x16x32_bf16 v[164:167], a[136:139], v[92:95], v[164:167]
  v_exp_f32 v133, v133
  v_mfma_f32_16x16x32_bf16 v[164:167], a[140:143], v[96:99], v[164:167]
  ds_read_b128 a[200:203], v2 offset:10240
  v_cvt_pk_bf16_f32 v220, v132, v133
  v_mfma_f32_16x16x32_bf16 v[172:175], a[128:131], v[100:103], v[48:51]
  global_load_lds_dwordx4 v3, s[94:95] offset:0 sc1
  v_mfma_f32_16x16x32_bf16 v[172:175], a[132:135], v[104:107], v[172:175]
  v_exp_f32 v134, v134
  v_mfma_f32_16x16x32_bf16 v[172:175], a[136:139], v[108:111], v[172:175]
  ds_read_b128 a[204:207], v2 offset:11264
  ds_read_b128 a[208:211], v2 offset:12288
  v_mfma_f32_16x16x32_bf16 v[172:175], a[140:143], v[112:115], v[172:175]
  v_exp_f32 v135, v135
  v_mfma_f32_16x16x32_bf16 v[168:171], a[144:147], v[84:87], v[44:47]
  ds_read_b128 a[212:215], v2 offset:13312
  v_cvt_pk_bf16_f32 v221, v134, v135
  v_mfma_f32_16x16x32_bf16 v[168:171], a[148:151], v[88:91], v[168:171]
  v_exp_f32 v136, v136
  v_mfma_f32_16x16x32_bf16 v[168:171], a[152:155], v[92:95], v[168:171]
  global_load_lds_dwordx4 v3, s[94:95] offset:1024 sc1
  v_mfma_f32_16x16x32_bf16 v[168:171], a[156:159], v[96:99], v[168:171]
  ds_read_b128 a[216:219], v2 offset:14336
  ds_read_b128 a[220:223], v2 offset:15360
  v_mfma_f32_16x16x32_bf16 v[176:179], a[144:147], v[100:103], v[48:51]
  v_exp_f32 v137, v137
  v_mfma_f32_16x16x32_bf16 v[176:179], a[148:151], v[104:107], v[176:179]
  ds_read_b128 a[224:227], v2 offset:20480
  v_cvt_pk_bf16_f32 v222, v136, v137
  v_mfma_f32_16x16x32_bf16 v[176:179], a[152:155], v[108:111], v[176:179]
  v_exp_f32 v138, v138
  v_mfma_f32_16x16x32_bf16 v[176:179], a[156:159], v[112:115], v[176:179]
  global_load_lds_dwordx4 v3, s[94:95] offset:2048 sc1
  v_mfma_f32_16x16x32_bf16 a[64:67], a[160:163], v[188:191], a[64:67]
  ds_read_b128 a[228:231], v2 offset:21504
  ds_read_b128 a[232:235], v2 offset:22528
  v_mfma_f32_16x16x32_bf16 a[64:67], a[176:179], v[204:207], a[64:67]
  v_exp_f32 v139, v139
  v_mfma_f32_16x16x32_bf16 a[96:99], a[160:163], v[192:195], a[96:99]
  ds_read_b128 a[236:239], v2 offset:23552
  v_cvt_pk_bf16_f32 v223, v138, v139
  v_mfma_f32_16x16x32_bf16 a[96:99], a[176:179], v[208:211], a[96:99]
  v_exp_f32 v140, v140
  v_mfma_f32_16x16x32_bf16 a[100:103], a[164:167], v[192:195], a[100:103]
  v_exp_f32 v141, v141
  v_mfma_f32_16x16x32_bf16 a[100:103], a[180:183], v[208:211], a[100:103]
  global_load_lds_dwordx4 v3, s[94:95] offset:3072 sc1
  v_mfma_f32_16x16x32_bf16 a[68:71], a[164:167], v[188:191], a[68:71]
  ds_read_b128 a[240:243], v2 offset:28672
  v_cvt_pk_bf16_f32 v224, v140, v141
  v_mfma_f32_16x16x32_bf16 a[68:71], a[180:183], v[204:207], a[68:71]
  ds_read_b128 a[244:247], v2 offset:29696
  ds_read_b128 a[248:251], v2 offset:30720
  v_mfma_f32_16x16x32_bf16 v[28:31], v[16:19], v[188:191], v[28:31]
  v_exp_f32 v142, v142
  v_mfma_f32_16x16x32_bf16 v[28:31], v[16:19], v[204:207], v[28:31]
  v_exp_f32 v143, v143
  v_mfma_f32_16x16x32_bf16 a[72:75], a[168:171], v[188:191], a[72:75]
  ds_read_b128 a[252:255], v2 offset:31744
  v_cvt_pk_bf16_f32 v225, v142, v143
  v_mfma_f32_16x16x32_bf16 a[72:75], a[184:187], v[204:207], a[72:75]
  v_add_u32 v3, 0x4000, v3
  s_sub_u32 s25, s25, 1
  v_mfma_f32_16x16x32_bf16 a[104:107], a[168:171], v[192:195], a[104:107]
  v_exp_f32 v144, v144
  v_mfma_f32_16x16x32_bf16 a[104:107], a[184:187], v[208:211], a[104:107]
  v_exp_f32 v145, v145
  v_mfma_f32_16x16x32_bf16 a[108:111], a[172:175], v[192:195], a[108:111]
  v_cvt_pk_bf16_f32 v226, v144, v145
  v_mfma_f32_16x16x32_bf16 a[108:111], a[188:191], v[208:211], a[108:111]
  v_exp_f32 v146, v146
  v_mfma_f32_16x16x32_bf16 a[76:79], a[172:175], v[188:191], a[76:79]
  s_waitcnt vmcnt(16) lgkmcnt(0)
  s_barrier
  v_mfma_f32_16x16x32_bf16 a[76:79], a[188:191], v[204:207], a[76:79]
  v_exp_f32 v147, v147
  s_nop 0
  v_cvt_pk_bf16_f32 v227, v146, v147
  v_mfma_f32_16x16x32_bf16 v[132:135], a[192:195], v[84:87], v[44:47]
  ds_read_b128 a[128:131], v2 offset:32768
  s_mov_b32 m0, s30
  v_mfma_f32_16x16x32_bf16 v[132:135], a[196:199], v[88:91], v[132:135]
  v_exp_f32 v164, v164
  v_mfma_f32_16x16x32_bf16 v[132:135], a[200:203], v[92:95], v[132:135]
  v_exp_f32 v165, v165
  v_mfma_f32_16x16x32_bf16 v[132:135], a[204:207], v[96:99], v[132:135]
  ds_read_b128 a[132:135], v2 offset:33792
  ds_read_b128 a[136:139], v2 offset:34816
  v_mfma_f32_16x16x32_bf16 v[140:143], a[192:195], v[100:103], v[48:51]
  ds_read_b128 a[140:143], v2 offset:35840
  v_cvt_pk_bf16_f32 v236, v164, v165
  v_mfma_f32_16x16x32_bf16 v[140:143], a[196:199], v[104:107], v[140:143]
  v_exp_f32 v166, v166
  v_mfma_f32_16x16x32_bf16 v[140:143], a[200:203], v[108:111], v[140:143]
  v_exp_f32 v167, v167
  v_mfma_f32_16x16x32_bf16 v[140:143], a[204:207], v[112:115], v[140:143]
  ds_read_b128 a[144:147], v2 offset:36864
  v_cvt_pk_bf16_f32 v237, v166, v167
  v_mfma_f32_16x16x32_bf16 v[136:139], a[208:211], v[84:87], v[44:47]
  v_exp_f32 v168, v168
  v_mfma_f32_16x16x32_bf16 v[136:139], a[212:215], v[88:91], v[136:139]
  ds_read_b128 a[148:151], v2 offset:37888
  ds_read_b128 a[152:155], v2 offset:38912
  v_mfma_f32_16x16x32_bf16 v[136:139], a[216:219], v[92:95], v[136:139]
  v_exp_f32 v169, v169
  v_mfma_f32_16x16x32_bf16 v[136:139], a[220:223], v[96:99], v[136:139]
  ds_read_b128 a[156:159], v2 offset:39936
  v_cvt_pk_bf16_f32 v238, v168, v169
  v_mfma_f32_16x16x32_bf16 v[144:147], a[208:211], v[100:103], v[48:51]
  v_exp_f32 v170, v170
  v_mfma_f32_16x16x32_bf16 v[144:147], a[212:215], v[104:107], v[144:147]
  global_load_lds_dwordx4 v3, s[94:95] offset:-4096 sc1
  v_mfma_f32_16x16x32_bf16 v[144:147], a[216:219], v[108:111], v[144:147]
  ds_read_b128 a[160:163], v2 offset:49152
  ds_read_b128 a[164:167], v2 offset:50176
  v_mfma_f32_16x16x32_bf16 v[144:147], a[220:223], v[112:115], v[144:147]
  v_exp_f32 v171, v171
  v_mfma_f32_16x16x32_bf16 a[80:83], a[224:227], v[188:191], a[80:83]
  v_exp_f32 v172, v172
  v_mfma_f32_16x16x32_bf16 a[80:83], a[240:243], v[204:207], a[80:83]
  ds_read_b128 a[168:171], v2 offset:51200
  v_cvt_pk_bf16_f32 v239, v170, v171
  v_mfma_f32_16x16x32_bf16 a[112:115], a[224:227], v[192:195], a[112:115]
  v_exp_f32 v173, v173
  v_mfma_f32_16x16x32_bf16 a[112:115], a[240:243], v[208:211], a[112:115]
  global_load_lds_dwordx4 v3, s[94:95] offset:-3072 sc1
  v_mfma_f32_16x16x32_bf16 a[116:119], a[228:231], v[192:195], a[116:119]
  ds_read_b128 a[172:175], v2 offset:52224
  v_cvt_pk_bf16_f32 v240, v172, v173
  v_mfma_f32_16x16x32_bf16 a[116:119], a[244:247], v[208:211], a[116:119]
  v_exp_f32 v174, v174
  v_mfma_f32_16x16x32_bf16 a[84:87], a[228:231], v[188:191], a[84:87]
  ds_read_b128 a[176:179], v2 offset:57344
  ds_read_b128 a[180:183], v2 offset:58368
  v_mfma_f32_16x16x32_bf16 a[84:87], a[244:247], v[204:207], a[84:87]
  v_exp_f32 v175, v175
  v_mfma_f32_16x16x32_bf16 v[32:35], v[16:19], v[192:195], v[32:35]
  v_exp_f32 v176, v176
  v_cvt_pk_bf16_f32 v241, v174, v175
  v_mfma_f32_16x16x32_bf16 v[32:35], v[16:19], v[208:211], v[32:35]
  ds_read_b128 a[184:187], v2 offset:59392
  ds_read_b128 a[188:191], v2 offset:60416
  v_mfma_f32_16x16x32_bf16 a[88:91], a[232:235], v[188:191], a[88:91]
  v_exp_f32 v177, v177
  v_mfma_f32_16x16x32_bf16 a[88:91], a[248:251], v[204:207], a[88:91]
  global_load_lds_dwordx4 v3, s[94:95] offset:-2048 sc1
  v_mfma_f32_16x16x32_bf16 a[120:123], a[232:235], v[192:195], a[120:123]
  v_exp_f32 v178, v178
  v_cvt_pk_bf16_f32 v242, v176, v177
  v_mfma_f32_16x16x32_bf16 a[120:123], a[248:251], v[208:211], a[120:123]
  v_exp_f32 v179, v179
  v_mfma_f32_16x16x32_bf16 a[124:127], a[236:239], v[192:195], a[124:127]
  v_cvt_pk_bf16_f32 v243, v178, v179
  v_mfma_f32_16x16x32_bf16 a[124:127], a[252:255], v[208:211], a[124:127]
  global_load_lds_dwordx4 v3, s[94:95] offset:-1024 sc1
  v_mfma_f32_16x16x32_bf16 a[92:95], a[236:239], v[188:191], a[92:95]
  s_waitcnt lgkmcnt(0)
  v_mfma_f32_16x16x32_bf16 a[92:95], a[252:255], v[204:207], a[92:95]
  s_cbranch_scc0 adaLN_cond__compressed_kv_cla__mixer_channel_mlp__prompt_kernel_lb
  s_mov_b32 s24, 0x3f08000
adaLN_cond__compressed_kv_cla__mixer_channel_mlp__prompt_kernel_bd:
  s_waitcnt vmcnt(12)
  s_mov_b32 s40, 0
  v_cmp_ne_u64 vcc, s[76:77], v[244:245]
  v_cmp_ne_u64_e64 s[42:43], s[76:77], v[246:247]
  s_nop 1
  s_or_b64 vcc, vcc, s[42:43]
  s_cbranch_vccz adaLN_cond__compressed_kv_cla__mixer_channel_mlp__prompt_kernel_ok26
adaLN_cond__compressed_kv_cla__mixer_channel_mlp__prompt_kernel_sp27:
  s_sleep 2
  buffer_load_dwordx2 v[244:245], v4, s[12:15], s24 offen offset:0 sc1
  buffer_load_dwordx2 v[246:247], v4, s[12:15], s24 offen offset:1024 sc1
  s_waitcnt vmcnt(0)
  s_add_u32 s40, s40, 1
  v_cmp_ne_u64 vcc, s[76:77], v[244:245]
  v_cmp_ne_u64_e64 s[42:43], s[76:77], v[246:247]
  s_nop 1
  s_or_b64 vcc, vcc, s[42:43]
  s_cbranch_vccz adaLN_cond__compressed_kv_cla__mixer_channel_mlp__prompt_kernel_ok26
  s_cmp_lt_u32 s40, 0x4000
  s_cbranch_scc1 adaLN_cond__compressed_kv_cla__mixer_channel_mlp__prompt_kernel_sp27
adaLN_cond__compressed_kv_cla__mixer_channel_mlp__prompt_kernel_ok26:
  s_mov_b32 s23, s22
  s_lshl_b32 s29, s20, 12
  s_lshl_b32 s40, s23, 19
  s_lshl_b32 s41, s20, 17
  s_add_u32 s40, s40, s41
  s_add_u32 s30, s40, 0x1000000
  v_mfma_f32_16x16x32_bf16 v[164:167], a[128:131], v[84:87], v[44:47]
  ds_read_b128 a[192:195], v2 offset:40960
  v_cmp_gt_i32_e64 s[48:49], 0, v5
  v_mfma_f32_16x16x32_bf16 v[164:167], a[132:135], v[88:91], v[164:167]
  v_exp_f32 v140, v140
  v_mfma_f32_16x16x32_bf16 v[164:167], a[136:139], v[92:95], v[164:167]
  ds_read_b128 a[196:199], v2 offset:41984
  s_add_u32 s33, s30, 0
  v_mfma_f32_16x16x32_bf16 v[164:167], a[140:143], v[96:99], v[164:167]
  ds_read_b128 a[200:203], v2 offset:43008
  v_cndmask_b32_e64 v132, v132, v7, s[48:49]
  v_mfma_f32_16x16x32_bf16 v[172:175], a[128:131], v[100:103], v[48:51]
  v_exp_f32 v141, v141
  v_mfma_f32_16x16x32_bf16 v[172:175], a[132:135], v[104:107], v[172:175]
  ds_read_b128 a[204:207], v2 offset:44032
  v_cmp_gt_i32_e64 s[50:51], 1, v5
  v_mfma_f32_16x16x32_bf16 v[172:175], a[136:139], v[108:111], v[172:175]
  ds_read_b128 a[208:211], v2 offset:45056
  v_cvt_pk_bf16_f32 v192, v140, v141
  v_mfma_f32_16x16x32_bf16 v[172:175], a[140:143], v[112:115], v[172:175]
  v_cndmask_b32_e64 v133, v133, v7, s[50:51]
  s_add_u32 m0, s29, 131072
  v_mfma_f32_16x16x32_bf16 v[168:171], a[144:147], v[84:87], v[44:47]
  v_exp_f32 v142, v142
  v_cmp_gt_i32_e64 s[52:53], 2, v5
  v_mfma_f32_16x16x32_bf16 v[168:171], a[148:151], v[88:91], v[168:171]
  buffer_load_dwordx4 v4, s[12:15], s33 offen offset:0 sc1 lds
  v_cndmask_b32_e64 v134, v134, v7, s[52:53]
  v_mfma_f32_16x16x32_bf16 v[168:171], a[152:155], v[92:95], v[168:171]
  v_exp_f32 v143, v143
  v_cmp_gt_i32_e64 s[54:55], 3, v5
  v_mfma_f32_16x16x32_bf16 v[168:171], a[156:159], v[96:99], v[168:171]
  ds_read_b128 a[212:215], v2 offset:46080
  v_cvt_pk_bf16_f32 v193, v142, v143
  v_cndmask_b32_e64 v135, v135, v7, s[54:55]
  v_mfma_f32_16x16x32_bf16 v[176:179], a[144:147], v[100:103], v[48:51]
  v_exp_f32 v144, v144
  v_cmp_gt_i32_e64 s[48:49], 16, v5
  v_mfma_f32_16x16x32_bf16 v[176:179], a[148:151], v[104:107], v[176:179]
  buffer_load_dwordx4 v4, s[12:15], s33 offen offset:1024 sc1 lds
  ds_read_b128 a[216:219], v2 offset:47104
  v_cndmask_b32_e64 v136, v136, v7, s[48:49]
  v_mfma_f32_16x16x32_bf16 v[176:179], a[152:155], v[108:111], v[176:179]
  v_exp_f32 v145, v145
  v_cmp_gt_i32_e64 s[50:51], 17, v5
  v_mfma_f32_16x16x32_bf16 v[176:179], a[156:159], v[112:115], v[176:179]
  buffer_load_dwordx4 v4, s[12:15], s33 offen offset:2048 sc1 lds
  ds_read_b128 a[220:223], v2 offset:48128
  v_cvt_pk_bf16_f32 v194, v144, v145
  v_cndmask_b32_e64 v137, v137, v7, s[50:51]
  v_mfma_f32_16x16x32_bf16 a[64:67], a[160:163], v[220:223], a[64:67]
  ds_read_b128 a[224:227], v2 offset:53248
  v_cmp_gt_i32_e64 s[52:53], 18, v5
  v_exp_f32 v146, v146
  v_mfma_f32_16x16x32_bf16 a[64:67], a[176:179], v[236:239], a[64:67]
  ds_read_b128 a[228:231], v2 offset:54272
  v_cndmask_b32_e64 v138, v138, v7, s[52:53]
  v_mfma_f32_16x16x32_bf16 a[96:99], a[160:163], v[224:227], a[96:99]
  buffer_load_dwordx4 v4, s[12:15], s33 offen offset:3072 sc1 lds
  v_exp_f32 v147, v147
  v_cmp_gt_i32_e64 s[54:55], 19, v5
  v_mfma_f32_16x16x32_bf16 a[96:99], a[176:179], v[240:243], a[96:99]
  ds_read_b128 a[232:235], v2 offset:55296
  v_cvt_pk_bf16_f32 v195, v146, v147
  v_cndmask_b32_e64 v139, v139, v7, s[54:55]
  s_add_u32 s33, s30, 16384
  v_mfma_f32_16x16x32_bf16 a[100:103], a[164:167], v[224:227], a[100:103]
  v_exp_f32 v132, v132
  v_mfma_f32_16x16x32_bf16 a[100:103], a[180:183], v[240:243], a[100:103]
  ds_read_b128 a[236:239], v2 offset:56320
  s_add_u32 m0, s29, 147456
  v_mfma_f32_16x16x32_bf16 a[68:71], a[164:167], v[220:223], a[68:71]
  v_exp_f32 v133, v133
  v_mfma_f32_16x16x32_bf16 a[68:71], a[180:183], v[236:239], a[68:71]
  ds_read_b128 a[240:243], v2 offset:61440
  v_cvt_pk_bf16_f32 v188, v132, v133
  v_mfma_f32_16x16x32_bf16 v[28:31], v[16:19], v[220:223], v[28:31]
  ds_read_b128 a[244:247], v2 offset:62464
  ds_read_b128 a[248:251], v2 offset:63488
  v_exp_f32 v134, v134
  v_mfma_f32_16x16x32_bf16 v[28:31], v[16:19], v[236:239], v[28:31]
  buffer_load_dwordx4 v4, s[12:15], s33 offen offset:0 sc1 lds
  v_mfma_f32_16x16x32_bf16 a[72:75], a[168:171], v[220:223], a[72:75]
  v_exp_f32 v135, v135
  v_mfma_f32_16x16x32_bf16 a[72:75], a[184:187], v[236:239], a[72:75]
  ds_read_b128 a[252:255], v2 offset:64512
  v_cvt_pk_bf16_f32 v189, v134, v135
  v_mfma_f32_16x16x32_bf16 a[104:107], a[168:171], v[224:227], a[104:107]
  buffer_load_dwordx4 v4, s[12:15], s33 offen offset:1024 sc1 lds
  v_exp_f32 v136, v136
  v_mfma_f32_16x16x32_bf16 a[104:107], a[184:187], v[240:243], a[104:107]
  buffer_load_dwordx4 v4, s[12:15], s33 offen offset:2048 sc1 lds
  v_mfma_f32_16x16x32_bf16 a[108:111], a[172:175], v[224:227], a[108:111]
  v_exp_f32 v137, v137
  v_mfma_f32_16x16x32_bf16 a[108:111], a[188:191], v[240:243], a[108:111]
  v_cvt_pk_bf16_f32 v190, v136, v137
  v_mfma_f32_16x16x32_bf16 a[76:79], a[172:175], v[220:223], a[76:79]
  s_waitcnt vmcnt(19) lgkmcnt(0)
  s_barrier
  v_mfma_f32_16x16x32_bf16 a[76:79], a[188:191], v[236:239], a[76:79]
  buffer_load_dwordx4 v4, s[12:15], s33 offen offset:3072 sc1 lds
  v_exp_f32 v138, v138
  v_exp_f32 v139, v139
  s_nop 0
  v_cvt_pk_bf16_f32 v191, v138, v139
  v_mfma_f32_16x16x32_bf16 v[140:143], a[192:195], v[100:103], v[48:51]
  ds_read_b128 a[128:131], v254 offset:0
  v_cmp_gt_i32_e64 s[48:49], 32, v5
  v_mfma_f32_16x16x32_bf16 v[140:143], a[196:199], v[104:107], v[140:143]
  v_exp_f32 v172, v172
  v_mfma_f32_16x16x32_bf16 v[140:143], a[200:203], v[108:111], v[140:143]
  ds_read_b128 a[132:135], v254 offset:1024
  v_cndmask_b32_e64 v164, v164, v7, s[48:49]
  v_mfma_f32_16x16x32_bf16 v[140:143], a[204:207], v[112:115], v[140:143]
  ds_read_b128 a[136:139], v254 offset:2048
  v_cmp_gt_i32_e64 s[50:51], 33, v5
  v_mfma_f32_16x16x32_bf16 v[144:147], a[208:211], v[100:103], v[48:51]
  v_exp_f32 v173, v173
  v_mfma_f32_16x16x32_bf16 v[144:147], a[212:215], v[104:107], v[144:147]
  ds_read_b128 a[140:143], v254 offset:3072
  s_add_u32 s33, s30, 32768
  v_mfma_f32_16x16x32_bf16 v[144:147], a[216:219], v[108:111], v[144:147]
  v_exp_f32 v174, v174
  v_cvt_pk_bf16_f32 v208, v172, v173
  v_cmp_gt_i32_e64 s[52:53], 34, v5
  v_cndmask_b32_e64 v165, v165, v7, s[50:51]
  v_mfma_f32_16x16x32_bf16 v[144:147], a[220:223], v[112:115], v[144:147]
  ds_read_b128 a[144:147], v254 offset:4096
  v_cndmask_b32_e64 v166, v166, v7, s[52:53]
  v_mfma_f32_16x16x32_bf16 a[80:83], a[224:227], v[220:223], a[80:83]
  ds_read_b128 a[148:151], v254 offset:5120
  v_cmp_gt_i32_e64 s[54:55], 35, v5
  v_exp_f32 v175, v175
  v_mfma_f32_16x16x32_bf16 a[80:83], a[240:243], v[236:239], a[80:83]
  ds_read_b128 a[152:155], v254 offset:6144
  v_cvt_pk_bf16_f32 v209, v174, v175
  v_exp_f32 v176, v176
  v_cndmask_b32_e64 v167, v167, v7, s[54:55]
  s_add_u32 m0, s29, 32768
  v_mfma_f32_16x16x32_bf16 a[112:115], a[224:227], v[224:227], a[112:115]
  ds_read_b128 a[156:159], v254 offset:7168
  v_cmp_gt_i32_e64 s[48:49], 48, v5
  v_mfma_f32_16x16x32_bf16 a[112:115], a[240:243], v[240:243], a[112:115]
  v_exp_f32 v177, v177
  v_cmp_gt_i32_e64 s[50:51], 49, v5
  v_cndmask_b32_e64 v168, v168, v7, s[48:49]
  v_mfma_f32_16x16x32_bf16 a[116:119], a[228:231], v[224:227], a[116:119]
  ds_read_b128 a[160:163], v254 offset:16384
  v_cvt_pk_bf16_f32 v210, v176, v177
  v_exp_f32 v178, v178
  v_cndmask_b32_e64 v169, v169, v7, s[50:51]
  v_mfma_f32_16x16x32_bf16 a[116:119], a[244:247], v[240:243], a[116:119]
  ds_read_b128 a[164:167], v254 offset:17408
  v_cmp_gt_i32_e64 s[52:53], 50, v5
  v_mfma_f32_16x16x32_bf16 a[84:87], a[228:231], v[220:223], a[84:87]
  buffer_load_dwordx4 v4, s[12:15], s33 offen offset:0 sc1 lds
  ds_read_b128 a[168:171], v254 offset:18432
  v_exp_f32 v179, v179
  v_cmp_gt_i32_e64 s[54:55], 51, v5
  v_cndmask_b32_e64 v170, v170, v7, s[52:53]
  v_mfma_f32_16x16x32_bf16 a[84:87], a[244:247], v[236:239], a[84:87]
  ds_read_b128 a[172:175], v254 offset:19456
  v_cvt_pk_bf16_f32 v211, v178, v179
  v_exp_f32 v164, v164
  v_cndmask_b32_e64 v171, v171, v7, s[54:55]
  v_mfma_f32_16x16x32_bf16 v[32:35], v[16:19], v[224:227], v[32:35]
  ds_read_b128 a[176:179], v254 offset:24576
  ds_read_b128 a[180:183], v254 offset:25600
  buffer_load_dwordx4 v4, s[12:15], s33 offen offset:1024 sc1 lds
  v_mfma_f32_16x16x32_bf16 v[32:35], v[16:19], v[240:243], v[32:35]
  v_exp_f32 v165, v165
  v_mfma_f32_16x16x32_bf16 a[88:91], a[232:235], v[220:223], a[88:91]
  ds_read_b128 a[184:187], v254 offset:26624
  v_cvt_pk_bf16_f32 v204, v164, v165
  v_exp_f32 v166, v166
  v_mfma_f32_16x16x32_bf16 a[88:91], a[248:251], v[236:239], a[88:91]
  ds_read_b128 a[188:191], v254 offset:27648
  v_mfma_f32_16x16x32_bf16 a[120:123], a[232:235], v[224:227], a[120:123]
  v_exp_f32 v167, v167
  v_mfma_f32_16x16x32_bf16 a[120:123], a[248:251], v[240:243], a[120:123]
  buffer_load_dwordx4 v4, s[12:15], s33 offen offset:2048 sc1 lds
  v_exp_f32 v168, v168
  v_cvt_pk_bf16_f32 v205, v166, v167
  v_mfma_f32_16x16x32_bf16 a[124:127], a[236:239], v[224:227], a[124:127]
  v_exp_f32 v169, v169
  v_mfma_f32_16x16x32_bf16 a[124:127], a[252:255], v[240:243], a[124:127]
  buffer_load_dwordx4 v4, s[12:15], s33 offen offset:3072 sc1 lds
  v_mfma_f32_16x16x32_bf16 a[92:95], a[236:239], v[220:223], a[92:95]
  s_waitcnt lgkmcnt(0)
  v_cvt_pk_bf16_f32 v206, v168, v169
  v_mfma_f32_16x16x32_bf16 a[92:95], a[252:255], v[236:239], a[92:95]
  v_exp_f32 v170, v170
  v_exp_f32 v171, v171
  s_nop 0
  v_cvt_pk_bf16_f32 v207, v170, v171
  v_mfma_f32_16x16x32_bf16 v[172:175], a[128:131], v[100:103], v[48:51]
  ds_read_b128 a[224:227], v254 offset:20480
  v_cmp_gt_i32_e64 s[48:49], 0, v6
  v_mfma_f32_16x16x32_bf16 v[172:175], a[132:135], v[104:107], v[172:175]
  v_cmp_gt_i32_e64 s[50:51], 1, v6
  v_cndmask_b32_e64 v140, v140, v7, s[48:49]
  v_mfma_f32_16x16x32_bf16 v[172:175], a[136:139], v[108:111], v[172:175]
  v_exp_f32 v140, v140
  v_mfma_f32_16x16x32_bf16 v[172:175], a[140:143], v[112:115], v[172:175]
  ds_read_b128 a[228:231], v254 offset:21504
  s_add_u32 s33, s30, 49152
  v_mfma_f32_16x16x32_bf16 v[176:179], a[144:147], v[100:103], v[48:51]
  ds_read_b128 a[232:235], v254 offset:22528
  v_cmp_gt_i32_e64 s[52:53], 2, v6
  v_mfma_f32_16x16x32_bf16 v[176:179], a[148:151], v[104:107], v[176:179]
  v_cndmask_b32_e64 v141, v141, v7, s[50:51]
  v_cndmask_b32_e64 v142, v142, v7, s[52:53]
  v_mfma_f32_16x16x32_bf16 v[176:179], a[152:155], v[108:111], v[176:179]
  v_exp_f32 v141, v141
  v_mfma_f32_16x16x32_bf16 v[176:179], a[156:159], v[112:115], v[176:179]
  ds_read_b128 a[236:239], v254 offset:23552
  v_cmp_gt_i32_e64 s[54:55], 3, v6
  v_mfma_f32_16x16x32_bf16 a[64:67], a[160:163], v[188:191], a[64:67]
  v_cvt_pk_bf16_f32 v224, v140, v141
  v_cndmask_b32_e64 v143, v143, v7, s[54:55]
  v_mfma_f32_16x16x32_bf16 a[64:67], a[176:179], v[204:207], a[64:67]
  ds_read_b128 a[240:243], v254 offset:28672
  s_add_u32 m0, s29, 49152
  v_mfma_f32_16x16x32_bf16 a[96:99], a[160:163], v[192:195], a[96:99]
  v_cmp_gt_i32_e64 s[48:49], 16, v6
  v_cmp_gt_i32_e64 s[50:51], 17, v6
  v_mfma_f32_16x16x32_bf16 a[96:99], a[176:179], v[208:211], a[96:99]
  v_exp_f32 v142, v142
  v_cndmask_b32_e64 v144, v144, v7, s[48:49]
  v_mfma_f32_16x16x32_bf16 a[100:103], a[164:167], v[192:195], a[100:103]
  ds_read_b128 a[244:247], v254 offset:29696
  v_cndmask_b32_e64 v145, v145, v7, s[50:51]
  v_mfma_f32_16x16x32_bf16 a[100:103], a[180:183], v[208:211], a[100:103]
  ds_read_b128 a[248:251], v254 offset:30720
  v_cmp_gt_i32_e64 s[52:53], 18, v6
  v_mfma_f32_16x16x32_bf16 a[68:71], a[164:167], v[188:191], a[68:71]
  buffer_load_dwordx4 v4, s[12:15], s33 offen offset:0 sc1 lds
  v_exp_f32 v143, v143
  v_cmp_gt_i32_e64 s[54:55], 19, v6
  v_cndmask_b32_e64 v146, v146, v7, s[52:53]
  v_mfma_f32_16x16x32_bf16 a[68:71], a[180:183], v[204:207], a[68:71]
  ds_read_b128 a[252:255], v254 offset:31744
  v_cvt_pk_bf16_f32 v225, v142, v143
  v_cndmask_b32_e64 v147, v147, v7, s[54:55]
  v_mfma_f32_16x16x32_bf16 v[28:31], v[16:19], v[188:191], v[28:31]
  buffer_load_dwordx4 v4, s[12:15], s33 offen offset:1024 sc1 lds
  v_mfma_f32_16x16x32_bf16 v[28:31], v[16:19], v[204:207], v[28:31]
  v_exp_f32 v144, v144
  v_mfma_f32_16x16x32_bf16 a[72:75], a[168:171], v[188:191], a[72:75]
  v_exp_f32 v145, v145
  v_mfma_f32_16x16x32_bf16 a[72:75], a[184:187], v[204:207], a[72:75]
  buffer_load_dwordx4 v4, s[12:15], s33 offen offset:2048 sc1 lds
  v_mfma_f32_16x16x32_bf16 a[104:107], a[168:171], v[192:195], a[104:107]
  v_cvt_pk_bf16_f32 v226, v144, v145
  v_mfma_f32_16x16x32_bf16 a[104:107], a[184:187], v[208:211], a[104:107]
  v_exp_f32 v146, v146
  v_mfma_f32_16x16x32_bf16 a[108:111], a[172:175], v[192:195], a[108:111]
  buffer_load_dwordx4 v4, s[12:15], s33 offen offset:3072 sc1 lds
  v_mfma_f32_16x16x32_bf16 a[108:111], a[188:191], v[208:211], a[108:111]
  v_exp_f32 v147, v147
  v_mfma_f32_16x16x32_bf16 a[76:79], a[172:175], v[188:191], a[76:79]
  s_waitcnt vmcnt(16) lgkmcnt(0)
  s_barrier
  v_mfma_f32_16x16x32_bf16 a[76:79], a[188:191], v[204:207], a[76:79]
  v_cvt_pk_bf16_f32 v227, v146, v147
  s_nop 1
  v_mfma_f32_16x16x32_bf16 a[80:83], a[224:227], v[188:191], a[80:83]
  ds_read_b128 a[160:163], v254 offset:49152
  v_cmp_gt_i32_e64 s[48:49], 32, v6
  v_mfma_f32_16x16x32_bf16 a[80:83], a[240:243], v[204:207], a[80:83]
  ds_read_b128 a[164:167], v254 offset:50176
  s_add_u32 s33, s30, 65536
  v_mfma_f32_16x16x32_bf16 a[112:115], a[224:227], v[192:195], a[112:115]
  ds_read_b128 a[168:171], v254 offset:51200
  v_cmp_gt_i32_e64 s[50:51], 33, v6
  v_mfma_f32_16x16x32_bf16 a[112:115], a[240:243], v[208:211], a[112:115]
  ds_read_b128 a[172:175], v254 offset:52224
  v_cndmask_b32_e64 v172, v172, v7, s[48:49]
  v_mfma_f32_16x16x32_bf16 a[116:119], a[228:231], v[192:195], a[116:119]
  v_exp_f32 v172, v172
  s_add_u32 m0, s29, 0
  v_mfma_f32_16x16x32_bf16 a[116:119], a[244:247], v[208:211], a[116:119]
  ds_read_b128 a[176:179], v254 offset:57344
  v_cmp_gt_i32_e64 s[52:53], 34, v6
  v_cndmask_b32_e64 v173, v173, v7, s[50:51]
  v_mfma_f32_16x16x32_bf16 a[84:87], a[228:231], v[188:191], a[84:87]
  buffer_load_dwordx4 v4, s[12:15], s33 offen offset:0 sc1 lds
  v_exp_f32 v173, v173
  v_cmp_gt_i32_e64 s[54:55], 35, v6
  v_cndmask_b32_e64 v174, v174, v7, s[52:53]
  v_mfma_f32_16x16x32_bf16 a[84:87], a[244:247], v[204:207], a[84:87]
  buffer_load_dwordx4 v4, s[12:15], s33 offen offset:1024 sc1 lds
  v_cvt_pk_bf16_f32 v240, v172, v173
  v_cmp_gt_i32_e64 s[48:49], 48, v6
  v_cndmask_b32_e64 v175, v175, v7, s[54:55]
  v_mfma_f32_16x16x32_bf16 v[32:35], v[16:19], v[192:195], v[32:35]
  buffer_load_dwordx4 v4, s[12:15], s33 offen offset:2048 sc1 lds
  v_exp_f32 v174, v174
  v_cmp_gt_i32_e64 s[50:51], 49, v6
  v_cndmask_b32_e64 v176, v176, v7, s[48:49]
  v_mfma_f32_16x16x32_bf16 v[32:35], v[16:19], v[208:211], v[32:35]
  ds_read_b128 a[180:183], v254 offset:58368
  v_cmp_gt_i32_e64 s[52:53], 50, v6
  v_cndmask_b32_e64 v177, v177, v7, s[50:51]
  v_mfma_f32_16x16x32_bf16 a[88:91], a[232:235], v[188:191], a[88:91]
  buffer_load_dwordx4 v4, s[12:15], s33 offen offset:3072 sc1 lds
  ds_read_b128 a[184:187], v254 offset:59392
  v_exp_f32 v175, v175
  v_cmp_gt_i32_e64 s[54:55], 51, v6
  v_cndmask_b32_e64 v178, v178, v7, s[52:53]
  s_add_u32 s33, s30, 81920
  v_mfma_f32_16x16x32_bf16 a[88:91], a[248:251], v[204:207], a[88:91]
  ds_read_b128 a[188:191], v254 offset:60416
  v_cvt_pk_bf16_f32 v241, v174, v175
  v_cndmask_b32_e64 v179, v179, v7, s[54:55]
  s_add_u32 m0, s29, 16384
  v_mfma_f32_16x16x32_bf16 a[120:123], a[232:235], v[192:195], a[120:123]
  v_exp_f32 v176, v176
  v_mfma_f32_16x16x32_bf16 a[120:123], a[248:251], v[208:211], a[120:123]
  buffer_load_dwordx4 v4, s[12:15], s33 offen offset:0 sc1 lds
  buffer_load_dwordx4 v4, s[12:15], s33 offen offset:1024 sc1 lds
  v_mfma_f32_16x16x32_bf16 a[124:127], a[236:239], v[192:195], a[124:127]
  v_exp_f32 v177, v177
  v_mfma_f32_16x16x32_bf16 a[124:127], a[252:255], v[208:211], a[124:127]
  buffer_load_dwordx4 v4, s[12:15], s33 offen offset:2048 sc1 lds
  v_cvt_pk_bf16_f32 v242, v176, v177
  v_mfma_f32_16x16x32_bf16 a[92:95], a[236:239], v[188:191], a[92:95]
  s_waitcnt lgkmcnt(0)
  v_mfma_f32_16x16x32_bf16 a[92:95], a[252:255], v[204:207], a[92:95]
  buffer_load_dwordx4 v4, s[12:15], s33 offen offset:3072 sc1 lds
  v_exp_f32 v178, v178
  v_exp_f32 v179, v179
  s_nop 0
  v_cvt_pk_bf16_f32 v243, v178, v179
  ds_read_b128 a[224:227], v254 offset:53248
  ds_read_b128 a[228:231], v254 offset:54272
  ds_read_b128 a[232:235], v254 offset:55296
  ds_read_b128 a[236:239], v254 offset:56320
  ds_read_b128 a[240:243], v254 offset:61440
  ds_read_b128 a[244:247], v254 offset:62464
  ds_read_b128 a[248:251], v254 offset:63488
  ds_read_b128 a[252:255], v254 offset:64512
  v_mfma_f32_16x16x32_bf16 a[96:99], a[160:163], v[224:227], a[96:99]
  v_mfma_f32_16x16x32_bf16 a[96:99], a[176:179], v[240:243], a[96:99]
  v_mfma_f32_16x16x32_bf16 a[100:103], a[164:167], v[224:227], a[100:103]
  v_mfma_f32_16x16x32_bf16 a[100:103], a[180:183], v[240:243], a[100:103]
  v_mfma_f32_16x16x32_bf16 v[32:35], v[16:19], v[224:227], v[32:35]
  v_mfma_f32_16x16x32_bf16 v[32:35], v[16:19], v[240:243], v[32:35]
  v_mfma_f32_16x16x32_bf16 a[104:107], a[168:171], v[224:227], a[104:107]
  v_mfma_f32_16x16x32_bf16 a[104:107], a[184:187], v[240:243], a[104:107]
  v_mfma_f32_16x16x32_bf16 a[108:111], a[172:175], v[224:227], a[108:111]
  v_mfma_f32_16x16x32_bf16 a[108:111], a[188:191], v[240:243], a[108:111]
  s_waitcnt lgkmcnt(0)
  v_mfma_f32_16x16x32_bf16 a[112:115], a[224:227], v[224:227], a[112:115]
  v_mfma_f32_16x16x32_bf16 a[112:115], a[240:243], v[240:243], a[112:115]
  v_mfma_f32_16x16x32_bf16 a[116:119], a[228:231], v[224:227], a[116:119]
  v_mfma_f32_16x16x32_bf16 a[116:119], a[244:247], v[240:243], a[116:119]
  v_mfma_f32_16x16x32_bf16 a[120:123], a[232:235], v[224:227], a[120:123]
  v_mfma_f32_16x16x32_bf16 a[120:123], a[248:251], v[240:243], a[120:123]
  v_mfma_f32_16x16x32_bf16 a[124:127], a[236:239], v[224:227], a[124:127]
  v_mfma_f32_16x16x32_bf16 a[124:127], a[252:255], v[240:243], a[124:127]
  s_barrier
  s_mov_b32 s40, 0x5f800000
  s_mov_b32 s41, 0x1f800000
  s_nop 5
  v_cmp_nlt_f32_e64 s[42:43], v28, s40
  v_cmp_nlt_f32_e64 s[44:45], v32, s40
  v_cmp_ngt_f32_e64 s[46:47], v28, s41
  v_cmp_ngt_f32_e64 s[48:49], v32, s41
  s_nop 1
  s_or_b64 s[42:43], s[42:43], s[44:45]
  s_or_b64 s[46:47], s[46:47], s[48:49]
  s_or_b64 s[42:43], s[42:43], s[46:47]
  s_cbranch_scc1 adaLN_cond__compressed_kv_cla__mixer_channel_mlp__prompt_kernel_slowhi
adaLN_cond__compressed_kv_cla__mixer_channel_mlp__prompt_kernel_hiep:
  s_add_u32 s49, s30, 4096
  buffer_load_dwordx4 a[160:163], v4, s[12:15], s49 offen offset:0 sc1
  buffer_load_dwordx4 a[164:167], v4, s[12:15], s49 offen offset:1024 sc1
  buffer_load_dwordx4 a[168:171], v4, s[12:15], s49 offen offset:2048 sc1
  buffer_load_dwordx4 a[172:175], v4, s[12:15], s49 offen offset:3072 sc1
  s_add_u32 s49, s30, 8192
  buffer_load_dwordx4 a[176:179], v4, s[12:15], s49 offen offset:0 sc1
  buffer_load_dwordx4 a[180:183], v4, s[12:15], s49 offen offset:1024 sc1
  buffer_load_dwordx4 a[184:187], v4, s[12:15], s49 offen offset:2048 sc1
  buffer_load_dwordx4 a[188:191], v4, s[12:15], s49 offen offset:3072 sc1
  s_add_u32 s49, s30, 12288
  buffer_load_dwordx4 a[192:195], v4, s[12:15], s49 offen offset:0 sc1
  buffer_load_dwordx4 a[196:199], v4, s[12:15], s49 offen offset:1024 sc1
  buffer_load_dwordx4 a[200:203], v4, s[12:15], s49 offen offset:2048 sc1
  buffer_load_dwordx4 a[204:207], v4, s[12:15], s49 offen offset:3072 sc1
  s_add_u32 s49, s30, 20480
  buffer_load_dwordx4 a[208:211], v4, s[12:15], s49 offen offset:0 sc1
  buffer_load_dwordx4 a[212:215], v4, s[12:15], s49 offen offset:1024 sc1
  buffer_load_dwordx4 a[216:219], v4, s[12:15], s49 offen offset:2048 sc1
  buffer_load_dwordx4 a[220:223], v4, s[12:15], s49 offen offset:3072 sc1
  v_rcp_f32 v248, v28
  v_rcp_f32 v249, v32
  v_accvgpr_read_b32 v8, a64
  v_accvgpr_read_b32 v9, a65
  v_accvgpr_read_b32 v10, a66
  v_accvgpr_read_b32 v11, a67
  v_accvgpr_read_b32 v12, a68
  v_accvgpr_read_b32 v13, a69
  v_accvgpr_read_b32 v14, a70
  v_accvgpr_read_b32 v15, a71
  v_pk_mul_f32 v[8:9], v[8:9], v[248:249] op_sel:[0,0] op_sel_hi:[1,0]
  v_pk_mul_f32 v[10:11], v[10:11], v[248:249] op_sel:[0,0] op_sel_hi:[1,0]
  v_pk_mul_f32 v[12:13], v[12:13], v[248:249] op_sel:[0,0] op_sel_hi:[1,0]
  v_pk_mul_f32 v[14:15], v[14:15], v[248:249] op_sel:[0,0] op_sel_hi:[1,0]
  v_cvt_pk_bf16_f32 v8, v8, v9
  v_cvt_pk_bf16_f32 v9, v10, v11
  v_cvt_pk_bf16_f32 v10, v12, v13
  v_cvt_pk_bf16_f32 v11, v14, v15
  buffer_store_dwordx4 v[8:11], v4, s[12:15], s36 offen offset:0 sc1
  v_accvgpr_read_b32 v212, a72
  v_accvgpr_read_b32 v213, a73
  v_accvgpr_read_b32 v214, a74
  v_accvgpr_read_b32 v215, a75
  v_accvgpr_read_b32 v216, a76
  v_accvgpr_read_b32 v217, a77
  v_accvgpr_read_b32 v218, a78
  v_accvgpr_read_b32 v219, a79
  v_pk_mul_f32 v[212:213], v[212:213], v[248:249] op_sel:[0,0] op_sel_hi:[1,0]
  v_pk_mul_f32 v[214:215], v[214:215], v[248:249] op_sel:[0,0] op_sel_hi:[1,0]
  v_pk_mul_f32 v[216:217], v[216:217], v[248:249] op_sel:[0,0] op_sel_hi:[1,0]
  v_pk_mul_f32 v[218:219], v[218:219], v[248:249] op_sel:[0,0] op_sel_hi:[1,0]
  v_cvt_pk_bf16_f32 v212, v212, v213
  v_cvt_pk_bf16_f32 v213, v214, v215
  v_cvt_pk_bf16_f32 v214, v216, v217
  v_cvt_pk_bf16_f32 v215, v218, v219
  buffer_store_dwordx4 v[212:215], v4, s[12:15], s36 offen offset:1024 sc1
  v_accvgpr_read_b32 v8, a80
  v_accvgpr_read_b32 v9, a81
  v_accvgpr_read_b32 v10, a82
  v_accvgpr_read_b32 v11, a83
  v_accvgpr_read_b32 v12, a84
  v_accvgpr_read_b32 v13, a85
  v_accvgpr_read_b32 v14, a86
  v_accvgpr_read_b32 v15, a87
  v_pk_mul_f32 v[8:9], v[8:9], v[248:249] op_sel:[0,0] op_sel_hi:[1,0]
  v_pk_mul_f32 v[10:11], v[10:11], v[248:249] op_sel:[0,0] op_sel_hi:[1,0]
  v_pk_mul_f32 v[12:13], v[12:13], v[248:249] op_sel:[0,0] op_sel_hi:[1,0]
  v_pk_mul_f32 v[14:15], v[14:15], v[248:249] op_sel:[0,0] op_sel_hi:[1,0]
  v_cvt_pk_bf16_f32 v8, v8, v9
  v_cvt_pk_bf16_f32 v9, v10, v11
  v_cvt_pk_bf16_f32 v10, v12, v13
  v_cvt_pk_bf16_f32 v11, v14, v15
  buffer_store_dwordx4 v[8:11], v4, s[12:15], s36 offen offset:2048 sc1
  v_accvgpr_read_b32 v212, a88
  v_accvgpr_read_b32 v213, a89
  v_accvgpr_read_b32 v214, a90
  v_accvgpr_read_b32 v215, a91
  v_accvgpr_read_b32 v216, a92
  v_accvgpr_read_b32 v217, a93
  v_accvgpr_read_b32 v218, a94
  v_accvgpr_read_b32 v219, a95
  v_pk_mul_f32 v[212:213], v[212:213], v[248:249] op_sel:[0,0] op_sel_hi:[1,0]
  v_pk_mul_f32 v[214:215], v[214:215], v[248:249] op_sel:[0,0] op_sel_hi:[1,0]
  v_pk_mul_f32 v[216:217], v[216:217], v[248:249] op_sel:[0,0] op_sel_hi:[1,0]
  v_pk_mul_f32 v[218:219], v[218:219], v[248:249] op_sel:[0,0] op_sel_hi:[1,0]
  v_cvt_pk_bf16_f32 v212, v212, v213
  v_cvt_pk_bf16_f32 v213, v214, v215
  v_cvt_pk_bf16_f32 v214, v216, v217
  v_cvt_pk_bf16_f32 v215, v218, v219
  buffer_store_dwordx4 v[212:215], v4, s[12:15], s36 offen offset:3072 sc1
  v_accvgpr_read_b32 v8, a96
  v_accvgpr_read_b32 v9, a97
  v_accvgpr_read_b32 v10, a98
  v_accvgpr_read_b32 v11, a99
  v_accvgpr_read_b32 v12, a100
  v_accvgpr_read_b32 v13, a101
  v_accvgpr_read_b32 v14, a102
  v_accvgpr_read_b32 v15, a103
  v_pk_mul_f32 v[8:9], v[8:9], v[248:249] op_sel:[0,1] op_sel_hi:[1,1]
  v_pk_mul_f32 v[10:11], v[10:11], v[248:249] op_sel:[0,1] op_sel_hi:[1,1]
  v_pk_mul_f32 v[12:13], v[12:13], v[248:249] op_sel:[0,1] op_sel_hi:[1,1]
  v_pk_mul_f32 v[14:15], v[14:15], v[248:249] op_sel:[0,1] op_sel_hi:[1,1]
  v_cvt_pk_bf16_f32 v8, v8, v9
  v_cvt_pk_bf16_f32 v9, v10, v11
  v_cvt_pk_bf16_f32 v10, v12, v13
  v_cvt_pk_bf16_f32 v11, v14, v15
  buffer_store_dwordx4 v[8:11], v4, s[12:15], s37 offen offset:0 sc1
  v_accvgpr_read_b32 v212, a104
  v_accvgpr_read_b32 v213, a105
  v_accvgpr_read_b32 v214, a106
  v_accvgpr_read_b32 v215, a107
  v_accvgpr_read_b32 v216, a108
  v_accvgpr_read_b32 v217, a109
  v_accvgpr_read_b32 v218, a110
  v_accvgpr_read_b32 v219, a111
  v_pk_mul_f32 v[212:213], v[212:213], v[248:249] op_sel:[0,1] op_sel_hi:[1,1]
  v_pk_mul_f32 v[214:215], v[214:215], v[248:249] op_sel:[0,1] op_sel_hi:[1,1]
  v_pk_mul_f32 v[216:217], v[216:217], v[248:249] op_sel:[0,1] op_sel_hi:[1,1]
  v_pk_mul_f32 v[218:219], v[218:219], v[248:249] op_sel:[0,1] op_sel_hi:[1,1]
  v_cvt_pk_bf16_f32 v212, v212, v213
  v_cvt_pk_bf16_f32 v213, v214, v215
  v_cvt_pk_bf16_f32 v214, v216, v217
  v_cvt_pk_bf16_f32 v215, v218, v219
  buffer_store_dwordx4 v[212:215], v4, s[12:15], s37 offen offset:1024 sc1
  v_accvgpr_read_b32 v8, a112
  v_accvgpr_read_b32 v9, a113
  v_accvgpr_read_b32 v10, a114
  v_accvgpr_read_b32 v11, a115
  v_accvgpr_read_b32 v12, a116
  v_accvgpr_read_b32 v13, a117
  v_accvgpr_read_b32 v14, a118
  v_accvgpr_read_b32 v15, a119
  v_pk_mul_f32 v[8:9], v[8:9], v[248:249] op_sel:[0,1] op_sel_hi:[1,1]
  v_pk_mul_f32 v[10:11], v[10:11], v[248:249] op_sel:[0,1] op_sel_hi:[1,1]
  v_pk_mul_f32 v[12:13], v[12:13], v[248:249] op_sel:[0,1] op_sel_hi:[1,1]
  v_pk_mul_f32 v[14:15], v[14:15], v[248:249] op_sel:[0,1] op_sel_hi:[1,1]
  v_cvt_pk_bf16_f32 v8, v8, v9
  v_cvt_pk_bf16_f32 v9, v10, v11
  v_cvt_pk_bf16_f32 v10, v12, v13
  v_cvt_pk_bf16_f32 v11, v14, v15
  buffer_store_dwordx4 v[8:11], v4, s[12:15], s37 offen offset:2048 sc1
  v_accvgpr_read_b32 v212, a120
  v_accvgpr_read_b32 v213, a121
  v_accvgpr_read_b32 v214, a122
  v_accvgpr_read_b32 v215, a123
  v_accvgpr_read_b32 v216, a124
  v_accvgpr_read_b32 v217, a125
  v_accvgpr_read_b32 v218, a126
  v_accvgpr_read_b32 v219, a127
  v_pk_mul_f32 v[212:213], v[212:213], v[248:249] op_sel:[0,1] op_sel_hi:[1,1]
  v_pk_mul_f32 v[214:215], v[214:215], v[248:249] op_sel:[0,1] op_sel_hi:[1,1]
  v_pk_mul_f32 v[216:217], v[216:217], v[248:249] op_sel:[0,1] op_sel_hi:[1,1]
  v_pk_mul_f32 v[218:219], v[218:219], v[248:249] op_sel:[0,1] op_sel_hi:[1,1]
  v_cvt_pk_bf16_f32 v212, v212, v213
  v_cvt_pk_bf16_f32 v213, v214, v215
  v_cvt_pk_bf16_f32 v214, v216, v217
  v_cvt_pk_bf16_f32 v215, v218, v219
  buffer_store_dwordx4 v[212:215], v4, s[12:15], s37 offen offset:3072 sc1
adaLN_cond__compressed_kv_cla__mixer_channel_mlp__prompt_kernel_back:
  s_add_u32 s49, s30, 24576
  buffer_load_dwordx4 a[224:227], v4, s[12:15], s49 offen offset:0 sc1
  buffer_load_dwordx4 a[228:231], v4, s[12:15], s49 offen offset:1024 sc1
  buffer_load_dwordx4 a[232:235], v4, s[12:15], s49 offen offset:2048 sc1
  buffer_load_dwordx4 a[236:239], v4, s[12:15], s49 offen offset:3072 sc1
  s_add_u32 s49, s30, 28672
  buffer_load_dwordx4 a[240:243], v4, s[12:15], s49 offen offset:0 sc1
  buffer_load_dwordx4 a[244:247], v4, s[12:15], s49 offen offset:1024 sc1
  buffer_load_dwordx4 a[248:251], v4, s[12:15], s49 offen offset:2048 sc1
  buffer_load_dwordx4 a[252:255], v4, s[12:15], s49 offen offset:3072 sc1
  s_add_u32 s40, s20, 0
  s_and_b32 s40, s40, 3
  s_mul_i32 s40, s40, 131072
  v_add_u32 v232, s40, v4
  s_add_u32 s40, s20, 1
  s_and_b32 s40, s40, 3
  s_mul_i32 s40, s40, 131072
  v_add_u32 v233, s40, v4
  s_add_u32 s40, s20, 2
  s_and_b32 s40, s40, 3
  s_mul_i32 s40, s40, 131072
  v_add_u32 v234, s40, v4
  s_add_u32 s40, s20, 3
  s_and_b32 s40, s40, 3
  s_mul_i32 s40, s40, 131072
  v_add_u32 v235, s40, v4
  v_lshrrev_b32 v14, 4, v1
  s_lshl_b32 s40, s98, 2
  s_add_u32 s38, s40, s20
  s_lshl_b32 s41, s38, 14
  s_lshl_b32 s42, s23, 7
  s_add_u32 s41, s41, s42
  v_and_b32 v18, 15, v1
  v_lshlrev_b32 v18, 10, v18
  v_lshl_add_u32 v18, v14, 3, v18
  v_add_u32 v236, s41, v18
  s_lshl_b32 s41, s23, 8
  v_lshlrev_b32 v18, 4, v14
  v_add_u32 v237, s41, v18
  v_add_u32 v242, 0x10000, v4
  v_add_u32 v228, s29, v4
  v_add_u32 v229, 0x20000, v228
  s_lshl_b32 s33, s98, 19
  s_lshl_b32 s41, s20, 15
  s_add_u32 s33, s33, s41
  s_add_u32 s33, s33, 0x2000000
  s_lshl_b32 s40, s22, 9
  s_lshl_b32 s41, s21, 4
  s_add_u32 s41, s41, 0x3f02000
  s_add_u32 s46, s41, s40
  s_sub_u32 s40, 7680, s40
  s_add_u32 s47, s41, s40
  s_lshr_b32 s48, s98, 1
  s_lshl_b32 s48, s48, 9
  s_add_u32 s48, s48, 0x3f02000
  s_lshl_b32 s40, s20, 7
  s_add_u32 s48, s48, s40
  v_and_b32 v5, 7, v1
  v_lshlrev_b32 v5, 4, v5
  s_waitcnt vmcnt(8)
  s_barrier
  v_mov_b32 v6, s76
  v_mov_b32 v7, s77
  buffer_store_dwordx2 v[6:7], v0, s[12:15], s46 offen sc1
  buffer_store_dwordx2 v[6:7], v0, s[12:15], s47 offen sc1
  buffer_store_dwordx2 v[6:7], v0, s[12:15], s89 offen sc1
  s_mul_i32 s40, s23, 229376
  s_mul_i32 s41, s20, 57344
  s_add_u32 s40, s40, s41
  s_add_u32 s32, s40, 0x1600000
  s_mul_i32 s40, s23, 7
  s_lshl_b32 s41, s20, 1
  s_add_u32 s40, s40, s41
  s_lshl_b32 s40, s40, 15
  s_add_u32 s31, s40, 0x1400000
  s_cmp_eq_u32 s20, 3
  s_mov_b32 s40, 0x8000
  s_cselect_b32 s40, 0x10000000, s40
  s_add_u32 s24, s31, s40
  ds_read_b128 a[128:131], v229 offset:0
  ds_read_b128 a[132:135], v229 offset:1024
  ds_read_b128 a[136:139], v229 offset:2048
  ds_read_b128 a[140:143], v229 offset:3072
  s_add_u32 s49, s30, 36864
  buffer_load_dwordx4 v[144:147], v4, s[12:15], s49 offen offset:0 sc1
  buffer_load_dwordx4 v[148:151], v4, s[12:15], s49 offen offset:1024 sc1
  buffer_load_dwordx4 v[152:155], v4, s[12:15], s49 offen offset:2048 sc1
  buffer_load_dwordx4 v[156:159], v4, s[12:15], s49 offen offset:3072 sc1
  s_add_u32 s49, s30, 40960
  buffer_load_dwordx4 v[160:163], v4, s[12:15], s49 offen offset:0 sc1
  buffer_load_dwordx4 v[164:167], v4, s[12:15], s49 offen offset:1024 sc1
  buffer_load_dwordx4 v[168:171], v4, s[12:15], s49 offen offset:2048 sc1
  buffer_load_dwordx4 v[172:175], v4, s[12:15], s49 offen offset:3072 sc1
  s_add_u32 s49, s30, 45056
  buffer_load_dwordx4 v[176:179], v4, s[12:15], s49 offen offset:0 sc1
  buffer_load_dwordx4 v[180:183], v4, s[12:15], s49 offen offset:1024 sc1
  buffer_load_dwordx4 v[184:187], v4, s[12:15], s49 offen offset:2048 sc1
  buffer_load_dwordx4 v[188:191], v4, s[12:15], s49 offen offset:3072 sc1
  s_add_u32 s49, s30, 53248
  buffer_load_dwordx4 v[192:195], v4, s[12:15], s49 offen offset:0 sc1
  buffer_load_dwordx4 v[196:199], v4, s[12:15], s49 offen offset:1024 sc1
  buffer_load_dwordx4 v[200:203], v4, s[12:15], s49 offen offset:2048 sc1
  buffer_load_dwordx4 v[204:207], v4, s[12:15], s49 offen offset:3072 sc1
  s_add_u32 s49, s30, 57344
  buffer_load_dwordx4 v[208:211], v4, s[12:15], s49 offen offset:0 sc1
  buffer_load_dwordx4 v[212:215], v4, s[12:15], s49 offen offset:1024 sc1
  buffer_load_dwordx4 v[216:219], v4, s[12:15], s49 offen offset:2048 sc1
  buffer_load_dwordx4 v[220:223], v4, s[12:15], s49 offen offset:3072 sc1
  s_add_u32 s49, s30, 61440
  buffer_load_dwordx4 v[80:83], v4, s[12:15], s49 offen offset:0 sc1
  buffer_load_dwordx4 v[84:87], v4, s[12:15], s49 offen offset:1024 sc1
  buffer_load_dwordx4 v[88:91], v4, s[12:15], s49 offen offset:2048 sc1
  buffer_load_dwordx4 v[92:95], v4, s[12:15], s49 offen offset:3072 sc1
  s_add_u32 s49, s30, 69632
  buffer_load_dwordx4 v[96:99], v4, s[12:15], s49 offen offset:0 sc1
  buffer_load_dwordx4 v[100:103], v4, s[12:15], s49 offen offset:1024 sc1
  buffer_load_dwordx4 v[104:107], v4, s[12:15], s49 offen offset:2048 sc1
  buffer_load_dwordx4 v[108:111], v4, s[12:15], s49 offen offset:3072 sc1
  s_add_u32 s49, s30, 73728
  buffer_load_dwordx4 v[112:115], v4, s[12:15], s49 offen offset:0 sc1
  buffer_load_dwordx4 v[116:119], v4, s[12:15], s49 offen offset:1024 sc1
  buffer_load_dwordx4 v[120:123], v4, s[12:15], s49 offen offset:2048 sc1
  buffer_load_dwordx4 v[124:127], v4, s[12:15], s49 offen offset:3072 sc1
  s_add_u32 s49, s30, 77824
  buffer_load_dwordx4 v[128:131], v4, s[12:15], s49 offen offset:0 sc1
  buffer_load_dwordx4 v[132:135], v4, s[12:15], s49 offen offset:1024 sc1
  buffer_load_dwordx4 v[136:139], v4, s[12:15], s49 offen offset:2048 sc1
  buffer_load_dwordx4 v[140:143], v4, s[12:15], s49 offen offset:3072 sc1
  s_add_u32 s49, s30, 86016
  buffer_load_dwordx4 a[96:99], v4, s[12:15], s49 offen offset:0 sc1
  buffer_load_dwordx4 a[100:103], v4, s[12:15], s49 offen offset:1024 sc1
  buffer_load_dwordx4 a[104:107], v4, s[12:15], s49 offen offset:2048 sc1
  buffer_load_dwordx4 a[108:111], v4, s[12:15], s49 offen offset:3072 sc1
  s_add_u32 s49, s30, 90112
  buffer_load_dwordx4 a[112:115], v4, s[12:15], s49 offen offset:0 sc1
  buffer_load_dwordx4 a[116:119], v4, s[12:15], s49 offen offset:1024 sc1
  buffer_load_dwordx4 a[120:123], v4, s[12:15], s49 offen offset:2048 sc1
  buffer_load_dwordx4 a[124:127], v4, s[12:15], s49 offen offset:3072 sc1
  buffer_load_dwordx2 v[6:7], v5, s[12:15], s48 offen sc1
  s_waitcnt vmcnt(0)
  s_mov_b32 s40, 0
  v_cmp_ne_u64 vcc, s[76:77], v[6:7]
  s_nop 0
  s_cbranch_vccz adaLN_cond__compressed_kv_cla__mixer_channel_mlp__prompt_kernel_ok1
adaLN_cond__compressed_kv_cla__mixer_channel_mlp__prompt_kernel_sp2:
  s_sleep 2
  buffer_load_dwordx2 v[6:7], v5, s[12:15], s48 offen sc1
  s_waitcnt vmcnt(0)
  s_add_u32 s40, s40, 1
  v_cmp_ne_u64 vcc, s[76:77], v[6:7]
  s_nop 0
  s_cbranch_vccz adaLN_cond__compressed_kv_cla__mixer_channel_mlp__prompt_kernel_ok1
  s_cmp_lt_u32 s40, 0x4000
  s_cbranch_scc1 adaLN_cond__compressed_kv_cla__mixer_channel_mlp__prompt_kernel_sp2
adaLN_cond__compressed_kv_cla__mixer_channel_mlp__prompt_kernel_ok1:
  buffer_load_dwordx4 a[0:3], v232, s[12:15], s33 offen offset:0 sc1
  buffer_load_dwordx4 a[4:7], v233, s[12:15], s33 offen offset:0 sc1
  buffer_load_dwordx4 a[8:11], v234, s[12:15], s33 offen offset:0 sc1
  buffer_load_dwordx4 a[12:15], v235, s[12:15], s33 offen offset:0 sc1
  buffer_load_dwordx4 a[16:19], v232, s[12:15], s33 offen offset:1024 sc1
  buffer_load_dwordx4 a[20:23], v233, s[12:15], s33 offen offset:1024 sc1
  buffer_load_dwordx4 a[24:27], v234, s[12:15], s33 offen offset:1024 sc1
  buffer_load_dwordx4 a[28:31], v235, s[12:15], s33 offen offset:1024 sc1
  s_waitcnt vmcnt(4)
  s_waitcnt lgkmcnt(0)
  v_mfma_f32_16x16x32_bf16 v[16:19], a[128:131], a[0:3], 0
  s_add_u32 s49, s30, 94208
  s_add_u32 m0, s29, 131072
  v_mfma_f32_16x16x32_bf16 v[20:23], a[132:135], a[0:3], 0
  buffer_load_dwordx4 v4, s[12:15], s49 offen offset:0 sc1 lds
  v_mfma_f32_16x16x32_bf16 v[24:27], a[136:139], a[0:3], 0
  buffer_load_dwordx4 v4, s[12:15], s49 offen offset:1024 sc1 lds
  v_mfma_f32_16x16x32_bf16 v[28:31], a[140:143], a[0:3], 0
  buffer_load_dwordx4 v4, s[12:15], s49 offen offset:2048 sc1 lds
  v_mfma_f32_16x16x32_bf16 v[32:35], a[128:131], a[4:7], 0
  buffer_load_dwordx4 v4, s[12:15], s49 offen offset:3072 sc1 lds
  v_mfma_f32_16x16x32_bf16 v[36:39], a[132:135], a[4:7], 0
  buffer_load_dwordx4 a[32:35], v232, s[12:15], s33 offen offset:2048 sc1
  v_mfma_f32_16x16x32_bf16 v[40:43], a[136:139], a[4:7], 0
  buffer_load_dwordx4 a[36:39], v233, s[12:15], s33 offen offset:2048 sc1
  v_mfma_f32_16x16x32_bf16 v[44:47], a[140:143], a[4:7], 0
  buffer_load_dwordx4 a[40:43], v234, s[12:15], s33 offen offset:2048 sc1
  v_mfma_f32_16x16x32_bf16 v[48:51], a[128:131], a[8:11], 0
  buffer_load_dwordx4 a[44:47], v235, s[12:15], s33 offen offset:2048 sc1
  v_mfma_f32_16x16x32_bf16 v[52:55], a[132:135], a[8:11], 0
  buffer_load_dwordx4 a[48:51], v232, s[12:15], s33 offen offset:3072 sc1
  v_mfma_f32_16x16x32_bf16 v[56:59], a[136:139], a[8:11], 0
  buffer_load_dwordx4 a[52:55], v233, s[12:15], s33 offen offset:3072 sc1
  v_mfma_f32_16x16x32_bf16 v[60:63], a[140:143], a[8:11], 0
  buffer_load_dwordx4 a[56:59], v234, s[12:15], s33 offen offset:3072 sc1
  v_mfma_f32_16x16x32_bf16 v[64:67], a[128:131], a[12:15], 0
  buffer_load_dwordx4 a[60:63], v235, s[12:15], s33 offen offset:3072 sc1
  v_mfma_f32_16x16x32_bf16 v[68:71], a[132:135], a[12:15], 0
  s_add_u32 s33, s33, 4096
  v_mfma_f32_16x16x32_bf16 v[72:75], a[136:139], a[12:15], 0
  v_mfma_f32_16x16x32_bf16 v[76:79], a[140:143], a[12:15], 0
  s_waitcnt vmcnt(12)
  s_waitcnt lgkmcnt(0)
  v_mfma_f32_16x16x32_bf16 v[16:19], a[160:163], a[16:19], v[16:19]
  buffer_load_dwordx4 a[64:67], v232, s[12:15], s33 offen offset:0 sc1
  v_mfma_f32_16x16x32_bf16 v[20:23], a[164:167], a[16:19], v[20:23]
  buffer_load_dwordx4 a[68:71], v233, s[12:15], s33 offen offset:0 sc1
  v_mfma_f32_16x16x32_bf16 v[24:27], a[168:171], a[16:19], v[24:27]
  buffer_load_dwordx4 a[72:75], v234, s[12:15], s33 offen offset:0 sc1
  v_mfma_f32_16x16x32_bf16 v[28:31], a[172:175], a[16:19], v[28:31]
  buffer_load_dwordx4 a[76:79], v235, s[12:15], s33 offen offset:0 sc1
  v_mfma_f32_16x16x32_bf16 v[32:35], a[160:163], a[20:23], v[32:35]
  buffer_load_dwordx4 a[80:83], v232, s[12:15], s33 offen offset:1024 sc1
  v_mfma_f32_16x16x32_bf16 v[36:39], a[164:167], a[20:23], v[36:39]
  buffer_load_dwordx4 a[84:87], v233, s[12:15], s33 offen offset:1024 sc1
  v_mfma_f32_16x16x32_bf16 v[40:43], a[168:171], a[20:23], v[40:43]
  buffer_load_dwordx4 a[88:91], v234, s[12:15], s33 offen offset:1024 sc1
  v_mfma_f32_16x16x32_bf16 v[44:47], a[172:175], a[20:23], v[44:47]
  buffer_load_dwordx4 a[92:95], v235, s[12:15], s33 offen offset:1024 sc1
  v_mfma_f32_16x16x32_bf16 v[48:51], a[160:163], a[24:27], v[48:51]
  v_mfma_f32_16x16x32_bf16 v[52:55], a[164:167], a[24:27], v[52:55]
  v_mfma_f32_16x16x32_bf16 v[56:59], a[168:171], a[24:27], v[56:59]
  v_mfma_f32_16x16x32_bf16 v[60:63], a[172:175], a[24:27], v[60:63]
  v_mfma_f32_16x16x32_bf16 v[64:67], a[160:163], a[28:31], v[64:67]
  v_mfma_f32_16x16x32_bf16 v[68:71], a[164:167], a[28:31], v[68:71]
  v_mfma_f32_16x16x32_bf16 v[72:75], a[168:171], a[28:31], v[72:75]
  v_mfma_f32_16x16x32_bf16 v[76:79], a[172:175], a[28:31], v[76:79]
  s_waitcnt vmcnt(12)
  s_waitcnt lgkmcnt(0)
  v_mfma_f32_16x16x32_bf16 v[16:19], a[176:179], a[32:35], v[16:19]
  buffer_load_dwordx4 a[0:3], v232, s[12:15], s33 offen offset:2048 sc1
  v_mfma_f32_16x16x32_bf16 v[20:23], a[180:183], a[32:35], v[20:23]
  buffer_load_dwordx4 a[4:7], v233, s[12:15], s33 offen offset:2048 sc1
  v_mfma_f32_16x16x32_bf16 v[24:27], a[184:187], a[32:35], v[24:27]
  buffer_load_dwordx4 a[8:11], v234, s[12:15], s33 offen offset:2048 sc1
  v_mfma_f32_16x16x32_bf16 v[28:31], a[188:191], a[32:35], v[28:31]
  buffer_load_dwordx4 a[12:15], v235, s[12:15], s33 offen offset:2048 sc1
  v_mfma_f32_16x16x32_bf16 v[32:35], a[176:179], a[36:39], v[32:35]
  buffer_load_dwordx4 a[16:19], v232, s[12:15], s33 offen offset:3072 sc1
  v_mfma_f32_16x16x32_bf16 v[36:39], a[180:183], a[36:39], v[36:39]
  buffer_load_dwordx4 a[20:23], v233, s[12:15], s33 offen offset:3072 sc1
  v_mfma_f32_16x16x32_bf16 v[40:43], a[184:187], a[36:39], v[40:43]
  buffer_load_dwordx4 a[24:27], v234, s[12:15], s33 offen offset:3072 sc1
  v_mfma_f32_16x16x32_bf16 v[44:47], a[188:191], a[36:39], v[44:47]
  buffer_load_dwordx4 a[28:31], v235, s[12:15], s33 offen offset:3072 sc1
  v_mfma_f32_16x16x32_bf16 v[48:51], a[176:179], a[40:43], v[48:51]
  s_add_u32 s33, s33, 4096
  v_mfma_f32_16x16x32_bf16 v[52:55], a[180:183], a[40:43], v[52:55]
  v_mfma_f32_16x16x32_bf16 v[56:59], a[184:187], a[40:43], v[56:59]
  v_mfma_f32_16x16x32_bf16 v[60:63], a[188:191], a[40:43], v[60:63]
  v_mfma_f32_16x16x32_bf16 v[64:67], a[176:179], a[44:47], v[64:67]
  v_mfma_f32_16x16x32_bf16 v[68:71], a[180:183], a[44:47], v[68:71]
  v_mfma_f32_16x16x32_bf16 v[72:75], a[184:187], a[44:47], v[72:75]
  v_mfma_f32_16x16x32_bf16 v[76:79], a[188:191], a[44:47], v[76:79]
  s_waitcnt vmcnt(16)
  s_waitcnt lgkmcnt(0)
  v_mfma_f32_16x16x32_bf16 v[16:19], a[192:195], a[48:51], v[16:19]
  buffer_load_dwordx4 a[32:35], v232, s[12:15], s33 offen offset:0 sc1
  v_mfma_f32_16x16x32_bf16 v[20:23], a[196:199], a[48:51], v[20:23]
  buffer_load_dwordx4 a[36:39], v233, s[12:15], s33 offen offset:0 sc1
  v_mfma_f32_16x16x32_bf16 v[24:27], a[200:203], a[48:51], v[24:27]
  ds_read_b128 a[144:147], v229 offset:16384
  ds_read_b128 a[148:151], v229 offset:17408
  v_mfma_f32_16x16x32_bf16 v[28:31], a[204:207], a[48:51], v[28:31]
  buffer_load_dwordx4 a[40:43], v234, s[12:15], s33 offen offset:0 sc1
  v_mfma_f32_16x16x32_bf16 v[32:35], a[192:195], a[52:55], v[32:35]
  buffer_load_dwordx4 a[44:47], v235, s[12:15], s33 offen offset:0 sc1
  v_mfma_f32_16x16x32_bf16 v[36:39], a[196:199], a[52:55], v[36:39]
  buffer_load_dwordx4 a[48:51], v232, s[12:15], s33 offen offset:1024 sc1
  v_mfma_f32_16x16x32_bf16 v[40:43], a[200:203], a[52:55], v[40:43]
  ds_read_b128 a[152:155], v229 offset:18432
  ds_read_b128 a[156:159], v229 offset:19456
  v_mfma_f32_16x16x32_bf16 v[44:47], a[204:207], a[52:55], v[44:47]
  buffer_load_dwordx4 a[52:55], v233, s[12:15], s33 offen offset:1024 sc1
  v_mfma_f32_16x16x32_bf16 v[48:51], a[192:195], a[56:59], v[48:51]
  v_mfma_f32_16x16x32_bf16 v[52:55], a[196:199], a[56:59], v[52:55]
  v_mfma_f32_16x16x32_bf16 v[56:59], a[200:203], a[56:59], v[56:59]
  v_mfma_f32_16x16x32_bf16 v[60:63], a[204:207], a[56:59], v[60:63]
  buffer_load_dwordx4 a[56:59], v234, s[12:15], s33 offen offset:1024 sc1
  v_mfma_f32_16x16x32_bf16 v[64:67], a[192:195], a[60:63], v[64:67]
  v_mfma_f32_16x16x32_bf16 v[68:71], a[196:199], a[60:63], v[68:71]
  v_mfma_f32_16x16x32_bf16 v[72:75], a[200:203], a[60:63], v[72:75]
  v_mfma_f32_16x16x32_bf16 v[76:79], a[204:207], a[60:63], v[76:79]
  buffer_load_dwordx4 a[60:63], v235, s[12:15], s33 offen offset:1024 sc1
  s_waitcnt vmcnt(20)
  s_waitcnt lgkmcnt(0)
  v_mfma_f32_16x16x32_bf16 v[16:19], a[144:147], a[64:67], v[16:19]
  s_add_u32 s49, s30, 98304
  s_add_u32 m0, s29, 147456
  v_mfma_f32_16x16x32_bf16 v[20:23], a[148:151], a[64:67], v[20:23]
  buffer_load_dwordx4 v4, s[12:15], s49 offen offset:0 sc1 lds
  v_mfma_f32_16x16x32_bf16 v[24:27], a[152:155], a[64:67], v[24:27]
  buffer_load_dwordx4 v4, s[12:15], s49 offen offset:1024 sc1 lds
  v_mfma_f32_16x16x32_bf16 v[28:31], a[156:159], a[64:67], v[28:31]
  buffer_load_dwordx4 v4, s[12:15], s49 offen offset:2048 sc1 lds
  v_mfma_f32_16x16x32_bf16 v[32:35], a[144:147], a[68:71], v[32:35]
  buffer_load_dwordx4 v4, s[12:15], s49 offen offset:3072 sc1 lds
  v_mfma_f32_16x16x32_bf16 v[36:39], a[148:151], a[68:71], v[36:39]
  buffer_load_dwordx4 a[64:67], v232, s[12:15], s33 offen offset:2048 sc1
  v_mfma_f32_16x16x32_bf16 v[40:43], a[152:155], a[68:71], v[40:43]
  v_mfma_f32_16x16x32_bf16 v[44:47], a[156:159], a[68:71], v[44:47]
  buffer_load_dwordx4 a[68:71], v233, s[12:15], s33 offen offset:2048 sc1
  v_mfma_f32_16x16x32_bf16 v[48:51], a[144:147], a[72:75], v[48:51]
  v_mfma_f32_16x16x32_bf16 v[52:55], a[148:151], a[72:75], v[52:55]
  v_mfma_f32_16x16x32_bf16 v[56:59], a[152:155], a[72:75], v[56:59]
  v_mfma_f32_16x16x32_bf16 v[60:63], a[156:159], a[72:75], v[60:63]
  buffer_load_dwordx4 a[72:75], v234, s[12:15], s33 offen offset:2048 sc1
  v_mfma_f32_16x16x32_bf16 v[64:67], a[144:147], a[76:79], v[64:67]
  v_mfma_f32_16x16x32_bf16 v[68:71], a[148:151], a[76:79], v[68:71]
  v_mfma_f32_16x16x32_bf16 v[72:75], a[152:155], a[76:79], v[72:75]
  v_mfma_f32_16x16x32_bf16 v[76:79], a[156:159], a[76:79], v[76:79]
  buffer_load_dwordx4 a[76:79], v235, s[12:15], s33 offen offset:2048 sc1
  s_waitcnt vmcnt(24)
  s_waitcnt lgkmcnt(0)
  v_mfma_f32_16x16x32_bf16 v[16:19], a[208:211], a[80:83], v[16:19]
  v_mfma_f32_16x16x32_bf16 v[20:23], a[212:215], a[80:83], v[20:23]
  v_mfma_f32_16x16x32_bf16 v[24:27], a[216:219], a[80:83], v[24:27]
  v_mfma_f32_16x16x32_bf16 v[28:31], a[220:223], a[80:83], v[28:31]
  buffer_load_dwordx4 a[80:83], v232, s[12:15], s33 offen offset:3072 sc1
  v_mfma_f32_16x16x32_bf16 v[32:35], a[208:211], a[84:87], v[32:35]
  v_mfma_f32_16x16x32_bf16 v[36:39], a[212:215], a[84:87], v[36:39]
  v_mfma_f32_16x16x32_bf16 v[40:43], a[216:219], a[84:87], v[40:43]
  v_mfma_f32_16x16x32_bf16 v[44:47], a[220:223], a[84:87], v[44:47]
  buffer_load_dwordx4 a[84:87], v233, s[12:15], s33 offen offset:3072 sc1
  v_mfma_f32_16x16x32_bf16 v[48:51], a[208:211], a[88:91], v[48:51]
  v_mfma_f32_16x16x32_bf16 v[52:55], a[212:215], a[88:91], v[52:55]
  v_mfma_f32_16x16x32_bf16 v[56:59], a[216:219], a[88:91], v[56:59]
  v_mfma_f32_16x16x32_bf16 v[60:63], a[220:223], a[88:91], v[60:63]
  buffer_load_dwordx4 a[88:91], v234, s[12:15], s33 offen offset:3072 sc1
  v_mfma_f32_16x16x32_bf16 v[64:67], a[208:211], a[92:95], v[64:67]
  v_mfma_f32_16x16x32_bf16 v[68:71], a[212:215], a[92:95], v[68:71]
  v_mfma_f32_16x16x32_bf16 v[72:75], a[216:219], a[92:95], v[72:75]
  v_mfma_f32_16x16x32_bf16 v[76:79], a[220:223], a[92:95], v[76:79]
  buffer_load_dwordx4 a[92:95], v235, s[12:15], s33 offen offset:3072 sc1
  s_add_u32 s33, s33, 4096
  s_waitcnt vmcnt(24)
  s_waitcnt lgkmcnt(0)
  v_mfma_f32_16x16x32_bf16 v[16:19], a[224:227], a[0:3], v[16:19]
  v_mfma_f32_16x16x32_bf16 v[20:23], a[228:231], a[0:3], v[20:23]
  v_mfma_f32_16x16x32_bf16 v[24:27], a[232:235], a[0:3], v[24:27]
  v_mfma_f32_16x16x32_bf16 v[28:31], a[236:239], a[0:3], v[28:31]
  buffer_load_dwordx4 a[0:3], v232, s[12:15], s33 offen offset:0 sc1
  v_mfma_f32_16x16x32_bf16 v[32:35], a[224:227], a[4:7], v[32:35]
  v_mfma_f32_16x16x32_bf16 v[36:39], a[228:231], a[4:7], v[36:39]
  v_mfma_f32_16x16x32_bf16 v[40:43], a[232:235], a[4:7], v[40:43]
  v_mfma_f32_16x16x32_bf16 v[44:47], a[236:239], a[4:7], v[44:47]
  buffer_load_dwordx4 a[4:7], v233, s[12:15], s33 offen offset:0 sc1
  v_mfma_f32_16x16x32_bf16 v[48:51], a[224:227], a[8:11], v[48:51]
  v_mfma_f32_16x16x32_bf16 v[52:55], a[228:231], a[8:11], v[52:55]
  v_mfma_f32_16x16x32_bf16 v[56:59], a[232:235], a[8:11], v[56:59]
  v_mfma_f32_16x16x32_bf16 v[60:63], a[236:239], a[8:11], v[60:63]
  buffer_load_dwordx4 a[8:11], v234, s[12:15], s33 offen offset:0 sc1
  v_mfma_f32_16x16x32_bf16 v[64:67], a[224:227], a[12:15], v[64:67]
  v_mfma_f32_16x16x32_bf16 v[68:71], a[228:231], a[12:15], v[68:71]
  v_mfma_f32_16x16x32_bf16 v[72:75], a[232:235], a[12:15], v[72:75]
  v_mfma_f32_16x16x32_bf16 v[76:79], a[236:239], a[12:15], v[76:79]
  buffer_load_dwordx4 a[12:15], v235, s[12:15], s33 offen offset:0 sc1
  s_waitcnt vmcnt(24)
  s_waitcnt lgkmcnt(0)
  v_mfma_f32_16x16x32_bf16 v[16:19], a[240:243], a[16:19], v[16:19]
  ds_read_b128 a[128:131], v228 offset:32768
  v_mfma_f32_16x16x32_bf16 v[20:23], a[244:247], a[16:19], v[20:23]
  v_mfma_f32_16x16x32_bf16 v[24:27], a[248:251], a[16:19], v[24:27]
  ds_read_b128 a[132:135], v228 offset:33792
  v_mfma_f32_16x16x32_bf16 v[28:31], a[252:255], a[16:19], v[28:31]
  buffer_load_dwordx4 a[16:19], v232, s[12:15], s33 offen offset:1024 sc1
  v_mfma_f32_16x16x32_bf16 v[32:35], a[240:243], a[20:23], v[32:35]
  ds_read_b128 a[136:139], v228 offset:34816
  v_mfma_f32_16x16x32_bf16 v[36:39], a[244:247], a[20:23], v[36:39]
  v_mfma_f32_16x16x32_bf16 v[40:43], a[248:251], a[20:23], v[40:43]
  ds_read_b128 a[140:143], v228 offset:35840
  v_mfma_f32_16x16x32_bf16 v[44:47], a[252:255], a[20:23], v[44:47]
  buffer_load_dwordx4 a[20:23], v233, s[12:15], s33 offen offset:1024 sc1
  v_mfma_f32_16x16x32_bf16 v[48:51], a[240:243], a[24:27], v[48:51]
  v_mfma_f32_16x16x32_bf16 v[52:55], a[244:247], a[24:27], v[52:55]
  v_mfma_f32_16x16x32_bf16 v[56:59], a[248:251], a[24:27], v[56:59]
  v_mfma_f32_16x16x32_bf16 v[60:63], a[252:255], a[24:27], v[60:63]
  buffer_load_dwordx4 a[24:27], v234, s[12:15], s33 offen offset:1024 sc1
  v_mfma_f32_16x16x32_bf16 v[64:67], a[240:243], a[28:31], v[64:67]
  v_mfma_f32_16x16x32_bf16 v[68:71], a[244:247], a[28:31], v[68:71]
  v_mfma_f32_16x16x32_bf16 v[72:75], a[248:251], a[28:31], v[72:75]
  v_mfma_f32_16x16x32_bf16 v[76:79], a[252:255], a[28:31], v[76:79]
  buffer_load_dwordx4 a[28:31], v235, s[12:15], s33 offen offset:1024 sc1
  s_waitcnt vmcnt(24)
  s_waitcnt lgkmcnt(0)
  v_mfma_f32_16x16x32_bf16 v[16:19], a[128:131], a[32:35], v[16:19]
  s_add_u32 s49, s30, 102400
  s_add_u32 m0, s29, 32768
  v_mfma_f32_16x16x32_bf16 v[20:23], a[132:135], a[32:35], v[20:23]
  buffer_load_dwordx4 v4, s[12:15], s49 offen offset:0 sc1 lds
  v_mfma_f32_16x16x32_bf16 v[24:27], a[136:139], a[32:35], v[24:27]
  buffer_load_dwordx4 v4, s[12:15], s49 offen offset:1024 sc1 lds
  v_mfma_f32_16x16x32_bf16 v[28:31], a[140:143], a[32:35], v[28:31]
  buffer_load_dwordx4 v4, s[12:15], s49 offen offset:2048 sc1 lds
  v_mfma_f32_16x16x32_bf16 v[32:35], a[128:131], a[36:39], v[32:35]
  buffer_load_dwordx4 v4, s[12:15], s49 offen offset:3072 sc1 lds
  v_mfma_f32_16x16x32_bf16 v[36:39], a[132:135], a[36:39], v[36:39]
  buffer_load_dwordx4 a[32:35], v232, s[12:15], s33 offen offset:2048 sc1
  v_mfma_f32_16x16x32_bf16 v[40:43], a[136:139], a[36:39], v[40:43]
  v_mfma_f32_16x16x32_bf16 v[44:47], a[140:143], a[36:39], v[44:47]
  buffer_load_dwordx4 a[36:39], v233, s[12:15], s33 offen offset:2048 sc1
  v_mfma_f32_16x16x32_bf16 v[48:51], a[128:131], a[40:43], v[48:51]
  v_mfma_f32_16x16x32_bf16 v[52:55], a[132:135], a[40:43], v[52:55]
  v_mfma_f32_16x16x32_bf16 v[56:59], a[136:139], a[40:43], v[56:59]
  v_mfma_f32_16x16x32_bf16 v[60:63], a[140:143], a[40:43], v[60:63]
  buffer_load_dwordx4 a[40:43], v234, s[12:15], s33 offen offset:2048 sc1
  v_mfma_f32_16x16x32_bf16 v[64:67], a[128:131], a[44:47], v[64:67]
  v_mfma_f32_16x16x32_bf16 v[68:71], a[132:135], a[44:47], v[68:71]
  v_mfma_f32_16x16x32_bf16 v[72:75], a[136:139], a[44:47], v[72:75]
  v_mfma_f32_16x16x32_bf16 v[76:79], a[140:143], a[44:47], v[76:79]
  buffer_load_dwordx4 a[44:47], v235, s[12:15], s33 offen offset:2048 sc1
  s_waitcnt vmcnt(28)
  s_waitcnt lgkmcnt(0)
  v_mfma_f32_16x16x32_bf16 v[16:19], v[144:147], a[48:51], v[16:19]
  v_mfma_f32_16x16x32_bf16 v[20:23], v[148:151], a[48:51], v[20:23]
  v_mfma_f32_16x16x32_bf16 v[24:27], v[152:155], a[48:51], v[24:27]
  v_mfma_f32_16x16x32_bf16 v[28:31], v[156:159], a[48:51], v[28:31]
  buffer_load_dwordx4 a[48:51], v232, s[12:15], s33 offen offset:3072 sc1
  v_mfma_f32_16x16x32_bf16 v[32:35], v[144:147], a[52:55], v[32:35]
  v_mfma_f32_16x16x32_bf16 v[36:39], v[148:151], a[52:55], v[36:39]
  v_mfma_f32_16x16x32_bf16 v[40:43], v[152:155], a[52:55], v[40:43]
  v_mfma_f32_16x16x32_bf16 v[44:47], v[156:159], a[52:55], v[44:47]
  buffer_load_dwordx4 a[52:55], v233, s[12:15], s33 offen offset:3072 sc1
  v_mfma_f32_16x16x32_bf16 v[48:51], v[144:147], a[56:59], v[48:51]
  v_mfma_f32_16x16x32_bf16 v[52:55], v[148:151], a[56:59], v[52:55]
  v_mfma_f32_16x16x32_bf16 v[56:59], v[152:155], a[56:59], v[56:59]
  v_mfma_f32_16x16x32_bf16 v[60:63], v[156:159], a[56:59], v[60:63]
  buffer_load_dwordx4 a[56:59], v234, s[12:15], s33 offen offset:3072 sc1
  v_mfma_f32_16x16x32_bf16 v[64:67], v[144:147], a[60:63], v[64:67]
  v_mfma_f32_16x16x32_bf16 v[68:71], v[148:151], a[60:63], v[68:71]
  v_mfma_f32_16x16x32_bf16 v[72:75], v[152:155], a[60:63], v[72:75]
  v_mfma_f32_16x16x32_bf16 v[76:79], v[156:159], a[60:63], v[76:79]
  buffer_load_dwordx4 a[60:63], v235, s[12:15], s33 offen offset:3072 sc1
  s_add_u32 s33, s33, 4096
  s_waitcnt vmcnt(24)
  s_waitcnt lgkmcnt(0)
  v_mfma_f32_16x16x32_bf16 v[16:19], v[160:163], a[64:67], v[16:19]
  v_mfma_f32_16x16x32_bf16 v[20:23], v[164:167], a[64:67], v[20:23]
  v_mfma_f32_16x16x32_bf16 v[24:27], v[168:171], a[64:67], v[24:27]
  v_mfma_f32_16x16x32_bf16 v[28:31], v[172:175], a[64:67], v[28:31]
  buffer_load_dwordx4 a[64:67], v232, s[12:15], s33 offen offset:0 sc1
  v_mfma_f32_16x16x32_bf16 v[32:35], v[160:163], a[68:71], v[32:35]
  v_mfma_f32_16x16x32_bf16 v[36:39], v[164:167], a[68:71], v[36:39]
  v_mfma_f32_16x16x32_bf16 v[40:43], v[168:171], a[68:71], v[40:43]
  v_mfma_f32_16x16x32_bf16 v[44:47], v[172:175], a[68:71], v[44:47]
  buffer_load_dwordx4 a[68:71], v233, s[12:15], s33 offen offset:0 sc1
  v_mfma_f32_16x16x32_bf16 v[48:51], v[160:163], a[72:75], v[48:51]
  v_mfma_f32_16x16x32_bf16 v[52:55], v[164:167], a[72:75], v[52:55]
  v_mfma_f32_16x16x32_bf16 v[56:59], v[168:171], a[72:75], v[56:59]
  v_mfma_f32_16x16x32_bf16 v[60:63], v[172:175], a[72:75], v[60:63]
  buffer_load_dwordx4 a[72:75], v234, s[12:15], s33 offen offset:0 sc1
  v_mfma_f32_16x16x32_bf16 v[64:67], v[160:163], a[76:79], v[64:67]
  v_mfma_f32_16x16x32_bf16 v[68:71], v[164:167], a[76:79], v[68:71]
  v_mfma_f32_16x16x32_bf16 v[72:75], v[168:171], a[76:79], v[72:75]
  v_mfma_f32_16x16x32_bf16 v[76:79], v[172:175], a[76:79], v[76:79]
  buffer_load_dwordx4 a[76:79], v235, s[12:15], s33 offen offset:0 sc1
  s_waitcnt vmcnt(24)
  s_waitcnt lgkmcnt(0)
  v_mfma_f32_16x16x32_bf16 v[16:19], v[176:179], a[80:83], v[16:19]
  ds_read_b128 a[144:147], v228 offset:49152
  v_mfma_f32_16x16x32_bf16 v[20:23], v[180:183], a[80:83], v[20:23]
  v_mfma_f32_16x16x32_bf16 v[24:27], v[184:187], a[80:83], v[24:27]
  ds_read_b128 a[148:151], v228 offset:50176
  v_mfma_f32_16x16x32_bf16 v[28:31], v[188:191], a[80:83], v[28:31]
  buffer_load_dwordx4 a[80:83], v232, s[12:15], s33 offen offset:1024 sc1
  v_mfma_f32_16x16x32_bf16 v[32:35], v[176:179], a[84:87], v[32:35]
  ds_read_b128 a[152:155], v228 offset:51200
  v_mfma_f32_16x16x32_bf16 v[36:39], v[180:183], a[84:87], v[36:39]
  v_mfma_f32_16x16x32_bf16 v[40:43], v[184:187], a[84:87], v[40:43]
  ds_read_b128 a[156:159], v228 offset:52224
  v_mfma_f32_16x16x32_bf16 v[44:47], v[188:191], a[84:87], v[44:47]
  buffer_load_dwordx4 a[84:87], v233, s[12:15], s33 offen offset:1024 sc1
  v_mfma_f32_16x16x32_bf16 v[48:51], v[176:179], a[88:91], v[48:51]
  v_mfma_f32_16x16x32_bf16 v[52:55], v[180:183], a[88:91], v[52:55]
  v_mfma_f32_16x16x32_bf16 v[56:59], v[184:187], a[88:91], v[56:59]
  v_mfma_f32_16x16x32_bf16 v[60:63], v[188:191], a[88:91], v[60:63]
  buffer_load_dwordx4 a[88:91], v234, s[12:15], s33 offen offset:1024 sc1
  v_mfma_f32_16x16x32_bf16 v[64:67], v[176:179], a[92:95], v[64:67]
  v_mfma_f32_16x16x32_bf16 v[68:71], v[180:183], a[92:95], v[68:71]
  v_mfma_f32_16x16x32_bf16 v[72:75], v[184:187], a[92:95], v[72:75]
  v_mfma_f32_16x16x32_bf16 v[76:79], v[188:191], a[92:95], v[76:79]
  buffer_load_dwordx4 a[92:95], v235, s[12:15], s33 offen offset:1024 sc1
  s_waitcnt vmcnt(24)
  s_waitcnt lgkmcnt(0)
  v_mfma_f32_16x16x32_bf16 v[16:19], a[144:147], a[0:3], v[16:19]
  s_add_u32 s49, s30, 106496
  s_add_u32 m0, s29, 49152
  v_mfma_f32_16x16x32_bf16 v[20:23], a[148:151], a[0:3], v[20:23]
  buffer_load_dwordx4 v4, s[12:15], s49 offen offset:0 sc1 lds
  v_mfma_f32_16x16x32_bf16 v[24:27], a[152:155], a[0:3], v[24:27]
  buffer_load_dwordx4 v4, s[12:15], s49 offen offset:1024 sc1 lds
  v_mfma_f32_16x16x32_bf16 v[28:31], a[156:159], a[0:3], v[28:31]
  buffer_load_dwordx4 v4, s[12:15], s49 offen offset:2048 sc1 lds
  v_mfma_f32_16x16x32_bf16 v[32:35], a[144:147], a[4:7], v[32:35]
  buffer_load_dwordx4 v4, s[12:15], s49 offen offset:3072 sc1 lds
  v_mfma_f32_16x16x32_bf16 v[36:39], a[148:151], a[4:7], v[36:39]
  buffer_load_dwordx4 a[0:3], v232, s[12:15], s33 offen offset:2048 sc1
  v_mfma_f32_16x16x32_bf16 v[40:43], a[152:155], a[4:7], v[40:43]
  v_mfma_f32_16x16x32_bf16 v[44:47], a[156:159], a[4:7], v[44:47]
  buffer_load_dwordx4 a[4:7], v233, s[12:15], s33 offen offset:2048 sc1
  v_mfma_f32_16x16x32_bf16 v[48:51], a[144:147], a[8:11], v[48:51]
  v_mfma_f32_16x16x32_bf16 v[52:55], a[148:151], a[8:11], v[52:55]
  v_mfma_f32_16x16x32_bf16 v[56:59], a[152:155], a[8:11], v[56:59]
  v_mfma_f32_16x16x32_bf16 v[60:63], a[156:159], a[8:11], v[60:63]
  buffer_load_dwordx4 a[8:11], v234, s[12:15], s33 offen offset:2048 sc1
  v_mfma_f32_16x16x32_bf16 v[64:67], a[144:147], a[12:15], v[64:67]
  v_mfma_f32_16x16x32_bf16 v[68:71], a[148:151], a[12:15], v[68:71]
  v_mfma_f32_16x16x32_bf16 v[72:75], a[152:155], a[12:15], v[72:75]
  v_mfma_f32_16x16x32_bf16 v[76:79], a[156:159], a[12:15], v[76:79]
  buffer_load_dwordx4 a[12:15], v235, s[12:15], s33 offen offset:2048 sc1
  s_waitcnt vmcnt(28)
  s_waitcnt lgkmcnt(0)
  v_mfma_f32_16x16x32_bf16 v[16:19], v[192:195], a[16:19], v[16:19]
  v_mfma_f32_16x16x32_bf16 v[20:23], v[196:199], a[16:19], v[20:23]
  v_mfma_f32_16x16x32_bf16 v[24:27], v[200:203], a[16:19], v[24:27]
  v_mfma_f32_16x16x32_bf16 v[28:31], v[204:207], a[16:19], v[28:31]
  buffer_load_dwordx4 a[16:19], v232, s[12:15], s33 offen offset:3072 sc1
  v_mfma_f32_16x16x32_bf16 v[32:35], v[192:195], a[20:23], v[32:35]
  v_mfma_f32_16x16x32_bf16 v[36:39], v[196:199], a[20:23], v[36:39]
  v_mfma_f32_16x16x32_bf16 v[40:43], v[200:203], a[20:23], v[40:43]
  v_mfma_f32_16x16x32_bf16 v[44:47], v[204:207], a[20:23], v[44:47]
  buffer_load_dwordx4 a[20:23], v233, s[12:15], s33 offen offset:3072 sc1
  v_mfma_f32_16x16x32_bf16 v[48:51], v[192:195], a[24:27], v[48:51]
  v_mfma_f32_16x16x32_bf16 v[52:55], v[196:199], a[24:27], v[52:55]
  v_mfma_f32_16x16x32_bf16 v[56:59], v[200:203], a[24:27], v[56:59]
  v_mfma_f32_16x16x32_bf16 v[60:63], v[204:207], a[24:27], v[60:63]
  buffer_load_dwordx4 a[24:27], v234, s[12:15], s33 offen offset:3072 sc1
  v_mfma_f32_16x16x32_bf16 v[64:67], v[192:195], a[28:31], v[64:67]
  v_mfma_f32_16x16x32_bf16 v[68:71], v[196:199], a[28:31], v[68:71]
  v_mfma_f32_16x16x32_bf16 v[72:75], v[200:203], a[28:31], v[72:75]
  v_mfma_f32_16x16x32_bf16 v[76:79], v[204:207], a[28:31], v[76:79]
  buffer_load_dwordx4 a[28:31], v235, s[12:15], s33 offen offset:3072 sc1
  s_add_u32 s33, s33, 4096
  s_waitcnt vmcnt(24)
  s_waitcnt lgkmcnt(0)
  v_mfma_f32_16x16x32_bf16 v[16:19], v[208:211], a[32:35], v[16:19]
  v_mfma_f32_16x16x32_bf16 v[20:23], v[212:215], a[32:35], v[20:23]
  v_mfma_f32_16x16x32_bf16 v[24:27], v[216:219], a[32:35], v[24:27]
  v_mfma_f32_16x16x32_bf16 v[28:31], v[220:223], a[32:35], v[28:31]
  buffer_load_dwordx4 a[32:35], v232, s[12:15], s33 offen offset:0 sc1
  v_mfma_f32_16x16x32_bf16 v[32:35], v[208:211], a[36:39], v[32:35]
  v_mfma_f32_16x16x32_bf16 v[36:39], v[212:215], a[36:39], v[36:39]
  v_mfma_f32_16x16x32_bf16 v[40:43], v[216:219], a[36:39], v[40:43]
  v_mfma_f32_16x16x32_bf16 v[44:47], v[220:223], a[36:39], v[44:47]
  buffer_load_dwordx4 a[36:39], v233, s[12:15], s33 offen offset:0 sc1
  v_mfma_f32_16x16x32_bf16 v[48:51], v[208:211], a[40:43], v[48:51]
  v_mfma_f32_16x16x32_bf16 v[52:55], v[212:215], a[40:43], v[52:55]
  v_mfma_f32_16x16x32_bf16 v[56:59], v[216:219], a[40:43], v[56:59]
  v_mfma_f32_16x16x32_bf16 v[60:63], v[220:223], a[40:43], v[60:63]
  buffer_load_dwordx4 a[40:43], v234, s[12:15], s33 offen offset:0 sc1
  v_mfma_f32_16x16x32_bf16 v[64:67], v[208:211], a[44:47], v[64:67]
  v_mfma_f32_16x16x32_bf16 v[68:71], v[212:215], a[44:47], v[68:71]
  v_mfma_f32_16x16x32_bf16 v[72:75], v[216:219], a[44:47], v[72:75]
  v_mfma_f32_16x16x32_bf16 v[76:79], v[220:223], a[44:47], v[76:79]
  buffer_load_dwordx4 a[44:47], v235, s[12:15], s33 offen offset:0 sc1
  s_waitcnt vmcnt(24)
  s_waitcnt lgkmcnt(0)
  v_mfma_f32_16x16x32_bf16 v[16:19], v[80:83], a[48:51], v[16:19]
  ds_read_b128 a[128:131], v228 offset:0
  v_mfma_f32_16x16x32_bf16 v[20:23], v[84:87], a[48:51], v[20:23]
  v_mfma_f32_16x16x32_bf16 v[24:27], v[88:91], a[48:51], v[24:27]
  ds_read_b128 a[132:135], v228 offset:1024
  v_mfma_f32_16x16x32_bf16 v[28:31], v[92:95], a[48:51], v[28:31]
  buffer_load_dwordx4 a[48:51], v232, s[12:15], s33 offen offset:1024 sc1
  v_mfma_f32_16x16x32_bf16 v[32:35], v[80:83], a[52:55], v[32:35]
  ds_read_b128 a[136:139], v228 offset:2048
  v_mfma_f32_16x16x32_bf16 v[36:39], v[84:87], a[52:55], v[36:39]
  v_mfma_f32_16x16x32_bf16 v[40:43], v[88:91], a[52:55], v[40:43]
  ds_read_b128 a[140:143], v228 offset:3072
  v_mfma_f32_16x16x32_bf16 v[44:47], v[92:95], a[52:55], v[44:47]
  buffer_load_dwordx4 a[52:55], v233, s[12:15], s33 offen offset:1024 sc1
  v_mfma_f32_16x16x32_bf16 v[48:51], v[80:83], a[56:59], v[48:51]
  v_mfma_f32_16x16x32_bf16 v[52:55], v[84:87], a[56:59], v[52:55]
  v_mfma_f32_16x16x32_bf16 v[56:59], v[88:91], a[56:59], v[56:59]
  v_mfma_f32_16x16x32_bf16 v[60:63], v[92:95], a[56:59], v[60:63]
  buffer_load_dwordx4 a[56:59], v234, s[12:15], s33 offen offset:1024 sc1
  v_mfma_f32_16x16x32_bf16 v[64:67], v[80:83], a[60:63], v[64:67]
  v_mfma_f32_16x16x32_bf16 v[68:71], v[84:87], a[60:63], v[68:71]
  v_mfma_f32_16x16x32_bf16 v[72:75], v[88:91], a[60:63], v[72:75]
  v_mfma_f32_16x16x32_bf16 v[76:79], v[92:95], a[60:63], v[76:79]
  buffer_load_dwordx4 a[60:63], v235, s[12:15], s33 offen offset:1024 sc1
  s_waitcnt vmcnt(24)
  s_waitcnt lgkmcnt(0)
  v_mfma_f32_16x16x32_bf16 v[16:19], a[128:131], a[64:67], v[16:19]
  s_add_u32 s49, s30, 110592
  s_add_u32 m0, s29, 0
  v_mfma_f32_16x16x32_bf16 v[20:23], a[132:135], a[64:67], v[20:23]
  buffer_load_dwordx4 v4, s[12:15], s49 offen offset:0 sc1 lds
  v_mfma_f32_16x16x32_bf16 v[24:27], a[136:139], a[64:67], v[24:27]
  buffer_load_dwordx4 v4, s[12:15], s49 offen offset:1024 sc1 lds
  v_mfma_f32_16x16x32_bf16 v[28:31], a[140:143], a[64:67], v[28:31]
  buffer_load_dwordx4 v4, s[12:15], s49 offen offset:2048 sc1 lds
  v_mfma_f32_16x16x32_bf16 v[32:35], a[128:131], a[68:71], v[32:35]
  buffer_load_dwordx4 v4, s[12:15], s49 offen offset:3072 sc1 lds
  v_mfma_f32_16x16x32_bf16 v[36:39], a[132:135], a[68:71], v[36:39]
  buffer_load_dwordx4 a[64:67], v232, s[12:15], s33 offen offset:2048 sc1
  v_mfma_f32_16x16x32_bf16 v[40:43], a[136:139], a[68:71], v[40:43]
  v_mfma_f32_16x16x32_bf16 v[44:47], a[140:143], a[68:71], v[44:47]
  buffer_load_dwordx4 a[68:71], v233, s[12:15], s33 offen offset:2048 sc1
  v_mfma_f32_16x16x32_bf16 v[48:51], a[128:131], a[72:75], v[48:51]
  v_mfma_f32_16x16x32_bf16 v[52:55], a[132:135], a[72:75], v[52:55]
  v_mfma_f32_16x16x32_bf16 v[56:59], a[136:139], a[72:75], v[56:59]
  v_mfma_f32_16x16x32_bf16 v[60:63], a[140:143], a[72:75], v[60:63]
  buffer_load_dwordx4 a[72:75], v234, s[12:15], s33 offen offset:2048 sc1
  v_mfma_f32_16x16x32_bf16 v[64:67], a[128:131], a[76:79], v[64:67]
  v_mfma_f32_16x16x32_bf16 v[68:71], a[132:135], a[76:79], v[68:71]
  v_mfma_f32_16x16x32_bf16 v[72:75], a[136:139], a[76:79], v[72:75]
  v_mfma_f32_16x16x32_bf16 v[76:79], a[140:143], a[76:79], v[76:79]
  buffer_load_dwordx4 a[76:79], v235, s[12:15], s33 offen offset:2048 sc1
  s_waitcnt vmcnt(28)
  s_waitcnt lgkmcnt(0)
  v_mfma_f32_16x16x32_bf16 v[16:19], v[96:99], a[80:83], v[16:19]
  v_mfma_f32_16x16x32_bf16 v[20:23], v[100:103], a[80:83], v[20:23]
  v_mfma_f32_16x16x32_bf16 v[24:27], v[104:107], a[80:83], v[24:27]
  v_mfma_f32_16x16x32_bf16 v[28:31], v[108:111], a[80:83], v[28:31]
  buffer_load_dwordx4 a[80:83], v232, s[12:15], s33 offen offset:3072 sc1
  v_mfma_f32_16x16x32_bf16 v[32:35], v[96:99], a[84:87], v[32:35]
  v_mfma_f32_16x16x32_bf16 v[36:39], v[100:103], a[84:87], v[36:39]
  v_mfma_f32_16x16x32_bf16 v[40:43], v[104:107], a[84:87], v[40:43]
  v_mfma_f32_16x16x32_bf16 v[44:47], v[108:111], a[84:87], v[44:47]
  buffer_load_dwordx4 a[84:87], v233, s[12:15], s33 offen offset:3072 sc1
  v_mfma_f32_16x16x32_bf16 v[48:51], v[96:99], a[88:91], v[48:51]
  v_mfma_f32_16x16x32_bf16 v[52:55], v[100:103], a[88:91], v[52:55]
  v_mfma_f32_16x16x32_bf16 v[56:59], v[104:107], a[88:91], v[56:59]
  v_mfma_f32_16x16x32_bf16 v[60:63], v[108:111], a[88:91], v[60:63]
  buffer_load_dwordx4 a[88:91], v234, s[12:15], s33 offen offset:3072 sc1
  v_mfma_f32_16x16x32_bf16 v[64:67], v[96:99], a[92:95], v[64:67]
  v_mfma_f32_16x16x32_bf16 v[68:71], v[100:103], a[92:95], v[68:71]
  v_mfma_f32_16x16x32_bf16 v[72:75], v[104:107], a[92:95], v[72:75]
  v_mfma_f32_16x16x32_bf16 v[76:79], v[108:111], a[92:95], v[76:79]
  buffer_load_dwordx4 a[92:95], v235, s[12:15], s33 offen offset:3072 sc1
  s_add_u32 s33, s33, 4096
  s_waitcnt vmcnt(24)
  s_waitcnt lgkmcnt(0)
  v_mfma_f32_16x16x32_bf16 v[16:19], v[112:115], a[0:3], v[16:19]
  s_mov_b32 s44, 0x3f08000
  v_mfma_f32_16x16x32_bf16 v[20:23], v[116:119], a[0:3], v[20:23]
  buffer_load_dwordx2 v[8:9], v4, s[12:15], s44 offen offset:2048 sc1
  v_mfma_f32_16x16x32_bf16 v[24:27], v[120:123], a[0:3], v[24:27]
  buffer_load_dwordx2 v[10:11], v4, s[12:15], s44 offen offset:3072 sc1
  v_mfma_f32_16x16x32_bf16 v[28:31], v[124:127], a[0:3], v[28:31]
  buffer_load_dwordx4 a[0:3], v232, s[12:15], s33 offen offset:0 sc1
  v_mfma_f32_16x16x32_bf16 v[32:35], v[112:115], a[4:7], v[32:35]
  v_mfma_f32_16x16x32_bf16 v[36:39], v[116:119], a[4:7], v[36:39]
  v_mfma_f32_16x16x32_bf16 v[40:43], v[120:123], a[4:7], v[40:43]
  v_mfma_f32_16x16x32_bf16 v[44:47], v[124:127], a[4:7], v[44:47]
  buffer_load_dwordx4 a[4:7], v233, s[12:15], s33 offen offset:0 sc1
  v_mfma_f32_16x16x32_bf16 v[48:51], v[112:115], a[8:11], v[48:51]
  v_mfma_f32_16x16x32_bf16 v[52:55], v[116:119], a[8:11], v[52:55]
  v_mfma_f32_16x16x32_bf16 v[56:59], v[120:123], a[8:11], v[56:59]
  v_mfma_f32_16x16x32_bf16 v[60:63], v[124:127], a[8:11], v[60:63]
  buffer_load_dwordx4 a[8:11], v234, s[12:15], s33 offen offset:0 sc1
  v_mfma_f32_16x16x32_bf16 v[64:67], v[112:115], a[12:15], v[64:67]
  v_mfma_f32_16x16x32_bf16 v[68:71], v[116:119], a[12:15], v[68:71]
  v_mfma_f32_16x16x32_bf16 v[72:75], v[120:123], a[12:15], v[72:75]
  v_mfma_f32_16x16x32_bf16 v[76:79], v[124:127], a[12:15], v[76:79]
  buffer_load_dwordx4 a[12:15], v235, s[12:15], s33 offen offset:0 sc1
  s_waitcnt vmcnt(26)
  s_waitcnt lgkmcnt(0)
  v_mfma_f32_16x16x32_bf16 v[16:19], v[128:131], a[16:19], v[16:19]
  ds_read_b128 a[144:147], v228 offset:16384
  v_mfma_f32_16x16x32_bf16 v[20:23], v[132:135], a[16:19], v[20:23]
  v_mfma_f32_16x16x32_bf16 v[24:27], v[136:139], a[16:19], v[24:27]
  ds_read_b128 a[148:151], v228 offset:17408
  v_mfma_f32_16x16x32_bf16 v[28:31], v[140:143], a[16:19], v[28:31]
  buffer_load_dwordx4 a[16:19], v232, s[12:15], s33 offen offset:1024 sc1
  v_mfma_f32_16x16x32_bf16 v[32:35], v[128:131], a[20:23], v[32:35]
  ds_read_b128 a[152:155], v228 offset:18432
  v_mfma_f32_16x16x32_bf16 v[36:39], v[132:135], a[20:23], v[36:39]
  v_mfma_f32_16x16x32_bf16 v[40:43], v[136:139], a[20:23], v[40:43]
  ds_read_b128 a[156:159], v228 offset:19456
  v_mfma_f32_16x16x32_bf16 v[44:47], v[140:143], a[20:23], v[44:47]
  buffer_load_dwordx4 a[20:23], v233, s[12:15], s33 offen offset:1024 sc1
  v_mfma_f32_16x16x32_bf16 v[48:51], v[128:131], a[24:27], v[48:51]
  v_mfma_f32_16x16x32_bf16 v[52:55], v[132:135], a[24:27], v[52:55]
  v_mfma_f32_16x16x32_bf16 v[56:59], v[136:139], a[24:27], v[56:59]
  v_mfma_f32_16x16x32_bf16 v[60:63], v[140:143], a[24:27], v[60:63]
  buffer_load_dwordx4 a[24:27], v234, s[12:15], s33 offen offset:1024 sc1
  v_mfma_f32_16x16x32_bf16 v[64:67], v[128:131], a[28:31], v[64:67]
  v_mfma_f32_16x16x32_bf16 v[68:71], v[132:135], a[28:31], v[68:71]
  v_mfma_f32_16x16x32_bf16 v[72:75], v[136:139], a[28:31], v[72:75]
  v_mfma_f32_16x16x32_bf16 v[76:79], v[140:143], a[28:31], v[76:79]
  buffer_load_dwordx4 a[28:31], v235, s[12:15], s33 offen offset:1024 sc1
  s_waitcnt vmcnt(26)
  s_waitcnt lgkmcnt(0)
  v_mfma_f32_16x16x32_bf16 v[16:19], a[144:147], a[32:35], v[16:19]
  s_add_u32 s49, s30, 114688
  s_add_u32 m0, s29, 16384
  v_mfma_f32_16x16x32_bf16 v[20:23], a[148:151], a[32:35], v[20:23]
  buffer_load_dwordx4 v4, s[12:15], s49 offen offset:0 sc1 lds
  v_mfma_f32_16x16x32_bf16 v[24:27], a[152:155], a[32:35], v[24:27]
  buffer_load_dwordx4 v4, s[12:15], s49 offen offset:1024 sc1 lds
  v_mfma_f32_16x16x32_bf16 v[28:31], a[156:159], a[32:35], v[28:31]
  buffer_load_dwordx4 v4, s[12:15], s49 offen offset:2048 sc1 lds
  v_mfma_f32_16x16x32_bf16 v[32:35], a[144:147], a[36:39], v[32:35]
  buffer_load_dwordx4 v4, s[12:15], s49 offen offset:3072 sc1 lds
  v_mfma_f32_16x16x32_bf16 v[36:39], a[148:151], a[36:39], v[36:39]
  buffer_load_dwordx4 a[32:35], v232, s[12:15], s33 offen offset:2048 sc1
  v_mfma_f32_16x16x32_bf16 v[40:43], a[152:155], a[36:39], v[40:43]
  v_mfma_f32_16x16x32_bf16 v[44:47], a[156:159], a[36:39], v[44:47]
  buffer_load_dwordx4 a[36:39], v233, s[12:15], s33 offen offset:2048 sc1
  v_mfma_f32_16x16x32_bf16 v[48:51], a[144:147], a[40:43], v[48:51]
  v_mfma_f32_16x16x32_bf16 v[52:55], a[148:151], a[40:43], v[52:55]
  v_mfma_f32_16x16x32_bf16 v[56:59], a[152:155], a[40:43], v[56:59]
  v_mfma_f32_16x16x32_bf16 v[60:63], a[156:159], a[40:43], v[60:63]
  buffer_load_dwordx4 a[40:43], v234, s[12:15], s33 offen offset:2048 sc1
  v_mfma_f32_16x16x32_bf16 v[64:67], a[144:147], a[44:47], v[64:67]
  v_mfma_f32_16x16x32_bf16 v[68:71], a[148:151], a[44:47], v[68:71]
  v_mfma_f32_16x16x32_bf16 v[72:75], a[152:155], a[44:47], v[72:75]
  v_mfma_f32_16x16x32_bf16 v[76:79], a[156:159], a[44:47], v[76:79]
  buffer_load_dwordx4 a[44:47], v235, s[12:15], s33 offen offset:2048 sc1
  s_waitcnt vmcnt(30)
  s_waitcnt lgkmcnt(0)
  v_mfma_f32_16x16x32_bf16 v[16:19], a[96:99], a[48:51], v[16:19]
  v_mfma_f32_16x16x32_bf16 v[20:23], a[100:103], a[48:51], v[20:23]
  v_mfma_f32_16x16x32_bf16 v[24:27], a[104:107], a[48:51], v[24:27]
  v_mfma_f32_16x16x32_bf16 v[28:31], a[108:111], a[48:51], v[28:31]
  buffer_load_dwordx4 a[48:51], v232, s[12:15], s33 offen offset:3072 sc1
  v_mfma_f32_16x16x32_bf16 v[32:35], a[96:99], a[52:55], v[32:35]
  v_mfma_f32_16x16x32_bf16 v[36:39], a[100:103], a[52:55], v[36:39]
  v_mfma_f32_16x16x32_bf16 v[40:43], a[104:107], a[52:55], v[40:43]
  v_mfma_f32_16x16x32_bf16 v[44:47], a[108:111], a[52:55], v[44:47]
  buffer_load_dwordx4 a[52:55], v233, s[12:15], s33 offen offset:3072 sc1
  v_mfma_f32_16x16x32_bf16 v[48:51], a[96:99], a[56:59], v[48:51]
  v_mfma_f32_16x16x32_bf16 v[52:55], a[100:103], a[56:59], v[52:55]
  v_mfma_f32_16x16x32_bf16 v[56:59], a[104:107], a[56:59], v[56:59]
  v_mfma_f32_16x16x32_bf16 v[60:63], a[108:111], a[56:59], v[60:63]
  buffer_load_dwordx4 a[56:59], v234, s[12:15], s33 offen offset:3072 sc1
  v_mfma_f32_16x16x32_bf16 v[64:67], a[96:99], a[60:63], v[64:67]
  v_mfma_f32_16x16x32_bf16 v[68:71], a[100:103], a[60:63], v[68:71]
  v_mfma_f32_16x16x32_bf16 v[72:75], a[104:107], a[60:63], v[72:75]
  v_mfma_f32_16x16x32_bf16 v[76:79], a[108:111], a[60:63], v[76:79]
  buffer_load_dwordx4 a[60:63], v235, s[12:15], s33 offen offset:3072 sc1
  s_add_u32 s33, s33, 4096
  s_waitcnt vmcnt(26)
  s_waitcnt lgkmcnt(0)
  v_mfma_f32_16x16x32_bf16 v[16:19], a[112:115], a[64:67], v[16:19]
  ds_read_b128 a[128:131], v229 offset:0
  v_mfma_f32_16x16x32_bf16 v[20:23], a[116:119], a[64:67], v[20:23]
  v_mfma_f32_16x16x32_bf16 v[24:27], a[120:123], a[64:67], v[24:27]
  ds_read_b128 a[132:135], v229 offset:1024
  v_mfma_f32_16x16x32_bf16 v[28:31], a[124:127], a[64:67], v[28:31]
  buffer_load_dwordx4 a[64:67], v232, s[12:15], s33 offen offset:0 sc1
  v_mfma_f32_16x16x32_bf16 v[32:35], a[112:115], a[68:71], v[32:35]
  ds_read_b128 a[136:139], v229 offset:2048
  v_mfma_f32_16x16x32_bf16 v[36:39], a[116:119], a[68:71], v[36:39]
  v_mfma_f32_16x16x32_bf16 v[40:43], a[120:123], a[68:71], v[40:43]
  ds_read_b128 a[140:143], v229 offset:3072
  v_mfma_f32_16x16x32_bf16 v[44:47], a[124:127], a[68:71], v[44:47]
  buffer_load_dwordx4 a[68:71], v233, s[12:15], s33 offen offset:0 sc1
  v_mfma_f32_16x16x32_bf16 v[48:51], a[112:115], a[72:75], v[48:51]
  v_mfma_f32_16x16x32_bf16 v[52:55], a[116:119], a[72:75], v[52:55]
  v_mfma_f32_16x16x32_bf16 v[56:59], a[120:123], a[72:75], v[56:59]
  v_mfma_f32_16x16x32_bf16 v[60:63], a[124:127], a[72:75], v[60:63]
  buffer_load_dwordx4 a[72:75], v234, s[12:15], s33 offen offset:0 sc1
  v_mfma_f32_16x16x32_bf16 v[64:67], a[112:115], a[76:79], v[64:67]
  v_mfma_f32_16x16x32_bf16 v[68:71], a[116:119], a[76:79], v[68:71]
  v_mfma_f32_16x16x32_bf16 v[72:75], a[120:123], a[76:79], v[72:75]
  v_mfma_f32_16x16x32_bf16 v[76:79], a[124:127], a[76:79], v[76:79]
  buffer_load_dwordx4 a[76:79], v235, s[12:15], s33 offen offset:0 sc1
  s_waitcnt vmcnt(26)
  s_waitcnt lgkmcnt(0)
  v_mfma_f32_16x16x32_bf16 v[16:19], a[128:131], a[80:83], v[16:19]
  ds_read_b128 a[144:147], v229 offset:16384
  s_add_u32 s49, s30, 118784
  v_mfma_f32_16x16x32_bf16 v[20:23], a[132:135], a[80:83], v[20:23]
  s_add_u32 m0, s29, 131072
  v_mfma_f32_16x16x32_bf16 v[24:27], a[136:139], a[80:83], v[24:27]
  buffer_load_dwordx4 v4, s[12:15], s49 offen offset:0 sc1 lds
  v_mfma_f32_16x16x32_bf16 v[28:31], a[140:143], a[80:83], v[28:31]
  buffer_load_dwordx4 v4, s[12:15], s49 offen offset:1024 sc1 lds
  v_mfma_f32_16x16x32_bf16 v[32:35], a[128:131], a[84:87], v[32:35]
  ds_read_b128 a[148:151], v229 offset:17408
  ds_read_b128 a[152:155], v229 offset:18432
  v_mfma_f32_16x16x32_bf16 v[36:39], a[132:135], a[84:87], v[36:39]
  buffer_load_dwordx4 v4, s[12:15], s49 offen offset:2048 sc1 lds
  v_mfma_f32_16x16x32_bf16 v[40:43], a[136:139], a[84:87], v[40:43]
  buffer_load_dwordx4 v4, s[12:15], s49 offen offset:3072 sc1 lds
  v_mfma_f32_16x16x32_bf16 v[44:47], a[140:143], a[84:87], v[44:47]
  buffer_load_dwordx4 a[80:83], v232, s[12:15], s33 offen offset:1024 sc1
  v_mfma_f32_16x16x32_bf16 v[48:51], a[128:131], a[88:91], v[48:51]
  ds_read_b128 a[156:159], v229 offset:19456
  v_mfma_f32_16x16x32_bf16 v[52:55], a[132:135], a[88:91], v[52:55]
  buffer_load_dwordx4 a[84:87], v233, s[12:15], s33 offen offset:1024 sc1
  v_mfma_f32_16x16x32_bf16 v[56:59], a[136:139], a[88:91], v[56:59]
  v_mfma_f32_16x16x32_bf16 v[60:63], a[140:143], a[88:91], v[60:63]
  buffer_load_dwordx4 a[88:91], v234, s[12:15], s33 offen offset:1024 sc1
  v_mfma_f32_16x16x32_bf16 v[64:67], a[128:131], a[92:95], v[64:67]
  v_mfma_f32_16x16x32_bf16 v[68:71], a[132:135], a[92:95], v[68:71]
  v_mfma_f32_16x16x32_bf16 v[72:75], a[136:139], a[92:95], v[72:75]
  v_mfma_f32_16x16x32_bf16 v[76:79], a[140:143], a[92:95], v[76:79]
  buffer_load_dwordx4 a[92:95], v235, s[12:15], s33 offen offset:1024 sc1
  s_waitcnt vmcnt(28)
  s_waitcnt lgkmcnt(0)
  v_mfma_f32_16x16x32_bf16 v[16:19], a[144:147], a[0:3], v[16:19]
  ds_read_b128 a[128:131], v228 offset:32768
  s_add_u32 s49, s30, 122880
  v_mfma_f32_16x16x32_bf16 v[20:23], a[148:151], a[0:3], v[20:23]
  s_add_u32 m0, s29, 147456
  v_mfma_f32_16x16x32_bf16 v[24:27], a[152:155], a[0:3], v[24:27]
  buffer_load_dwordx4 v4, s[12:15], s49 offen offset:0 sc1 lds
  v_mfma_f32_16x16x32_bf16 v[28:31], a[156:159], a[0:3], v[28:31]
  buffer_load_dwordx4 v4, s[12:15], s49 offen offset:1024 sc1 lds
  v_mfma_f32_16x16x32_bf16 v[32:35], a[144:147], a[4:7], v[32:35]
  ds_read_b128 a[132:135], v228 offset:33792
  ds_read_b128 a[136:139], v228 offset:34816
  v_mfma_f32_16x16x32_bf16 v[36:39], a[148:151], a[4:7], v[36:39]
  buffer_load_dwordx4 v4, s[12:15], s49 offen offset:2048 sc1 lds
  v_mfma_f32_16x16x32_bf16 v[40:43], a[152:155], a[4:7], v[40:43]
  buffer_load_dwordx4 v4, s[12:15], s49 offen offset:3072 sc1 lds
  v_mfma_f32_16x16x32_bf16 v[44:47], a[156:159], a[4:7], v[44:47]
  buffer_load_dwordx4 a[0:3], v232, s[12:15], s33 offen offset:2048 sc1
  v_mfma_f32_16x16x32_bf16 v[48:51], a[144:147], a[8:11], v[48:51]
  ds_read_b128 a[140:143], v228 offset:35840
  v_mfma_f32_16x16x32_bf16 v[52:55], a[148:151], a[8:11], v[52:55]
  buffer_load_dwordx4 a[4:7], v233, s[12:15], s33 offen offset:2048 sc1
  v_mfma_f32_16x16x32_bf16 v[56:59], a[152:155], a[8:11], v[56:59]
  v_mfma_f32_16x16x32_bf16 v[60:63], a[156:159], a[8:11], v[60:63]
  buffer_load_dwordx4 a[8:11], v234, s[12:15], s33 offen offset:2048 sc1
  v_mfma_f32_16x16x32_bf16 v[64:67], a[144:147], a[12:15], v[64:67]
  v_mfma_f32_16x16x32_bf16 v[68:71], a[148:151], a[12:15], v[68:71]
  v_mfma_f32_16x16x32_bf16 v[72:75], a[152:155], a[12:15], v[72:75]
  v_mfma_f32_16x16x32_bf16 v[76:79], a[156:159], a[12:15], v[76:79]
  buffer_load_dwordx4 a[12:15], v235, s[12:15], s33 offen offset:2048 sc1
  s_waitcnt vmcnt(32)
  s_waitcnt lgkmcnt(0)
  v_mfma_f32_16x16x32_bf16 v[16:19], a[128:131], a[16:19], v[16:19]
  ds_read_b128 a[144:147], v228 offset:49152
  s_add_u32 s49, s30, 126976
  v_mfma_f32_16x16x32_bf16 v[20:23], a[132:135], a[16:19], v[20:23]
  s_add_u32 m0, s29, 32768
  v_mfma_f32_16x16x32_bf16 v[24:27], a[136:139], a[16:19], v[24:27]
  buffer_load_dwordx4 v4, s[12:15], s49 offen offset:0 sc1 lds
  v_mfma_f32_16x16x32_bf16 v[28:31], a[140:143], a[16:19], v[28:31]
  buffer_load_dwordx4 v4, s[12:15], s49 offen offset:1024 sc1 lds
  v_mfma_f32_16x16x32_bf16 v[32:35], a[128:131], a[20:23], v[32:35]
  ds_read_b128 a[148:151], v228 offset:50176
  ds_read_b128 a[152:155], v228 offset:51200
  v_mfma_f32_16x16x32_bf16 v[36:39], a[132:135], a[20:23], v[36:39]
  buffer_load_dwordx4 v4, s[12:15], s49 offen offset:2048 sc1 lds
  v_mfma_f32_16x16x32_bf16 v[40:43], a[136:139], a[20:23], v[40:43]
  buffer_load_dwordx4 v4, s[12:15], s49 offen offset:3072 sc1 lds
  v_mfma_f32_16x16x32_bf16 v[44:47], a[140:143], a[20:23], v[44:47]
  buffer_load_dwordx4 a[16:19], v232, s[12:15], s33 offen offset:3072 sc1
  v_mfma_f32_16x16x32_bf16 v[48:51], a[128:131], a[24:27], v[48:51]
  ds_read_b128 a[156:159], v228 offset:52224
  v_mfma_f32_16x16x32_bf16 v[52:55], a[132:135], a[24:27], v[52:55]
  buffer_load_dwordx4 a[20:23], v233, s[12:15], s33 offen offset:3072 sc1
  v_mfma_f32_16x16x32_bf16 v[56:59], a[136:139], a[24:27], v[56:59]
  v_mfma_f32_16x16x32_bf16 v[60:63], a[140:143], a[24:27], v[60:63]
  buffer_load_dwordx4 a[24:27], v234, s[12:15], s33 offen offset:3072 sc1
  v_mfma_f32_16x16x32_bf16 v[64:67], a[128:131], a[28:31], v[64:67]
  v_mfma_f32_16x16x32_bf16 v[68:71], a[132:135], a[28:31], v[68:71]
  v_mfma_f32_16x16x32_bf16 v[72:75], a[136:139], a[28:31], v[72:75]
  v_mfma_f32_16x16x32_bf16 v[76:79], a[140:143], a[28:31], v[76:79]
  buffer_load_dwordx4 a[28:31], v235, s[12:15], s33 offen offset:3072 sc1
  s_add_u32 s33, s33, 4096
  s_mov_b32 s40, 0
  v_cmp_ne_u64 vcc, s[76:77], v[8:9]
  v_cmp_ne_u64_e64 s[42:43], s[76:77], v[10:11]
  s_nop 1
  s_or_b64 vcc, vcc, s[42:43]
  s_cbranch_vccz adaLN_cond__compressed_kv_cla__mixer_channel_mlp__prompt_kernel_ok3
adaLN_cond__compressed_kv_cla__mixer_channel_mlp__prompt_kernel_sp4:
  s_sleep 2
  buffer_load_dwordx2 v[8:9], v4, s[12:15], s44 offen offset:2048 sc1
  buffer_load_dwordx2 v[10:11], v4, s[12:15], s44 offen offset:3072 sc1
  s_waitcnt vmcnt(0)
  s_add_u32 s40, s40, 1
  v_cmp_ne_u64 vcc, s[76:77], v[8:9]
  v_cmp_ne_u64_e64 s[42:43], s[76:77], v[10:11]
  s_nop 1
  s_or_b64 vcc, vcc, s[42:43]
  s_cbranch_vccz adaLN_cond__compressed_kv_cla__mixer_channel_mlp__prompt_kernel_ok3
  s_cmp_lt_u32 s40, 0x4000
  s_cbranch_scc1 adaLN_cond__compressed_kv_cla__mixer_channel_mlp__prompt_kernel_sp4
adaLN_cond__compressed_kv_cla__mixer_channel_mlp__prompt_kernel_ok3:
  s_waitcnt vmcnt(32)
  s_waitcnt lgkmcnt(0)
  v_mfma_f32_16x16x32_bf16 v[16:19], a[144:147], a[32:35], v[16:19]
  ds_read_b128 a[128:131], v228 offset:0
  s_add_u32 s49, s31, 16384
  v_mfma_f32_16x16x32_bf16 v[20:23], a[148:151], a[32:35], v[20:23]
  s_add_u32 s3, s24, 16384
  v_mfma_f32_16x16x32_bf16 v[24:27], a[152:155], a[32:35], v[24:27]
  buffer_load_dwordx4 a[160:163], v4, s[12:15], s49 offen offset:0 sc1
  v_mfma_f32_16x16x32_bf16 v[28:31], a[156:159], a[32:35], v[28:31]
  buffer_load_dwordx4 a[164:167], v4, s[12:15], s49 offen offset:1024 sc1
  v_mfma_f32_16x16x32_bf16 v[32:35], a[144:147], a[36:39], v[32:35]
  ds_read_b128 a[132:135], v228 offset:1024
  ds_read_b128 a[136:139], v228 offset:2048
  v_mfma_f32_16x16x32_bf16 v[36:39], a[148:151], a[36:39], v[36:39]
  buffer_load_dwordx4 a[168:171], v4, s[12:15], s3 offen offset:0 sc1
  v_mfma_f32_16x16x32_bf16 v[40:43], a[152:155], a[36:39], v[40:43]
  buffer_load_dwordx4 a[172:175], v4, s[12:15], s3 offen offset:1024 sc1
  v_mfma_f32_16x16x32_bf16 v[44:47], a[156:159], a[36:39], v[44:47]
  ds_read_b128 a[140:143], v228 offset:3072
  v_lshrrev_b32 v12, 4, v1
  v_mfma_f32_16x16x32_bf16 v[48:51], a[144:147], a[40:43], v[48:51]
  v_min_u32 v12, 2, v12
  v_lshlrev_b32 v12, 11, v12
  v_mfma_f32_16x16x32_bf16 v[52:55], a[148:151], a[40:43], v[52:55]
  v_and_b32 v13, 15, v1
  v_lshl_add_u32 v12, v13, 4, v12
  v_mfma_f32_16x16x32_bf16 v[56:59], a[152:155], a[40:43], v[56:59]
  s_lshl_b32 s41, s23, 8
  s_add_u32 s41, s41, 0x3e11000
  v_mfma_f32_16x16x32_bf16 v[60:63], a[156:159], a[40:43], v[60:63]
  s_lshl_b32 s40, s20, 14
  s_add_u32 m0, s40, 0x10000
  v_mfma_f32_16x16x32_bf16 v[64:67], a[144:147], a[44:47], v[64:67]
  s_add_u32 s40, s40, 0x10000
  v_mfma_f32_16x16x32_bf16 v[68:71], a[148:151], a[44:47], v[68:71]
  buffer_load_dwordx4 v12, s[12:15], s41 offen sc1 lds
  v_mfma_f32_16x16x32_bf16 v[72:75], a[152:155], a[44:47], v[72:75]
  v_lshlrev_b32 v13, 4, v14
  v_add_u32 v13, s40, v13
  v_mfma_f32_16x16x32_bf16 v[76:79], a[156:159], a[44:47], v[76:79]
  global_load_dwordx2 v[80:81], v236, s[64:65] offset:0
  global_load_dwordx2 v[82:83], v236, s[64:65] offset:32
  global_load_dwordx2 v[84:85], v236, s[64:65] offset:64
  global_load_dwordx2 v[86:87], v236, s[64:65] offset:96
  s_mul_i32 s41, s23, 448
  s_lshl_b32 s42, s20, 7
  s_add_u32 s41, s41, s42
  v_lshlrev_b32 v15, 3, v14
  v_add_u32 v15, s41, v15
  global_load_dwordx2 v[164:165], v15, s[80:81] offset:0
  global_load_dwordx2 v[166:167], v15, s[80:81] offset:32
  v_min_u32 v15, 3416, v15
  global_load_dwordx2 v[168:169], v15, s[80:81] offset:64
  global_load_dwordx2 v[170:171], v15, s[80:81] offset:96
  v_lshrrev_b32 v15, 1, v237
  global_load_dwordx2 v[216:217], v15, s[84:85] offset:0
  global_load_dwordx2 v[218:219], v15, s[84:85] offset:32
  global_load_dwordx2 v[220:221], v15, s[84:85] offset:64
  global_load_dwordx2 v[222:223], v15, s[84:85] offset:96
  s_waitcnt vmcnt(45)
  s_waitcnt lgkmcnt(0)
  v_mfma_f32_16x16x32_bf16 v[16:19], a[128:131], a[48:51], v[16:19]
  ds_read_b128 a[144:147], v228 offset:16384
  s_add_u32 s49, s31, 18432
  v_mfma_f32_16x16x32_bf16 v[20:23], a[132:135], a[48:51], v[20:23]
  s_add_u32 s3, s24, 18432
  s_add_u32 s40, s20, 1
  v_mfma_f32_16x16x32_bf16 v[24:27], a[136:139], a[48:51], v[24:27]
  ds_read_b128 a[148:151], v228 offset:17408
  s_and_b32 s40, s40, 3
  v_mfma_f32_16x16x32_bf16 v[28:31], a[140:143], a[48:51], v[28:31]
  buffer_load_dwordx4 a[176:179], v4, s[12:15], s49 offen offset:0 sc1
  v_mfma_f32_16x16x32_bf16 v[32:35], a[128:131], a[52:55], v[32:35]
  ds_read_b128 a[152:155], v228 offset:18432
  s_lshl_b32 s40, s40, 14
  v_mfma_f32_16x16x32_bf16 v[36:39], a[132:135], a[52:55], v[36:39]
  buffer_load_dwordx4 a[180:183], v4, s[12:15], s49 offen offset:1024 sc1
  v_mfma_f32_16x16x32_bf16 v[40:43], a[136:139], a[52:55], v[40:43]
  ds_read_b128 a[156:159], v228 offset:19456
  v_add_u32 v9, s40, v242
  v_mfma_f32_16x16x32_bf16 v[44:47], a[140:143], a[52:55], v[44:47]
  buffer_load_dwordx4 a[184:187], v4, s[12:15], s3 offen offset:0 sc1
  v_mfma_f32_16x16x32_bf16 v[48:51], a[128:131], a[56:59], v[48:51]
  buffer_load_dwordx4 a[188:191], v4, s[12:15], s3 offen offset:1024 sc1
  v_mfma_f32_16x16x32_bf16 v[52:55], a[132:135], a[56:59], v[52:55]
  s_add_u32 s40, s20, 2
  s_and_b32 s40, s40, 3
  v_mfma_f32_16x16x32_bf16 v[56:59], a[136:139], a[56:59], v[56:59]
  s_lshl_b32 s40, s40, 14
  v_add_u32 v10, s40, v242
  v_mfma_f32_16x16x32_bf16 v[60:63], a[140:143], a[56:59], v[60:63]
  s_add_u32 s40, s20, 3
  s_and_b32 s40, s40, 3
  v_mfma_f32_16x16x32_bf16 v[64:67], a[128:131], a[60:63], v[64:67]
  s_lshl_b32 s40, s40, 14
  v_add_u32 v11, s40, v242
  v_mfma_f32_16x16x32_bf16 v[68:71], a[132:135], a[60:63], v[68:71]
  s_lshl_b32 s40, s20, 14
  v_add_u32 v8, s40, v242
  v_mfma_f32_16x16x32_bf16 v[72:75], a[136:139], a[60:63], v[72:75]
  v_mfma_f32_16x16x32_bf16 v[76:79], a[140:143], a[60:63], v[76:79]
  s_waitcnt vmcnt(45)
  s_waitcnt vmcnt(41)
  s_waitcnt lgkmcnt(0)
  v_mfma_f32_16x16x32_bf16 v[16:19], a[144:147], a[64:67], v[16:19]
  ds_read_b128 a[128:131], v229 offset:0
  s_add_u32 s49, s31, 20480
  v_mfma_f32_16x16x32_bf16 v[20:23], a[148:151], a[64:67], v[20:23]
  s_add_u32 s3, s24, 20480
  s_waitcnt vmcnt(12)
  v_mfma_f32_16x16x32_bf16 v[24:27], a[152:155], a[64:67], v[24:27]
  ds_read_b128 a[132:135], v229 offset:1024
  ds_read_b128 v[96:99], v13 offset:0
  v_mfma_f32_16x16x32_bf16 v[28:31], a[156:159], a[64:67], v[28:31]
  buffer_load_dwordx4 a[192:195], v4, s[12:15], s49 offen offset:0 sc1
  v_mfma_f32_16x16x32_bf16 v[32:35], a[144:147], a[68:71], v[32:35]
  ds_read_b128 a[136:139], v229 offset:2048
  ds_read_b128 v[100:103], v13 offset:64
  v_mfma_f32_16x16x32_bf16 v[36:39], a[148:151], a[68:71], v[36:39]
  buffer_load_dwordx4 a[196:199], v4, s[12:15], s49 offen offset:1024 sc1
  v_mfma_f32_16x16x32_bf16 v[40:43], a[152:155], a[68:71], v[40:43]
  ds_read_b128 a[140:143], v229 offset:3072
  ds_read_b128 v[104:107], v13 offset:128
  v_mfma_f32_16x16x32_bf16 v[44:47], a[156:159], a[68:71], v[44:47]
  buffer_load_dwordx4 a[200:203], v4, s[12:15], s3 offen offset:0 sc1
  v_mfma_f32_16x16x32_bf16 v[48:51], a[144:147], a[72:75], v[48:51]
  buffer_load_dwordx4 a[204:207], v4, s[12:15], s3 offen offset:1024 sc1
  v_mfma_f32_16x16x32_bf16 v[52:55], a[148:151], a[72:75], v[52:55]
  ds_read_b128 v[108:111], v13 offset:192
  ds_read_b128 v[112:115], v13 offset:256
  v_mfma_f32_16x16x32_bf16 v[56:59], a[152:155], a[72:75], v[56:59]
  ds_read_b128 v[116:119], v13 offset:320
  ds_read_b128 v[120:123], v13 offset:384
  v_mfma_f32_16x16x32_bf16 v[60:63], a[156:159], a[72:75], v[60:63]
  ds_read_b128 v[124:127], v13 offset:448
  ds_read_b128 v[128:131], v13 offset:512
  v_mfma_f32_16x16x32_bf16 v[64:67], a[144:147], a[76:79], v[64:67]
  ds_read_b128 v[132:135], v13 offset:576
  ds_read_b128 v[136:139], v13 offset:640
  v_mfma_f32_16x16x32_bf16 v[68:71], a[148:151], a[76:79], v[68:71]
  ds_read_b128 v[140:143], v13 offset:704
  v_lshlrev_b32 v144, 16, v80
  v_mfma_f32_16x16x32_bf16 v[72:75], a[152:155], a[76:79], v[72:75]
  v_and_b32 v145, 0xffff0000, v80
  v_lshlrev_b32 v146, 16, v81
  v_mfma_f32_16x16x32_bf16 v[76:79], a[156:159], a[76:79], v[76:79]
  v_and_b32 v147, 0xffff0000, v81
  v_lshlrev_b32 v148, 16, v82
  v_and_b32 v149, 0xffff0000, v82
  v_lshlrev_b32 v150, 16, v83
  v_and_b32 v151, 0xffff0000, v83
  v_lshlrev_b32 v152, 16, v84
  v_and_b32 v153, 0xffff0000, v84
  v_lshlrev_b32 v154, 16, v85
  s_waitcnt lgkmcnt(0)
  v_mfma_f32_16x16x32_bf16 v[16:19], a[128:131], a[80:83], v[16:19]
  ds_read_b128 a[144:147], v229 offset:16384
  s_add_u32 s49, s31, 22528
  v_mfma_f32_16x16x32_bf16 v[20:23], a[132:135], a[80:83], v[20:23]
  s_add_u32 s3, s24, 22528
  v_and_b32 v155, 0xffff0000, v85
  v_mfma_f32_16x16x32_bf16 v[24:27], a[136:139], a[80:83], v[24:27]
  ds_read_b128 a[148:151], v229 offset:17408
  v_lshlrev_b32 v156, 16, v86
  v_mfma_f32_16x16x32_bf16 v[28:31], a[140:143], a[80:83], v[28:31]
  buffer_load_dwordx4 a[208:211], v4, s[12:15], s49 offen offset:0 sc1
  v_mfma_f32_16x16x32_bf16 v[32:35], a[128:131], a[84:87], v[32:35]
  ds_read_b128 a[152:155], v229 offset:18432
  v_and_b32 v157, 0xffff0000, v86
  v_mfma_f32_16x16x32_bf16 v[36:39], a[132:135], a[84:87], v[36:39]
  buffer_load_dwordx4 a[212:215], v4, s[12:15], s49 offen offset:1024 sc1
  v_mfma_f32_16x16x32_bf16 v[40:43], a[136:139], a[84:87], v[40:43]
  ds_read_b128 a[156:159], v229 offset:19456
  v_lshlrev_b32 v158, 16, v87
  v_mfma_f32_16x16x32_bf16 v[44:47], a[140:143], a[84:87], v[44:47]
  buffer_load_dwordx4 a[216:219], v4, s[12:15], s3 offen offset:0 sc1
  v_mfma_f32_16x16x32_bf16 v[48:51], a[128:131], a[88:91], v[48:51]
  buffer_load_dwordx4 a[220:223], v4, s[12:15], s3 offen offset:1024 sc1
  v_mfma_f32_16x16x32_bf16 v[52:55], a[132:135], a[88:91], v[52:55]
  v_and_b32 v159, 0xffff0000, v87
  v_mfma_f32_16x16x32_bf16 v[56:59], a[136:139], a[88:91], v[56:59]
  v_add_f32 v128, 1.0, v128
  v_add_f32 v129, 1.0, v129
  v_mfma_f32_16x16x32_bf16 v[60:63], a[140:143], a[88:91], v[60:63]
  v_add_f32 v130, 1.0, v130
  v_add_f32 v131, 1.0, v131
  v_mfma_f32_16x16x32_bf16 v[64:67], a[128:131], a[92:95], v[64:67]
  v_add_f32 v132, 1.0, v132
  v_add_f32 v133, 1.0, v133
  v_mfma_f32_16x16x32_bf16 v[68:71], a[132:135], a[92:95], v[68:71]
  v_add_f32 v134, 1.0, v134
  v_add_f32 v135, 1.0, v135
  v_mfma_f32_16x16x32_bf16 v[72:75], a[136:139], a[92:95], v[72:75]
  v_add_f32 v136, 1.0, v136
  v_add_f32 v137, 1.0, v137
  v_mfma_f32_16x16x32_bf16 v[76:79], a[140:143], a[92:95], v[76:79]
  v_add_f32 v138, 1.0, v138
  v_add_f32 v139, 1.0, v139
  v_add_f32 v140, 1.0, v140
  v_add_f32 v141, 1.0, v141
  v_add_f32 v142, 1.0, v142
  v_add_f32 v143, 1.0, v143
  v_cvt_pk_bf16_f32 v80, v128, v129
  v_cvt_pk_bf16_f32 v81, v130, v131
  s_waitcnt lgkmcnt(0)
  v_mfma_f32_16x16x32_bf16 v[16:19], a[144:147], a[0:3], v[16:19]
  ds_read_b128 a[128:131], v228 offset:32768
  s_add_u32 s49, s31, 24576
  v_mfma_f32_16x16x32_bf16 v[20:23], a[148:151], a[0:3], v[20:23]
  s_add_u32 s3, s24, 24576
  v_cvt_pk_bf16_f32 v82, v132, v133
  v_mfma_f32_16x16x32_bf16 v[24:27], a[152:155], a[0:3], v[24:27]
  ds_read_b128 a[132:135], v228 offset:33792
  v_cvt_pk_bf16_f32 v83, v134, v135
  v_mfma_f32_16x16x32_bf16 v[28:31], a[156:159], a[0:3], v[28:31]
  buffer_load_dwordx4 a[224:227], v4, s[12:15], s49 offen offset:0 sc1
  v_mfma_f32_16x16x32_bf16 v[32:35], a[144:147], a[4:7], v[32:35]
  ds_read_b128 a[136:139], v228 offset:34816
  v_cvt_pk_bf16_f32 v84, v136, v137
  v_mfma_f32_16x16x32_bf16 v[36:39], a[148:151], a[4:7], v[36:39]
  buffer_load_dwordx4 a[228:231], v4, s[12:15], s49 offen offset:1024 sc1
  v_mfma_f32_16x16x32_bf16 v[40:43], a[152:155], a[4:7], v[40:43]
  ds_read_b128 a[140:143], v228 offset:35840
  v_cvt_pk_bf16_f32 v85, v138, v139
  v_mfma_f32_16x16x32_bf16 v[44:47], a[156:159], a[4:7], v[44:47]
  buffer_load_dwordx4 a[232:235], v4, s[12:15], s3 offen offset:0 sc1
  v_mfma_f32_16x16x32_bf16 v[48:51], a[144:147], a[8:11], v[48:51]
  buffer_load_dwordx4 a[236:239], v4, s[12:15], s3 offen offset:1024 sc1
  v_mfma_f32_16x16x32_bf16 v[52:55], a[148:151], a[8:11], v[52:55]
  v_cvt_pk_bf16_f32 v86, v140, v141
  v_cvt_pk_bf16_f32 v87, v142, v143
  v_mfma_f32_16x16x32_bf16 v[56:59], a[152:155], a[8:11], v[56:59]
  v_lshlrev_b32 v128, 16, v80
  v_and_b32 v129, 0xffff0000, v80
  v_mfma_f32_16x16x32_bf16 v[60:63], a[156:159], a[8:11], v[60:63]
  v_lshlrev_b32 v130, 16, v81
  v_and_b32 v131, 0xffff0000, v81
  v_mfma_f32_16x16x32_bf16 v[64:67], a[144:147], a[12:15], v[64:67]
  v_lshlrev_b32 v132, 16, v82
  v_and_b32 v133, 0xffff0000, v82
  v_mfma_f32_16x16x32_bf16 v[68:71], a[148:151], a[12:15], v[68:71]
  v_lshlrev_b32 v134, 16, v83
  v_and_b32 v135, 0xffff0000, v83
  v_mfma_f32_16x16x32_bf16 v[72:75], a[152:155], a[12:15], v[72:75]
  v_lshlrev_b32 v136, 16, v84
  v_and_b32 v137, 0xffff0000, v84
  v_mfma_f32_16x16x32_bf16 v[76:79], a[156:159], a[12:15], v[76:79]
  v_lshlrev_b32 v138, 16, v85
  v_and_b32 v139, 0xffff0000, v85
  v_lshlrev_b32 v140, 16, v86
  v_and_b32 v141, 0xffff0000, v86
  v_lshlrev_b32 v142, 16, v87
  v_and_b32 v143, 0xffff0000, v87
  s_waitcnt lgkmcnt(0)
  v_mfma_f32_16x16x32_bf16 v[32:35], a[128:131], a[20:23], v[32:35]
  s_add_u32 s49, s31, 26624
  s_add_u32 s3, s24, 26624
  v_mfma_f32_16x16x32_bf16 v[36:39], a[132:135], a[20:23], v[36:39]
  buffer_load_dwordx4 a[240:243], v4, s[12:15], s49 offen offset:0 sc1
  v_mfma_f32_16x16x32_bf16 v[40:43], a[136:139], a[20:23], v[40:43]
  buffer_load_dwordx4 a[244:247], v4, s[12:15], s49 offen offset:1024 sc1
  v_mfma_f32_16x16x32_bf16 v[44:47], a[140:143], a[20:23], v[44:47]
  buffer_load_dwordx4 a[248:251], v4, s[12:15], s3 offen offset:0 sc1
  v_mfma_f32_16x16x32_bf16 v[48:51], a[128:131], a[24:27], v[48:51]
  buffer_load_dwordx4 a[252:255], v4, s[12:15], s3 offen offset:1024 sc1
  v_mfma_f32_16x16x32_bf16 v[52:55], a[132:135], a[24:27], v[52:55]
  v_mfma_f32_16x16x32_bf16 v[56:59], a[136:139], a[24:27], v[56:59]
  v_mfma_f32_16x16x32_bf16 v[60:63], a[140:143], a[24:27], v[60:63]
  v_mfma_f32_16x16x32_bf16 v[64:67], a[128:131], a[28:31], v[64:67]
  ds_write_b128 v9, v[32:35] offset:4096
  v_mfma_f32_16x16x32_bf16 v[68:71], a[132:135], a[28:31], v[68:71]
  ds_write_b128 v9, v[36:39] offset:5120
  v_mfma_f32_16x16x32_bf16 v[72:75], a[136:139], a[28:31], v[72:75]
  ds_write_b128 v9, v[40:43] offset:6144
  v_mfma_f32_16x16x32_bf16 v[76:79], a[140:143], a[28:31], v[76:79]
  ds_write_b128 v9, v[44:47] offset:7168
  v_mfma_f32_16x16x32_bf16 v[16:19], a[128:131], a[16:19], v[16:19]
  ds_write_b128 v10, v[48:51] offset:8192
  v_mfma_f32_16x16x32_bf16 v[20:23], a[132:135], a[16:19], v[20:23]
  ds_write_b128 v10, v[52:55] offset:9216
  v_mfma_f32_16x16x32_bf16 v[24:27], a[136:139], a[16:19], v[24:27]
  ds_write_b128 v10, v[56:59] offset:10240
  v_mfma_f32_16x16x32_bf16 v[28:31], a[140:143], a[16:19], v[28:31]
  ds_write_b128 v10, v[60:63] offset:11264
  ds_write_b128 v11, v[64:67] offset:12288
  ds_write_b128 v11, v[68:71] offset:13312
  ds_write_b128 v11, v[72:75] offset:14336
  ds_write_b128 v11, v[76:79] offset:15360
  s_waitcnt lgkmcnt(0)
  s_barrier
  ds_read_b128 v[32:35], v8 offset:4096
  ds_read_b128 v[36:39], v8 offset:5120
  ds_read_b128 v[40:43], v8 offset:6144
  ds_read_b128 v[44:47], v8 offset:7168
  ds_read_b128 v[48:51], v8 offset:8192
  ds_read_b128 v[52:55], v8 offset:9216
  ds_read_b128 v[56:59], v8 offset:10240
  ds_read_b128 v[60:63], v8 offset:11264
  ds_read_b128 v[64:67], v8 offset:12288
  ds_read_b128 v[68:71], v8 offset:13312
  ds_read_b128 v[72:75], v8 offset:14336
  ds_read_b128 v[76:79], v8 offset:15360
  s_add_u32 s49, s31, 28672
  s_add_u32 s3, s24, 28672
  buffer_load_dwordx4 a[96:99], v4, s[12:15], s49 offen offset:0 sc1
  buffer_load_dwordx4 a[100:103], v4, s[12:15], s49 offen offset:1024 sc1
  buffer_load_dwordx4 a[104:107], v4, s[12:15], s3 offen offset:0 sc1
  buffer_load_dwordx4 a[108:111], v4, s[12:15], s3 offen offset:1024 sc1
  s_add_u32 s49, s31, 30720
  s_add_u32 s3, s24, 30720
  buffer_load_dwordx4 a[112:115], v4, s[12:15], s49 offen offset:0 sc1
  buffer_load_dwordx4 a[116:119], v4, s[12:15], s49 offen offset:1024 sc1
  buffer_load_dwordx4 a[120:123], v4, s[12:15], s3 offen offset:0 sc1
  buffer_load_dwordx4 a[124:127], v4, s[12:15], s3 offen offset:1024 sc1
  s_add_u32 s49, s31, 0
  s_add_u32 s3, s24, 0
  s_add_u32 m0, s29, 49152
  s_nop 0
  buffer_load_dwordx4 v4, s[12:15], s49 offen offset:0 sc1 lds
  buffer_load_dwordx4 v4, s[12:15], s49 offen offset:1024 sc1 lds
  s_add_u32 m0, s29, 51200
  s_nop 0
  buffer_load_dwordx4 v4, s[12:15], s3 offen offset:0 sc1 lds
  buffer_load_dwordx4 v4, s[12:15], s3 offen offset:1024 sc1 lds
  s_add_u32 s49, s31, 2048
  s_add_u32 s3, s24, 2048
  s_add_u32 m0, s29, 0
  s_nop 0
  buffer_load_dwordx4 v4, s[12:15], s49 offen offset:0 sc1 lds
  buffer_load_dwordx4 v4, s[12:15], s49 offen offset:1024 sc1 lds
  s_add_u32 m0, s29, 2048
  s_nop 0
  buffer_load_dwordx4 v4, s[12:15], s3 offen offset:0 sc1 lds
  buffer_load_dwordx4 v4, s[12:15], s3 offen offset:1024 sc1 lds
  s_waitcnt lgkmcnt(8)
  v_pk_add_f32 v[16:17], v[16:17], v[32:33]
  v_pk_add_f32 v[18:19], v[18:19], v[34:35]
  v_pk_add_f32 v[20:21], v[20:21], v[36:37]
  v_pk_add_f32 v[22:23], v[22:23], v[38:39]
  v_pk_add_f32 v[24:25], v[24:25], v[40:41]
  v_pk_add_f32 v[26:27], v[26:27], v[42:43]
  v_pk_add_f32 v[28:29], v[28:29], v[44:45]
  v_pk_add_f32 v[30:31], v[30:31], v[46:47]
  s_waitcnt lgkmcnt(4)
  v_pk_add_f32 v[16:17], v[16:17], v[48:49]
  v_pk_add_f32 v[18:19], v[18:19], v[50:51]
  v_pk_add_f32 v[20:21], v[20:21], v[52:53]
  v_pk_add_f32 v[22:23], v[22:23], v[54:55]
  v_pk_add_f32 v[24:25], v[24:25], v[56:57]
  v_pk_add_f32 v[26:27], v[26:27], v[58:59]
  v_pk_add_f32 v[28:29], v[28:29], v[60:61]
  v_pk_add_f32 v[30:31], v[30:31], v[62:63]
  s_waitcnt lgkmcnt(0)
  v_pk_add_f32 v[16:17], v[16:17], v[64:65]
  v_pk_add_f32 v[18:19], v[18:19], v[66:67]
  v_pk_add_f32 v[20:21], v[20:21], v[68:69]
  v_pk_add_f32 v[22:23], v[22:23], v[70:71]
  v_pk_add_f32 v[24:25], v[24:25], v[72:73]
  v_pk_add_f32 v[26:27], v[26:27], v[74:75]
  v_pk_add_f32 v[28:29], v[28:29], v[76:77]
  v_pk_add_f32 v[30:31], v[30:31], v[78:79]
  v_pk_fma_f32 v[144:145], v[96:97], v[16:17], v[144:145]
  v_pk_fma_f32 v[146:147], v[98:99], v[18:19], v[146:147]
  v_pk_fma_f32 v[148:149], v[100:101], v[20:21], v[148:149]
  v_pk_fma_f32 v[150:151], v[102:103], v[22:23], v[150:151]
  v_pk_fma_f32 v[152:153], v[104:105], v[24:25], v[152:153]
  v_pk_fma_f32 v[154:155], v[106:107], v[26:27], v[154:155]
  v_pk_fma_f32 v[156:157], v[108:109], v[28:29], v[156:157]
  v_pk_fma_f32 v[158:159], v[110:111], v[30:31], v[158:159]
  v_cvt_pk_bf16_f32 v244, v144, v145
  v_cvt_pk_bf16_f32 v245, v146, v147
  v_cvt_pk_bf16_f32 v246, v148, v149
  v_cvt_pk_bf16_f32 v247, v150, v151
  v_cvt_pk_bf16_f32 v248, v152, v153
  v_cvt_pk_bf16_f32 v249, v154, v155
  v_cvt_pk_bf16_f32 v250, v156, v157
  v_cvt_pk_bf16_f32 v251, v158, v159
  v_lshlrev_b32 v144, 16, v244
  v_and_b32 v145, 0xffff0000, v244
  v_lshlrev_b32 v146, 16, v245
  v_and_b32 v147, 0xffff0000, v245
  v_lshlrev_b32 v148, 16, v246
  v_and_b32 v149, 0xffff0000, v246
  v_lshlrev_b32 v150, 16, v247
  v_and_b32 v151, 0xffff0000, v247
  v_lshlrev_b32 v152, 16, v248
  v_and_b32 v153, 0xffff0000, v248
  v_lshlrev_b32 v154, 16, v249
  v_and_b32 v155, 0xffff0000, v249
  v_lshlrev_b32 v156, 16, v250
  v_and_b32 v157, 0xffff0000, v250
  v_lshlrev_b32 v158, 16, v251
  v_and_b32 v159, 0xffff0000, v251
  v_pk_mul_f32 v[32:33], v[144:145], v[128:129]
  v_pk_mul_f32 v[34:35], v[146:147], v[130:131]
  v_pk_mul_f32 v[36:37], v[148:149], v[132:133]
  v_pk_mul_f32 v[38:39], v[150:151], v[134:135]
  v_pk_mul_f32 v[40:41], v[152:153], v[136:137]
  v_pk_mul_f32 v[42:43], v[154:155], v[138:139]
  v_pk_mul_f32 v[44:45], v[156:157], v[140:141]
  v_pk_mul_f32 v[46:47], v[158:159], v[142:143]
  v_cvt_pk_bf16_f32 v48, v32, v33
  v_cvt_pk_bf16_f32 v49, v34, v35
  v_cvt_pk_bf16_f32 v50, v36, v37
  v_cvt_pk_bf16_f32 v51, v38, v39
  v_cvt_pk_bf16_f32 v52, v40, v41
  v_cvt_pk_bf16_f32 v53, v42, v43
  v_cvt_pk_bf16_f32 v54, v44, v45
  v_cvt_pk_bf16_f32 v55, v46, v47
  s_lshl_b32 s45, s38, 14
  s_lshl_b32 s41, s23, 11
  s_add_u32 s45, s45, s41
  s_add_u32 s41, s45, 0x3000000
  buffer_store_dwordx4 v[48:51], v4, s[12:15], s41 offen offset:0
  buffer_store_dwordx4 v[52:55], v4, s[12:15], s41 offen offset:1024
  v_lshlrev_b32 v32, 16, v48
  v_and_b32 v33, 0xffff0000, v48
  v_lshlrev_b32 v34, 16, v49
  v_and_b32 v35, 0xffff0000, v49
  v_lshlrev_b32 v36, 16, v50
  v_and_b32 v37, 0xffff0000, v50
  v_lshlrev_b32 v38, 16, v51
  v_and_b32 v39, 0xffff0000, v51
  v_lshlrev_b32 v40, 16, v52
  v_and_b32 v41, 0xffff0000, v52
  v_lshlrev_b32 v42, 16, v53
  v_and_b32 v43, 0xffff0000, v53
  v_lshlrev_b32 v44, 16, v54
  v_and_b32 v45, 0xffff0000, v54
  v_lshlrev_b32 v46, 16, v55
  v_and_b32 v47, 0xffff0000, v55
  v_pk_mul_f32 v[58:59], v[144:145], v[144:145]
  v_pk_mul_f32 v[62:63], v[32:33], v[32:33]
  v_pk_mul_f32 v[64:65], v[32:33], v[128:129]
  v_pk_mul_f32 v[66:67], v[32:33], v[112:113]
  v_pk_add_f32 v[56:57], v[144:145], v[146:147]
  v_pk_fma_f32 v[58:59], v[146:147], v[146:147], v[58:59]
  v_pk_add_f32 v[60:61], v[32:33], v[34:35]
  v_pk_fma_f32 v[62:63], v[34:35], v[34:35], v[62:63]
  v_pk_fma_f32 v[64:65], v[34:35], v[130:131], v[64:65]
  v_pk_fma_f32 v[66:67], v[34:35], v[114:115], v[66:67]
  v_pk_add_f32 v[56:57], v[56:57], v[148:149]
  v_pk_fma_f32 v[58:59], v[148:149], v[148:149], v[58:59]
  v_pk_add_f32 v[60:61], v[60:61], v[36:37]
  v_pk_fma_f32 v[62:63], v[36:37], v[36:37], v[62:63]
  v_pk_fma_f32 v[64:65], v[36:37], v[132:133], v[64:65]
  v_pk_fma_f32 v[66:67], v[36:37], v[116:117], v[66:67]
  v_pk_add_f32 v[56:57], v[56:57], v[150:151]
  v_pk_fma_f32 v[58:59], v[150:151], v[150:151], v[58:59]
  v_pk_add_f32 v[60:61], v[60:61], v[38:39]
  v_pk_fma_f32 v[62:63], v[38:39], v[38:39], v[62:63]
  v_pk_fma_f32 v[64:65], v[38:39], v[134:135], v[64:65]
  v_pk_fma_f32 v[66:67], v[38:39], v[118:119], v[66:67]
  v_pk_add_f32 v[56:57], v[56:57], v[152:153]
  v_pk_fma_f32 v[58:59], v[152:153], v[152:153], v[58:59]
  v_pk_add_f32 v[60:61], v[60:61], v[40:41]
  v_pk_fma_f32 v[62:63], v[40:41], v[40:41], v[62:63]
  v_pk_fma_f32 v[64:65], v[40:41], v[136:137], v[64:65]
  v_pk_fma_f32 v[66:67], v[40:41], v[120:121], v[66:67]
  v_pk_add_f32 v[56:57], v[56:57], v[154:155]
  v_pk_fma_f32 v[58:59], v[154:155], v[154:155], v[58:59]
  v_pk_add_f32 v[60:61], v[60:61], v[42:43]
  v_pk_fma_f32 v[62:63], v[42:43], v[42:43], v[62:63]
  v_pk_fma_f32 v[64:65], v[42:43], v[138:139], v[64:65]
  v_pk_fma_f32 v[66:67], v[42:43], v[122:123], v[66:67]
  v_pk_add_f32 v[56:57], v[56:57], v[156:157]
  v_pk_fma_f32 v[58:59], v[156:157], v[156:157], v[58:59]
  v_pk_add_f32 v[60:61], v[60:61], v[44:45]
  v_pk_fma_f32 v[62:63], v[44:45], v[44:45], v[62:63]
  v_pk_fma_f32 v[64:65], v[44:45], v[140:141], v[64:65]
  v_pk_fma_f32 v[66:67], v[44:45], v[124:125], v[66:67]
  v_pk_add_f32 v[56:57], v[56:57], v[158:159]
  v_pk_fma_f32 v[58:59], v[158:159], v[158:159], v[58:59]
  v_pk_add_f32 v[60:61], v[60:61], v[46:47]
  v_pk_fma_f32 v[62:63], v[46:47], v[46:47], v[62:63]
  v_pk_fma_f32 v[64:65], v[46:47], v[142:143], v[64:65]
  v_pk_fma_f32 v[66:67], v[46:47], v[126:127], v[66:67]
  v_add_f32 v16, v56, v57
  v_add_f32 v17, v58, v59
  v_add_f32 v18, v60, v61
  v_add_f32 v19, v62, v63
  v_add_f32 v20, v64, v65
  v_add_f32 v21, v66, v67
  v_mov_b32 v22, 0
  v_mov_b32 v23, 0
  v_and_b32 v13, 15, v1
  v_lshlrev_b32 v13, 5, v13
  v_permlane32_swap_b32 v16, v20
  v_permlane32_swap_b32 v17, v21
  v_permlane32_swap_b32 v18, v22
  v_permlane32_swap_b32 v19, v23
  v_add_f32 v16, v16, v20
  v_add_f32 v17, v17, v21
  v_add_f32 v18, v18, v22
  v_add_f32 v19, v19, v23
  v_lshl_add_u32 v12, v14, 3, v13
  s_lshl_b32 s41, s23, 16
  v_permlane16_swap_b32 v16, v18
  v_permlane16_swap_b32 v17, v19
  v_add_f32 v16, v16, v18
  v_add_f32 v17, v17, v19
  s_lshl_b32 s42, s38, 9
  s_add_u32 s41, s41, s42
  s_add_u32 s41, s41, 0x3e20000
  buffer_store_dwordx2 v[16:17], v12, s[12:15], s41 offen offset:0
  s_add_u32 s49, s31, 4096
  s_add_u32 s3, s24, 4096
  s_add_u32 m0, s29, 16384
  s_nop 0
  buffer_load_dwordx4 v4, s[12:15], s49 offen offset:0 sc1 lds
  buffer_load_dwordx4 v4, s[12:15], s49 offen offset:1024 sc1 lds
  s_add_u32 m0, s29, 18432
  s_nop 0
  buffer_load_dwordx4 v4, s[12:15], s3 offen offset:0 sc1 lds
  buffer_load_dwordx4 v4, s[12:15], s3 offen offset:1024 sc1 lds
  s_add_u32 s49, s31, 6144
  s_add_u32 s3, s24, 6144
  s_add_u32 m0, s29, 131072
  s_nop 0
  buffer_load_dwordx4 v4, s[12:15], s49 offen offset:0 sc1 lds
  buffer_load_dwordx4 v4, s[12:15], s49 offen offset:1024 sc1 lds
  s_add_u32 m0, s29, 133120
  s_nop 0
  buffer_load_dwordx4 v4, s[12:15], s3 offen offset:0 sc1 lds
  buffer_load_dwordx4 v4, s[12:15], s3 offen offset:1024 sc1 lds
  s_lshl_b32 s40, s98, 7
  s_add_u32 s48, s40, 0x3f04000
  s_lshl_b32 s41, s23, 4
  s_add_u32 s46, s48, s41
  s_waitcnt vmcnt(8)
  s_barrier
  s_cmp_lg_u32 s96, 0
  s_cbranch_scc1 adaLN_cond__compressed_kv_cla__mixer_channel_mlp__prompt_kernel_rel5
adaLN_cond__compressed_kv_cla__mixer_channel_mlp__prompt_kernel_relb6:
  v_mov_b32 v6, s76
  v_mov_b32 v7, s77
  s_or_b32 s97, s46, s96
  buffer_store_dwordx2 v[6:7], v0, s[12:15], s97 offen
  s_xor_b32 s97, s97, 0x10000000
  buffer_store_dwordx2 v[6:7], v0, s[12:15], s97 offen sc1
  v_and_b32 v5, 15, v1
  v_lshlrev_b32 v5, 4, v5
  v_lshl_add_u32 v5, v14, 8, v5
  s_mov_b32 exec_lo, 0x00070007
  s_mov_b32 exec_hi, 0x00070007
  s_mov_b32 s41, 0x3e14000
  buffer_load_dwordx4 a[0:3], v5, s[12:15], s41 offen offset:0 sc1
  buffer_load_dwordx4 a[4:7], v5, s[12:15], s41 offen offset:1024 sc1
  buffer_load_dwordx4 a[8:11], v5, s[12:15], s41 offen offset:2048 sc1
  buffer_load_dwordx4 a[12:15], v5, s[12:15], s41 offen offset:3072 sc1
  s_mov_b32 s41, 0x3e15000
  buffer_load_dwordx4 a[16:19], v5, s[12:15], s41 offen offset:0 sc1
  buffer_load_dwordx4 a[20:23], v5, s[12:15], s41 offen offset:1024 sc1
  buffer_load_dwordx4 a[24:27], v5, s[12:15], s41 offen offset:2048 sc1
  buffer_load_dwordx4 a[28:31], v5, s[12:15], s41 offen offset:3072 sc1
  s_mov_b32 s41, 0x3e16000
  buffer_load_dwordx4 a[32:35], v5, s[12:15], s41 offen offset:0 sc1
  buffer_load_dwordx4 a[36:39], v5, s[12:15], s41 offen offset:1024 sc1
  buffer_load_dwordx4 a[40:43], v5, s[12:15], s41 offen offset:2048 sc1
  buffer_load_dwordx4 a[44:47], v5, s[12:15], s41 offen offset:3072 sc1
  s_mov_b32 s41, 0x3e17000
  buffer_load_dwordx4 a[48:51], v5, s[12:15], s41 offen offset:0 sc1
  buffer_load_dwordx4 a[52:55], v5, s[12:15], s41 offen offset:1024 sc1
  buffer_load_dwordx4 a[56:59], v5, s[12:15], s41 offen offset:2048 sc1
  buffer_load_dwordx4 a[60:63], v5, s[12:15], s41 offen offset:3072 sc1
  s_mov_b64 exec, -1
  v_and_b32 v5, 7, v1
  v_lshlrev_b32 v5, 4, v5
  s_add_u32 s49, s31, 8192
  s_add_u32 s3, s24, 8192
  s_add_u32 m0, s29, 147456
  s_nop 0
  buffer_load_dwordx4 v4, s[12:15], s49 offen offset:0 sc1 lds
  buffer_load_dwordx4 v4, s[12:15], s49 offen offset:1024 sc1 lds
  s_add_u32 m0, s29, 149504
  s_nop 0
  buffer_load_dwordx4 v4, s[12:15], s3 offen offset:0 sc1 lds
  buffer_load_dwordx4 v4, s[12:15], s3 offen offset:1024 sc1 lds
  s_add_u32 s49, s31, 10240
  s_add_u32 s3, s24, 10240
  s_add_u32 m0, s29, 32768
  s_nop 0
  buffer_load_dwordx4 v4, s[12:15], s49 offen offset:0 sc1 lds
  buffer_load_dwordx4 v4, s[12:15], s49 offen offset:1024 sc1 lds
  s_add_u32 m0, s29, 34816
  s_nop 0
  buffer_load_dwordx4 v4, s[12:15], s3 offen offset:0 sc1 lds
  buffer_load_dwordx4 v4, s[12:15], s3 offen offset:1024 sc1 lds
  buffer_load_dwordx2 v[6:7], v5, s[12:15], s48 offen sc1
  s_lshl_b32 s42, s38, 14
  s_add_u32 s44, s42, 0x3000000
  s_lshl_b32 s45, s20, 14
  s_add_u32 s45, s45, 0x10000
  v_lshl_add_u32 v13, v14, 17, v13
  s_lshl_b32 s47, s38, 9
  s_add_u32 s47, s47, 0x3e20000
  s_add_u32 s55, s47, 0x10000
  s_waitcnt vmcnt(9)
  v_mfma_f32_16x16x32_bf16 v[96:99], a[0:3], a[0:3], 0
  v_mfma_f32_16x16x32_bf16 v[96:99], a[4:7], a[4:7], v[96:99]
  v_mfma_f32_16x16x32_bf16 v[96:99], a[8:11], a[8:11], v[96:99]
  v_mfma_f32_16x16x32_bf16 v[96:99], a[12:15], a[12:15], v[96:99]
  v_mfma_f32_16x16x32_bf16 v[96:99], a[16:19], a[16:19], v[96:99]
  v_mfma_f32_16x16x32_bf16 v[96:99], a[20:23], a[20:23], v[96:99]
  v_mfma_f32_16x16x32_bf16 v[96:99], a[24:27], a[24:27], v[96:99]
  v_mfma_f32_16x16x32_bf16 v[96:99], a[28:31], a[28:31], v[96:99]
  v_mfma_f32_16x16x32_bf16 v[96:99], a[32:35], a[32:35], v[96:99]
  v_mfma_f32_16x16x32_bf16 v[96:99], a[36:39], a[36:39], v[96:99]
  v_mfma_f32_16x16x32_bf16 v[96:99], a[40:43], a[40:43], v[96:99]
  v_mfma_f32_16x16x32_bf16 v[96:99], a[44:47], a[44:47], v[96:99]
  v_mfma_f32_16x16x32_bf16 v[96:99], a[48:51], a[48:51], v[96:99]
  v_mfma_f32_16x16x32_bf16 v[96:99], a[52:55], a[52:55], v[96:99]
  v_mfma_f32_16x16x32_bf16 v[96:99], a[56:59], a[56:59], v[96:99]
  v_mfma_f32_16x16x32_bf16 v[96:99], a[60:63], a[60:63], v[96:99]
  v_mfma_f32_16x16x32_bf16 v[80:83], a[160:163], a[32:35], 0
  v_mfma_f32_16x16x32_bf16 v[84:87], a[164:167], a[32:35], 0
  v_mfma_f32_16x16x32_bf16 v[88:91], a[168:171], a[32:35], 0
  v_mfma_f32_16x16x32_bf16 v[92:95], a[172:175], a[32:35], 0
  v_mfma_f32_16x16x32_bf16 v[80:83], a[176:179], a[36:39], v[80:83]
  v_mfma_f32_16x16x32_bf16 v[84:87], a[180:183], a[36:39], v[84:87]
  v_mfma_f32_16x16x32_bf16 v[88:91], a[184:187], a[36:39], v[88:91]
  v_mfma_f32_16x16x32_bf16 v[92:95], a[188:191], a[36:39], v[92:95]
  v_mfma_f32_16x16x32_bf16 v[80:83], a[192:195], a[40:43], v[80:83]
  v_mfma_f32_16x16x32_bf16 v[84:87], a[196:199], a[40:43], v[84:87]
  v_mfma_f32_16x16x32_bf16 v[88:91], a[200:203], a[40:43], v[88:91]
  v_mfma_f32_16x16x32_bf16 v[92:95], a[204:207], a[40:43], v[92:95]
  v_mfma_f32_16x16x32_bf16 v[80:83], a[208:211], a[44:47], v[80:83]
  v_mfma_f32_16x16x32_bf16 v[84:87], a[212:215], a[44:47], v[84:87]
  v_mfma_f32_16x16x32_bf16 v[88:91], a[216:219], a[44:47], v[88:91]
  v_mfma_f32_16x16x32_bf16 v[92:95], a[220:223], a[44:47], v[92:95]
  v_mfma_f32_16x16x32_bf16 v[80:83], a[224:227], a[48:51], v[80:83]
  v_mfma_f32_16x16x32_bf16 v[84:87], a[228:231], a[48:51], v[84:87]
  v_mfma_f32_16x16x32_bf16 v[88:91], a[232:235], a[48:51], v[88:91]
  v_mfma_f32_16x16x32_bf16 v[92:95], a[236:239], a[48:51], v[92:95]
  v_mfma_f32_16x16x32_bf16 v[80:83], a[240:243], a[52:55], v[80:83]
  v_mfma_f32_16x16x32_bf16 v[84:87], a[244:247], a[52:55], v[84:87]
  v_mfma_f32_16x16x32_bf16 v[88:91], a[248:251], a[52:55], v[88:91]
  v_mfma_f32_16x16x32_bf16 v[92:95], a[252:255], a[52:55], v[92:95]
  v_mfma_f32_16x16x32_bf16 v[80:83], a[96:99], a[56:59], v[80:83]
  v_mfma_f32_16x16x32_bf16 v[84:87], a[100:103], a[56:59], v[84:87]
  v_mfma_f32_16x16x32_bf16 v[88:91], a[104:107], a[56:59], v[88:91]
  v_mfma_f32_16x16x32_bf16 v[92:95], a[108:111], a[56:59], v[92:95]
  v_mfma_f32_16x16x32_bf16 v[80:83], a[112:115], a[60:63], v[80:83]
  v_mfma_f32_16x16x32_bf16 v[84:87], a[116:119], a[60:63], v[84:87]
  v_mfma_f32_16x16x32_bf16 v[88:91], a[120:123], a[60:63], v[88:91]
  v_mfma_f32_16x16x32_bf16 v[92:95], a[124:127], a[60:63], v[92:95]
  s_waitcnt vmcnt(0)
  s_mov_b32 s40, 0
  v_cmp_ne_u64 vcc, s[76:77], v[6:7]
  s_nop 0
  s_cbranch_vccz adaLN_cond__compressed_kv_cla__mixer_channel_mlp__prompt_kernel_ok7
adaLN_cond__compressed_kv_cla__mixer_channel_mlp__prompt_kernel_sp8:
  s_sleep 2
  buffer_load_dwordx2 v[6:7], v5, s[12:15], s48 offen sc1
  s_waitcnt vmcnt(0)
  s_add_u32 s40, s40, 1
  v_cmp_ne_u64 vcc, s[76:77], v[6:7]
  s_nop 0
  s_cbranch_vccz adaLN_cond__compressed_kv_cla__mixer_channel_mlp__prompt_kernel_ok7
  s_cmp_lt_u32 s40, 0x4000
  s_cbranch_scc1 adaLN_cond__compressed_kv_cla__mixer_channel_mlp__prompt_kernel_sp8
adaLN_cond__compressed_kv_cla__mixer_channel_mlp__prompt_kernel_ok7:
  s_add_u32 m0, s45, 0
  s_nop 0
  buffer_load_dwordx4 v4, s[12:15], s44 offen offset:0 sc1 lds
  buffer_load_dwordx4 v4, s[12:15], s44 offen offset:1024 sc1 lds
  buffer_load_dwordx4 v4, s[12:15], s44 offen offset:2048 sc1 lds
  buffer_load_dwordx4 v4, s[12:15], s44 offen offset:3072 sc1 lds
  s_add_u32 s44, s44, 4096
  s_add_u32 m0, s45, 4096
  s_nop 0
  buffer_load_dwordx4 v4, s[12:15], s44 offen offset:0 sc1 lds
  buffer_load_dwordx4 v4, s[12:15], s44 offen offset:1024 sc1 lds
  buffer_load_dwordx4 v4, s[12:15], s44 offen offset:2048 sc1 lds
  buffer_load_dwordx4 v4, s[12:15], s44 offen offset:3072 sc1 lds
  s_add_u32 s44, s44, 4096
  s_add_u32 m0, s45, 8192
  s_nop 0
  buffer_load_dwordx4 v4, s[12:15], s44 offen offset:0 sc1 lds
  buffer_load_dwordx4 v4, s[12:15], s44 offen offset:1024 sc1 lds
  buffer_load_dwordx4 v4, s[12:15], s44 offen offset:2048 sc1 lds
  buffer_load_dwordx4 v4, s[12:15], s44 offen offset:3072 sc1 lds
  s_add_u32 s44, s44, 4096
  s_add_u32 m0, s45, 12288
  s_nop 0
  buffer_load_dwordx4 v4, s[12:15], s44 offen offset:0 sc1 lds
  buffer_load_dwordx4 v4, s[12:15], s44 offen offset:1024 sc1 lds
  buffer_load_dwordx4 v4, s[12:15], s44 offen offset:2048 sc1 lds
  buffer_load_dwordx4 v4, s[12:15], s44 offen offset:3072 sc1 lds
  ds_read_b128 a[144:147], v228 offset:49152
  ds_read_b128 a[148:151], v228 offset:50176
  ds_read_b128 a[152:155], v228 offset:51200
  ds_read_b128 a[156:159], v228 offset:52224
  v_readlane_b32 s50, v96, 0
  v_readlane_b32 s51, v96, 1
  v_readlane_b32 s52, v96, 2
  v_readlane_b32 s53, v97, 1
  v_readlane_b32 s54, v97, 2
  s_waitcnt vmcnt(12)
  s_barrier
  ds_read_b128 a[64:67], v242 offset:0
  ds_read_b128 a[68:71], v242 offset:16384
  ds_read_b128 a[72:75], v242 offset:32768
  ds_read_b128 a[76:79], v242 offset:49152
  s_waitcnt lgkmcnt(0)
  v_mfma_f32_16x16x32_bf16 v[16:19], a[144:147], a[64:67], 0
  ds_read_b128 a[80:83], v242 offset:1024
  v_mfma_f32_16x16x32_bf16 v[20:23], a[144:147], a[68:71], 0
  buffer_load_dwordx4 v[100:103], v13, s[12:15], s47 offen sc1
  v_mfma_f32_16x16x32_bf16 v[24:27], a[144:147], a[72:75], 0
  ds_read_b128 a[84:87], v242 offset:17408
  ds_read_b128 a[88:91], v242 offset:33792
  v_mfma_f32_16x16x32_bf16 v[28:31], a[144:147], a[76:79], 0
  buffer_load_dwordx2 v[104:105], v13, s[12:15], s47 offen offset:16 sc1
  v_mfma_f32_16x16x32_bf16 v[80:83], a[144:147], a[0:3], v[80:83]
  buffer_load_dwordx4 v[108:111], v13, s[12:15], s55 offen sc1
  v_mfma_f32_16x16x32_bf16 v[32:35], a[148:151], a[64:67], 0
  ds_read_b128 a[92:95], v242 offset:50176
  ds_read_b128 a[128:131], v228 offset:0
  v_mfma_f32_16x16x32_bf16 v[36:39], a[148:151], a[68:71], 0
  buffer_load_dwordx2 v[112:113], v13, s[12:15], s55 offen offset:16 sc1
  v_mfma_f32_16x16x32_bf16 v[40:43], a[148:151], a[72:75], 0
  ds_read_b128 a[132:135], v228 offset:1024
  ds_read_b128 a[136:139], v228 offset:2048
  v_mfma_f32_16x16x32_bf16 v[44:47], a[148:151], a[76:79], 0
  ds_read_b128 a[140:143], v228 offset:3072
  s_add_u32 s49, s31, 12288
  v_mfma_f32_16x16x32_bf16 v[84:87], a[148:151], a[0:3], v[84:87]
  s_add_u32 s3, s24, 12288
  s_add_u32 m0, s29, 49152
  v_mfma_f32_16x16x32_bf16 v[48:51], a[152:155], a[64:67], 0
  buffer_load_dwordx4 v4, s[12:15], s49 offen offset:0 sc1 lds
  v_mfma_f32_16x16x32_bf16 v[52:55], a[152:155], a[68:71], 0
  v_mfma_f32_16x16x32_bf16 v[56:59], a[152:155], a[72:75], 0
  buffer_load_dwordx4 v4, s[12:15], s49 offen offset:1024 sc1 lds
  v_mfma_f32_16x16x32_bf16 v[60:63], a[152:155], a[76:79], 0
  s_add_u32 m0, s29, 51200
  v_mfma_f32_16x16x32_bf16 v[88:91], a[152:155], a[0:3], v[88:91]
  v_mfma_f32_16x16x32_bf16 v[64:67], a[156:159], a[64:67], 0
  buffer_load_dwordx4 v4, s[12:15], s3 offen offset:0 sc1 lds
  v_mfma_f32_16x16x32_bf16 v[68:71], a[156:159], a[68:71], 0
  buffer_load_dwordx4 v4, s[12:15], s3 offen offset:1024 sc1 lds
  v_mfma_f32_16x16x32_bf16 v[72:75], a[156:159], a[72:75], 0
  v_mfma_f32_16x16x32_bf16 v[76:79], a[156:159], a[76:79], 0
  v_mfma_f32_16x16x32_bf16 v[92:95], a[156:159], a[0:3], v[92:95]
  s_waitcnt lgkmcnt(0)
  v_mfma_f32_16x16x32_bf16 v[16:19], a[128:131], a[80:83], v[16:19]
  ds_read_b128 a[64:67], v242 offset:2048
  v_mfma_f32_16x16x32_bf16 v[20:23], a[128:131], a[84:87], v[20:23]
  ds_read_b128 a[68:71], v242 offset:18432
  s_add_u32 s49, s31, 14336
  v_mfma_f32_16x16x32_bf16 v[24:27], a[128:131], a[88:91], v[24:27]
  ds_read_b128 a[72:75], v242 offset:34816
  v_mfma_f32_16x16x32_bf16 v[28:31], a[128:131], a[92:95], v[28:31]
  ds_read_b128 a[76:79], v242 offset:51200
  s_add_u32 s3, s24, 14336
  v_mfma_f32_16x16x32_bf16 v[80:83], a[128:131], a[4:7], v[80:83]
  v_mfma_f32_16x16x32_bf16 v[32:35], a[132:135], a[80:83], v[32:35]
  ds_read_b128 a[144:147], v228 offset:16384
  s_add_u32 m0, s29, 0
  v_mfma_f32_16x16x32_bf16 v[36:39], a[132:135], a[84:87], v[36:39]
  ds_read_b128 a[148:151], v228 offset:17408
  v_mfma_f32_16x16x32_bf16 v[40:43], a[132:135], a[88:91], v[40:43]
  buffer_load_dwordx4 v4, s[12:15], s49 offen offset:0 sc1 lds
  v_mfma_f32_16x16x32_bf16 v[44:47], a[132:135], a[92:95], v[44:47]
  ds_read_b128 a[152:155], v228 offset:18432
  ds_read_b128 a[156:159], v228 offset:19456
  v_mfma_f32_16x16x32_bf16 v[84:87], a[132:135], a[4:7], v[84:87]
  buffer_load_dwordx4 v4, s[12:15], s49 offen offset:1024 sc1 lds
  v_mfma_f32_16x16x32_bf16 v[48:51], a[136:139], a[80:83], v[48:51]
  v_mfma_f32_16x16x32_bf16 v[52:55], a[136:139], a[84:87], v[52:55]
  s_add_u32 m0, s29, 2048
  v_mfma_f32_16x16x32_bf16 v[56:59], a[136:139], a[88:91], v[56:59]
  v_mfma_f32_16x16x32_bf16 v[60:63], a[136:139], a[92:95], v[60:63]
  buffer_load_dwordx4 v4, s[12:15], s3 offen offset:0 sc1 lds
  v_mfma_f32_16x16x32_bf16 v[88:91], a[136:139], a[4:7], v[88:91]
  v_mfma_f32_16x16x32_bf16 v[64:67], a[140:143], a[80:83], v[64:67]
  buffer_load_dwordx4 v4, s[12:15], s3 offen offset:1024 sc1 lds
  v_mfma_f32_16x16x32_bf16 v[68:71], a[140:143], a[84:87], v[68:71]
  v_mfma_f32_16x16x32_bf16 v[72:75], a[140:143], a[88:91], v[72:75]
  v_mfma_f32_16x16x32_bf16 v[76:79], a[140:143], a[92:95], v[76:79]
  v_mfma_f32_16x16x32_bf16 v[92:95], a[140:143], a[4:7], v[92:95]
  s_waitcnt lgkmcnt(0)
  v_mfma_f32_16x16x32_bf16 v[16:19], a[144:147], a[64:67], v[16:19]
  ds_read_b128 a[80:83], v242 offset:3072
  s_waitcnt vmcnt(8)
  v_mfma_f32_16x16x32_bf16 v[20:23], a[144:147], a[68:71], v[20:23]
  ds_read_b128 a[84:87], v242 offset:19456
  s_add_u32 s49, s32, 32768
  v_mfma_f32_16x16x32_bf16 v[24:27], a[144:147], a[72:75], v[24:27]
  ds_read_b128 a[88:91], v242 offset:35840
  v_add_f32 v100, v100, v108
  v_mfma_f32_16x16x32_bf16 v[28:31], a[144:147], a[76:79], v[28:31]
  ds_read_b128 a[92:95], v242 offset:52224
  s_add_u32 m0, s29, 16384
  v_mfma_f32_16x16x32_bf16 v[80:83], a[144:147], a[8:11], v[80:83]
  v_add_f32 v101, v101, v109
  v_add_f32 v102, v102, v110
  v_mfma_f32_16x16x32_bf16 v[32:35], a[148:151], a[64:67], v[32:35]
  ds_read_b128 a[128:131], v229 offset:0
  v_add_f32 v103, v103, v111
  v_mfma_f32_16x16x32_bf16 v[36:39], a[148:151], a[68:71], v[36:39]
  ds_read_b128 a[132:135], v229 offset:1024
  v_add_f32 v104, v104, v112
  v_mfma_f32_16x16x32_bf16 v[40:43], a[148:151], a[72:75], v[40:43]
  ds_read_b128 a[136:139], v229 offset:2048
  v_add_f32 v105, v105, v113
  v_mfma_f32_16x16x32_bf16 v[44:47], a[148:151], a[76:79], v[44:47]
  ds_read_b128 a[140:143], v229 offset:3072
  v_mov_b32 v108, v100
  v_mfma_f32_16x16x32_bf16 v[84:87], a[148:151], a[8:11], v[84:87]
  buffer_load_dwordx4 v4, s[12:15], s49 offen offset:0 sc1 lds
  v_mfma_f32_16x16x32_bf16 v[48:51], a[152:155], a[64:67], v[48:51]
  buffer_load_dwordx4 v4, s[12:15], s49 offen offset:1024 sc1 lds
  v_mfma_f32_16x16x32_bf16 v[52:55], a[152:155], a[68:71], v[52:55]
  v_mov_b32 v109, v101
  v_mov_b32 v110, v102
  v_mfma_f32_16x16x32_bf16 v[56:59], a[152:155], a[72:75], v[56:59]
  buffer_load_dwordx4 v4, s[12:15], s49 offen offset:2048 sc1 lds
  v_mfma_f32_16x16x32_bf16 v[60:63], a[152:155], a[76:79], v[60:63]
  v_mov_b32 v111, v103
  v_mov_b32 v112, v104
  v_mfma_f32_16x16x32_bf16 v[88:91], a[152:155], a[8:11], v[88:91]
  v_mov_b32 v113, v105
  v_permlane32_swap_b32 v100, v108
  v_mfma_f32_16x16x32_bf16 v[64:67], a[156:159], a[64:67], v[64:67]
  buffer_load_dwordx4 v4, s[12:15], s49 offen offset:3072 sc1 lds
  v_mfma_f32_16x16x32_bf16 v[68:71], a[156:159], a[68:71], v[68:71]
  v_permlane32_swap_b32 v101, v109
  v_permlane32_swap_b32 v102, v110
  v_mfma_f32_16x16x32_bf16 v[72:75], a[156:159], a[72:75], v[72:75]
  v_permlane32_swap_b32 v103, v111
  v_permlane32_swap_b32 v104, v112
  v_mfma_f32_16x16x32_bf16 v[76:79], a[156:159], a[76:79], v[76:79]
  v_permlane32_swap_b32 v105, v113
  v_add_f32 v100, v100, v108
  v_mfma_f32_16x16x32_bf16 v[92:95], a[156:159], a[8:11], v[92:95]
  v_add_f32 v101, v101, v109
  v_add_f32 v102, v102, v110
  s_waitcnt lgkmcnt(0)
  s_barrier
  s_waitcnt lgkmcnt(0)
  v_mfma_f32_16x16x32_bf16 v[16:19], a[128:131], a[80:83], v[16:19]
  ds_read_b128 a[64:67], v242 offset:4096
  v_add_f32 v103, v103, v111
  v_mfma_f32_16x16x32_bf16 v[20:23], a[128:131], a[84:87], v[20:23]
  ds_read_b128 a[68:71], v242 offset:20480
  s_add_u32 s49, s32, 36864
  v_mfma_f32_16x16x32_bf16 v[24:27], a[128:131], a[88:91], v[24:27]
  ds_read_b128 a[72:75], v242 offset:36864
  v_add_f32 v104, v104, v112
  v_mfma_f32_16x16x32_bf16 v[28:31], a[128:131], a[92:95], v[28:31]
  ds_read_b128 a[76:79], v242 offset:53248
  s_add_u32 m0, s29, 131072
  v_mfma_f32_16x16x32_bf16 v[80:83], a[128:131], a[12:15], v[80:83]
  v_add_f32 v105, v105, v113
  v_mov_b32 v108, v100
  v_mfma_f32_16x16x32_bf16 v[32:35], a[132:135], a[80:83], v[32:35]
  ds_read_b128 a[144:147], v229 offset:16384
  v_mov_b32 v109, v101
  v_mfma_f32_16x16x32_bf16 v[36:39], a[132:135], a[84:87], v[36:39]
  ds_read_b128 a[148:151], v229 offset:17408
  v_mov_b32 v110, v102
  v_mfma_f32_16x16x32_bf16 v[40:43], a[132:135], a[88:91], v[40:43]
  ds_read_b128 a[152:155], v229 offset:18432
  v_mov_b32 v111, v103
  v_mfma_f32_16x16x32_bf16 v[44:47], a[132:135], a[92:95], v[44:47]
  ds_read_b128 a[156:159], v229 offset:19456
  v_mov_b32 v112, v104
  v_mfma_f32_16x16x32_bf16 v[84:87], a[132:135], a[12:15], v[84:87]
  buffer_load_dwordx4 v4, s[12:15], s49 offen offset:0 sc1 lds
  v_mfma_f32_16x16x32_bf16 v[48:51], a[136:139], a[80:83], v[48:51]
  buffer_load_dwordx4 v4, s[12:15], s49 offen offset:1024 sc1 lds
  v_mfma_f32_16x16x32_bf16 v[52:55], a[136:139], a[84:87], v[52:55]
  v_mov_b32 v113, v105
  v_permlane16_swap_b32 v100, v108
  v_mfma_f32_16x16x32_bf16 v[56:59], a[136:139], a[88:91], v[56:59]
  buffer_load_dwordx4 v4, s[12:15], s49 offen offset:2048 sc1 lds
  v_mfma_f32_16x16x32_bf16 v[60:63], a[136:139], a[92:95], v[60:63]
  v_permlane16_swap_b32 v101, v109
  v_permlane16_swap_b32 v102, v110
  v_mfma_f32_16x16x32_bf16 v[88:91], a[136:139], a[12:15], v[88:91]
  v_permlane16_swap_b32 v103, v111
  v_permlane16_swap_b32 v104, v112
  v_mfma_f32_16x16x32_bf16 v[64:67], a[140:143], a[80:83], v[64:67]
  buffer_load_dwordx4 v4, s[12:15], s49 offen offset:3072 sc1 lds
  v_mfma_f32_16x16x32_bf16 v[68:71], a[140:143], a[84:87], v[68:71]
  v_permlane16_swap_b32 v105, v113
  v_add_f32 v100, v100, v108
  v_mfma_f32_16x16x32_bf16 v[72:75], a[140:143], a[88:91], v[72:75]
  v_add_f32 v101, v101, v109
  v_add_f32 v102, v102, v110
  v_mfma_f32_16x16x32_bf16 v[76:79], a[140:143], a[92:95], v[76:79]
  v_add_f32 v103, v103, v111
  v_add_f32 v104, v104, v112
  v_mfma_f32_16x16x32_bf16 v[92:95], a[140:143], a[12:15], v[92:95]
  v_add_f32 v105, v105, v113
  v_mul_f32 v108, 0x3b000000, v100
  s_waitcnt lgkmcnt(0)
  v_mfma_f32_16x16x32_bf16 v[16:19], a[144:147], a[64:67], v[16:19]
  ds_read_b128 a[80:83], v242 offset:5120
  v_mul_f32 v101, 0x3b000000, v101
  v_mfma_f32_16x16x32_bf16 v[20:23], a[144:147], a[68:71], v[20:23]
  ds_read_b128 a[84:87], v242 offset:21504
  s_add_u32 s49, s32, 40960
  v_mfma_f32_16x16x32_bf16 v[24:27], a[144:147], a[72:75], v[24:27]
  ds_read_b128 a[88:91], v242 offset:37888
  v_fma_f32 v101, -v108, v108, v101
  v_mfma_f32_16x16x32_bf16 v[28:31], a[144:147], a[76:79], v[28:31]
  ds_read_b128 a[92:95], v242 offset:54272
  s_add_u32 m0, s29, 147456
  v_mfma_f32_16x16x32_bf16 v[80:83], a[144:147], a[16:19], v[80:83]
  v_max_f32 v101, 0, v101
  v_add_f32 v101, 0x3727c5ac, v101
  v_mfma_f32_16x16x32_bf16 v[32:35], a[148:151], a[64:67], v[32:35]
  v_rsq_f32 v109, v101
  v_mfma_f32_16x16x32_bf16 v[36:39], a[148:151], a[68:71], v[36:39]
  ds_read_b128 a[128:131], v228 offset:32768
  ds_read_b128 a[132:135], v228 offset:33792
  v_mfma_f32_16x16x32_bf16 v[40:43], a[148:151], a[72:75], v[40:43]
  ds_read_b128 a[136:139], v228 offset:34816
  v_fma_f32 v102, -v108, s52, v102
  v_mfma_f32_16x16x32_bf16 v[44:47], a[148:151], a[76:79], v[44:47]
  ds_read_b128 a[140:143], v228 offset:35840
  v_mul_f32 v110, s50, v108
  v_mfma_f32_16x16x32_bf16 v[84:87], a[148:151], a[16:19], v[84:87]
  buffer_load_dwordx4 v4, s[12:15], s49 offen offset:0 sc1 lds
  v_mfma_f32_16x16x32_bf16 v[48:51], a[152:155], a[64:67], v[48:51]
  buffer_load_dwordx4 v4, s[12:15], s49 offen offset:1024 sc1 lds
  v_mfma_f32_16x16x32_bf16 v[52:55], a[152:155], a[68:71], v[52:55]
  v_fma_f32 v110, -2.0, v104, v110
  v_fma_f32 v110, v110, v108, v103
  v_mfma_f32_16x16x32_bf16 v[56:59], a[152:155], a[72:75], v[56:59]
  buffer_load_dwordx4 v4, s[12:15], s49 offen offset:2048 sc1 lds
  v_mfma_f32_16x16x32_bf16 v[60:63], a[152:155], a[76:79], v[60:63]
  v_fma_f32 v111, -v108, s51, v105
  v_add_f32 v111, v111, v111
  v_mfma_f32_16x16x32_bf16 v[88:91], a[152:155], a[16:19], v[88:91]
  v_fma_f32 v102, v102, v109, s54
  v_mul_f32 v102, 0x3b000000, v102
  v_mfma_f32_16x16x32_bf16 v[64:67], a[156:159], a[64:67], v[64:67]
  buffer_load_dwordx4 v4, s[12:15], s49 offen offset:3072 sc1 lds
  v_mfma_f32_16x16x32_bf16 v[68:71], a[156:159], a[68:71], v[68:71]
  v_fma_f32 v112, v109, v110, v111
  v_fma_f32 v112, v112, v109, s53
  v_mfma_f32_16x16x32_bf16 v[72:75], a[156:159], a[72:75], v[72:75]
  v_mul_f32 v112, 0x3b000000, v112
  v_fma_f32 v112, -v102, v102, v112
  v_mfma_f32_16x16x32_bf16 v[76:79], a[156:159], a[76:79], v[76:79]
  v_max_f32 v112, 0, v112
  v_add_f32 v112, 0x3727c5ac, v112
  v_mfma_f32_16x16x32_bf16 v[92:95], a[156:159], a[16:19], v[92:95]
  v_rsq_f32 v118, v112
  s_nop 0
  v_mul_f32 v116, v118, v109
  v_mul_f32 v119, v118, v102
  s_waitcnt vmcnt(16)
  s_waitcnt lgkmcnt(0)
  v_mfma_f32_16x16x32_bf16 v[16:19], a[128:131], a[80:83], v[16:19]
  ds_read_b128 a[64:67], v242 offset:6144
  v_mul_f32 v117, v116, v108
  v_mfma_f32_16x16x32_bf16 v[20:23], a[128:131], a[84:87], v[20:23]
  ds_read_b128 a[68:71], v242 offset:22528
  s_add_u32 s49, s32, 45056
  v_mfma_f32_16x16x32_bf16 v[24:27], a[128:131], a[88:91], v[24:27]
  ds_read_b128 a[72:75], v242 offset:38912
  v_sub_f32 v119, 0, v119
  v_mfma_f32_16x16x32_bf16 v[28:31], a[128:131], a[92:95], v[28:31]
  ds_read_b128 a[76:79], v242 offset:55296
  s_add_u32 m0, s29, 32768
  v_mfma_f32_16x16x32_bf16 v[80:83], a[128:131], a[20:23], v[80:83]
  v_sub_f32 v117, 0, v117
  v_and_b32 v12, 15, v1
  v_mfma_f32_16x16x32_bf16 v[32:35], a[132:135], a[80:83], v[32:35]
  ds_read_b128 a[144:147], v228 offset:49152
  v_lshlrev_b32 v12, 4, v12
  v_mfma_f32_16x16x32_bf16 v[36:39], a[132:135], a[84:87], v[36:39]
  ds_read_b128 a[148:151], v228 offset:50176
  v_add_u32 v12, 0x10000, v12
  v_mfma_f32_16x16x32_bf16 v[40:43], a[132:135], a[88:91], v[40:43]
  ds_read_b128 a[152:155], v228 offset:51200
  s_lshl_b32 s41, s20, 14
  v_mfma_f32_16x16x32_bf16 v[44:47], a[132:135], a[92:95], v[44:47]
  ds_read_b128 a[156:159], v228 offset:52224
  v_add_u32 v13, s41, v12
  v_mfma_f32_16x16x32_bf16 v[84:87], a[132:135], a[20:23], v[84:87]
  buffer_load_dwordx4 v4, s[12:15], s49 offen offset:0 sc1 lds
  v_mfma_f32_16x16x32_bf16 v[48:51], a[136:139], a[80:83], v[48:51]
  buffer_load_dwordx4 v4, s[12:15], s49 offen offset:1024 sc1 lds
  v_mfma_f32_16x16x32_bf16 v[52:55], a[136:139], a[84:87], v[52:55]
  v_lshlrev_b32 v172, 16, v164
  v_mfma_f32_16x16x32_bf16 v[56:59], a[136:139], a[88:91], v[56:59]
  buffer_load_dwordx4 v4, s[12:15], s49 offen offset:2048 sc1 lds
  v_mfma_f32_16x16x32_bf16 v[60:63], a[136:139], a[92:95], v[60:63]
  v_and_b32 v173, 0xffff0000, v164
  v_lshlrev_b32 v174, 16, v165
  v_mfma_f32_16x16x32_bf16 v[88:91], a[136:139], a[20:23], v[88:91]
  v_and_b32 v175, 0xffff0000, v165
  v_lshlrev_b32 v176, 16, v166
  v_mfma_f32_16x16x32_bf16 v[64:67], a[140:143], a[80:83], v[64:67]
  buffer_load_dwordx4 v4, s[12:15], s49 offen offset:3072 sc1 lds
  v_mfma_f32_16x16x32_bf16 v[68:71], a[140:143], a[84:87], v[68:71]
  v_and_b32 v177, 0xffff0000, v166
  v_lshlrev_b32 v178, 16, v167
  v_mfma_f32_16x16x32_bf16 v[72:75], a[140:143], a[88:91], v[72:75]
  v_and_b32 v179, 0xffff0000, v167
  s_mov_b32 s62, 0xbdd2d3e8
  v_mfma_f32_16x16x32_bf16 v[76:79], a[140:143], a[92:95], v[76:79]
  s_mov_b32 s63, 0xbdd2d3e8
  v_mov_b32 v212, 0xc0135761
  v_mfma_f32_16x16x32_bf16 v[92:95], a[140:143], a[20:23], v[92:95]
  v_mov_b32 v213, 0xc0135761
  s_mul_i32 s41, s23, 7
  s_waitcnt vmcnt(16)
  s_waitcnt lgkmcnt(0)
  v_mfma_f32_16x16x32_bf16 v[16:19], a[144:147], a[64:67], v[16:19]
  ds_read_b128 a[80:83], v242 offset:7168
  s_lshl_b32 s42, s20, 1
  v_mfma_f32_16x16x32_bf16 v[20:23], a[144:147], a[68:71], v[20:23]
  ds_read_b128 a[84:87], v242 offset:23552
  s_add_u32 s49, s32, 49152
  v_mfma_f32_16x16x32_bf16 v[24:27], a[144:147], a[72:75], v[24:27]
  ds_read_b128 a[88:91], v242 offset:39936
  s_add_u32 s41, s41, s42
  v_mfma_f32_16x16x32_bf16 v[28:31], a[144:147], a[76:79], v[28:31]
  ds_read_b128 a[92:95], v242 offset:56320
  s_add_u32 m0, s29, 49152
  v_mfma_f32_16x16x32_bf16 v[80:83], a[144:147], a[24:27], v[80:83]
  s_mul_i32 s42, s41, 4682
  s_lshr_b32 s42, s42, 16
  v_mfma_f32_16x16x32_bf16 v[32:35], a[148:151], a[64:67], v[32:35]
  ds_read_b128 a[128:131], v228 offset:0
  s_mul_i32 s42, s42, 18
  v_mfma_f32_16x16x32_bf16 v[36:39], a[148:151], a[68:71], v[36:39]
  ds_read_b128 a[132:135], v228 offset:1024
  s_add_u32 s42, s42, s41
  v_mfma_f32_16x16x32_bf16 v[40:43], a[148:151], a[72:75], v[40:43]
  ds_read_b128 a[136:139], v228 offset:2048
  s_lshl_b32 s42, s42, 10
  v_mfma_f32_16x16x32_bf16 v[44:47], a[148:151], a[76:79], v[44:47]
  ds_read_b128 a[140:143], v228 offset:3072
  s_add_u32 s41, s41, 1
  v_mfma_f32_16x16x32_bf16 v[84:87], a[148:151], a[24:27], v[84:87]
  buffer_load_dwordx4 v4, s[12:15], s49 offen offset:0 sc1 lds
  v_mfma_f32_16x16x32_bf16 v[48:51], a[152:155], a[64:67], v[48:51]
  buffer_load_dwordx4 v4, s[12:15], s49 offen offset:1024 sc1 lds
  v_mfma_f32_16x16x32_bf16 v[52:55], a[152:155], a[68:71], v[52:55]
  s_mul_i32 s43, s41, 4682
  s_lshr_b32 s43, s43, 16
  v_mfma_f32_16x16x32_bf16 v[56:59], a[152:155], a[72:75], v[56:59]
  buffer_load_dwordx4 v4, s[12:15], s49 offen offset:2048 sc1 lds
  v_mfma_f32_16x16x32_bf16 v[60:63], a[152:155], a[76:79], v[60:63]
  s_mul_i32 s43, s43, 18
  s_add_u32 s43, s43, s41
  v_mfma_f32_16x16x32_bf16 v[88:91], a[152:155], a[24:27], v[88:91]
  s_lshl_b32 s43, s43, 10
  s_add_u32 s41, s41, 1
  v_mfma_f32_16x16x32_bf16 v[64:67], a[156:159], a[64:67], v[64:67]
  buffer_load_dwordx4 v4, s[12:15], s49 offen offset:3072 sc1 lds
  v_mfma_f32_16x16x32_bf16 v[68:71], a[156:159], a[68:71], v[68:71]
  s_mul_i32 s41, s98, 524288
  s_add_u32 s41, s41, 0x2004800
  v_mfma_f32_16x16x32_bf16 v[72:75], a[156:159], a[72:75], v[72:75]
  s_add_u32 s42, s42, s41
  s_add_u32 s43, s43, s41
  v_mfma_f32_16x16x32_bf16 v[76:79], a[156:159], a[76:79], v[76:79]
  v_add_u32 v8, 0, v4
  v_add_u32 v9, 131072, v4
  v_mfma_f32_16x16x32_bf16 v[92:95], a[156:159], a[24:27], v[92:95]
  v_add_u32 v10, 262144, v4
  v_add_u32 v11, 393216, v4
  s_waitcnt lgkmcnt(0)
  s_barrier
  s_waitcnt lgkmcnt(0)
  v_mfma_f32_16x16x32_bf16 v[16:19], a[128:131], a[80:83], v[16:19]
  ds_read_b128 a[64:67], v242 offset:8192
  v_mfma_f32_16x16x32_bf16 v[20:23], a[128:131], a[84:87], v[20:23]
  s_add_u32 s49, s32, 53248
  v_mfma_f32_16x16x32_bf16 v[24:27], a[128:131], a[88:91], v[24:27]
  ds_read_b128 a[68:71], v242 offset:24576
  v_mfma_f32_16x16x32_bf16 v[28:31], a[128:131], a[92:95], v[28:31]
  s_add_u32 m0, s29, 0
  v_mfma_f32_16x16x32_bf16 v[80:83], a[128:131], a[28:31], v[80:83]
  v_mfma_f32_16x16x32_bf16 v[32:35], a[132:135], a[80:83], v[32:35]
  ds_read_b128 a[72:75], v242 offset:40960
  v_mfma_f32_16x16x32_bf16 v[36:39], a[132:135], a[84:87], v[36:39]
  buffer_load_dwordx4 v4, s[12:15], s49 offen offset:0 sc1 lds
  v_mfma_f32_16x16x32_bf16 v[40:43], a[132:135], a[88:91], v[40:43]
  ds_read_b128 a[76:79], v242 offset:57344
  v_mfma_f32_16x16x32_bf16 v[44:47], a[132:135], a[92:95], v[44:47]
  v_mfma_f32_16x16x32_bf16 v[84:87], a[132:135], a[28:31], v[84:87]
  buffer_load_dwordx4 v4, s[12:15], s49 offen offset:1024 sc1 lds
  v_mfma_f32_16x16x32_bf16 v[48:51], a[136:139], a[80:83], v[48:51]
  v_mfma_f32_16x16x32_bf16 v[52:55], a[136:139], a[84:87], v[52:55]
  v_mfma_f32_16x16x32_bf16 v[56:59], a[136:139], a[88:91], v[56:59]
  buffer_load_dwordx4 v4, s[12:15], s49 offen offset:2048 sc1 lds
  v_mfma_f32_16x16x32_bf16 v[60:63], a[136:139], a[92:95], v[60:63]
  v_mfma_f32_16x16x32_bf16 v[88:91], a[136:139], a[28:31], v[88:91]
  v_mfma_f32_16x16x32_bf16 v[64:67], a[140:143], a[80:83], v[64:67]
  buffer_load_dwordx4 v4, s[12:15], s49 offen offset:3072 sc1 lds
  v_mfma_f32_16x16x32_bf16 v[68:71], a[140:143], a[84:87], v[68:71]
  v_mfma_f32_16x16x32_bf16 v[72:75], a[140:143], a[88:91], v[72:75]
  v_mfma_f32_16x16x32_bf16 v[76:79], a[140:143], a[92:95], v[76:79]
  v_mfma_f32_16x16x32_bf16 v[92:95], a[140:143], a[28:31], v[92:95]
  s_waitcnt lgkmcnt(0)
  v_mfma_f32_16x16x32_bf16 v[16:19], a[160:163], a[64:67], v[16:19]
  ds_read_b128 a[80:83], v242 offset:9216
  v_mfma_f32_16x16x32_bf16 v[20:23], a[160:163], a[68:71], v[20:23]
  v_mfma_f32_16x16x32_bf16 v[24:27], a[160:163], a[72:75], v[24:27]
  ds_read_b128 a[84:87], v242 offset:25600
  v_mfma_f32_16x16x32_bf16 v[28:31], a[160:163], a[76:79], v[28:31]
  v_mfma_f32_16x16x32_bf16 v[32:35], a[164:167], a[64:67], v[32:35]
  ds_read_b128 a[88:91], v242 offset:41984
  v_mfma_f32_16x16x32_bf16 v[36:39], a[164:167], a[68:71], v[36:39]
  v_mfma_f32_16x16x32_bf16 v[40:43], a[164:167], a[72:75], v[40:43]
  ds_read_b128 a[92:95], v242 offset:58368
  v_mfma_f32_16x16x32_bf16 v[44:47], a[164:167], a[76:79], v[44:47]
  v_mfma_f32_16x16x32_bf16 v[48:51], a[168:171], a[64:67], v[48:51]
  ds_write_b128 v13, v[116:119]
  v_mfma_f32_16x16x32_bf16 v[52:55], a[168:171], a[68:71], v[52:55]
  v_mfma_f32_16x16x32_bf16 v[56:59], a[168:171], a[72:75], v[56:59]
  v_mfma_f32_16x16x32_bf16 v[60:63], a[168:171], a[76:79], v[60:63]
  v_mfma_f32_16x16x32_bf16 v[64:67], a[172:175], a[64:67], v[64:67]
  v_mfma_f32_16x16x32_bf16 v[68:71], a[172:175], a[68:71], v[68:71]
  v_mfma_f32_16x16x32_bf16 v[72:75], a[172:175], a[72:75], v[72:75]
  v_mfma_f32_16x16x32_bf16 v[76:79], a[172:175], a[76:79], v[76:79]
  s_waitcnt lgkmcnt(0)
  v_mfma_f32_16x16x32_bf16 v[16:19], a[176:179], a[80:83], v[16:19]
  ds_read_b128 a[64:67], v242 offset:10240
  v_mfma_f32_16x16x32_bf16 v[20:23], a[176:179], a[84:87], v[20:23]
  s_add_u32 s49, s32, 0
  v_mfma_f32_16x16x32_bf16 v[24:27], a[176:179], a[88:91], v[24:27]
  ds_read_b128 a[68:71], v242 offset:26624
  v_mov_b32_dpp v180, v80 row_newbcast:0 row_mask:0xf bank_mask:0xf
  v_mfma_f32_16x16x32_bf16 v[28:31], a[176:179], a[92:95], v[28:31]
  buffer_load_dwordx4 a[160:163], v4, s[12:15], s49 offen offset:0 sc1
  v_mfma_f32_16x16x32_bf16 v[32:35], a[180:183], a[80:83], v[32:35]
  v_mov_b32_dpp v181, v81 row_newbcast:0 row_mask:0xf bank_mask:0xf
  v_mfma_f32_16x16x32_bf16 v[36:39], a[180:183], a[84:87], v[36:39]
  ds_read_b128 a[72:75], v242 offset:43008
  v_mov_b32_dpp v182, v82 row_newbcast:0 row_mask:0xf bank_mask:0xf
  v_mfma_f32_16x16x32_bf16 v[40:43], a[180:183], a[88:91], v[40:43]
  buffer_load_dwordx4 a[164:167], v4, s[12:15], s49 offen offset:1024 sc1
  v_mfma_f32_16x16x32_bf16 v[44:47], a[180:183], a[92:95], v[44:47]
  ds_read_b128 a[76:79], v242 offset:59392
  v_mov_b32_dpp v183, v83 row_newbcast:0 row_mask:0xf bank_mask:0xf
  v_mfma_f32_16x16x32_bf16 v[48:51], a[184:187], a[80:83], v[48:51]
  buffer_load_dwordx4 a[168:171], v4, s[12:15], s49 offen offset:2048 sc1
  v_mfma_f32_16x16x32_bf16 v[52:55], a[184:187], a[84:87], v[52:55]
  v_mov_b32_dpp v184, v84 row_newbcast:0 row_mask:0xf bank_mask:0xf
  v_mfma_f32_16x16x32_bf16 v[56:59], a[184:187], a[88:91], v[56:59]
  v_mov_b32_dpp v185, v85 row_newbcast:0 row_mask:0xf bank_mask:0xf
  v_mfma_f32_16x16x32_bf16 v[60:63], a[184:187], a[92:95], v[60:63]
  buffer_load_dwordx4 a[172:175], v4, s[12:15], s49 offen offset:3072 sc1
  v_mfma_f32_16x16x32_bf16 v[64:67], a[188:191], a[80:83], v[64:67]
  v_mov_b32_dpp v186, v86 row_newbcast:0 row_mask:0xf bank_mask:0xf
  v_mfma_f32_16x16x32_bf16 v[68:71], a[188:191], a[84:87], v[68:71]
  v_mov_b32_dpp v187, v87 row_newbcast:0 row_mask:0xf bank_mask:0xf
  v_mfma_f32_16x16x32_bf16 v[72:75], a[188:191], a[88:91], v[72:75]
  v_mfma_f32_16x16x32_bf16 v[76:79], a[188:191], a[92:95], v[76:79]
  s_waitcnt lgkmcnt(0)
  v_mfma_f32_16x16x32_bf16 v[16:19], a[192:195], a[64:67], v[16:19]
  ds_read_b128 a[80:83], v242 offset:11264
  v_mfma_f32_16x16x32_bf16 v[20:23], a[192:195], a[68:71], v[20:23]
  s_add_u32 s49, s32, 4096
  v_mfma_f32_16x16x32_bf16 v[24:27], a[192:195], a[72:75], v[24:27]
  ds_read_b128 a[84:87], v242 offset:27648
  v_mov_b32_dpp v188, v80 row_newbcast:1 row_mask:0xf bank_mask:0xf
  v_mfma_f32_16x16x32_bf16 v[28:31], a[192:195], a[76:79], v[28:31]
  buffer_load_dwordx4 a[176:179], v4, s[12:15], s49 offen offset:0 sc1
  v_mfma_f32_16x16x32_bf16 v[32:35], a[196:199], a[64:67], v[32:35]
  v_mov_b32_dpp v189, v81 row_newbcast:1 row_mask:0xf bank_mask:0xf
  v_mfma_f32_16x16x32_bf16 v[36:39], a[196:199], a[68:71], v[36:39]
  ds_read_b128 a[88:91], v242 offset:44032
  v_mov_b32_dpp v190, v82 row_newbcast:1 row_mask:0xf bank_mask:0xf
  v_mfma_f32_16x16x32_bf16 v[40:43], a[196:199], a[72:75], v[40:43]
  buffer_load_dwordx4 a[180:183], v4, s[12:15], s49 offen offset:1024 sc1
  v_mfma_f32_16x16x32_bf16 v[44:47], a[196:199], a[76:79], v[44:47]
  ds_read_b128 a[92:95], v242 offset:60416
  v_mov_b32_dpp v191, v83 row_newbcast:1 row_mask:0xf bank_mask:0xf
  v_mfma_f32_16x16x32_bf16 v[48:51], a[200:203], a[64:67], v[48:51]
  buffer_load_dwordx4 a[184:187], v4, s[12:15], s49 offen offset:2048 sc1
  v_mfma_f32_16x16x32_bf16 v[52:55], a[200:203], a[68:71], v[52:55]
  v_mov_b32_dpp v192, v84 row_newbcast:1 row_mask:0xf bank_mask:0xf
  v_mfma_f32_16x16x32_bf16 v[56:59], a[200:203], a[72:75], v[56:59]
  v_mov_b32_dpp v193, v85 row_newbcast:1 row_mask:0xf bank_mask:0xf
  v_mfma_f32_16x16x32_bf16 v[60:63], a[200:203], a[76:79], v[60:63]
  buffer_load_dwordx4 a[188:191], v4, s[12:15], s49 offen offset:3072 sc1
  v_mfma_f32_16x16x32_bf16 v[64:67], a[204:207], a[64:67], v[64:67]
  v_mov_b32_dpp v194, v86 row_newbcast:1 row_mask:0xf bank_mask:0xf
  v_mfma_f32_16x16x32_bf16 v[68:71], a[204:207], a[68:71], v[68:71]
  v_mov_b32_dpp v195, v87 row_newbcast:1 row_mask:0xf bank_mask:0xf
  v_mfma_f32_16x16x32_bf16 v[72:75], a[204:207], a[72:75], v[72:75]
  v_mfma_f32_16x16x32_bf16 v[76:79], a[204:207], a[76:79], v[76:79]
  s_waitcnt lgkmcnt(0)
  s_barrier
  s_waitcnt lgkmcnt(0)
  v_mfma_f32_16x16x32_bf16 v[16:19], a[208:211], a[80:83], v[16:19]
  ds_read_b128 a[64:67], v242 offset:12288
  v_mfma_f32_16x16x32_bf16 v[20:23], a[208:211], a[84:87], v[20:23]
  s_add_u32 s49, s32, 8192
  v_mfma_f32_16x16x32_bf16 v[24:27], a[208:211], a[88:91], v[24:27]
  ds_read_b128 a[68:71], v242 offset:28672
  v_mov_b32_dpp v196, v80 row_newbcast:2 row_mask:0xf bank_mask:0xf
  v_mfma_f32_16x16x32_bf16 v[28:31], a[208:211], a[92:95], v[28:31]
  buffer_load_dwordx4 a[192:195], v4, s[12:15], s49 offen offset:0 sc1
  v_mfma_f32_16x16x32_bf16 v[32:35], a[212:215], a[80:83], v[32:35]
  v_mov_b32_dpp v197, v81 row_newbcast:2 row_mask:0xf bank_mask:0xf
  v_mfma_f32_16x16x32_bf16 v[36:39], a[212:215], a[84:87], v[36:39]
  ds_read_b128 a[72:75], v242 offset:45056
  v_mov_b32_dpp v198, v82 row_newbcast:2 row_mask:0xf bank_mask:0xf
  v_mfma_f32_16x16x32_bf16 v[40:43], a[212:215], a[88:91], v[40:43]
  buffer_load_dwordx4 a[196:199], v4, s[12:15], s49 offen offset:1024 sc1
  v_mfma_f32_16x16x32_bf16 v[44:47], a[212:215], a[92:95], v[44:47]
  ds_read_b128 a[76:79], v242 offset:61440
  v_mov_b32_dpp v199, v83 row_newbcast:2 row_mask:0xf bank_mask:0xf
  v_mfma_f32_16x16x32_bf16 v[48:51], a[216:219], a[80:83], v[48:51]
  buffer_load_dwordx4 a[200:203], v4, s[12:15], s49 offen offset:2048 sc1
  v_mfma_f32_16x16x32_bf16 v[52:55], a[216:219], a[84:87], v[52:55]
  v_mov_b32_dpp v200, v84 row_newbcast:2 row_mask:0xf bank_mask:0xf
  v_mfma_f32_16x16x32_bf16 v[56:59], a[216:219], a[88:91], v[56:59]
  v_mov_b32_dpp v201, v85 row_newbcast:2 row_mask:0xf bank_mask:0xf
  v_mfma_f32_16x16x32_bf16 v[60:63], a[216:219], a[92:95], v[60:63]
  buffer_load_dwordx4 a[204:207], v4, s[12:15], s49 offen offset:3072 sc1
  v_mfma_f32_16x16x32_bf16 v[64:67], a[220:223], a[80:83], v[64:67]
  v_mov_b32_dpp v202, v86 row_newbcast:2 row_mask:0xf bank_mask:0xf
  v_mfma_f32_16x16x32_bf16 v[68:71], a[220:223], a[84:87], v[68:71]
  v_mov_b32_dpp v203, v87 row_newbcast:2 row_mask:0xf bank_mask:0xf
  v_mfma_f32_16x16x32_bf16 v[72:75], a[220:223], a[88:91], v[72:75]
  v_mfma_f32_16x16x32_bf16 v[76:79], a[220:223], a[92:95], v[76:79]
  s_waitcnt lgkmcnt(0)
  v_mfma_f32_16x16x32_bf16 v[16:19], a[224:227], a[64:67], v[16:19]
  ds_read_b128 a[80:83], v242 offset:13312
  v_mfma_f32_16x16x32_bf16 v[20:23], a[224:227], a[68:71], v[20:23]
  ds_read_b128 a[84:87], v242 offset:29696
  s_add_u32 s49, s32, 12288
  v_mfma_f32_16x16x32_bf16 v[24:27], a[224:227], a[72:75], v[24:27]
  ds_read_b128 a[88:91], v242 offset:46080
  v_mov_b32_dpp v120, v88 row_newbcast:0 row_mask:0xf bank_mask:0xf
  v_mfma_f32_16x16x32_bf16 v[28:31], a[224:227], a[76:79], v[28:31]
  ds_read_b128 a[92:95], v242 offset:62464
  v_mov_b32_dpp v121, v89 row_newbcast:0 row_mask:0xf bank_mask:0xf
  v_mfma_f32_16x16x32_bf16 v[32:35], a[228:231], a[64:67], v[32:35]
  buffer_load_dwordx4 a[208:211], v4, s[12:15], s49 offen offset:0 sc1
  v_mfma_f32_16x16x32_bf16 v[36:39], a[228:231], a[68:71], v[36:39]
  ds_read_b128 v[148:151], v12 offset:0
  v_mov_b32_dpp v122, v90 row_newbcast:0 row_mask:0xf bank_mask:0xf
  v_mfma_f32_16x16x32_bf16 v[40:43], a[228:231], a[72:75], v[40:43]
  ds_read_b128 v[152:155], v12 offset:16384
  v_mov_b32_dpp v123, v91 row_newbcast:0 row_mask:0xf bank_mask:0xf
  v_mfma_f32_16x16x32_bf16 v[44:47], a[228:231], a[76:79], v[44:47]
  buffer_load_dwordx4 a[212:215], v4, s[12:15], s49 offen offset:1024 sc1
  v_mfma_f32_16x16x32_bf16 v[48:51], a[232:235], a[64:67], v[48:51]
  ds_read_b128 v[156:159], v12 offset:32768
  ds_read_b128 v[160:163], v12 offset:49152
  v_mfma_f32_16x16x32_bf16 v[52:55], a[232:235], a[68:71], v[52:55]
  buffer_load_dwordx4 a[216:219], v4, s[12:15], s49 offen offset:2048 sc1
  v_mfma_f32_16x16x32_bf16 v[56:59], a[232:235], a[72:75], v[56:59]
  v_mov_b32_dpp v124, v92 row_newbcast:0 row_mask:0xf bank_mask:0xf
  v_mov_b32_dpp v125, v93 row_newbcast:0 row_mask:0xf bank_mask:0xf
  v_mfma_f32_16x16x32_bf16 v[60:63], a[232:235], a[76:79], v[60:63]
  buffer_load_dwordx4 a[220:223], v4, s[12:15], s49 offen offset:3072 sc1
  v_mfma_f32_16x16x32_bf16 v[64:67], a[236:239], a[64:67], v[64:67]
  v_mov_b32_dpp v126, v94 row_newbcast:0 row_mask:0xf bank_mask:0xf
  v_mfma_f32_16x16x32_bf16 v[68:71], a[236:239], a[68:71], v[68:71]
  v_mov_b32_dpp v127, v95 row_newbcast:0 row_mask:0xf bank_mask:0xf
  v_mfma_f32_16x16x32_bf16 v[72:75], a[236:239], a[72:75], v[72:75]
  v_mfma_f32_16x16x32_bf16 v[76:79], a[236:239], a[76:79], v[76:79]
  s_waitcnt lgkmcnt(0)
  v_mfma_f32_16x16x32_bf16 v[16:19], a[240:243], a[80:83], v[16:19]
  ds_read_b128 a[64:67], v242 offset:14336
  v_mfma_f32_16x16x32_bf16 v[20:23], a[240:243], a[84:87], v[20:23]
  s_add_u32 s49, s32, 16384
  v_mfma_f32_16x16x32_bf16 v[24:27], a[240:243], a[88:91], v[24:27]
  ds_read_b128 a[68:71], v242 offset:30720
  v_mov_b32_dpp v128, v88 row_newbcast:1 row_mask:0xf bank_mask:0xf
  v_mfma_f32_16x16x32_bf16 v[28:31], a[240:243], a[92:95], v[28:31]
  buffer_load_dwordx4 a[224:227], v4, s[12:15], s49 offen offset:0 sc1
  v_mfma_f32_16x16x32_bf16 v[32:35], a[244:247], a[80:83], v[32:35]
  v_mov_b32_dpp v129, v89 row_newbcast:1 row_mask:0xf bank_mask:0xf
  v_mfma_f32_16x16x32_bf16 v[36:39], a[244:247], a[84:87], v[36:39]
  ds_read_b128 a[72:75], v242 offset:47104
  v_mov_b32_dpp v130, v90 row_newbcast:1 row_mask:0xf bank_mask:0xf
  v_mfma_f32_16x16x32_bf16 v[40:43], a[244:247], a[88:91], v[40:43]
  buffer_load_dwordx4 a[228:231], v4, s[12:15], s49 offen offset:1024 sc1
  v_mfma_f32_16x16x32_bf16 v[44:47], a[244:247], a[92:95], v[44:47]
  ds_read_b128 a[76:79], v242 offset:63488
  v_mov_b32_dpp v131, v91 row_newbcast:1 row_mask:0xf bank_mask:0xf
  v_mfma_f32_16x16x32_bf16 v[48:51], a[248:251], a[80:83], v[48:51]
  buffer_load_dwordx4 a[232:235], v4, s[12:15], s49 offen offset:2048 sc1
  v_mfma_f32_16x16x32_bf16 v[52:55], a[248:251], a[84:87], v[52:55]
  v_mov_b32_dpp v132, v92 row_newbcast:1 row_mask:0xf bank_mask:0xf
  v_mfma_f32_16x16x32_bf16 v[56:59], a[248:251], a[88:91], v[56:59]
  v_mov_b32_dpp v133, v93 row_newbcast:1 row_mask:0xf bank_mask:0xf
  v_mfma_f32_16x16x32_bf16 v[60:63], a[248:251], a[92:95], v[60:63]
  buffer_load_dwordx4 a[236:239], v4, s[12:15], s49 offen offset:3072 sc1
  v_mfma_f32_16x16x32_bf16 v[64:67], a[252:255], a[80:83], v[64:67]
  v_mov_b32_dpp v134, v94 row_newbcast:1 row_mask:0xf bank_mask:0xf
  v_mfma_f32_16x16x32_bf16 v[68:71], a[252:255], a[84:87], v[68:71]
  v_mov_b32_dpp v135, v95 row_newbcast:1 row_mask:0xf bank_mask:0xf
  v_mfma_f32_16x16x32_bf16 v[72:75], a[252:255], a[88:91], v[72:75]
  v_mfma_f32_16x16x32_bf16 v[76:79], a[252:255], a[92:95], v[76:79]
  s_waitcnt lgkmcnt(0)
  v_mfma_f32_16x16x32_bf16 v[16:19], a[96:99], a[64:67], v[16:19]
  ds_read_b128 a[80:83], v242 offset:15360
  v_mfma_f32_16x16x32_bf16 v[20:23], a[96:99], a[68:71], v[20:23]
  s_add_u32 s49, s32, 20480
  v_mfma_f32_16x16x32_bf16 v[24:27], a[96:99], a[72:75], v[24:27]
  ds_read_b128 a[84:87], v242 offset:31744
  v_mov_b32_dpp v136, v88 row_newbcast:2 row_mask:0xf bank_mask:0xf
  v_mfma_f32_16x16x32_bf16 v[28:31], a[96:99], a[76:79], v[28:31]
  buffer_load_dwordx4 a[240:243], v4, s[12:15], s49 offen offset:0 sc1
  v_mfma_f32_16x16x32_bf16 v[32:35], a[100:103], a[64:67], v[32:35]
  v_mov_b32_dpp v137, v89 row_newbcast:2 row_mask:0xf bank_mask:0xf
  v_mfma_f32_16x16x32_bf16 v[36:39], a[100:103], a[68:71], v[36:39]
  ds_read_b128 a[88:91], v242 offset:48128
  v_mov_b32_dpp v138, v90 row_newbcast:2 row_mask:0xf bank_mask:0xf
  v_mfma_f32_16x16x32_bf16 v[40:43], a[100:103], a[72:75], v[40:43]
  buffer_load_dwordx4 a[244:247], v4, s[12:15], s49 offen offset:1024 sc1
  v_mfma_f32_16x16x32_bf16 v[44:47], a[100:103], a[76:79], v[44:47]
  ds_read_b128 a[92:95], v242 offset:64512
  v_mov_b32_dpp v139, v91 row_newbcast:2 row_mask:0xf bank_mask:0xf
  v_mfma_f32_16x16x32_bf16 v[48:51], a[104:107], a[64:67], v[48:51]
  buffer_load_dwordx4 a[248:251], v4, s[12:15], s49 offen offset:2048 sc1
  v_mfma_f32_16x16x32_bf16 v[52:55], a[104:107], a[68:71], v[52:55]
  v_mov_b32_dpp v140, v92 row_newbcast:2 row_mask:0xf bank_mask:0xf
  v_mfma_f32_16x16x32_bf16 v[56:59], a[104:107], a[72:75], v[56:59]
  v_mov_b32_dpp v141, v93 row_newbcast:2 row_mask:0xf bank_mask:0xf
  v_mfma_f32_16x16x32_bf16 v[60:63], a[104:107], a[76:79], v[60:63]
  buffer_load_dwordx4 a[252:255], v4, s[12:15], s49 offen offset:3072 sc1
  v_mfma_f32_16x16x32_bf16 v[64:67], a[108:111], a[64:67], v[64:67]
  v_mov_b32_dpp v142, v94 row_newbcast:2 row_mask:0xf bank_mask:0xf
  v_mfma_f32_16x16x32_bf16 v[68:71], a[108:111], a[68:71], v[68:71]
  v_mov_b32_dpp v143, v95 row_newbcast:2 row_mask:0xf bank_mask:0xf
  v_mfma_f32_16x16x32_bf16 v[72:75], a[108:111], a[72:75], v[72:75]
  v_mfma_f32_16x16x32_bf16 v[76:79], a[108:111], a[76:79], v[76:79]
  s_waitcnt lgkmcnt(0)
  v_mfma_f32_16x16x32_bf16 v[16:19], a[112:115], a[80:83], v[16:19]
  v_mfma_f32_16x16x32_bf16 v[20:23], a[112:115], a[84:87], v[20:23]
  v_mfma_f32_16x16x32_bf16 v[24:27], a[112:115], a[88:91], v[24:27]
  v_mfma_f32_16x16x32_bf16 v[28:31], a[112:115], a[92:95], v[28:31]
  v_mfma_f32_16x16x32_bf16 v[32:35], a[116:119], a[80:83], v[32:35]
  v_mfma_f32_16x16x32_bf16 v[36:39], a[116:119], a[84:87], v[36:39]
  v_mfma_f32_16x16x32_bf16 v[40:43], a[116:119], a[88:91], v[40:43]
  v_mfma_f32_16x16x32_bf16 v[44:47], a[116:119], a[92:95], v[44:47]
  v_mfma_f32_16x16x32_bf16 v[48:51], a[120:123], a[80:83], v[48:51]
  v_mfma_f32_16x16x32_bf16 v[52:55], a[120:123], a[84:87], v[52:55]
  v_mfma_f32_16x16x32_bf16 v[56:59], a[120:123], a[88:91], v[56:59]
  v_mfma_f32_16x16x32_bf16 v[60:63], a[120:123], a[92:95], v[60:63]
  v_mfma_f32_16x16x32_bf16 v[64:67], a[124:127], a[80:83], v[64:67]
  v_mfma_f32_16x16x32_bf16 v[68:71], a[124:127], a[84:87], v[68:71]
  v_mfma_f32_16x16x32_bf16 v[72:75], a[124:127], a[88:91], v[72:75]
  v_mfma_f32_16x16x32_bf16 v[76:79], a[124:127], a[92:95], v[76:79]
  s_nop 7
  s_add_u32 s49, s32, 24576
  buffer_load_dwordx4 a[96:99], v4, s[12:15], s49 offen offset:0 sc1
  v_pk_fma_f32 v[16:17], v[16:17], v[148:149], v[172:173] op_sel:[0,0,0] op_sel_hi:[1,0,1]
  v_pk_fma_f32 v[18:19], v[18:19], v[148:149], v[174:175] op_sel:[0,0,0] op_sel_hi:[1,0,1]
  v_pk_fma_f32 v[32:33], v[32:33], v[148:149], v[176:177] op_sel:[0,0,0] op_sel_hi:[1,0,1]
  v_pk_fma_f32 v[34:35], v[34:35], v[148:149], v[178:179] op_sel:[0,0,0] op_sel_hi:[1,0,1]
  v_pk_fma_f32 v[16:17], v[180:181], v[148:149], v[16:17] op_sel:[0,1,0] op_sel_hi:[1,1,1]
  v_pk_fma_f32 v[18:19], v[182:183], v[148:149], v[18:19] op_sel:[0,1,0] op_sel_hi:[1,1,1]
  v_pk_fma_f32 v[32:33], v[184:185], v[148:149], v[32:33] op_sel:[0,1,0] op_sel_hi:[1,1,1]
  v_pk_fma_f32 v[34:35], v[186:187], v[148:149], v[34:35] op_sel:[0,1,0] op_sel_hi:[1,1,1]
  v_pk_fma_f32 v[16:17], v[188:189], v[150:151], v[16:17] op_sel:[0,0,0] op_sel_hi:[1,0,1]
  v_pk_fma_f32 v[18:19], v[190:191], v[150:151], v[18:19] op_sel:[0,0,0] op_sel_hi:[1,0,1]
  v_pk_fma_f32 v[32:33], v[192:193], v[150:151], v[32:33] op_sel:[0,0,0] op_sel_hi:[1,0,1]
  v_pk_fma_f32 v[34:35], v[194:195], v[150:151], v[34:35] op_sel:[0,0,0] op_sel_hi:[1,0,1]
  v_pk_fma_f32 v[16:17], v[196:197], v[150:151], v[16:17] op_sel:[0,1,0] op_sel_hi:[1,1,1]
  v_pk_fma_f32 v[18:19], v[198:199], v[150:151], v[18:19] op_sel:[0,1,0] op_sel_hi:[1,1,1]
  v_pk_fma_f32 v[32:33], v[200:201], v[150:151], v[32:33] op_sel:[0,1,0] op_sel_hi:[1,1,1]
  v_pk_fma_f32 v[34:35], v[202:203], v[150:151], v[34:35] op_sel:[0,1,0] op_sel_hi:[1,1,1]
  v_pk_mul_f32 v[204:205], v[16:17], v[16:17]
  v_pk_mul_f32 v[206:207], v[18:19], v[18:19]
  v_pk_mul_f32 v[208:209], v[32:33], v[32:33]
  buffer_load_dwordx4 a[100:103], v4, s[12:15], s49 offen offset:1024 sc1
  v_pk_mul_f32 v[210:211], v[34:35], v[34:35]
  v_pk_fma_f32 v[204:205], v[204:205], s[62:63], v[212:213]
  v_pk_fma_f32 v[206:207], v[206:207], s[62:63], v[212:213]
  v_pk_fma_f32 v[208:209], v[208:209], s[62:63], v[212:213]
  v_pk_fma_f32 v[210:211], v[210:211], s[62:63], v[212:213]
  v_pk_mul_f32 v[204:205], v[204:205], v[16:17]
  v_pk_mul_f32 v[206:207], v[206:207], v[18:19]
  v_pk_mul_f32 v[208:209], v[208:209], v[32:33]
  v_pk_mul_f32 v[210:211], v[210:211], v[34:35]
  v_exp_f32 v204, v204
  v_exp_f32 v205, v205
  v_exp_f32 v206, v206
  v_exp_f32 v207, v207
  v_exp_f32 v208, v208
  v_exp_f32 v209, v209
  v_exp_f32 v210, v210
  v_exp_f32 v211, v211
  v_pk_add_f32 v[204:205], v[204:205], 1.0 op_sel_hi:[1,0]
  v_pk_add_f32 v[206:207], v[206:207], 1.0 op_sel_hi:[1,0]
  buffer_load_dwordx4 a[104:107], v4, s[12:15], s49 offen offset:2048 sc1
  v_pk_add_f32 v[208:209], v[208:209], 1.0 op_sel_hi:[1,0]
  v_pk_add_f32 v[210:211], v[210:211], 1.0 op_sel_hi:[1,0]
  v_rcp_f32 v204, v204
  v_rcp_f32 v205, v205
  v_rcp_f32 v206, v206
  v_rcp_f32 v207, v207
  v_rcp_f32 v208, v208
  v_rcp_f32 v209, v209
  v_rcp_f32 v210, v210
  v_rcp_f32 v211, v211
  v_pk_mul_f32 v[16:17], v[16:17], v[204:205]
  v_pk_mul_f32 v[18:19], v[18:19], v[206:207]
  v_pk_mul_f32 v[32:33], v[32:33], v[208:209]
  v_pk_mul_f32 v[34:35], v[34:35], v[210:211]
  v_cvt_pk_bf16_f32 v16, v16, v17
  v_cvt_pk_bf16_f32 v17, v18, v19
  v_cvt_pk_bf16_f32 v18, v32, v33
  v_cvt_pk_bf16_f32 v19, v34, v35
  buffer_store_dwordx4 v[16:19], v8, s[12:15], s42 offen offset:0
  buffer_load_dwordx4 a[108:111], v4, s[12:15], s49 offen offset:3072 sc1
  v_pk_fma_f32 v[20:21], v[20:21], v[152:153], v[172:173] op_sel:[0,0,0] op_sel_hi:[1,0,1]
  v_pk_fma_f32 v[22:23], v[22:23], v[152:153], v[174:175] op_sel:[0,0,0] op_sel_hi:[1,0,1]
  v_pk_fma_f32 v[36:37], v[36:37], v[152:153], v[176:177] op_sel:[0,0,0] op_sel_hi:[1,0,1]
  v_pk_fma_f32 v[38:39], v[38:39], v[152:153], v[178:179] op_sel:[0,0,0] op_sel_hi:[1,0,1]
  v_pk_fma_f32 v[20:21], v[180:181], v[152:153], v[20:21] op_sel:[0,1,0] op_sel_hi:[1,1,1]
  v_pk_fma_f32 v[22:23], v[182:183], v[152:153], v[22:23] op_sel:[0,1,0] op_sel_hi:[1,1,1]
  v_pk_fma_f32 v[36:37], v[184:185], v[152:153], v[36:37] op_sel:[0,1,0] op_sel_hi:[1,1,1]
  v_pk_fma_f32 v[38:39], v[186:187], v[152:153], v[38:39] op_sel:[0,1,0] op_sel_hi:[1,1,1]
  v_pk_fma_f32 v[20:21], v[188:189], v[154:155], v[20:21] op_sel:[0,0,0] op_sel_hi:[1,0,1]
  v_pk_fma_f32 v[22:23], v[190:191], v[154:155], v[22:23] op_sel:[0,0,0] op_sel_hi:[1,0,1]
  v_pk_fma_f32 v[36:37], v[192:193], v[154:155], v[36:37] op_sel:[0,0,0] op_sel_hi:[1,0,1]
  v_pk_fma_f32 v[38:39], v[194:195], v[154:155], v[38:39] op_sel:[0,0,0] op_sel_hi:[1,0,1]
  v_pk_fma_f32 v[20:21], v[196:197], v[154:155], v[20:21] op_sel:[0,1,0] op_sel_hi:[1,1,1]
  v_pk_fma_f32 v[22:23], v[198:199], v[154:155], v[22:23] op_sel:[0,1,0] op_sel_hi:[1,1,1]
  v_pk_fma_f32 v[36:37], v[200:201], v[154:155], v[36:37] op_sel:[0,1,0] op_sel_hi:[1,1,1]
  v_pk_fma_f32 v[38:39], v[202:203], v[154:155], v[38:39] op_sel:[0,1,0] op_sel_hi:[1,1,1]
  v_pk_mul_f32 v[204:205], v[20:21], v[20:21]
  v_pk_mul_f32 v[206:207], v[22:23], v[22:23]
  v_pk_mul_f32 v[208:209], v[36:37], v[36:37]
  s_add_u32 s49, s32, 28672
  buffer_load_dwordx4 a[112:115], v4, s[12:15], s49 offen offset:0 sc1
  v_pk_mul_f32 v[210:211], v[38:39], v[38:39]
  v_pk_fma_f32 v[204:205], v[204:205], s[62:63], v[212:213]
  v_pk_fma_f32 v[206:207], v[206:207], s[62:63], v[212:213]
  v_pk_fma_f32 v[208:209], v[208:209], s[62:63], v[212:213]
  v_pk_fma_f32 v[210:211], v[210:211], s[62:63], v[212:213]
  v_pk_mul_f32 v[204:205], v[204:205], v[20:21]
  v_pk_mul_f32 v[206:207], v[206:207], v[22:23]
  v_pk_mul_f32 v[208:209], v[208:209], v[36:37]
  v_pk_mul_f32 v[210:211], v[210:211], v[38:39]
  v_exp_f32 v204, v204
  v_exp_f32 v205, v205
  v_exp_f32 v206, v206
  v_exp_f32 v207, v207
  v_exp_f32 v208, v208
  v_exp_f32 v209, v209
  v_exp_f32 v210, v210
  v_exp_f32 v211, v211
  v_pk_add_f32 v[204:205], v[204:205], 1.0 op_sel_hi:[1,0]
  v_pk_add_f32 v[206:207], v[206:207], 1.0 op_sel_hi:[1,0]
  buffer_load_dwordx4 a[116:119], v4, s[12:15], s49 offen offset:1024 sc1
  v_pk_add_f32 v[208:209], v[208:209], 1.0 op_sel_hi:[1,0]
  v_pk_add_f32 v[210:211], v[210:211], 1.0 op_sel_hi:[1,0]
  v_rcp_f32 v204, v204
  v_rcp_f32 v205, v205
  v_rcp_f32 v206, v206
  v_rcp_f32 v207, v207
  v_rcp_f32 v208, v208
  v_rcp_f32 v209, v209
  v_rcp_f32 v210, v210
  v_rcp_f32 v211, v211
  v_pk_mul_f32 v[20:21], v[20:21], v[204:205]
  v_pk_mul_f32 v[22:23], v[22:23], v[206:207]
  v_pk_mul_f32 v[36:37], v[36:37], v[208:209]
  v_pk_mul_f32 v[38:39], v[38:39], v[210:211]
  v_cvt_pk_bf16_f32 v20, v20, v21
  v_cvt_pk_bf16_f32 v21, v22, v23
  v_cvt_pk_bf16_f32 v22, v36, v37
  v_cvt_pk_bf16_f32 v23, v38, v39
  buffer_store_dwordx4 v[20:23], v9, s[12:15], s42 offen offset:0
  buffer_load_dwordx4 a[120:123], v4, s[12:15], s49 offen offset:2048 sc1
  v_pk_fma_f32 v[24:25], v[24:25], v[156:157], v[172:173] op_sel:[0,0,0] op_sel_hi:[1,0,1]
  v_pk_fma_f32 v[26:27], v[26:27], v[156:157], v[174:175] op_sel:[0,0,0] op_sel_hi:[1,0,1]
  v_pk_fma_f32 v[40:41], v[40:41], v[156:157], v[176:177] op_sel:[0,0,0] op_sel_hi:[1,0,1]
  v_pk_fma_f32 v[42:43], v[42:43], v[156:157], v[178:179] op_sel:[0,0,0] op_sel_hi:[1,0,1]
  v_pk_fma_f32 v[24:25], v[180:181], v[156:157], v[24:25] op_sel:[0,1,0] op_sel_hi:[1,1,1]
  v_pk_fma_f32 v[26:27], v[182:183], v[156:157], v[26:27] op_sel:[0,1,0] op_sel_hi:[1,1,1]
  v_pk_fma_f32 v[40:41], v[184:185], v[156:157], v[40:41] op_sel:[0,1,0] op_sel_hi:[1,1,1]
  v_pk_fma_f32 v[42:43], v[186:187], v[156:157], v[42:43] op_sel:[0,1,0] op_sel_hi:[1,1,1]
  v_pk_fma_f32 v[24:25], v[188:189], v[158:159], v[24:25] op_sel:[0,0,0] op_sel_hi:[1,0,1]
  v_pk_fma_f32 v[26:27], v[190:191], v[158:159], v[26:27] op_sel:[0,0,0] op_sel_hi:[1,0,1]
  v_pk_fma_f32 v[40:41], v[192:193], v[158:159], v[40:41] op_sel:[0,0,0] op_sel_hi:[1,0,1]
  v_pk_fma_f32 v[42:43], v[194:195], v[158:159], v[42:43] op_sel:[0,0,0] op_sel_hi:[1,0,1]
  v_pk_fma_f32 v[24:25], v[196:197], v[158:159], v[24:25] op_sel:[0,1,0] op_sel_hi:[1,1,1]
  v_pk_fma_f32 v[26:27], v[198:199], v[158:159], v[26:27] op_sel:[0,1,0] op_sel_hi:[1,1,1]
  v_pk_fma_f32 v[40:41], v[200:201], v[158:159], v[40:41] op_sel:[0,1,0] op_sel_hi:[1,1,1]
  v_pk_fma_f32 v[42:43], v[202:203], v[158:159], v[42:43] op_sel:[0,1,0] op_sel_hi:[1,1,1]
  v_pk_mul_f32 v[204:205], v[24:25], v[24:25]
  v_pk_mul_f32 v[206:207], v[26:27], v[26:27]
  v_pk_mul_f32 v[208:209], v[40:41], v[40:41]
  buffer_load_dwordx4 a[124:127], v4, s[12:15], s49 offen offset:3072 sc1
  v_pk_mul_f32 v[210:211], v[42:43], v[42:43]
  v_pk_fma_f32 v[204:205], v[204:205], s[62:63], v[212:213]
  v_pk_fma_f32 v[206:207], v[206:207], s[62:63], v[212:213]
  v_pk_fma_f32 v[208:209], v[208:209], s[62:63], v[212:213]
  v_pk_fma_f32 v[210:211], v[210:211], s[62:63], v[212:213]
  v_pk_mul_f32 v[204:205], v[204:205], v[24:25]
  v_pk_mul_f32 v[206:207], v[206:207], v[26:27]
  v_pk_mul_f32 v[208:209], v[208:209], v[40:41]
  v_pk_mul_f32 v[210:211], v[210:211], v[42:43]
  v_exp_f32 v204, v204
  v_exp_f32 v205, v205
  v_exp_f32 v206, v206
  v_exp_f32 v207, v207
  v_exp_f32 v208, v208
  v_exp_f32 v209, v209
  v_exp_f32 v210, v210
  v_exp_f32 v211, v211
  v_pk_add_f32 v[204:205], v[204:205], 1.0 op_sel_hi:[1,0]
  v_pk_add_f32 v[206:207], v[206:207], 1.0 op_sel_hi:[1,0]
  s_mov_b32 s41, 0x3e12800
  buffer_load_dwordx4 v[96:99], v237, s[12:15], s41 offen offset:0 sc1
  v_pk_add_f32 v[208:209], v[208:209], 1.0 op_sel_hi:[1,0]
  v_pk_add_f32 v[210:211], v[210:211], 1.0 op_sel_hi:[1,0]
  v_rcp_f32 v204, v204
  v_rcp_f32 v205, v205
  v_rcp_f32 v206, v206
  v_rcp_f32 v207, v207
  v_rcp_f32 v208, v208
  v_rcp_f32 v209, v209
  v_rcp_f32 v210, v210
  v_rcp_f32 v211, v211
  v_pk_mul_f32 v[24:25], v[24:25], v[204:205]
  v_pk_mul_f32 v[26:27], v[26:27], v[206:207]
  v_pk_mul_f32 v[40:41], v[40:41], v[208:209]
  v_pk_mul_f32 v[42:43], v[42:43], v[210:211]
  v_cvt_pk_bf16_f32 v24, v24, v25
  v_cvt_pk_bf16_f32 v25, v26, v27
  v_cvt_pk_bf16_f32 v26, v40, v41
  v_cvt_pk_bf16_f32 v27, v42, v43
  s_waitcnt vmcnt(54)
  buffer_store_dwordx4 v[24:27], v10, s[12:15], s42 offen offset:0
  buffer_load_dwordx4 v[100:103], v237, s[12:15], s41 offen offset:64 sc1
  v_pk_fma_f32 v[28:29], v[28:29], v[160:161], v[172:173] op_sel:[0,0,0] op_sel_hi:[1,0,1]
  v_pk_fma_f32 v[30:31], v[30:31], v[160:161], v[174:175] op_sel:[0,0,0] op_sel_hi:[1,0,1]
  v_pk_fma_f32 v[44:45], v[44:45], v[160:161], v[176:177] op_sel:[0,0,0] op_sel_hi:[1,0,1]
  v_pk_fma_f32 v[46:47], v[46:47], v[160:161], v[178:179] op_sel:[0,0,0] op_sel_hi:[1,0,1]
  v_pk_fma_f32 v[28:29], v[180:181], v[160:161], v[28:29] op_sel:[0,1,0] op_sel_hi:[1,1,1]
  v_pk_fma_f32 v[30:31], v[182:183], v[160:161], v[30:31] op_sel:[0,1,0] op_sel_hi:[1,1,1]
  v_pk_fma_f32 v[44:45], v[184:185], v[160:161], v[44:45] op_sel:[0,1,0] op_sel_hi:[1,1,1]
  v_pk_fma_f32 v[46:47], v[186:187], v[160:161], v[46:47] op_sel:[0,1,0] op_sel_hi:[1,1,1]
  v_pk_fma_f32 v[28:29], v[188:189], v[162:163], v[28:29] op_sel:[0,0,0] op_sel_hi:[1,0,1]
  v_pk_fma_f32 v[30:31], v[190:191], v[162:163], v[30:31] op_sel:[0,0,0] op_sel_hi:[1,0,1]
  v_pk_fma_f32 v[44:45], v[192:193], v[162:163], v[44:45] op_sel:[0,0,0] op_sel_hi:[1,0,1]
  v_pk_fma_f32 v[46:47], v[194:195], v[162:163], v[46:47] op_sel:[0,0,0] op_sel_hi:[1,0,1]
  v_pk_fma_f32 v[28:29], v[196:197], v[162:163], v[28:29] op_sel:[0,1,0] op_sel_hi:[1,1,1]
  v_pk_fma_f32 v[30:31], v[198:199], v[162:163], v[30:31] op_sel:[0,1,0] op_sel_hi:[1,1,1]
  v_pk_fma_f32 v[44:45], v[200:201], v[162:163], v[44:45] op_sel:[0,1,0] op_sel_hi:[1,1,1]
  v_pk_fma_f32 v[46:47], v[202:203], v[162:163], v[46:47] op_sel:[0,1,0] op_sel_hi:[1,1,1]
  v_pk_mul_f32 v[204:205], v[28:29], v[28:29]
  v_pk_mul_f32 v[206:207], v[30:31], v[30:31]
  v_pk_mul_f32 v[208:209], v[44:45], v[44:45]
  buffer_load_dwordx4 v[104:107], v237, s[12:15], s41 offen offset:128 sc1
  v_pk_mul_f32 v[210:211], v[46:47], v[46:47]
  v_pk_fma_f32 v[204:205], v[204:205], s[62:63], v[212:213]
  v_pk_fma_f32 v[206:207], v[206:207], s[62:63], v[212:213]
  v_pk_fma_f32 v[208:209], v[208:209], s[62:63], v[212:213]
  v_pk_fma_f32 v[210:211], v[210:211], s[62:63], v[212:213]
  v_pk_mul_f32 v[204:205], v[204:205], v[28:29]
  v_pk_mul_f32 v[206:207], v[206:207], v[30:31]
  v_pk_mul_f32 v[208:209], v[208:209], v[44:45]
  v_pk_mul_f32 v[210:211], v[210:211], v[46:47]
  v_exp_f32 v204, v204
  v_exp_f32 v205, v205
  v_exp_f32 v206, v206
  v_exp_f32 v207, v207
  v_exp_f32 v208, v208
  v_exp_f32 v209, v209
  v_exp_f32 v210, v210
  v_exp_f32 v211, v211
  v_pk_add_f32 v[204:205], v[204:205], 1.0 op_sel_hi:[1,0]
  v_pk_add_f32 v[206:207], v[206:207], 1.0 op_sel_hi:[1,0]
  buffer_load_dwordx4 v[108:111], v237, s[12:15], s41 offen offset:192 sc1
  v_pk_add_f32 v[208:209], v[208:209], 1.0 op_sel_hi:[1,0]
  v_pk_add_f32 v[210:211], v[210:211], 1.0 op_sel_hi:[1,0]
  v_rcp_f32 v204, v204
  v_rcp_f32 v205, v205
  v_rcp_f32 v206, v206
  v_rcp_f32 v207, v207
  v_rcp_f32 v208, v208
  v_rcp_f32 v209, v209
  v_rcp_f32 v210, v210
  v_rcp_f32 v211, v211
  v_pk_mul_f32 v[28:29], v[28:29], v[204:205]
  v_pk_mul_f32 v[30:31], v[30:31], v[206:207]
  v_pk_mul_f32 v[44:45], v[44:45], v[208:209]
  v_pk_mul_f32 v[46:47], v[46:47], v[210:211]
  v_cvt_pk_bf16_f32 v28, v28, v29
  v_cvt_pk_bf16_f32 v29, v30, v31
  v_cvt_pk_bf16_f32 v30, v44, v45
  v_cvt_pk_bf16_f32 v31, v46, v47
  buffer_store_dwordx4 v[28:31], v11, s[12:15], s42 offen offset:0
  s_cmp_eq_u32 s20, 3
  s_cbranch_scc1 adaLN_cond__compressed_kv_cla__mixer_channel_mlp__prompt_kernel_p19
  v_lshlrev_b32 v172, 16, v168
  v_and_b32 v173, 0xffff0000, v168
  v_lshlrev_b32 v174, 16, v169
  v_and_b32 v175, 0xffff0000, v169
  v_lshlrev_b32 v176, 16, v170
  v_and_b32 v177, 0xffff0000, v170
  v_lshlrev_b32 v178, 16, v171
  v_and_b32 v179, 0xffff0000, v171
  v_pk_fma_f32 v[48:49], v[48:49], v[148:149], v[172:173] op_sel:[0,0,0] op_sel_hi:[1,0,1]
  v_pk_fma_f32 v[50:51], v[50:51], v[148:149], v[174:175] op_sel:[0,0,0] op_sel_hi:[1,0,1]
  v_pk_fma_f32 v[64:65], v[64:65], v[148:149], v[176:177] op_sel:[0,0,0] op_sel_hi:[1,0,1]
  v_pk_fma_f32 v[66:67], v[66:67], v[148:149], v[178:179] op_sel:[0,0,0] op_sel_hi:[1,0,1]
  v_pk_fma_f32 v[48:49], v[120:121], v[148:149], v[48:49] op_sel:[0,1,0] op_sel_hi:[1,1,1]
  v_pk_fma_f32 v[50:51], v[122:123], v[148:149], v[50:51] op_sel:[0,1,0] op_sel_hi:[1,1,1]
  v_pk_fma_f32 v[64:65], v[124:125], v[148:149], v[64:65] op_sel:[0,1,0] op_sel_hi:[1,1,1]
  v_pk_fma_f32 v[66:67], v[126:127], v[148:149], v[66:67] op_sel:[0,1,0] op_sel_hi:[1,1,1]
  v_pk_fma_f32 v[48:49], v[128:129], v[150:151], v[48:49] op_sel:[0,0,0] op_sel_hi:[1,0,1]
  v_pk_fma_f32 v[50:51], v[130:131], v[150:151], v[50:51] op_sel:[0,0,0] op_sel_hi:[1,0,1]
  v_pk_fma_f32 v[64:65], v[132:133], v[150:151], v[64:65] op_sel:[0,0,0] op_sel_hi:[1,0,1]
  v_pk_fma_f32 v[66:67], v[134:135], v[150:151], v[66:67] op_sel:[0,0,0] op_sel_hi:[1,0,1]
  v_pk_fma_f32 v[48:49], v[136:137], v[150:151], v[48:49] op_sel:[0,1,0] op_sel_hi:[1,1,1]
  v_pk_fma_f32 v[50:51], v[138:139], v[150:151], v[50:51] op_sel:[0,1,0] op_sel_hi:[1,1,1]
  v_pk_fma_f32 v[64:65], v[140:141], v[150:151], v[64:65] op_sel:[0,1,0] op_sel_hi:[1,1,1]
  v_pk_fma_f32 v[66:67], v[142:143], v[150:151], v[66:67] op_sel:[0,1,0] op_sel_hi:[1,1,1]
  v_pk_mul_f32 v[204:205], v[48:49], v[48:49]
  v_pk_mul_f32 v[206:207], v[50:51], v[50:51]
  v_pk_mul_f32 v[208:209], v[64:65], v[64:65]
  v_pk_mul_f32 v[210:211], v[66:67], v[66:67]
  v_pk_fma_f32 v[204:205], v[204:205], s[62:63], v[212:213]
  v_pk_fma_f32 v[206:207], v[206:207], s[62:63], v[212:213]
  v_pk_fma_f32 v[208:209], v[208:209], s[62:63], v[212:213]
  v_pk_fma_f32 v[210:211], v[210:211], s[62:63], v[212:213]
  v_pk_mul_f32 v[204:205], v[204:205], v[48:49]
  v_pk_mul_f32 v[206:207], v[206:207], v[50:51]
  v_pk_mul_f32 v[208:209], v[208:209], v[64:65]
  v_pk_mul_f32 v[210:211], v[210:211], v[66:67]
  v_exp_f32 v204, v204
  v_exp_f32 v205, v205
  v_exp_f32 v206, v206
  v_exp_f32 v207, v207
  v_exp_f32 v208, v208
  v_exp_f32 v209, v209
  v_exp_f32 v210, v210
  v_exp_f32 v211, v211
  v_pk_add_f32 v[204:205], v[204:205], 1.0 op_sel_hi:[1,0]
  v_pk_add_f32 v[206:207], v[206:207], 1.0 op_sel_hi:[1,0]
  v_pk_add_f32 v[208:209], v[208:209], 1.0 op_sel_hi:[1,0]
  v_pk_add_f32 v[210:211], v[210:211], 1.0 op_sel_hi:[1,0]
  v_rcp_f32 v204, v204
  v_rcp_f32 v205, v205
  v_rcp_f32 v206, v206
  v_rcp_f32 v207, v207
  v_rcp_f32 v208, v208
  v_rcp_f32 v209, v209
  v_rcp_f32 v210, v210
  v_rcp_f32 v211, v211
  v_pk_mul_f32 v[48:49], v[48:49], v[204:205]
  v_pk_mul_f32 v[50:51], v[50:51], v[206:207]
  v_pk_mul_f32 v[64:65], v[64:65], v[208:209]
  v_pk_mul_f32 v[66:67], v[66:67], v[210:211]
  v_cvt_pk_bf16_f32 v48, v48, v49
  v_cvt_pk_bf16_f32 v49, v50, v51
  v_cvt_pk_bf16_f32 v50, v64, v65
  v_cvt_pk_bf16_f32 v51, v66, v67
  buffer_store_dwordx4 v[48:51], v8, s[12:15], s43 offen offset:0
  v_pk_fma_f32 v[52:53], v[52:53], v[152:153], v[172:173] op_sel:[0,0,0] op_sel_hi:[1,0,1]
  v_pk_fma_f32 v[54:55], v[54:55], v[152:153], v[174:175] op_sel:[0,0,0] op_sel_hi:[1,0,1]
  v_pk_fma_f32 v[68:69], v[68:69], v[152:153], v[176:177] op_sel:[0,0,0] op_sel_hi:[1,0,1]
  v_pk_fma_f32 v[70:71], v[70:71], v[152:153], v[178:179] op_sel:[0,0,0] op_sel_hi:[1,0,1]
  v_pk_fma_f32 v[52:53], v[120:121], v[152:153], v[52:53] op_sel:[0,1,0] op_sel_hi:[1,1,1]
  v_pk_fma_f32 v[54:55], v[122:123], v[152:153], v[54:55] op_sel:[0,1,0] op_sel_hi:[1,1,1]
  v_pk_fma_f32 v[68:69], v[124:125], v[152:153], v[68:69] op_sel:[0,1,0] op_sel_hi:[1,1,1]
  v_pk_fma_f32 v[70:71], v[126:127], v[152:153], v[70:71] op_sel:[0,1,0] op_sel_hi:[1,1,1]
  v_pk_fma_f32 v[52:53], v[128:129], v[154:155], v[52:53] op_sel:[0,0,0] op_sel_hi:[1,0,1]
  v_pk_fma_f32 v[54:55], v[130:131], v[154:155], v[54:55] op_sel:[0,0,0] op_sel_hi:[1,0,1]
  v_pk_fma_f32 v[68:69], v[132:133], v[154:155], v[68:69] op_sel:[0,0,0] op_sel_hi:[1,0,1]
  v_pk_fma_f32 v[70:71], v[134:135], v[154:155], v[70:71] op_sel:[0,0,0] op_sel_hi:[1,0,1]
  v_pk_fma_f32 v[52:53], v[136:137], v[154:155], v[52:53] op_sel:[0,1,0] op_sel_hi:[1,1,1]
  v_pk_fma_f32 v[54:55], v[138:139], v[154:155], v[54:55] op_sel:[0,1,0] op_sel_hi:[1,1,1]
  v_pk_fma_f32 v[68:69], v[140:141], v[154:155], v[68:69] op_sel:[0,1,0] op_sel_hi:[1,1,1]
  v_pk_fma_f32 v[70:71], v[142:143], v[154:155], v[70:71] op_sel:[0,1,0] op_sel_hi:[1,1,1]
  v_pk_mul_f32 v[204:205], v[52:53], v[52:53]
  v_pk_mul_f32 v[206:207], v[54:55], v[54:55]
  v_pk_mul_f32 v[208:209], v[68:69], v[68:69]
  v_pk_mul_f32 v[210:211], v[70:71], v[70:71]
  v_pk_fma_f32 v[204:205], v[204:205], s[62:63], v[212:213]
  v_pk_fma_f32 v[206:207], v[206:207], s[62:63], v[212:213]
  v_pk_fma_f32 v[208:209], v[208:209], s[62:63], v[212:213]
  v_pk_fma_f32 v[210:211], v[210:211], s[62:63], v[212:213]
  v_pk_mul_f32 v[204:205], v[204:205], v[52:53]
  v_pk_mul_f32 v[206:207], v[206:207], v[54:55]
  v_pk_mul_f32 v[208:209], v[208:209], v[68:69]
  v_pk_mul_f32 v[210:211], v[210:211], v[70:71]
  v_exp_f32 v204, v204
  v_exp_f32 v205, v205
  v_exp_f32 v206, v206
  v_exp_f32 v207, v207
  v_exp_f32 v208, v208
  v_exp_f32 v209, v209
  v_exp_f32 v210, v210
  v_exp_f32 v211, v211
  v_pk_add_f32 v[204:205], v[204:205], 1.0 op_sel_hi:[1,0]
  v_pk_add_f32 v[206:207], v[206:207], 1.0 op_sel_hi:[1,0]
  v_pk_add_f32 v[208:209], v[208:209], 1.0 op_sel_hi:[1,0]
  v_pk_add_f32 v[210:211], v[210:211], 1.0 op_sel_hi:[1,0]
  v_rcp_f32 v204, v204
  v_rcp_f32 v205, v205
  v_rcp_f32 v206, v206
  v_rcp_f32 v207, v207
  v_rcp_f32 v208, v208
  v_rcp_f32 v209, v209
  v_rcp_f32 v210, v210
  v_rcp_f32 v211, v211
  v_pk_mul_f32 v[52:53], v[52:53], v[204:205]
  v_pk_mul_f32 v[54:55], v[54:55], v[206:207]
  v_pk_mul_f32 v[68:69], v[68:69], v[208:209]
  v_pk_mul_f32 v[70:71], v[70:71], v[210:211]
  v_cvt_pk_bf16_f32 v52, v52, v53
  v_cvt_pk_bf16_f32 v53, v54, v55
  v_cvt_pk_bf16_f32 v54, v68, v69
  v_cvt_pk_bf16_f32 v55, v70, v71
  buffer_store_dwordx4 v[52:55], v9, s[12:15], s43 offen offset:0
  v_pk_fma_f32 v[56:57], v[56:57], v[156:157], v[172:173] op_sel:[0,0,0] op_sel_hi:[1,0,1]
  v_pk_fma_f32 v[58:59], v[58:59], v[156:157], v[174:175] op_sel:[0,0,0] op_sel_hi:[1,0,1]
  v_pk_fma_f32 v[72:73], v[72:73], v[156:157], v[176:177] op_sel:[0,0,0] op_sel_hi:[1,0,1]
  v_pk_fma_f32 v[74:75], v[74:75], v[156:157], v[178:179] op_sel:[0,0,0] op_sel_hi:[1,0,1]
  v_pk_fma_f32 v[56:57], v[120:121], v[156:157], v[56:57] op_sel:[0,1,0] op_sel_hi:[1,1,1]
  v_pk_fma_f32 v[58:59], v[122:123], v[156:157], v[58:59] op_sel:[0,1,0] op_sel_hi:[1,1,1]
  v_pk_fma_f32 v[72:73], v[124:125], v[156:157], v[72:73] op_sel:[0,1,0] op_sel_hi:[1,1,1]
  v_pk_fma_f32 v[74:75], v[126:127], v[156:157], v[74:75] op_sel:[0,1,0] op_sel_hi:[1,1,1]
  v_pk_fma_f32 v[56:57], v[128:129], v[158:159], v[56:57] op_sel:[0,0,0] op_sel_hi:[1,0,1]
  v_pk_fma_f32 v[58:59], v[130:131], v[158:159], v[58:59] op_sel:[0,0,0] op_sel_hi:[1,0,1]
  v_pk_fma_f32 v[72:73], v[132:133], v[158:159], v[72:73] op_sel:[0,0,0] op_sel_hi:[1,0,1]
  v_pk_fma_f32 v[74:75], v[134:135], v[158:159], v[74:75] op_sel:[0,0,0] op_sel_hi:[1,0,1]
  v_pk_fma_f32 v[56:57], v[136:137], v[158:159], v[56:57] op_sel:[0,1,0] op_sel_hi:[1,1,1]
  v_pk_fma_f32 v[58:59], v[138:139], v[158:159], v[58:59] op_sel:[0,1,0] op_sel_hi:[1,1,1]
  v_pk_fma_f32 v[72:73], v[140:141], v[158:159], v[72:73] op_sel:[0,1,0] op_sel_hi:[1,1,1]
  v_pk_fma_f32 v[74:75], v[142:143], v[158:159], v[74:75] op_sel:[0,1,0] op_sel_hi:[1,1,1]
  v_pk_mul_f32 v[204:205], v[56:57], v[56:57]
  v_pk_mul_f32 v[206:207], v[58:59], v[58:59]
  v_pk_mul_f32 v[208:209], v[72:73], v[72:73]
  v_pk_mul_f32 v[210:211], v[74:75], v[74:75]
  v_pk_fma_f32 v[204:205], v[204:205], s[62:63], v[212:213]
  v_pk_fma_f32 v[206:207], v[206:207], s[62:63], v[212:213]
  v_pk_fma_f32 v[208:209], v[208:209], s[62:63], v[212:213]
  v_pk_fma_f32 v[210:211], v[210:211], s[62:63], v[212:213]
  v_pk_mul_f32 v[204:205], v[204:205], v[56:57]
  v_pk_mul_f32 v[206:207], v[206:207], v[58:59]
  v_pk_mul_f32 v[208:209], v[208:209], v[72:73]
  v_pk_mul_f32 v[210:211], v[210:211], v[74:75]
  v_exp_f32 v204, v204
  v_exp_f32 v205, v205
  v_exp_f32 v206, v206
  v_exp_f32 v207, v207
  v_exp_f32 v208, v208
  v_exp_f32 v209, v209
  v_exp_f32 v210, v210
  v_exp_f32 v211, v211
  v_pk_add_f32 v[204:205], v[204:205], 1.0 op_sel_hi:[1,0]
  v_pk_add_f32 v[206:207], v[206:207], 1.0 op_sel_hi:[1,0]
  v_pk_add_f32 v[208:209], v[208:209], 1.0 op_sel_hi:[1,0]
  v_pk_add_f32 v[210:211], v[210:211], 1.0 op_sel_hi:[1,0]
  v_rcp_f32 v204, v204
  v_rcp_f32 v205, v205
  v_rcp_f32 v206, v206
  v_rcp_f32 v207, v207
  v_rcp_f32 v208, v208
  v_rcp_f32 v209, v209
  v_rcp_f32 v210, v210
  v_rcp_f32 v211, v211
  v_pk_mul_f32 v[56:57], v[56:57], v[204:205]
  v_pk_mul_f32 v[58:59], v[58:59], v[206:207]
  v_pk_mul_f32 v[72:73], v[72:73], v[208:209]
  v_pk_mul_f32 v[74:75], v[74:75], v[210:211]
  v_cvt_pk_bf16_f32 v56, v56, v57
  v_cvt_pk_bf16_f32 v57, v58, v59
  v_cvt_pk_bf16_f32 v58, v72, v73
  v_cvt_pk_bf16_f32 v59, v74, v75
  buffer_store_dwordx4 v[56:59], v10, s[12:15], s43 offen offset:0
  v_pk_fma_f32 v[60:61], v[60:61], v[160:161], v[172:173] op_sel:[0,0,0] op_sel_hi:[1,0,1]
  v_pk_fma_f32 v[62:63], v[62:63], v[160:161], v[174:175] op_sel:[0,0,0] op_sel_hi:[1,0,1]
  v_pk_fma_f32 v[76:77], v[76:77], v[160:161], v[176:177] op_sel:[0,0,0] op_sel_hi:[1,0,1]
  v_pk_fma_f32 v[78:79], v[78:79], v[160:161], v[178:179] op_sel:[0,0,0] op_sel_hi:[1,0,1]
  v_pk_fma_f32 v[60:61], v[120:121], v[160:161], v[60:61] op_sel:[0,1,0] op_sel_hi:[1,1,1]
  v_pk_fma_f32 v[62:63], v[122:123], v[160:161], v[62:63] op_sel:[0,1,0] op_sel_hi:[1,1,1]
  v_pk_fma_f32 v[76:77], v[124:125], v[160:161], v[76:77] op_sel:[0,1,0] op_sel_hi:[1,1,1]
  v_pk_fma_f32 v[78:79], v[126:127], v[160:161], v[78:79] op_sel:[0,1,0] op_sel_hi:[1,1,1]
  v_pk_fma_f32 v[60:61], v[128:129], v[162:163], v[60:61] op_sel:[0,0,0] op_sel_hi:[1,0,1]
  v_pk_fma_f32 v[62:63], v[130:131], v[162:163], v[62:63] op_sel:[0,0,0] op_sel_hi:[1,0,1]
  v_pk_fma_f32 v[76:77], v[132:133], v[162:163], v[76:77] op_sel:[0,0,0] op_sel_hi:[1,0,1]
  v_pk_fma_f32 v[78:79], v[134:135], v[162:163], v[78:79] op_sel:[0,0,0] op_sel_hi:[1,0,1]
  v_pk_fma_f32 v[60:61], v[136:137], v[162:163], v[60:61] op_sel:[0,1,0] op_sel_hi:[1,1,1]
  v_pk_fma_f32 v[62:63], v[138:139], v[162:163], v[62:63] op_sel:[0,1,0] op_sel_hi:[1,1,1]
  v_pk_fma_f32 v[76:77], v[140:141], v[162:163], v[76:77] op_sel:[0,1,0] op_sel_hi:[1,1,1]
  v_pk_fma_f32 v[78:79], v[142:143], v[162:163], v[78:79] op_sel:[0,1,0] op_sel_hi:[1,1,1]
  v_pk_mul_f32 v[204:205], v[60:61], v[60:61]
  v_pk_mul_f32 v[206:207], v[62:63], v[62:63]
  v_pk_mul_f32 v[208:209], v[76:77], v[76:77]
  v_pk_mul_f32 v[210:211], v[78:79], v[78:79]
  v_pk_fma_f32 v[204:205], v[204:205], s[62:63], v[212:213]
  v_pk_fma_f32 v[206:207], v[206:207], s[62:63], v[212:213]
  v_pk_fma_f32 v[208:209], v[208:209], s[62:63], v[212:213]
  v_pk_fma_f32 v[210:211], v[210:211], s[62:63], v[212:213]
  v_pk_mul_f32 v[204:205], v[204:205], v[60:61]
  v_pk_mul_f32 v[206:207], v[206:207], v[62:63]
  v_pk_mul_f32 v[208:209], v[208:209], v[76:77]
  v_pk_mul_f32 v[210:211], v[210:211], v[78:79]
  v_exp_f32 v204, v204
  v_exp_f32 v205, v205
  v_exp_f32 v206, v206
  v_exp_f32 v207, v207
  v_exp_f32 v208, v208
  v_exp_f32 v209, v209
  v_exp_f32 v210, v210
  v_exp_f32 v211, v211
  v_pk_add_f32 v[204:205], v[204:205], 1.0 op_sel_hi:[1,0]
  v_pk_add_f32 v[206:207], v[206:207], 1.0 op_sel_hi:[1,0]
  v_pk_add_f32 v[208:209], v[208:209], 1.0 op_sel_hi:[1,0]
  v_pk_add_f32 v[210:211], v[210:211], 1.0 op_sel_hi:[1,0]
  v_rcp_f32 v204, v204
  v_rcp_f32 v205, v205
  v_rcp_f32 v206, v206
  v_rcp_f32 v207, v207
  v_rcp_f32 v208, v208
  v_rcp_f32 v209, v209
  v_rcp_f32 v210, v210
  v_rcp_f32 v211, v211
  v_pk_mul_f32 v[60:61], v[60:61], v[204:205]
  v_pk_mul_f32 v[62:63], v[62:63], v[206:207]
  v_pk_mul_f32 v[76:77], v[76:77], v[208:209]
  v_pk_mul_f32 v[78:79], v[78:79], v[210:211]
  v_cvt_pk_bf16_f32 v60, v60, v61
  v_cvt_pk_bf16_f32 v61, v62, v63
  v_cvt_pk_bf16_f32 v62, v76, v77
  v_cvt_pk_bf16_f32 v63, v78, v79
  buffer_store_dwordx4 v[60:63], v11, s[12:15], s43 offen offset:0
adaLN_cond__compressed_kv_cla__mixer_channel_mlp__prompt_kernel_p19:
  s_add_u32 s40, s20, 0
  s_and_b32 s40, s40, 3
  s_mul_i32 s40, s40, 131072
  v_add_u32 v232, s40, v4
  s_add_u32 s40, s20, 1
  s_and_b32 s40, s40, 3
  s_mul_i32 s40, s40, 131072
  v_add_u32 v233, s40, v4
  s_add_u32 s40, s20, 2
  s_and_b32 s40, s40, 3
  s_mul_i32 s40, s40, 131072
  v_add_u32 v234, s40, v4
  s_add_u32 s40, s20, 3
  s_and_b32 s40, s40, 3
  s_mul_i32 s40, s40, 131072
  v_add_u32 v235, s40, v4
  s_mul_i32 s33, s98, 524288
  s_mul_i32 s41, s20, 32768
  s_add_u32 s33, s33, s41
  s_add_u32 s33, s33, 0x2004800
  s_lshl_b32 s40, s98, 7
  s_add_u32 s48, s40, 0x3f05000
  s_lshl_b32 s41, s23, 4
  s_add_u32 s46, s48, s41
  s_waitcnt vmcnt(0)
  s_barrier
  s_cmp_lg_u32 s96, 0
  s_cbranch_scc1 adaLN_cond__compressed_kv_cla__mixer_channel_mlp__prompt_kernel_rel10
adaLN_cond__compressed_kv_cla__mixer_channel_mlp__prompt_kernel_relb11:
  v_mov_b32 v6, s76
  v_mov_b32 v7, s77
  s_or_b32 s97, s46, s96
  buffer_store_dwordx2 v[6:7], v0, s[12:15], s97 offen
  s_xor_b32 s97, s97, 0x10000000
  buffer_store_dwordx2 v[6:7], v0, s[12:15], s97 offen sc1
  s_lshl_b32 s40, s20, 5
  s_add_u32 s48, s48, s40
  v_and_b32 v5, 16, v5
  buffer_load_dwordx2 v[6:7], v5, s[12:15], s48 offen sc1
  s_waitcnt vmcnt(0)
  s_mov_b32 s40, 0
  v_cmp_ne_u64 vcc, s[76:77], v[6:7]
  s_nop 0
  s_cbranch_vccz adaLN_cond__compressed_kv_cla__mixer_channel_mlp__prompt_kernel_ok12
adaLN_cond__compressed_kv_cla__mixer_channel_mlp__prompt_kernel_sp13:
  s_sleep 2
  buffer_load_dwordx2 v[6:7], v5, s[12:15], s48 offen sc1
  s_waitcnt vmcnt(0)
  s_add_u32 s40, s40, 1
  v_cmp_ne_u64 vcc, s[76:77], v[6:7]
  s_nop 0
  s_cbranch_vccz adaLN_cond__compressed_kv_cla__mixer_channel_mlp__prompt_kernel_ok12
  s_cmp_lt_u32 s40, 0x4000
  s_cbranch_scc1 adaLN_cond__compressed_kv_cla__mixer_channel_mlp__prompt_kernel_sp13
adaLN_cond__compressed_kv_cla__mixer_channel_mlp__prompt_kernel_ok12:
  buffer_load_dwordx4 a[0:3], v232, s[12:15], s33 offen offset:0 sc1
  buffer_load_dwordx4 a[4:7], v233, s[12:15], s33 offen offset:0 sc1
  buffer_load_dwordx4 a[8:11], v234, s[12:15], s33 offen offset:0 sc1
  buffer_load_dwordx4 a[12:15], v235, s[12:15], s33 offen offset:0 sc1
  buffer_load_dwordx4 a[16:19], v232, s[12:15], s33 offen offset:1024 sc1
  buffer_load_dwordx4 a[20:23], v233, s[12:15], s33 offen offset:1024 sc1
  buffer_load_dwordx4 a[24:27], v234, s[12:15], s33 offen offset:1024 sc1
  buffer_load_dwordx4 a[28:31], v235, s[12:15], s33 offen offset:1024 sc1
  s_waitcnt vmcnt(4)
  s_waitcnt lgkmcnt(0)
  v_mfma_f32_16x16x32_bf16 v[16:19], a[160:163], a[0:3], 0
  buffer_load_dwordx4 a[32:35], v232, s[12:15], s33 offen offset:2048 sc1
  v_mfma_f32_16x16x32_bf16 v[20:23], a[164:167], a[0:3], 0
  buffer_load_dwordx4 a[36:39], v233, s[12:15], s33 offen offset:2048 sc1
  v_mfma_f32_16x16x32_bf16 v[24:27], a[168:171], a[0:3], 0
  buffer_load_dwordx4 a[40:43], v234, s[12:15], s33 offen offset:2048 sc1
  v_mfma_f32_16x16x32_bf16 v[28:31], a[172:175], a[0:3], 0
  buffer_load_dwordx4 a[44:47], v235, s[12:15], s33 offen offset:2048 sc1
  v_mfma_f32_16x16x32_bf16 v[32:35], a[160:163], a[4:7], 0
  buffer_load_dwordx4 a[48:51], v232, s[12:15], s33 offen offset:3072 sc1
  v_mfma_f32_16x16x32_bf16 v[36:39], a[164:167], a[4:7], 0
  buffer_load_dwordx4 a[52:55], v233, s[12:15], s33 offen offset:3072 sc1
  v_mfma_f32_16x16x32_bf16 v[40:43], a[168:171], a[4:7], 0
  buffer_load_dwordx4 a[56:59], v234, s[12:15], s33 offen offset:3072 sc1
  v_mfma_f32_16x16x32_bf16 v[44:47], a[172:175], a[4:7], 0
  buffer_load_dwordx4 a[60:63], v235, s[12:15], s33 offen offset:3072 sc1
  v_mfma_f32_16x16x32_bf16 v[48:51], a[160:163], a[8:11], 0
  s_add_u32 s33, s33, 4096
  v_mfma_f32_16x16x32_bf16 v[52:55], a[164:167], a[8:11], 0
  v_mfma_f32_16x16x32_bf16 v[56:59], a[168:171], a[8:11], 0
  v_mfma_f32_16x16x32_bf16 v[60:63], a[172:175], a[8:11], 0
  v_mfma_f32_16x16x32_bf16 v[64:67], a[160:163], a[12:15], 0
  v_mfma_f32_16x16x32_bf16 v[68:71], a[164:167], a[12:15], 0
  v_mfma_f32_16x16x32_bf16 v[72:75], a[168:171], a[12:15], 0
  v_mfma_f32_16x16x32_bf16 v[76:79], a[172:175], a[12:15], 0
  s_waitcnt vmcnt(8)
  s_waitcnt lgkmcnt(0)
  v_mfma_f32_16x16x32_bf16 v[16:19], a[176:179], a[16:19], v[16:19]
  buffer_load_dwordx4 a[64:67], v232, s[12:15], s33 offen offset:0 sc1
  v_mfma_f32_16x16x32_bf16 v[20:23], a[180:183], a[16:19], v[20:23]
  buffer_load_dwordx4 a[68:71], v233, s[12:15], s33 offen offset:0 sc1
  v_mfma_f32_16x16x32_bf16 v[24:27], a[184:187], a[16:19], v[24:27]
  buffer_load_dwordx4 a[72:75], v234, s[12:15], s33 offen offset:0 sc1
  v_mfma_f32_16x16x32_bf16 v[28:31], a[188:191], a[16:19], v[28:31]
  buffer_load_dwordx4 a[76:79], v235, s[12:15], s33 offen offset:0 sc1
  v_mfma_f32_16x16x32_bf16 v[32:35], a[176:179], a[20:23], v[32:35]
  buffer_load_dwordx4 a[80:83], v232, s[12:15], s33 offen offset:1024 sc1
  v_mfma_f32_16x16x32_bf16 v[36:39], a[180:183], a[20:23], v[36:39]
  buffer_load_dwordx4 a[84:87], v233, s[12:15], s33 offen offset:1024 sc1
  v_mfma_f32_16x16x32_bf16 v[40:43], a[184:187], a[20:23], v[40:43]
  buffer_load_dwordx4 a[88:91], v234, s[12:15], s33 offen offset:1024 sc1
  v_mfma_f32_16x16x32_bf16 v[44:47], a[188:191], a[20:23], v[44:47]
  buffer_load_dwordx4 a[92:95], v235, s[12:15], s33 offen offset:1024 sc1
  v_mfma_f32_16x16x32_bf16 v[48:51], a[176:179], a[24:27], v[48:51]
  v_mfma_f32_16x16x32_bf16 v[52:55], a[180:183], a[24:27], v[52:55]
  v_mfma_f32_16x16x32_bf16 v[56:59], a[184:187], a[24:27], v[56:59]
  v_mfma_f32_16x16x32_bf16 v[60:63], a[188:191], a[24:27], v[60:63]
  v_mfma_f32_16x16x32_bf16 v[64:67], a[176:179], a[28:31], v[64:67]
  v_mfma_f32_16x16x32_bf16 v[68:71], a[180:183], a[28:31], v[68:71]
  v_mfma_f32_16x16x32_bf16 v[72:75], a[184:187], a[28:31], v[72:75]
  v_mfma_f32_16x16x32_bf16 v[76:79], a[188:191], a[28:31], v[76:79]
  s_waitcnt vmcnt(12)
  s_waitcnt lgkmcnt(0)
  v_mfma_f32_16x16x32_bf16 v[16:19], a[192:195], a[32:35], v[16:19]
  buffer_load_dwordx4 v[128:131], v232, s[12:15], s33 offen offset:2048 sc1
  v_mfma_f32_16x16x32_bf16 v[20:23], a[196:199], a[32:35], v[20:23]
  buffer_load_dwordx4 v[132:135], v233, s[12:15], s33 offen offset:2048 sc1
  v_mfma_f32_16x16x32_bf16 v[24:27], a[200:203], a[32:35], v[24:27]
  buffer_load_dwordx4 v[136:139], v234, s[12:15], s33 offen offset:2048 sc1
  v_mfma_f32_16x16x32_bf16 v[28:31], a[204:207], a[32:35], v[28:31]
  buffer_load_dwordx4 v[140:143], v235, s[12:15], s33 offen offset:2048 sc1
  v_mfma_f32_16x16x32_bf16 v[32:35], a[192:195], a[36:39], v[32:35]
  buffer_load_dwordx4 v[144:147], v232, s[12:15], s33 offen offset:3072 sc1
  v_mfma_f32_16x16x32_bf16 v[36:39], a[196:199], a[36:39], v[36:39]
  buffer_load_dwordx4 v[148:151], v233, s[12:15], s33 offen offset:3072 sc1
  v_mfma_f32_16x16x32_bf16 v[40:43], a[200:203], a[36:39], v[40:43]
  buffer_load_dwordx4 v[152:155], v234, s[12:15], s33 offen offset:3072 sc1
  v_mfma_f32_16x16x32_bf16 v[44:47], a[204:207], a[36:39], v[44:47]
  buffer_load_dwordx4 v[156:159], v235, s[12:15], s33 offen offset:3072 sc1
  v_mfma_f32_16x16x32_bf16 v[48:51], a[192:195], a[40:43], v[48:51]
  s_add_u32 s33, s33, 4096
  v_mfma_f32_16x16x32_bf16 v[52:55], a[196:199], a[40:43], v[52:55]
  v_mfma_f32_16x16x32_bf16 v[56:59], a[200:203], a[40:43], v[56:59]
  v_mfma_f32_16x16x32_bf16 v[60:63], a[204:207], a[40:43], v[60:63]
  v_mfma_f32_16x16x32_bf16 v[64:67], a[192:195], a[44:47], v[64:67]
  v_mfma_f32_16x16x32_bf16 v[68:71], a[196:199], a[44:47], v[68:71]
  v_mfma_f32_16x16x32_bf16 v[72:75], a[200:203], a[44:47], v[72:75]
  v_mfma_f32_16x16x32_bf16 v[76:79], a[204:207], a[44:47], v[76:79]
  s_waitcnt vmcnt(16)
  s_waitcnt lgkmcnt(0)
  v_mfma_f32_16x16x32_bf16 v[16:19], a[208:211], a[48:51], v[16:19]
  buffer_load_dwordx4 v[160:163], v232, s[12:15], s33 offen offset:0 sc1
  v_mfma_f32_16x16x32_bf16 v[20:23], a[212:215], a[48:51], v[20:23]
  buffer_load_dwordx4 v[164:167], v233, s[12:15], s33 offen offset:0 sc1
  v_mfma_f32_16x16x32_bf16 v[24:27], a[216:219], a[48:51], v[24:27]
  buffer_load_dwordx4 v[168:171], v234, s[12:15], s33 offen offset:0 sc1
  v_mfma_f32_16x16x32_bf16 v[28:31], a[220:223], a[48:51], v[28:31]
  buffer_load_dwordx4 v[172:175], v235, s[12:15], s33 offen offset:0 sc1
  v_mfma_f32_16x16x32_bf16 v[32:35], a[208:211], a[52:55], v[32:35]
  v_mfma_f32_16x16x32_bf16 v[36:39], a[212:215], a[52:55], v[36:39]
  v_mfma_f32_16x16x32_bf16 v[40:43], a[216:219], a[52:55], v[40:43]
  v_mfma_f32_16x16x32_bf16 v[44:47], a[220:223], a[52:55], v[44:47]
  v_mfma_f32_16x16x32_bf16 v[48:51], a[208:211], a[56:59], v[48:51]
  v_mfma_f32_16x16x32_bf16 v[52:55], a[212:215], a[56:59], v[52:55]
  v_mfma_f32_16x16x32_bf16 v[56:59], a[216:219], a[56:59], v[56:59]
  v_mfma_f32_16x16x32_bf16 v[60:63], a[220:223], a[56:59], v[60:63]
  v_mfma_f32_16x16x32_bf16 v[64:67], a[208:211], a[60:63], v[64:67]
  v_mfma_f32_16x16x32_bf16 v[68:71], a[212:215], a[60:63], v[68:71]
  v_mfma_f32_16x16x32_bf16 v[72:75], a[216:219], a[60:63], v[72:75]
  v_mfma_f32_16x16x32_bf16 v[76:79], a[220:223], a[60:63], v[76:79]
  s_waitcnt vmcnt(16)
  s_waitcnt lgkmcnt(0)
  v_mfma_f32_16x16x32_bf16 v[16:19], a[224:227], a[64:67], v[16:19]
  buffer_load_dwordx4 v[176:179], v232, s[12:15], s33 offen offset:1024 sc1
  v_mfma_f32_16x16x32_bf16 v[20:23], a[228:231], a[64:67], v[20:23]
  buffer_load_dwordx4 v[180:183], v233, s[12:15], s33 offen offset:1024 sc1
  v_mfma_f32_16x16x32_bf16 v[24:27], a[232:235], a[64:67], v[24:27]
  buffer_load_dwordx4 v[184:187], v234, s[12:15], s33 offen offset:1024 sc1
  v_mfma_f32_16x16x32_bf16 v[28:31], a[236:239], a[64:67], v[28:31]
  buffer_load_dwordx4 v[188:191], v235, s[12:15], s33 offen offset:1024 sc1
  v_mfma_f32_16x16x32_bf16 v[32:35], a[224:227], a[68:71], v[32:35]
  v_mfma_f32_16x16x32_bf16 v[36:39], a[228:231], a[68:71], v[36:39]
  v_mfma_f32_16x16x32_bf16 v[40:43], a[232:235], a[68:71], v[40:43]
  v_mfma_f32_16x16x32_bf16 v[44:47], a[236:239], a[68:71], v[44:47]
  v_mfma_f32_16x16x32_bf16 v[48:51], a[224:227], a[72:75], v[48:51]
  v_mfma_f32_16x16x32_bf16 v[52:55], a[228:231], a[72:75], v[52:55]
  v_mfma_f32_16x16x32_bf16 v[56:59], a[232:235], a[72:75], v[56:59]
  v_mfma_f32_16x16x32_bf16 v[60:63], a[236:239], a[72:75], v[60:63]
  v_mfma_f32_16x16x32_bf16 v[64:67], a[224:227], a[76:79], v[64:67]
  v_mfma_f32_16x16x32_bf16 v[68:71], a[228:231], a[76:79], v[68:71]
  v_mfma_f32_16x16x32_bf16 v[72:75], a[232:235], a[76:79], v[72:75]
  v_mfma_f32_16x16x32_bf16 v[76:79], a[236:239], a[76:79], v[76:79]
  s_waitcnt vmcnt(16)
  s_waitcnt lgkmcnt(0)
  v_mfma_f32_16x16x32_bf16 v[16:19], a[240:243], a[80:83], v[16:19]
  buffer_load_dwordx4 v[192:195], v232, s[12:15], s33 offen offset:2048 sc1
  v_mfma_f32_16x16x32_bf16 v[20:23], a[244:247], a[80:83], v[20:23]
  buffer_load_dwordx4 v[196:199], v233, s[12:15], s33 offen offset:2048 sc1
  v_mfma_f32_16x16x32_bf16 v[24:27], a[248:251], a[80:83], v[24:27]
  buffer_load_dwordx4 v[200:203], v234, s[12:15], s33 offen offset:2048 sc1
  v_mfma_f32_16x16x32_bf16 v[28:31], a[252:255], a[80:83], v[28:31]
  buffer_load_dwordx4 v[204:207], v235, s[12:15], s33 offen offset:2048 sc1
  v_mfma_f32_16x16x32_bf16 v[32:35], a[240:243], a[84:87], v[32:35]
  v_mfma_f32_16x16x32_bf16 v[36:39], a[244:247], a[84:87], v[36:39]
  v_mfma_f32_16x16x32_bf16 v[40:43], a[248:251], a[84:87], v[40:43]
  v_mfma_f32_16x16x32_bf16 v[44:47], a[252:255], a[84:87], v[44:47]
  v_mfma_f32_16x16x32_bf16 v[48:51], a[240:243], a[88:91], v[48:51]
  v_mfma_f32_16x16x32_bf16 v[52:55], a[244:247], a[88:91], v[52:55]
  v_mfma_f32_16x16x32_bf16 v[56:59], a[248:251], a[88:91], v[56:59]
  v_mfma_f32_16x16x32_bf16 v[60:63], a[252:255], a[88:91], v[60:63]
  v_mfma_f32_16x16x32_bf16 v[64:67], a[240:243], a[92:95], v[64:67]
  v_mfma_f32_16x16x32_bf16 v[68:71], a[244:247], a[92:95], v[68:71]
  v_mfma_f32_16x16x32_bf16 v[72:75], a[248:251], a[92:95], v[72:75]
  v_mfma_f32_16x16x32_bf16 v[76:79], a[252:255], a[92:95], v[76:79]
  s_waitcnt vmcnt(16)
  s_waitcnt lgkmcnt(0)
  v_mfma_f32_16x16x32_bf16 v[16:19], a[96:99], v[128:131], v[16:19]
  buffer_load_dwordx4 a[0:3], v232, s[12:15], s33 offen offset:3072 sc1
  v_mfma_f32_16x16x32_bf16 v[20:23], a[100:103], v[128:131], v[20:23]
  buffer_load_dwordx4 a[4:7], v233, s[12:15], s33 offen offset:3072 sc1
  v_mfma_f32_16x16x32_bf16 v[24:27], a[104:107], v[128:131], v[24:27]
  buffer_load_dwordx4 a[8:11], v234, s[12:15], s33 offen offset:3072 sc1
  v_mfma_f32_16x16x32_bf16 v[28:31], a[108:111], v[128:131], v[28:31]
  buffer_load_dwordx4 a[12:15], v235, s[12:15], s33 offen offset:3072 sc1
  v_mfma_f32_16x16x32_bf16 v[32:35], a[96:99], v[132:135], v[32:35]
  s_add_u32 s33, s33, 4096
  v_mfma_f32_16x16x32_bf16 v[36:39], a[100:103], v[132:135], v[36:39]
  v_mfma_f32_16x16x32_bf16 v[40:43], a[104:107], v[132:135], v[40:43]
  v_mfma_f32_16x16x32_bf16 v[44:47], a[108:111], v[132:135], v[44:47]
  v_mfma_f32_16x16x32_bf16 v[48:51], a[96:99], v[136:139], v[48:51]
  v_mfma_f32_16x16x32_bf16 v[52:55], a[100:103], v[136:139], v[52:55]
  v_mfma_f32_16x16x32_bf16 v[56:59], a[104:107], v[136:139], v[56:59]
  v_mfma_f32_16x16x32_bf16 v[60:63], a[108:111], v[136:139], v[60:63]
  v_mfma_f32_16x16x32_bf16 v[64:67], a[96:99], v[140:143], v[64:67]
  v_mfma_f32_16x16x32_bf16 v[68:71], a[100:103], v[140:143], v[68:71]
  v_mfma_f32_16x16x32_bf16 v[72:75], a[104:107], v[140:143], v[72:75]
  v_mfma_f32_16x16x32_bf16 v[76:79], a[108:111], v[140:143], v[76:79]
  s_waitcnt vmcnt(16)
  s_waitcnt lgkmcnt(0)
  v_mfma_f32_16x16x32_bf16 v[16:19], a[112:115], v[144:147], v[16:19]
  buffer_load_dwordx4 a[16:19], v232, s[12:15], s33 offen offset:0 sc1
  v_mfma_f32_16x16x32_bf16 v[20:23], a[116:119], v[144:147], v[20:23]
  buffer_load_dwordx4 a[20:23], v233, s[12:15], s33 offen offset:0 sc1
  v_mfma_f32_16x16x32_bf16 v[24:27], a[120:123], v[144:147], v[24:27]
  ds_read_b128 a[144:147], v228 offset:16384
  ds_read_b128 a[148:151], v228 offset:17408
  v_mfma_f32_16x16x32_bf16 v[28:31], a[124:127], v[144:147], v[28:31]
  buffer_load_dwordx4 a[24:27], v234, s[12:15], s33 offen offset:0 sc1
  v_mfma_f32_16x16x32_bf16 v[32:35], a[112:115], v[148:151], v[32:35]
  buffer_load_dwordx4 a[28:31], v235, s[12:15], s33 offen offset:0 sc1
  v_mfma_f32_16x16x32_bf16 v[36:39], a[116:119], v[148:151], v[36:39]
  ds_read_b128 a[152:155], v228 offset:18432
  v_mfma_f32_16x16x32_bf16 v[40:43], a[120:123], v[148:151], v[40:43]
  ds_read_b128 a[156:159], v228 offset:19456
  v_mfma_f32_16x16x32_bf16 v[44:47], a[124:127], v[148:151], v[44:47]
  v_mfma_f32_16x16x32_bf16 v[48:51], a[112:115], v[152:155], v[48:51]
  v_mfma_f32_16x16x32_bf16 v[52:55], a[116:119], v[152:155], v[52:55]
  v_mfma_f32_16x16x32_bf16 v[56:59], a[120:123], v[152:155], v[56:59]
  v_mfma_f32_16x16x32_bf16 v[60:63], a[124:127], v[152:155], v[60:63]
  v_mfma_f32_16x16x32_bf16 v[64:67], a[112:115], v[156:159], v[64:67]
  v_mfma_f32_16x16x32_bf16 v[68:71], a[116:119], v[156:159], v[68:71]
  v_mfma_f32_16x16x32_bf16 v[72:75], a[120:123], v[156:159], v[72:75]
  v_mfma_f32_16x16x32_bf16 v[76:79], a[124:127], v[156:159], v[76:79]
  s_waitcnt vmcnt(16)
  s_waitcnt lgkmcnt(0)
  v_mfma_f32_16x16x32_bf16 v[16:19], a[144:147], v[160:163], v[16:19]
  buffer_load_dwordx4 a[32:35], v232, s[12:15], s33 offen offset:1024 sc1
  v_mfma_f32_16x16x32_bf16 v[20:23], a[148:151], v[160:163], v[20:23]
  buffer_load_dwordx4 a[36:39], v233, s[12:15], s33 offen offset:1024 sc1
  v_mfma_f32_16x16x32_bf16 v[24:27], a[152:155], v[160:163], v[24:27]
  ds_read_b128 a[128:131], v229 offset:0
  ds_read_b128 a[132:135], v229 offset:1024
  v_mfma_f32_16x16x32_bf16 v[28:31], a[156:159], v[160:163], v[28:31]
  buffer_load_dwordx4 a[40:43], v234, s[12:15], s33 offen offset:1024 sc1
  v_mfma_f32_16x16x32_bf16 v[32:35], a[144:147], v[164:167], v[32:35]
  buffer_load_dwordx4 a[44:47], v235, s[12:15], s33 offen offset:1024 sc1
  v_mfma_f32_16x16x32_bf16 v[36:39], a[148:151], v[164:167], v[36:39]
  ds_read_b128 a[136:139], v229 offset:2048
  v_mfma_f32_16x16x32_bf16 v[40:43], a[152:155], v[164:167], v[40:43]
  ds_read_b128 a[140:143], v229 offset:3072
  v_mfma_f32_16x16x32_bf16 v[44:47], a[156:159], v[164:167], v[44:47]
  v_mfma_f32_16x16x32_bf16 v[48:51], a[144:147], v[168:171], v[48:51]
  v_mfma_f32_16x16x32_bf16 v[52:55], a[148:151], v[168:171], v[52:55]
  v_mfma_f32_16x16x32_bf16 v[56:59], a[152:155], v[168:171], v[56:59]
  v_mfma_f32_16x16x32_bf16 v[60:63], a[156:159], v[168:171], v[60:63]
  v_mfma_f32_16x16x32_bf16 v[64:67], a[144:147], v[172:175], v[64:67]
  v_mfma_f32_16x16x32_bf16 v[68:71], a[148:151], v[172:175], v[68:71]
  v_mfma_f32_16x16x32_bf16 v[72:75], a[152:155], v[172:175], v[72:75]
  v_mfma_f32_16x16x32_bf16 v[76:79], a[156:159], v[172:175], v[76:79]
  s_waitcnt vmcnt(16)
  s_waitcnt lgkmcnt(0)
  v_mfma_f32_16x16x32_bf16 v[16:19], a[128:131], v[176:179], v[16:19]
  ds_read_b128 a[144:147], v229 offset:16384
  s_add_u32 s40, s20, 1
  v_mfma_f32_16x16x32_bf16 v[20:23], a[132:135], v[176:179], v[20:23]
  s_and_b32 s40, s40, 3
  s_lshl_b32 s40, s40, 14
  v_mfma_f32_16x16x32_bf16 v[24:27], a[136:139], v[176:179], v[24:27]
  ds_read_b128 a[148:151], v229 offset:17408
  v_add_u32 v9, s40, v242
  v_mfma_f32_16x16x32_bf16 v[28:31], a[140:143], v[176:179], v[28:31]
  s_add_u32 s40, s20, 2
  s_and_b32 s40, s40, 3
  v_mfma_f32_16x16x32_bf16 v[32:35], a[128:131], v[180:183], v[32:35]
  ds_read_b128 a[152:155], v229 offset:18432
  s_lshl_b32 s40, s40, 14
  v_mfma_f32_16x16x32_bf16 v[36:39], a[132:135], v[180:183], v[36:39]
  v_add_u32 v10, s40, v242
  s_add_u32 s40, s20, 3
  v_mfma_f32_16x16x32_bf16 v[40:43], a[136:139], v[180:183], v[40:43]
  ds_read_b128 a[156:159], v229 offset:19456
  s_and_b32 s40, s40, 3
  v_mfma_f32_16x16x32_bf16 v[44:47], a[140:143], v[180:183], v[44:47]
  s_lshl_b32 s40, s40, 14
  v_add_u32 v11, s40, v242
  v_mfma_f32_16x16x32_bf16 v[48:51], a[128:131], v[184:187], v[48:51]
  s_lshl_b32 s40, s20, 14
  v_add_u32 v8, s40, v242
  v_mfma_f32_16x16x32_bf16 v[52:55], a[132:135], v[184:187], v[52:55]
  v_mfma_f32_16x16x32_bf16 v[56:59], a[136:139], v[184:187], v[56:59]
  v_mfma_f32_16x16x32_bf16 v[60:63], a[140:143], v[184:187], v[60:63]
  v_mfma_f32_16x16x32_bf16 v[64:67], a[128:131], v[188:191], v[64:67]
  v_mfma_f32_16x16x32_bf16 v[68:71], a[132:135], v[188:191], v[68:71]
  v_mfma_f32_16x16x32_bf16 v[72:75], a[136:139], v[188:191], v[72:75]
  v_mfma_f32_16x16x32_bf16 v[76:79], a[140:143], v[188:191], v[76:79]
  s_waitcnt vmcnt(12)
  s_waitcnt lgkmcnt(0)
  v_mfma_f32_16x16x32_bf16 v[16:19], a[144:147], v[192:195], v[16:19]
  ds_read_b128 a[128:131], v228 offset:32768
  v_lshlrev_b32 v80, 16, v244
  v_mfma_f32_16x16x32_bf16 v[20:23], a[148:151], v[192:195], v[20:23]
  v_and_b32 v81, 0xffff0000, v244
  v_lshlrev_b32 v82, 16, v245
  v_mfma_f32_16x16x32_bf16 v[24:27], a[152:155], v[192:195], v[24:27]
  ds_read_b128 a[132:135], v228 offset:33792
  v_and_b32 v83, 0xffff0000, v245
  v_mfma_f32_16x16x32_bf16 v[28:31], a[156:159], v[192:195], v[28:31]
  v_lshlrev_b32 v84, 16, v246
  v_and_b32 v85, 0xffff0000, v246
  v_mfma_f32_16x16x32_bf16 v[32:35], a[144:147], v[196:199], v[32:35]
  ds_read_b128 a[136:139], v228 offset:34816
  v_lshlrev_b32 v86, 16, v247
  v_mfma_f32_16x16x32_bf16 v[36:39], a[148:151], v[196:199], v[36:39]
  v_and_b32 v87, 0xffff0000, v247
  v_lshlrev_b32 v88, 16, v248
  v_mfma_f32_16x16x32_bf16 v[40:43], a[152:155], v[196:199], v[40:43]
  ds_read_b128 a[140:143], v228 offset:35840
  v_and_b32 v89, 0xffff0000, v248
  v_mfma_f32_16x16x32_bf16 v[44:47], a[156:159], v[196:199], v[44:47]
  v_lshlrev_b32 v90, 16, v249
  v_and_b32 v91, 0xffff0000, v249
  v_mfma_f32_16x16x32_bf16 v[48:51], a[144:147], v[200:203], v[48:51]
  v_lshlrev_b32 v92, 16, v250
  v_and_b32 v93, 0xffff0000, v250
  v_mfma_f32_16x16x32_bf16 v[52:55], a[148:151], v[200:203], v[52:55]
  v_lshlrev_b32 v94, 16, v251
  v_and_b32 v95, 0xffff0000, v251
  v_mfma_f32_16x16x32_bf16 v[56:59], a[152:155], v[200:203], v[56:59]
  v_mfma_f32_16x16x32_bf16 v[60:63], a[156:159], v[200:203], v[60:63]
  v_mfma_f32_16x16x32_bf16 v[64:67], a[144:147], v[204:207], v[64:67]
  v_mfma_f32_16x16x32_bf16 v[68:71], a[148:151], v[204:207], v[68:71]
  v_mfma_f32_16x16x32_bf16 v[72:75], a[152:155], v[204:207], v[72:75]
  v_mfma_f32_16x16x32_bf16 v[76:79], a[156:159], v[204:207], v[76:79]
  s_waitcnt vmcnt(8)
  s_waitcnt lgkmcnt(0)
  v_mfma_f32_16x16x32_bf16 v[16:19], a[128:131], a[0:3], v[16:19]
  ds_read_b128 a[144:147], v228 offset:49152
  v_lshlrev_b32 v208, 16, v216
  v_mfma_f32_16x16x32_bf16 v[20:23], a[132:135], a[0:3], v[20:23]
  v_and_b32 v209, 0xffff0000, v216
  v_lshlrev_b32 v210, 16, v217
  v_mfma_f32_16x16x32_bf16 v[24:27], a[136:139], a[0:3], v[24:27]
  ds_read_b128 a[148:151], v228 offset:50176
  v_and_b32 v211, 0xffff0000, v217
  v_mfma_f32_16x16x32_bf16 v[28:31], a[140:143], a[0:3], v[28:31]
  v_lshlrev_b32 v212, 16, v218
  v_and_b32 v213, 0xffff0000, v218
  v_mfma_f32_16x16x32_bf16 v[32:35], a[128:131], a[4:7], v[32:35]
  ds_read_b128 a[152:155], v228 offset:51200
  v_lshlrev_b32 v214, 16, v219
  v_mfma_f32_16x16x32_bf16 v[36:39], a[132:135], a[4:7], v[36:39]
  v_and_b32 v215, 0xffff0000, v219
  v_lshlrev_b32 v216, 16, v220
  v_mfma_f32_16x16x32_bf16 v[40:43], a[136:139], a[4:7], v[40:43]
  ds_read_b128 a[156:159], v228 offset:52224
  v_and_b32 v217, 0xffff0000, v220
  v_mfma_f32_16x16x32_bf16 v[44:47], a[140:143], a[4:7], v[44:47]
  v_lshlrev_b32 v218, 16, v221
  v_and_b32 v219, 0xffff0000, v221
  v_mfma_f32_16x16x32_bf16 v[48:51], a[128:131], a[8:11], v[48:51]
  v_lshlrev_b32 v220, 16, v222
  v_and_b32 v221, 0xffff0000, v222
  v_mfma_f32_16x16x32_bf16 v[52:55], a[132:135], a[8:11], v[52:55]
  v_lshlrev_b32 v222, 16, v223
  v_and_b32 v223, 0xffff0000, v223
  v_mfma_f32_16x16x32_bf16 v[56:59], a[136:139], a[8:11], v[56:59]
  v_fmac_f32 v80, v96, v208
  v_mfma_f32_16x16x32_bf16 v[60:63], a[140:143], a[8:11], v[60:63]
  v_mfma_f32_16x16x32_bf16 v[64:67], a[128:131], a[12:15], v[64:67]
  v_mfma_f32_16x16x32_bf16 v[68:71], a[132:135], a[12:15], v[68:71]
  v_mfma_f32_16x16x32_bf16 v[72:75], a[136:139], a[12:15], v[72:75]
  v_mfma_f32_16x16x32_bf16 v[76:79], a[140:143], a[12:15], v[76:79]
  s_waitcnt vmcnt(4)
  s_waitcnt lgkmcnt(0)
  v_mfma_f32_16x16x32_bf16 v[16:19], a[144:147], a[16:19], v[16:19]
  ds_read_b128 a[128:131], v228 offset:0
  v_fmac_f32 v81, v97, v209
  v_mfma_f32_16x16x32_bf16 v[20:23], a[148:151], a[16:19], v[20:23]
  v_fmac_f32 v82, v98, v210
  v_fmac_f32 v83, v99, v211
  v_mfma_f32_16x16x32_bf16 v[24:27], a[152:155], a[16:19], v[24:27]
  ds_read_b128 a[132:135], v228 offset:1024
  v_fmac_f32 v84, v100, v212
  v_mfma_f32_16x16x32_bf16 v[28:31], a[156:159], a[16:19], v[28:31]
  v_fmac_f32 v85, v101, v213
  v_fmac_f32 v86, v102, v214
  v_mfma_f32_16x16x32_bf16 v[32:35], a[144:147], a[20:23], v[32:35]
  ds_read_b128 a[136:139], v228 offset:2048
  v_fmac_f32 v87, v103, v215
  v_mfma_f32_16x16x32_bf16 v[36:39], a[148:151], a[20:23], v[36:39]
  v_fmac_f32 v88, v104, v216
  v_fmac_f32 v89, v105, v217
  v_mfma_f32_16x16x32_bf16 v[40:43], a[152:155], a[20:23], v[40:43]
  ds_read_b128 a[140:143], v228 offset:3072
  v_fmac_f32 v90, v106, v218
  v_mfma_f32_16x16x32_bf16 v[44:47], a[156:159], a[20:23], v[44:47]
  v_fmac_f32 v91, v107, v219
  v_fmac_f32 v92, v108, v220
  v_mfma_f32_16x16x32_bf16 v[48:51], a[144:147], a[24:27], v[48:51]
  v_fmac_f32 v93, v109, v221
  v_fmac_f32 v94, v110, v222
  v_mfma_f32_16x16x32_bf16 v[52:55], a[148:151], a[24:27], v[52:55]
  v_fmac_f32 v95, v111, v223
  v_mfma_f32_16x16x32_bf16 v[56:59], a[152:155], a[24:27], v[56:59]
  v_mfma_f32_16x16x32_bf16 v[60:63], a[156:159], a[24:27], v[60:63]
  v_mfma_f32_16x16x32_bf16 v[64:67], a[144:147], a[28:31], v[64:67]
  v_mfma_f32_16x16x32_bf16 v[68:71], a[148:151], a[28:31], v[68:71]
  v_mfma_f32_16x16x32_bf16 v[72:75], a[152:155], a[28:31], v[72:75]
  v_mfma_f32_16x16x32_bf16 v[76:79], a[156:159], a[28:31], v[76:79]
  s_waitcnt vmcnt(0)
  s_waitcnt lgkmcnt(0)
  v_mfma_f32_16x16x32_bf16 v[32:35], a[128:131], a[36:39], v[32:35]
  v_mfma_f32_16x16x32_bf16 v[36:39], a[132:135], a[36:39], v[36:39]
  v_mfma_f32_16x16x32_bf16 v[40:43], a[136:139], a[36:39], v[40:43]
  v_mfma_f32_16x16x32_bf16 v[44:47], a[140:143], a[36:39], v[44:47]
  v_mfma_f32_16x16x32_bf16 v[48:51], a[128:131], a[40:43], v[48:51]
  v_mfma_f32_16x16x32_bf16 v[52:55], a[132:135], a[40:43], v[52:55]
  v_mfma_f32_16x16x32_bf16 v[56:59], a[136:139], a[40:43], v[56:59]
  v_mfma_f32_16x16x32_bf16 v[60:63], a[140:143], a[40:43], v[60:63]
  v_mfma_f32_16x16x32_bf16 v[64:67], a[128:131], a[44:47], v[64:67]
  ds_write_b128 v9, v[32:35] offset:4096
  v_mfma_f32_16x16x32_bf16 v[68:71], a[132:135], a[44:47], v[68:71]
  ds_write_b128 v9, v[36:39] offset:5120
  v_mfma_f32_16x16x32_bf16 v[72:75], a[136:139], a[44:47], v[72:75]
  ds_write_b128 v9, v[40:43] offset:6144
  v_mfma_f32_16x16x32_bf16 v[76:79], a[140:143], a[44:47], v[76:79]
  ds_write_b128 v9, v[44:47] offset:7168
  v_mfma_f32_16x16x32_bf16 v[16:19], a[128:131], a[32:35], v[16:19]
  ds_write_b128 v10, v[48:51] offset:8192
  v_mfma_f32_16x16x32_bf16 v[20:23], a[132:135], a[32:35], v[20:23]
  ds_write_b128 v10, v[52:55] offset:9216
  v_mfma_f32_16x16x32_bf16 v[24:27], a[136:139], a[32:35], v[24:27]
  ds_write_b128 v10, v[56:59] offset:10240
  v_mfma_f32_16x16x32_bf16 v[28:31], a[140:143], a[32:35], v[28:31]
  ds_write_b128 v10, v[60:63] offset:11264
  s_or_b32 s40, s20, s23
  s_cbranch_scc1 adaLN_cond__compressed_kv_cla__mixer_channel_mlp__prompt_kernel_wb14
  buffer_wbl2 sc1
adaLN_cond__compressed_kv_cla__mixer_channel_mlp__prompt_kernel_wb14:
  ds_write_b128 v11, v[64:67] offset:12288
  ds_write_b128 v11, v[68:71] offset:13312
  ds_write_b128 v11, v[72:75] offset:14336
  ds_write_b128 v11, v[76:79] offset:15360
  s_waitcnt lgkmcnt(0)
  s_barrier
  ds_read_b128 v[32:35], v8 offset:4096
  ds_read_b128 v[36:39], v8 offset:5120
  ds_read_b128 v[40:43], v8 offset:6144
  ds_read_b128 v[44:47], v8 offset:7168
  ds_read_b128 v[48:51], v8 offset:8192
  ds_read_b128 v[52:55], v8 offset:9216
  ds_read_b128 v[56:59], v8 offset:10240
  ds_read_b128 v[60:63], v8 offset:11264
  ds_read_b128 v[64:67], v8 offset:12288
  ds_read_b128 v[68:71], v8 offset:13312
  ds_read_b128 v[72:75], v8 offset:14336
  ds_read_b128 v[76:79], v8 offset:15360
  s_waitcnt lgkmcnt(8)
  v_pk_add_f32 v[16:17], v[16:17], v[32:33]
  v_pk_add_f32 v[18:19], v[18:19], v[34:35]
  v_pk_add_f32 v[20:21], v[20:21], v[36:37]
  v_pk_add_f32 v[22:23], v[22:23], v[38:39]
  v_pk_add_f32 v[24:25], v[24:25], v[40:41]
  v_pk_add_f32 v[26:27], v[26:27], v[42:43]
  v_pk_add_f32 v[28:29], v[28:29], v[44:45]
  v_pk_add_f32 v[30:31], v[30:31], v[46:47]
  s_waitcnt lgkmcnt(4)
  v_pk_add_f32 v[16:17], v[16:17], v[48:49]
  v_pk_add_f32 v[18:19], v[18:19], v[50:51]
  v_pk_add_f32 v[20:21], v[20:21], v[52:53]
  v_pk_add_f32 v[22:23], v[22:23], v[54:55]
  v_pk_add_f32 v[24:25], v[24:25], v[56:57]
  v_pk_add_f32 v[26:27], v[26:27], v[58:59]
  v_pk_add_f32 v[28:29], v[28:29], v[60:61]
  v_pk_add_f32 v[30:31], v[30:31], v[62:63]
  s_waitcnt lgkmcnt(0)
  v_pk_add_f32 v[16:17], v[16:17], v[64:65]
  v_pk_add_f32 v[18:19], v[18:19], v[66:67]
  v_pk_add_f32 v[20:21], v[20:21], v[68:69]
  v_pk_add_f32 v[22:23], v[22:23], v[70:71]
  v_pk_add_f32 v[24:25], v[24:25], v[72:73]
  v_pk_add_f32 v[26:27], v[26:27], v[74:75]
  v_pk_add_f32 v[28:29], v[28:29], v[76:77]
  v_pk_add_f32 v[30:31], v[30:31], v[78:79]
  v_pk_fma_f32 v[80:81], v[96:97], v[16:17], v[80:81]
  v_pk_fma_f32 v[82:83], v[98:99], v[18:19], v[82:83]
  v_pk_fma_f32 v[84:85], v[100:101], v[20:21], v[84:85]
  v_pk_fma_f32 v[86:87], v[102:103], v[22:23], v[86:87]
  v_pk_fma_f32 v[88:89], v[104:105], v[24:25], v[88:89]
  v_pk_fma_f32 v[90:91], v[106:107], v[26:27], v[90:91]
  v_pk_fma_f32 v[92:93], v[108:109], v[28:29], v[92:93]
  v_pk_fma_f32 v[94:95], v[110:111], v[30:31], v[94:95]
  v_cvt_pk_bf16_f32 v48, v80, v81
  v_cvt_pk_bf16_f32 v49, v82, v83
  v_cvt_pk_bf16_f32 v50, v84, v85
  v_cvt_pk_bf16_f32 v51, v86, v87
  v_cvt_pk_bf16_f32 v52, v88, v89
  v_cvt_pk_bf16_f32 v53, v90, v91
  v_cvt_pk_bf16_f32 v54, v92, v93
  v_cvt_pk_bf16_f32 v55, v94, v95
  global_store_dwordx2 v236, v[48:49], s[90:91] offset:0 nt
  global_store_dwordx2 v236, v[50:51], s[90:91] offset:32 nt
  global_store_dwordx2 v236, v[52:53], s[90:91] offset:64 nt
  global_store_dwordx2 v236, v[54:55], s[90:91] offset:96 nt
  s_endpgm
adaLN_cond__compressed_kv_cla__mixer_channel_mlp__prompt_kernel_slowlo:
  s_mov_b32 s40, s22
  s_lshl_b32 s41, s40, 7
  v_add_u32 v218, s41, v5
  s_add_u32 s41, s41, 64
  v_add_u32 v219, s41, v6
  s_add_u32 s40, s40, 1
  s_lshl_b32 s28, s40, 2
  s_mul_i32 s38, s21, 0x90000
  s_add_u32 s39, s38, 0x6400000
  s_add_u32 s38, s38, 0x5000000
  v_add_u32 v214, 4096, v4
  v_mov_b32 v212, v7
  v_mov_b32 v213, v7
  v_mov_b32 v20, 0
  v_mov_b32 v21, 0
  v_mov_b32 v22, 0
  v_mov_b32 v23, 0
  v_accvgpr_write_b32 a0, 0
  v_accvgpr_write_b32 a1, 0
  v_accvgpr_write_b32 a2, 0
  v_accvgpr_write_b32 a3, 0
  v_accvgpr_write_b32 a4, 0
  v_accvgpr_write_b32 a5, 0
  v_accvgpr_write_b32 a6, 0
  v_accvgpr_write_b32 a7, 0
  v_accvgpr_write_b32 a8, 0
  v_accvgpr_write_b32 a9, 0
  v_accvgpr_write_b32 a10, 0
  v_accvgpr_write_b32 a11, 0
  v_accvgpr_write_b32 a12, 0
  v_accvgpr_write_b32 a13, 0
  v_accvgpr_write_b32 a14, 0
  v_accvgpr_write_b32 a15, 0
  v_accvgpr_write_b32 a16, 0
  v_accvgpr_write_b32 a17, 0
  v_accvgpr_write_b32 a18, 0
  v_accvgpr_write_b32 a19, 0
  v_accvgpr_write_b32 a20, 0
  v_accvgpr_write_b32 a21, 0
  v_accvgpr_write_b32 a22, 0
  v_accvgpr_write_b32 a23, 0
  v_accvgpr_write_b32 a24, 0
  v_accvgpr_write_b32 a25, 0
  v_accvgpr_write_b32 a26, 0
  v_accvgpr_write_b32 a27, 0
  v_accvgpr_write_b32 a28, 0
  v_accvgpr_write_b32 a29, 0
  v_accvgpr_write_b32 a30, 0
  v_accvgpr_write_b32 a31, 0
  v_mov_b32 v24, 0
  v_mov_b32 v25, 0
  v_mov_b32 v26, 0
  v_mov_b32 v27, 0
  v_accvgpr_write_b32 a32, 0
  v_accvgpr_write_b32 a33, 0
  v_accvgpr_write_b32 a34, 0
  v_accvgpr_write_b32 a35, 0
  v_accvgpr_write_b32 a36, 0
  v_accvgpr_write_b32 a37, 0
  v_accvgpr_write_b32 a38, 0
  v_accvgpr_write_b32 a39, 0
  v_accvgpr_write_b32 a40, 0
  v_accvgpr_write_b32 a41, 0
  v_accvgpr_write_b32 a42, 0
  v_accvgpr_write_b32 a43, 0
  v_accvgpr_write_b32 a44, 0
  v_accvgpr_write_b32 a45, 0
  v_accvgpr_write_b32 a46, 0
  v_accvgpr_write_b32 a47, 0
  v_accvgpr_write_b32 a48, 0
  v_accvgpr_write_b32 a49, 0
  v_accvgpr_write_b32 a50, 0
  v_accvgpr_write_b32 a51, 0
  v_accvgpr_write_b32 a52, 0
  v_accvgpr_write_b32 a53, 0
  v_accvgpr_write_b32 a54, 0
  v_accvgpr_write_b32 a55, 0
  v_accvgpr_write_b32 a56, 0
  v_accvgpr_write_b32 a57, 0
  v_accvgpr_write_b32 a58, 0
  v_accvgpr_write_b32 a59, 0
  v_accvgpr_write_b32 a60, 0
  v_accvgpr_write_b32 a61, 0
  v_accvgpr_write_b32 a62, 0
  v_accvgpr_write_b32 a63, 0
adaLN_cond__compressed_kv_cla__mixer_channel_mlp__prompt_kernel_sllo:
  buffer_load_dwordx4 a[192:195], v4, s[12:15], s38 offen offset:0 sc1
  buffer_load_dwordx4 a[196:199], v4, s[12:15], s38 offen offset:1024 sc1
  buffer_load_dwordx4 a[200:203], v4, s[12:15], s38 offen offset:2048 sc1
  buffer_load_dwordx4 a[204:207], v4, s[12:15], s38 offen offset:3072 sc1
  buffer_load_dwordx4 a[208:211], v214, s[12:15], s38 offen offset:0 sc1
  buffer_load_dwordx4 a[212:215], v214, s[12:15], s38 offen offset:1024 sc1
  buffer_load_dwordx4 a[216:219], v214, s[12:15], s38 offen offset:2048 sc1
  buffer_load_dwordx4 a[220:223], v214, s[12:15], s38 offen offset:3072 sc1
  buffer_load_dwordx4 a[224:227], v4, s[12:15], s39 offen offset:0 sc1
  buffer_load_dwordx4 a[228:231], v4, s[12:15], s39 offen offset:1024 sc1
  buffer_load_dwordx4 a[232:235], v4, s[12:15], s39 offen offset:2048 sc1
  buffer_load_dwordx4 a[236:239], v4, s[12:15], s39 offen offset:3072 sc1
  buffer_load_dwordx4 a[240:243], v214, s[12:15], s39 offen offset:0 sc1
  buffer_load_dwordx4 a[244:247], v214, s[12:15], s39 offen offset:1024 sc1
  buffer_load_dwordx4 a[248:251], v214, s[12:15], s39 offen offset:2048 sc1
  buffer_load_dwordx4 a[252:255], v214, s[12:15], s39 offen offset:3072 sc1
  s_add_u32 s38, s38, 8192
  s_add_u32 s39, s39, 8192
  s_waitcnt vmcnt(0)
  v_mfma_f32_16x16x32_bf16 v[116:119], a[192:195], v[52:55], 0
  v_mfma_f32_16x16x32_bf16 v[116:119], a[196:199], v[56:59], v[116:119]
  v_mfma_f32_16x16x32_bf16 v[116:119], a[200:203], v[60:63], v[116:119]
  v_mfma_f32_16x16x32_bf16 v[116:119], a[204:207], v[64:67], v[116:119]
  v_mfma_f32_16x16x32_bf16 v[120:123], a[208:211], v[52:55], 0
  v_mfma_f32_16x16x32_bf16 v[120:123], a[212:215], v[56:59], v[120:123]
  v_mfma_f32_16x16x32_bf16 v[120:123], a[216:219], v[60:63], v[120:123]
  v_mfma_f32_16x16x32_bf16 v[120:123], a[220:223], v[64:67], v[120:123]
  v_mfma_f32_16x16x32_bf16 v[124:127], a[192:195], v[68:71], 0
  v_mfma_f32_16x16x32_bf16 v[124:127], a[196:199], v[72:75], v[124:127]
  v_mfma_f32_16x16x32_bf16 v[124:127], a[200:203], v[76:79], v[124:127]
  v_mfma_f32_16x16x32_bf16 v[124:127], a[204:207], v[80:83], v[124:127]
  v_mfma_f32_16x16x32_bf16 v[128:131], a[208:211], v[68:71], 0
  v_mfma_f32_16x16x32_bf16 v[128:131], a[212:215], v[72:75], v[128:131]
  v_mfma_f32_16x16x32_bf16 v[128:131], a[216:219], v[76:79], v[128:131]
  v_mfma_f32_16x16x32_bf16 v[128:131], a[220:223], v[80:83], v[128:131]
  s_nop 7
  v_cmp_gt_i32_e64 s[48:49], 0, v218
  v_cmp_gt_i32_e64 s[50:51], 1, v218
  v_cmp_gt_i32_e64 s[52:53], 2, v218
  v_cmp_gt_i32_e64 s[54:55], 3, v218
  v_cndmask_b32_e64 v116, v116, v7, s[48:49]
  v_cndmask_b32_e64 v117, v117, v7, s[50:51]
  v_cndmask_b32_e64 v118, v118, v7, s[52:53]
  v_cndmask_b32_e64 v119, v119, v7, s[54:55]
  v_cmp_gt_i32_e64 s[48:49], 16, v218
  v_cmp_gt_i32_e64 s[50:51], 17, v218
  v_cmp_gt_i32_e64 s[52:53], 18, v218
  v_cmp_gt_i32_e64 s[54:55], 19, v218
  v_cndmask_b32_e64 v120, v120, v7, s[48:49]
  v_cndmask_b32_e64 v121, v121, v7, s[50:51]
  v_cndmask_b32_e64 v122, v122, v7, s[52:53]
  v_cndmask_b32_e64 v123, v123, v7, s[54:55]
  v_max3_f32 v8, v116, v117, v118
  v_max3_f32 v8, v8, v119, v120
  v_max3_f32 v8, v8, v121, v122
  v_max3_f32 v8, v8, v123, v212
  v_subrev_u32 v218, 32, v218
  v_cmp_gt_i32_e64 s[48:49], 0, v219
  v_cmp_gt_i32_e64 s[50:51], 1, v219
  v_cmp_gt_i32_e64 s[52:53], 2, v219
  v_cmp_gt_i32_e64 s[54:55], 3, v219
  v_cndmask_b32_e64 v124, v124, v7, s[48:49]
  v_cndmask_b32_e64 v125, v125, v7, s[50:51]
  v_cndmask_b32_e64 v126, v126, v7, s[52:53]
  v_cndmask_b32_e64 v127, v127, v7, s[54:55]
  v_cmp_gt_i32_e64 s[48:49], 16, v219
  v_cmp_gt_i32_e64 s[50:51], 17, v219
  v_cmp_gt_i32_e64 s[52:53], 18, v219
  v_cmp_gt_i32_e64 s[54:55], 19, v219
  v_cndmask_b32_e64 v128, v128, v7, s[48:49]
  v_cndmask_b32_e64 v129, v129, v7, s[50:51]
  v_cndmask_b32_e64 v130, v130, v7, s[52:53]
  v_cndmask_b32_e64 v131, v131, v7, s[54:55]
  v_max3_f32 v9, v124, v125, v126
  v_max3_f32 v9, v9, v127, v128
  v_max3_f32 v9, v9, v129, v130
  v_max3_f32 v9, v9, v131, v213
  v_subrev_u32 v219, 32, v219
  v_mov_b32 v10, v8
  v_mov_b32 v11, v9
  s_nop 1
  v_permlane32_swap_b32 v8, v9
  v_permlane32_swap_b32 v10, v11
  v_max_f32 v8, v8, v9
  v_max_f32 v10, v10, v11
  s_nop 1
  v_permlane16_swap_b32 v8, v10
  v_max_f32 v8, v8, v10
  v_mov_b32 v10, v8
  s_nop 1
  v_permlane16_swap_b32 v8, v10
  v_mov_b32 v9, v8
  v_mov_b32 v11, v10
  s_nop 1
  v_permlane32_swap_b32 v8, v9
  v_permlane32_swap_b32 v10, v11
  v_sub_f32 v216, v212, v8
  v_exp_f32 v216, v216
  v_mov_b32 v212, v8
  v_sub_f32 v116, v116, v8
  v_sub_f32 v117, v117, v8
  v_sub_f32 v118, v118, v8
  v_sub_f32 v119, v119, v8
  v_sub_f32 v120, v120, v8
  v_sub_f32 v121, v121, v8
  v_sub_f32 v122, v122, v8
  v_sub_f32 v123, v123, v8
  v_exp_f32 v116, v116
  v_exp_f32 v117, v117
  v_exp_f32 v118, v118
  v_exp_f32 v119, v119
  v_exp_f32 v120, v120
  v_exp_f32 v121, v121
  v_exp_f32 v122, v122
  v_exp_f32 v123, v123
  s_nop 0
  v_cvt_pk_bf16_f32 v180, v116, v117
  v_cvt_pk_bf16_f32 v181, v118, v119
  v_cvt_pk_bf16_f32 v182, v120, v121
  v_cvt_pk_bf16_f32 v183, v122, v123
  v_mul_f32 v20, v20, v216
  v_mul_f32 v21, v21, v216
  v_mul_f32 v22, v22, v216
  v_mul_f32 v23, v23, v216
  v_accvgpr_read_b32 v215, a0
  v_mul_f32 v215, v215, v216
  v_accvgpr_write_b32 a0, v215
  v_accvgpr_read_b32 v215, a1
  v_mul_f32 v215, v215, v216
  v_accvgpr_write_b32 a1, v215
  v_accvgpr_read_b32 v215, a2
  v_mul_f32 v215, v215, v216
  v_accvgpr_write_b32 a2, v215
  v_accvgpr_read_b32 v215, a3
  v_mul_f32 v215, v215, v216
  v_accvgpr_write_b32 a3, v215
  v_accvgpr_read_b32 v215, a4
  v_mul_f32 v215, v215, v216
  v_accvgpr_write_b32 a4, v215
  v_accvgpr_read_b32 v215, a5
  v_mul_f32 v215, v215, v216
  v_accvgpr_write_b32 a5, v215
  v_accvgpr_read_b32 v215, a6
  v_mul_f32 v215, v215, v216
  v_accvgpr_write_b32 a6, v215
  v_accvgpr_read_b32 v215, a7
  v_mul_f32 v215, v215, v216
  v_accvgpr_write_b32 a7, v215
  v_accvgpr_read_b32 v215, a8
  v_mul_f32 v215, v215, v216
  v_accvgpr_write_b32 a8, v215
  v_accvgpr_read_b32 v215, a9
  v_mul_f32 v215, v215, v216
  v_accvgpr_write_b32 a9, v215
  v_accvgpr_read_b32 v215, a10
  v_mul_f32 v215, v215, v216
  v_accvgpr_write_b32 a10, v215
  v_accvgpr_read_b32 v215, a11
  v_mul_f32 v215, v215, v216
  v_accvgpr_write_b32 a11, v215
  v_accvgpr_read_b32 v215, a12
  v_mul_f32 v215, v215, v216
  v_accvgpr_write_b32 a12, v215
  v_accvgpr_read_b32 v215, a13
  v_mul_f32 v215, v215, v216
  v_accvgpr_write_b32 a13, v215
  v_accvgpr_read_b32 v215, a14
  v_mul_f32 v215, v215, v216
  v_accvgpr_write_b32 a14, v215
  v_accvgpr_read_b32 v215, a15
  v_mul_f32 v215, v215, v216
  v_accvgpr_write_b32 a15, v215
  v_accvgpr_read_b32 v215, a16
  v_mul_f32 v215, v215, v216
  v_accvgpr_write_b32 a16, v215
  v_accvgpr_read_b32 v215, a17
  v_mul_f32 v215, v215, v216
  v_accvgpr_write_b32 a17, v215
  v_accvgpr_read_b32 v215, a18
  v_mul_f32 v215, v215, v216
  v_accvgpr_write_b32 a18, v215
  v_accvgpr_read_b32 v215, a19
  v_mul_f32 v215, v215, v216
  v_accvgpr_write_b32 a19, v215
  v_accvgpr_read_b32 v215, a20
  v_mul_f32 v215, v215, v216
  v_accvgpr_write_b32 a20, v215
  v_accvgpr_read_b32 v215, a21
  v_mul_f32 v215, v215, v216
  v_accvgpr_write_b32 a21, v215
  v_accvgpr_read_b32 v215, a22
  v_mul_f32 v215, v215, v216
  v_accvgpr_write_b32 a22, v215
  v_accvgpr_read_b32 v215, a23
  v_mul_f32 v215, v215, v216
  v_accvgpr_write_b32 a23, v215
  v_accvgpr_read_b32 v215, a24
  v_mul_f32 v215, v215, v216
  v_accvgpr_write_b32 a24, v215
  v_accvgpr_read_b32 v215, a25
  v_mul_f32 v215, v215, v216
  v_accvgpr_write_b32 a25, v215
  v_accvgpr_read_b32 v215, a26
  v_mul_f32 v215, v215, v216
  v_accvgpr_write_b32 a26, v215
  v_accvgpr_read_b32 v215, a27
  v_mul_f32 v215, v215, v216
  v_accvgpr_write_b32 a27, v215
  v_accvgpr_read_b32 v215, a28
  v_mul_f32 v215, v215, v216
  v_accvgpr_write_b32 a28, v215
  v_accvgpr_read_b32 v215, a29
  v_mul_f32 v215, v215, v216
  v_accvgpr_write_b32 a29, v215
  v_accvgpr_read_b32 v215, a30
  v_mul_f32 v215, v215, v216
  v_accvgpr_write_b32 a30, v215
  v_accvgpr_read_b32 v215, a31
  v_mul_f32 v215, v215, v216
  v_accvgpr_write_b32 a31, v215
  v_sub_f32 v217, v213, v9
  v_exp_f32 v217, v217
  v_mov_b32 v213, v9
  v_sub_f32 v124, v124, v9
  v_sub_f32 v125, v125, v9
  v_sub_f32 v126, v126, v9
  v_sub_f32 v127, v127, v9
  v_sub_f32 v128, v128, v9
  v_sub_f32 v129, v129, v9
  v_sub_f32 v130, v130, v9
  v_sub_f32 v131, v131, v9
  v_exp_f32 v124, v124
  v_exp_f32 v125, v125
  v_exp_f32 v126, v126
  v_exp_f32 v127, v127
  v_exp_f32 v128, v128
  v_exp_f32 v129, v129
  v_exp_f32 v130, v130
  v_exp_f32 v131, v131
  s_nop 0
  v_cvt_pk_bf16_f32 v184, v124, v125
  v_cvt_pk_bf16_f32 v185, v126, v127
  v_cvt_pk_bf16_f32 v186, v128, v129
  v_cvt_pk_bf16_f32 v187, v130, v131
  v_mul_f32 v24, v24, v217
  v_mul_f32 v25, v25, v217
  v_mul_f32 v26, v26, v217
  v_mul_f32 v27, v27, v217
  v_accvgpr_read_b32 v215, a32
  v_mul_f32 v215, v215, v217
  v_accvgpr_write_b32 a32, v215
  v_accvgpr_read_b32 v215, a33
  v_mul_f32 v215, v215, v217
  v_accvgpr_write_b32 a33, v215
  v_accvgpr_read_b32 v215, a34
  v_mul_f32 v215, v215, v217
  v_accvgpr_write_b32 a34, v215
  v_accvgpr_read_b32 v215, a35
  v_mul_f32 v215, v215, v217
  v_accvgpr_write_b32 a35, v215
  v_accvgpr_read_b32 v215, a36
  v_mul_f32 v215, v215, v217
  v_accvgpr_write_b32 a36, v215
  v_accvgpr_read_b32 v215, a37
  v_mul_f32 v215, v215, v217
  v_accvgpr_write_b32 a37, v215
  v_accvgpr_read_b32 v215, a38
  v_mul_f32 v215, v215, v217
  v_accvgpr_write_b32 a38, v215
  v_accvgpr_read_b32 v215, a39
  v_mul_f32 v215, v215, v217
  v_accvgpr_write_b32 a39, v215
  v_accvgpr_read_b32 v215, a40
  v_mul_f32 v215, v215, v217
  v_accvgpr_write_b32 a40, v215
  v_accvgpr_read_b32 v215, a41
  v_mul_f32 v215, v215, v217
  v_accvgpr_write_b32 a41, v215
  v_accvgpr_read_b32 v215, a42
  v_mul_f32 v215, v215, v217
  v_accvgpr_write_b32 a42, v215
  v_accvgpr_read_b32 v215, a43
  v_mul_f32 v215, v215, v217
  v_accvgpr_write_b32 a43, v215
  v_accvgpr_read_b32 v215, a44
  v_mul_f32 v215, v215, v217
  v_accvgpr_write_b32 a44, v215
  v_accvgpr_read_b32 v215, a45
  v_mul_f32 v215, v215, v217
  v_accvgpr_write_b32 a45, v215
  v_accvgpr_read_b32 v215, a46
  v_mul_f32 v215, v215, v217
  v_accvgpr_write_b32 a46, v215
  v_accvgpr_read_b32 v215, a47
  v_mul_f32 v215, v215, v217
  v_accvgpr_write_b32 a47, v215
  v_accvgpr_read_b32 v215, a48
  v_mul_f32 v215, v215, v217
  v_accvgpr_write_b32 a48, v215
  v_accvgpr_read_b32 v215, a49
  v_mul_f32 v215, v215, v217
  v_accvgpr_write_b32 a49, v215
  v_accvgpr_read_b32 v215, a50
  v_mul_f32 v215, v215, v217
  v_accvgpr_write_b32 a50, v215
  v_accvgpr_read_b32 v215, a51
  v_mul_f32 v215, v215, v217
  v_accvgpr_write_b32 a51, v215
  v_accvgpr_read_b32 v215, a52
  v_mul_f32 v215, v215, v217
  v_accvgpr_write_b32 a52, v215
  v_accvgpr_read_b32 v215, a53
  v_mul_f32 v215, v215, v217
  v_accvgpr_write_b32 a53, v215
  v_accvgpr_read_b32 v215, a54
  v_mul_f32 v215, v215, v217
  v_accvgpr_write_b32 a54, v215
  v_accvgpr_read_b32 v215, a55
  v_mul_f32 v215, v215, v217
  v_accvgpr_write_b32 a55, v215
  v_accvgpr_read_b32 v215, a56
  v_mul_f32 v215, v215, v217
  v_accvgpr_write_b32 a56, v215
  v_accvgpr_read_b32 v215, a57
  v_mul_f32 v215, v215, v217
  v_accvgpr_write_b32 a57, v215
  v_accvgpr_read_b32 v215, a58
  v_mul_f32 v215, v215, v217
  v_accvgpr_write_b32 a58, v215
  v_accvgpr_read_b32 v215, a59
  v_mul_f32 v215, v215, v217
  v_accvgpr_write_b32 a59, v215
  v_accvgpr_read_b32 v215, a60
  v_mul_f32 v215, v215, v217
  v_accvgpr_write_b32 a60, v215
  v_accvgpr_read_b32 v215, a61
  v_mul_f32 v215, v215, v217
  v_accvgpr_write_b32 a61, v215
  v_accvgpr_read_b32 v215, a62
  v_mul_f32 v215, v215, v217
  v_accvgpr_write_b32 a62, v215
  v_accvgpr_read_b32 v215, a63
  v_mul_f32 v215, v215, v217
  v_accvgpr_write_b32 a63, v215
  s_nop 1
  v_mfma_f32_16x16x32_bf16 a[0:3], a[224:227], v[180:183], a[0:3]
  v_mfma_f32_16x16x32_bf16 a[4:7], a[228:231], v[180:183], a[4:7]
  v_mfma_f32_16x16x32_bf16 a[8:11], a[232:235], v[180:183], a[8:11]
  v_mfma_f32_16x16x32_bf16 a[12:15], a[236:239], v[180:183], a[12:15]
  v_mfma_f32_16x16x32_bf16 a[16:19], a[240:243], v[180:183], a[16:19]
  v_mfma_f32_16x16x32_bf16 a[20:23], a[244:247], v[180:183], a[20:23]
  v_mfma_f32_16x16x32_bf16 a[24:27], a[248:251], v[180:183], a[24:27]
  v_mfma_f32_16x16x32_bf16 a[28:31], a[252:255], v[180:183], a[28:31]
  v_mfma_f32_16x16x32_bf16 v[20:23], v[16:19], v[180:183], v[20:23]
  v_mfma_f32_16x16x32_bf16 a[32:35], a[224:227], v[184:187], a[32:35]
  v_mfma_f32_16x16x32_bf16 a[36:39], a[228:231], v[184:187], a[36:39]
  v_mfma_f32_16x16x32_bf16 a[40:43], a[232:235], v[184:187], a[40:43]
  v_mfma_f32_16x16x32_bf16 a[44:47], a[236:239], v[184:187], a[44:47]
  v_mfma_f32_16x16x32_bf16 a[48:51], a[240:243], v[184:187], a[48:51]
  v_mfma_f32_16x16x32_bf16 a[52:55], a[244:247], v[184:187], a[52:55]
  v_mfma_f32_16x16x32_bf16 a[56:59], a[248:251], v[184:187], a[56:59]
  v_mfma_f32_16x16x32_bf16 a[60:63], a[252:255], v[184:187], a[60:63]
  v_mfma_f32_16x16x32_bf16 v[24:27], v[16:19], v[184:187], v[24:27]
  s_nop 7
  s_sub_u32 s28, s28, 1
  s_cmp_lg_u32 s28, 0
  s_cbranch_scc1 adaLN_cond__compressed_kv_cla__mixer_channel_mlp__prompt_kernel_sllo
  s_branch adaLN_cond__compressed_kv_cla__mixer_channel_mlp__prompt_kernel_loep
adaLN_cond__compressed_kv_cla__mixer_channel_mlp__prompt_kernel_slowhi:
  s_sub_u32 s40, 15, s22
  s_lshl_b32 s41, s40, 7
  v_add_u32 v218, s41, v5
  s_add_u32 s41, s41, 64
  v_add_u32 v219, s41, v6
  s_add_u32 s40, s40, 1
  s_lshl_b32 s28, s40, 2
  s_mul_i32 s38, s21, 0x90000
  s_add_u32 s39, s38, 0x6400000
  s_add_u32 s38, s38, 0x5000000
  v_add_u32 v214, 4096, v4
  v_mov_b32 v212, v7
  v_mov_b32 v213, v7
  v_mov_b32 v28, 0
  v_mov_b32 v29, 0
  v_mov_b32 v30, 0
  v_mov_b32 v31, 0
  v_accvgpr_write_b32 a64, 0
  v_accvgpr_write_b32 a65, 0
  v_accvgpr_write_b32 a66, 0
  v_accvgpr_write_b32 a67, 0
  v_accvgpr_write_b32 a68, 0
  v_accvgpr_write_b32 a69, 0
  v_accvgpr_write_b32 a70, 0
  v_accvgpr_write_b32 a71, 0
  v_accvgpr_write_b32 a72, 0
  v_accvgpr_write_b32 a73, 0
  v_accvgpr_write_b32 a74, 0
  v_accvgpr_write_b32 a75, 0
  v_accvgpr_write_b32 a76, 0
  v_accvgpr_write_b32 a77, 0
  v_accvgpr_write_b32 a78, 0
  v_accvgpr_write_b32 a79, 0
  v_accvgpr_write_b32 a80, 0
  v_accvgpr_write_b32 a81, 0
  v_accvgpr_write_b32 a82, 0
  v_accvgpr_write_b32 a83, 0
  v_accvgpr_write_b32 a84, 0
  v_accvgpr_write_b32 a85, 0
  v_accvgpr_write_b32 a86, 0
  v_accvgpr_write_b32 a87, 0
  v_accvgpr_write_b32 a88, 0
  v_accvgpr_write_b32 a89, 0
  v_accvgpr_write_b32 a90, 0
  v_accvgpr_write_b32 a91, 0
  v_accvgpr_write_b32 a92, 0
  v_accvgpr_write_b32 a93, 0
  v_accvgpr_write_b32 a94, 0
  v_accvgpr_write_b32 a95, 0
  v_mov_b32 v32, 0
  v_mov_b32 v33, 0
  v_mov_b32 v34, 0
  v_mov_b32 v35, 0
  v_accvgpr_write_b32 a96, 0
  v_accvgpr_write_b32 a97, 0
  v_accvgpr_write_b32 a98, 0
  v_accvgpr_write_b32 a99, 0
  v_accvgpr_write_b32 a100, 0
  v_accvgpr_write_b32 a101, 0
  v_accvgpr_write_b32 a102, 0
  v_accvgpr_write_b32 a103, 0
  v_accvgpr_write_b32 a104, 0
  v_accvgpr_write_b32 a105, 0
  v_accvgpr_write_b32 a106, 0
  v_accvgpr_write_b32 a107, 0
  v_accvgpr_write_b32 a108, 0
  v_accvgpr_write_b32 a109, 0
  v_accvgpr_write_b32 a110, 0
  v_accvgpr_write_b32 a111, 0
  v_accvgpr_write_b32 a112, 0
  v_accvgpr_write_b32 a113, 0
  v_accvgpr_write_b32 a114, 0
  v_accvgpr_write_b32 a115, 0
  v_accvgpr_write_b32 a116, 0
  v_accvgpr_write_b32 a117, 0
  v_accvgpr_write_b32 a118, 0
  v_accvgpr_write_b32 a119, 0
  v_accvgpr_write_b32 a120, 0
  v_accvgpr_write_b32 a121, 0
  v_accvgpr_write_b32 a122, 0
  v_accvgpr_write_b32 a123, 0
  v_accvgpr_write_b32 a124, 0
  v_accvgpr_write_b32 a125, 0
  v_accvgpr_write_b32 a126, 0
  v_accvgpr_write_b32 a127, 0
adaLN_cond__compressed_kv_cla__mixer_channel_mlp__prompt_kernel_slhi:
  buffer_load_dwordx4 a[128:131], v4, s[12:15], s38 offen offset:0 sc1
  buffer_load_dwordx4 a[132:135], v4, s[12:15], s38 offen offset:1024 sc1
  buffer_load_dwordx4 a[136:139], v4, s[12:15], s38 offen offset:2048 sc1
  buffer_load_dwordx4 a[140:143], v4, s[12:15], s38 offen offset:3072 sc1
  buffer_load_dwordx4 a[144:147], v214, s[12:15], s38 offen offset:0 sc1
  buffer_load_dwordx4 a[148:151], v214, s[12:15], s38 offen offset:1024 sc1
  buffer_load_dwordx4 a[152:155], v214, s[12:15], s38 offen offset:2048 sc1
  buffer_load_dwordx4 a[156:159], v214, s[12:15], s38 offen offset:3072 sc1
  buffer_load_dwordx4 a[160:163], v4, s[12:15], s39 offen offset:0 sc1
  buffer_load_dwordx4 a[164:167], v4, s[12:15], s39 offen offset:1024 sc1
  buffer_load_dwordx4 a[168:171], v4, s[12:15], s39 offen offset:2048 sc1
  buffer_load_dwordx4 a[172:175], v4, s[12:15], s39 offen offset:3072 sc1
  buffer_load_dwordx4 a[176:179], v214, s[12:15], s39 offen offset:0 sc1
  buffer_load_dwordx4 a[180:183], v214, s[12:15], s39 offen offset:1024 sc1
  buffer_load_dwordx4 a[184:187], v214, s[12:15], s39 offen offset:2048 sc1
  buffer_load_dwordx4 a[188:191], v214, s[12:15], s39 offen offset:3072 sc1
  s_add_u32 s38, s38, 8192
  s_add_u32 s39, s39, 8192
  s_waitcnt vmcnt(0)
  v_mfma_f32_16x16x32_bf16 v[132:135], a[128:131], v[84:87], 0
  v_mfma_f32_16x16x32_bf16 v[132:135], a[132:135], v[88:91], v[132:135]
  v_mfma_f32_16x16x32_bf16 v[132:135], a[136:139], v[92:95], v[132:135]
  v_mfma_f32_16x16x32_bf16 v[132:135], a[140:143], v[96:99], v[132:135]
  v_mfma_f32_16x16x32_bf16 v[136:139], a[144:147], v[84:87], 0
  v_mfma_f32_16x16x32_bf16 v[136:139], a[148:151], v[88:91], v[136:139]
  v_mfma_f32_16x16x32_bf16 v[136:139], a[152:155], v[92:95], v[136:139]
  v_mfma_f32_16x16x32_bf16 v[136:139], a[156:159], v[96:99], v[136:139]
  v_mfma_f32_16x16x32_bf16 v[140:143], a[128:131], v[100:103], 0
  v_mfma_f32_16x16x32_bf16 v[140:143], a[132:135], v[104:107], v[140:143]
  v_mfma_f32_16x16x32_bf16 v[140:143], a[136:139], v[108:111], v[140:143]
  v_mfma_f32_16x16x32_bf16 v[140:143], a[140:143], v[112:115], v[140:143]
  v_mfma_f32_16x16x32_bf16 v[144:147], a[144:147], v[100:103], 0
  v_mfma_f32_16x16x32_bf16 v[144:147], a[148:151], v[104:107], v[144:147]
  v_mfma_f32_16x16x32_bf16 v[144:147], a[152:155], v[108:111], v[144:147]
  v_mfma_f32_16x16x32_bf16 v[144:147], a[156:159], v[112:115], v[144:147]
  s_nop 7
  v_cmp_gt_i32_e64 s[48:49], 0, v218
  v_cmp_gt_i32_e64 s[50:51], 1, v218
  v_cmp_gt_i32_e64 s[52:53], 2, v218
  v_cmp_gt_i32_e64 s[54:55], 3, v218
  v_cndmask_b32_e64 v132, v132, v7, s[48:49]
  v_cndmask_b32_e64 v133, v133, v7, s[50:51]
  v_cndmask_b32_e64 v134, v134, v7, s[52:53]
  v_cndmask_b32_e64 v135, v135, v7, s[54:55]
  v_cmp_gt_i32_e64 s[48:49], 16, v218
  v_cmp_gt_i32_e64 s[50:51], 17, v218
  v_cmp_gt_i32_e64 s[52:53], 18, v218
  v_cmp_gt_i32_e64 s[54:55], 19, v218
  v_cndmask_b32_e64 v136, v136, v7, s[48:49]
  v_cndmask_b32_e64 v137, v137, v7, s[50:51]
  v_cndmask_b32_e64 v138, v138, v7, s[52:53]
  v_cndmask_b32_e64 v139, v139, v7, s[54:55]
  v_max3_f32 v8, v132, v133, v134
  v_max3_f32 v8, v8, v135, v136
  v_max3_f32 v8, v8, v137, v138
  v_max3_f32 v8, v8, v139, v212
  v_subrev_u32 v218, 32, v218
  v_cmp_gt_i32_e64 s[48:49], 0, v219
  v_cmp_gt_i32_e64 s[50:51], 1, v219
  v_cmp_gt_i32_e64 s[52:53], 2, v219
  v_cmp_gt_i32_e64 s[54:55], 3, v219
  v_cndmask_b32_e64 v140, v140, v7, s[48:49]
  v_cndmask_b32_e64 v141, v141, v7, s[50:51]
  v_cndmask_b32_e64 v142, v142, v7, s[52:53]
  v_cndmask_b32_e64 v143, v143, v7, s[54:55]
  v_cmp_gt_i32_e64 s[48:49], 16, v219
  v_cmp_gt_i32_e64 s[50:51], 17, v219
  v_cmp_gt_i32_e64 s[52:53], 18, v219
  v_cmp_gt_i32_e64 s[54:55], 19, v219
  v_cndmask_b32_e64 v144, v144, v7, s[48:49]
  v_cndmask_b32_e64 v145, v145, v7, s[50:51]
  v_cndmask_b32_e64 v146, v146, v7, s[52:53]
  v_cndmask_b32_e64 v147, v147, v7, s[54:55]
  v_max3_f32 v9, v140, v141, v142
  v_max3_f32 v9, v9, v143, v144
  v_max3_f32 v9, v9, v145, v146
  v_max3_f32 v9, v9, v147, v213
  v_subrev_u32 v219, 32, v219
  v_mov_b32 v10, v8
  v_mov_b32 v11, v9
  s_nop 1
  v_permlane32_swap_b32 v8, v9
  v_permlane32_swap_b32 v10, v11
  v_max_f32 v8, v8, v9
  v_max_f32 v10, v10, v11
  s_nop 1
  v_permlane16_swap_b32 v8, v10
  v_max_f32 v8, v8, v10
  v_mov_b32 v10, v8
  s_nop 1
  v_permlane16_swap_b32 v8, v10
  v_mov_b32 v9, v8
  v_mov_b32 v11, v10
  s_nop 1
  v_permlane32_swap_b32 v8, v9
  v_permlane32_swap_b32 v10, v11
  v_sub_f32 v216, v212, v8
  v_exp_f32 v216, v216
  v_mov_b32 v212, v8
  v_sub_f32 v132, v132, v8
  v_sub_f32 v133, v133, v8
  v_sub_f32 v134, v134, v8
  v_sub_f32 v135, v135, v8
  v_sub_f32 v136, v136, v8
  v_sub_f32 v137, v137, v8
  v_sub_f32 v138, v138, v8
  v_sub_f32 v139, v139, v8
  v_exp_f32 v132, v132
  v_exp_f32 v133, v133
  v_exp_f32 v134, v134
  v_exp_f32 v135, v135
  v_exp_f32 v136, v136
  v_exp_f32 v137, v137
  v_exp_f32 v138, v138
  v_exp_f32 v139, v139
  s_nop 0
  v_cvt_pk_bf16_f32 v188, v132, v133
  v_cvt_pk_bf16_f32 v189, v134, v135
  v_cvt_pk_bf16_f32 v190, v136, v137
  v_cvt_pk_bf16_f32 v191, v138, v139
  v_mul_f32 v28, v28, v216
  v_mul_f32 v29, v29, v216
  v_mul_f32 v30, v30, v216
  v_mul_f32 v31, v31, v216
  v_accvgpr_read_b32 v215, a64
  v_mul_f32 v215, v215, v216
  v_accvgpr_write_b32 a64, v215
  v_accvgpr_read_b32 v215, a65
  v_mul_f32 v215, v215, v216
  v_accvgpr_write_b32 a65, v215
  v_accvgpr_read_b32 v215, a66
  v_mul_f32 v215, v215, v216
  v_accvgpr_write_b32 a66, v215
  v_accvgpr_read_b32 v215, a67
  v_mul_f32 v215, v215, v216
  v_accvgpr_write_b32 a67, v215
  v_accvgpr_read_b32 v215, a68
  v_mul_f32 v215, v215, v216
  v_accvgpr_write_b32 a68, v215
  v_accvgpr_read_b32 v215, a69
  v_mul_f32 v215, v215, v216
  v_accvgpr_write_b32 a69, v215
  v_accvgpr_read_b32 v215, a70
  v_mul_f32 v215, v215, v216
  v_accvgpr_write_b32 a70, v215
  v_accvgpr_read_b32 v215, a71
  v_mul_f32 v215, v215, v216
  v_accvgpr_write_b32 a71, v215
  v_accvgpr_read_b32 v215, a72
  v_mul_f32 v215, v215, v216
  v_accvgpr_write_b32 a72, v215
  v_accvgpr_read_b32 v215, a73
  v_mul_f32 v215, v215, v216
  v_accvgpr_write_b32 a73, v215
  v_accvgpr_read_b32 v215, a74
  v_mul_f32 v215, v215, v216
  v_accvgpr_write_b32 a74, v215
  v_accvgpr_read_b32 v215, a75
  v_mul_f32 v215, v215, v216
  v_accvgpr_write_b32 a75, v215
  v_accvgpr_read_b32 v215, a76
  v_mul_f32 v215, v215, v216
  v_accvgpr_write_b32 a76, v215
  v_accvgpr_read_b32 v215, a77
  v_mul_f32 v215, v215, v216
  v_accvgpr_write_b32 a77, v215
  v_accvgpr_read_b32 v215, a78
  v_mul_f32 v215, v215, v216
  v_accvgpr_write_b32 a78, v215
  v_accvgpr_read_b32 v215, a79
  v_mul_f32 v215, v215, v216
  v_accvgpr_write_b32 a79, v215
  v_accvgpr_read_b32 v215, a80
  v_mul_f32 v215, v215, v216
  v_accvgpr_write_b32 a80, v215
  v_accvgpr_read_b32 v215, a81
  v_mul_f32 v215, v215, v216
  v_accvgpr_write_b32 a81, v215
  v_accvgpr_read_b32 v215, a82
  v_mul_f32 v215, v215, v216
  v_accvgpr_write_b32 a82, v215
  v_accvgpr_read_b32 v215, a83
  v_mul_f32 v215, v215, v216
  v_accvgpr_write_b32 a83, v215
  v_accvgpr_read_b32 v215, a84
  v_mul_f32 v215, v215, v216
  v_accvgpr_write_b32 a84, v215
  v_accvgpr_read_b32 v215, a85
  v_mul_f32 v215, v215, v216
  v_accvgpr_write_b32 a85, v215
  v_accvgpr_read_b32 v215, a86
  v_mul_f32 v215, v215, v216
  v_accvgpr_write_b32 a86, v215
  v_accvgpr_read_b32 v215, a87
  v_mul_f32 v215, v215, v216
  v_accvgpr_write_b32 a87, v215
  v_accvgpr_read_b32 v215, a88
  v_mul_f32 v215, v215, v216
  v_accvgpr_write_b32 a88, v215
  v_accvgpr_read_b32 v215, a89
  v_mul_f32 v215, v215, v216
  v_accvgpr_write_b32 a89, v215
  v_accvgpr_read_b32 v215, a90
  v_mul_f32 v215, v215, v216
  v_accvgpr_write_b32 a90, v215
  v_accvgpr_read_b32 v215, a91
  v_mul_f32 v215, v215, v216
  v_accvgpr_write_b32 a91, v215
  v_accvgpr_read_b32 v215, a92
  v_mul_f32 v215, v215, v216
  v_accvgpr_write_b32 a92, v215
  v_accvgpr_read_b32 v215, a93
  v_mul_f32 v215, v215, v216
  v_accvgpr_write_b32 a93, v215
  v_accvgpr_read_b32 v215, a94
  v_mul_f32 v215, v215, v216
  v_accvgpr_write_b32 a94, v215
  v_accvgpr_read_b32 v215, a95
  v_mul_f32 v215, v215, v216
  v_accvgpr_write_b32 a95, v215
  v_sub_f32 v217, v213, v9
  v_exp_f32 v217, v217
  v_mov_b32 v213, v9
  v_sub_f32 v140, v140, v9
  v_sub_f32 v141, v141, v9
  v_sub_f32 v142, v142, v9
  v_sub_f32 v143, v143, v9
  v_sub_f32 v144, v144, v9
  v_sub_f32 v145, v145, v9
  v_sub_f32 v146, v146, v9
  v_sub_f32 v147, v147, v9
  v_exp_f32 v140, v140
  v_exp_f32 v141, v141
  v_exp_f32 v142, v142
  v_exp_f32 v143, v143
  v_exp_f32 v144, v144
  v_exp_f32 v145, v145
  v_exp_f32 v146, v146
  v_exp_f32 v147, v147
  s_nop 0
  v_cvt_pk_bf16_f32 v192, v140, v141
  v_cvt_pk_bf16_f32 v193, v142, v143
  v_cvt_pk_bf16_f32 v194, v144, v145
  v_cvt_pk_bf16_f32 v195, v146, v147
  v_mul_f32 v32, v32, v217
  v_mul_f32 v33, v33, v217
  v_mul_f32 v34, v34, v217
  v_mul_f32 v35, v35, v217
  v_accvgpr_read_b32 v215, a96
  v_mul_f32 v215, v215, v217
  v_accvgpr_write_b32 a96, v215
  v_accvgpr_read_b32 v215, a97
  v_mul_f32 v215, v215, v217
  v_accvgpr_write_b32 a97, v215
  v_accvgpr_read_b32 v215, a98
  v_mul_f32 v215, v215, v217
  v_accvgpr_write_b32 a98, v215
  v_accvgpr_read_b32 v215, a99
  v_mul_f32 v215, v215, v217
  v_accvgpr_write_b32 a99, v215
  v_accvgpr_read_b32 v215, a100
  v_mul_f32 v215, v215, v217
  v_accvgpr_write_b32 a100, v215
  v_accvgpr_read_b32 v215, a101
  v_mul_f32 v215, v215, v217
  v_accvgpr_write_b32 a101, v215
  v_accvgpr_read_b32 v215, a102
  v_mul_f32 v215, v215, v217
  v_accvgpr_write_b32 a102, v215
  v_accvgpr_read_b32 v215, a103
  v_mul_f32 v215, v215, v217
  v_accvgpr_write_b32 a103, v215
  v_accvgpr_read_b32 v215, a104
  v_mul_f32 v215, v215, v217
  v_accvgpr_write_b32 a104, v215
  v_accvgpr_read_b32 v215, a105
  v_mul_f32 v215, v215, v217
  v_accvgpr_write_b32 a105, v215
  v_accvgpr_read_b32 v215, a106
  v_mul_f32 v215, v215, v217
  v_accvgpr_write_b32 a106, v215
  v_accvgpr_read_b32 v215, a107
  v_mul_f32 v215, v215, v217
  v_accvgpr_write_b32 a107, v215
  v_accvgpr_read_b32 v215, a108
  v_mul_f32 v215, v215, v217
  v_accvgpr_write_b32 a108, v215
  v_accvgpr_read_b32 v215, a109
  v_mul_f32 v215, v215, v217
  v_accvgpr_write_b32 a109, v215
  v_accvgpr_read_b32 v215, a110
  v_mul_f32 v215, v215, v217
  v_accvgpr_write_b32 a110, v215
  v_accvgpr_read_b32 v215, a111
  v_mul_f32 v215, v215, v217
  v_accvgpr_write_b32 a111, v215
  v_accvgpr_read_b32 v215, a112
  v_mul_f32 v215, v215, v217
  v_accvgpr_write_b32 a112, v215
  v_accvgpr_read_b32 v215, a113
  v_mul_f32 v215, v215, v217
  v_accvgpr_write_b32 a113, v215
  v_accvgpr_read_b32 v215, a114
  v_mul_f32 v215, v215, v217
  v_accvgpr_write_b32 a114, v215
  v_accvgpr_read_b32 v215, a115
  v_mul_f32 v215, v215, v217
  v_accvgpr_write_b32 a115, v215
  v_accvgpr_read_b32 v215, a116
  v_mul_f32 v215, v215, v217
  v_accvgpr_write_b32 a116, v215
  v_accvgpr_read_b32 v215, a117
  v_mul_f32 v215, v215, v217
  v_accvgpr_write_b32 a117, v215
  v_accvgpr_read_b32 v215, a118
  v_mul_f32 v215, v215, v217
  v_accvgpr_write_b32 a118, v215
  v_accvgpr_read_b32 v215, a119
  v_mul_f32 v215, v215, v217
  v_accvgpr_write_b32 a119, v215
  v_accvgpr_read_b32 v215, a120
  v_mul_f32 v215, v215, v217
  v_accvgpr_write_b32 a120, v215
  v_accvgpr_read_b32 v215, a121
  v_mul_f32 v215, v215, v217
  v_accvgpr_write_b32 a121, v215
  v_accvgpr_read_b32 v215, a122
  v_mul_f32 v215, v215, v217
  v_accvgpr_write_b32 a122, v215
  v_accvgpr_read_b32 v215, a123
  v_mul_f32 v215, v215, v217
  v_accvgpr_write_b32 a123, v215
  v_accvgpr_read_b32 v215, a124
  v_mul_f32 v215, v215, v217
  v_accvgpr_write_b32 a124, v215
  v_accvgpr_read_b32 v215, a125
  v_mul_f32 v215, v215, v217
  v_accvgpr_write_b32 a125, v215
  v_accvgpr_read_b32 v215, a126
  v_mul_f32 v215, v215, v217
  v_accvgpr_write_b32 a126, v215
  v_accvgpr_read_b32 v215, a127
  v_mul_f32 v215, v215, v217
  v_accvgpr_write_b32 a127, v215
  s_nop 1
  v_mfma_f32_16x16x32_bf16 a[64:67], a[160:163], v[188:191], a[64:67]
  v_mfma_f32_16x16x32_bf16 a[68:71], a[164:167], v[188:191], a[68:71]
  v_mfma_f32_16x16x32_bf16 a[72:75], a[168:171], v[188:191], a[72:75]
  v_mfma_f32_16x16x32_bf16 a[76:79], a[172:175], v[188:191], a[76:79]
  v_mfma_f32_16x16x32_bf16 a[80:83], a[176:179], v[188:191], a[80:83]
  v_mfma_f32_16x16x32_bf16 a[84:87], a[180:183], v[188:191], a[84:87]
  v_mfma_f32_16x16x32_bf16 a[88:91], a[184:187], v[188:191], a[88:91]
  v_mfma_f32_16x16x32_bf16 a[92:95], a[188:191], v[188:191], a[92:95]
  v_mfma_f32_16x16x32_bf16 v[28:31], v[16:19], v[188:191], v[28:31]
  v_mfma_f32_16x16x32_bf16 a[96:99], a[160:163], v[192:195], a[96:99]
  v_mfma_f32_16x16x32_bf16 a[100:103], a[164:167], v[192:195], a[100:103]
  v_mfma_f32_16x16x32_bf16 a[104:107], a[168:171], v[192:195], a[104:107]
  v_mfma_f32_16x16x32_bf16 a[108:111], a[172:175], v[192:195], a[108:111]
  v_mfma_f32_16x16x32_bf16 a[112:115], a[176:179], v[192:195], a[112:115]
  v_mfma_f32_16x16x32_bf16 a[116:119], a[180:183], v[192:195], a[116:119]
  v_mfma_f32_16x16x32_bf16 a[120:123], a[184:187], v[192:195], a[120:123]
  v_mfma_f32_16x16x32_bf16 a[124:127], a[188:191], v[192:195], a[124:127]
  v_mfma_f32_16x16x32_bf16 v[32:35], v[16:19], v[192:195], v[32:35]
  s_nop 7
  s_sub_u32 s28, s28, 1
  s_cmp_lg_u32 s28, 0
  s_cbranch_scc1 adaLN_cond__compressed_kv_cla__mixer_channel_mlp__prompt_kernel_slhi
  s_branch adaLN_cond__compressed_kv_cla__mixer_channel_mlp__prompt_kernel_hiep
adaLN_cond__compressed_kv_cla__mixer_channel_mlp__prompt_kernel_rel5:
  buffer_wbl2 sc1
  s_waitcnt vmcnt(0)
  s_branch adaLN_cond__compressed_kv_cla__mixer_channel_mlp__prompt_kernel_relb6
adaLN_cond__compressed_kv_cla__mixer_channel_mlp__prompt_kernel_rel10:
  buffer_wbl2 sc1
  s_waitcnt vmcnt(0)
  s_branch adaLN_cond__compressed_kv_cla__mixer_channel_mlp__prompt_kernel_relb11
adaLN_cond__compressed_kv_cla__mixer_channel_mlp__prompt_kernel_rel22:
  buffer_wbl2 sc1
  s_waitcnt vmcnt(0)
  s_branch adaLN_cond__compressed_kv_cla__mixer_channel_mlp__prompt_kernel_relb23
adaLN_cond__compressed_kv_cla__mixer_channel_mlp__prompt_kernel_last:
  s_endpgm
.section .rodata,"a"
.p2align 6
.amdhsa_kernel adaLN_cond__compressed_kv_cla__mixer_channel_mlp__prompt_kernel
  .amdhsa_next_free_vgpr 512
  .amdhsa_next_free_sgpr 102
  .amdhsa_accum_offset 256
  .amdhsa_group_segment_fixed_size 0
  .amdhsa_kernarg_size 128
  .amdhsa_user_sgpr_count 2
  .amdhsa_user_sgpr_kernarg_segment_ptr 1
  .amdhsa_system_sgpr_workgroup_id_x 1
  .amdhsa_float_denorm_mode_32 3
.end_amdhsa_kernel
```
